```python
import torch

def _softmax(x, axis=-1):
    return torch.softmax(x, dim=axis)

def _gelu(x):
    return torch.nn.functional.gelu(x, approximate='tanh')

def _silu(x):
    return torch.nn.functional.silu(x)

def _sigmoid(x):
    return torch.sigmoid(x)

def _layernorm(x, axis=-1, eps=1e-05):
    m = x.mean(dim=axis, keepdim=True)
    v = x.var(dim=axis, keepdim=True, unbiased=False)
    return (x - m) / torch.sqrt(v + eps)

def _scatter_add(tgt, idx, src, axis=0):
    return tgt.clone().index_add_(axis, idx, src)

def _segment_sum(src, seg, n):
    out = torch.zeros((n,) + src.shape[1:], dtype=src.dtype)
    return out.index_add_(0, seg, src)

def _pad(x, pw):
    flat = tuple((v for pair in reversed(pw) for v in pair))
    return torch.nn.functional.pad(x, flat)
kernel_name = 'adaLN_cond__grouped_kv_mqa__dense_activation_relu__prompt'

def setup_inputs():

    _w = lambda a: (lambda t: t.to(torch.bfloat16) if t.is_floating_point() else t)(torch.as_tensor(a))

    def _A_setup():
        B, S, D, H = (1, 2048, 1024, 32)
        Dh = D // H
        return {'x': _w((lambda *s: torch.randn(*s, dtype=torch.bfloat16) * 0.05)(B, S, D)), 'wq': _w((lambda *s: torch.randn(*s, dtype=torch.bfloat16) * 0.05)(D, H * Dh)), 'wk': _w((lambda *s: torch.randn(*s, dtype=torch.bfloat16) * 0.05)(D, Dh)), 'wv': _w((lambda *s: torch.randn(*s, dtype=torch.bfloat16) * 0.05)(D, Dh)), 'wo': _w((lambda *s: torch.randn(*s, dtype=torch.bfloat16) * 0.05)(H * Dh, D))}
    _A_in = _A_setup()

    def _B_setup():
        B, S, D, Dff = (1, 2048, 1024, 3584)
        return {'x': _w((lambda *s: torch.randn(*s, dtype=torch.bfloat16) * 0.05)(B, S, D)), 'w1': _w((lambda *s: torch.randn(*s, dtype=torch.bfloat16) * 0.05)(D, Dff)), 'w2': _w((lambda *s: torch.randn(*s, dtype=torch.bfloat16) * 0.05)(Dff, D))}
    _B_in = _B_setup()
    return {'A_x': _A_in['x'], 'A_wq': _A_in['wq'], 'A_wk': _A_in['wk'], 'A_wv': _A_in['wv'], 'A_wo': _A_in['wo'], 'B_x': _B_in['x'], 'B_w1': _B_in['w1'], 'B_w2': _B_in['w2'], 'c': _w((lambda *s: torch.randn(*s, dtype=torch.bfloat16) * 0.2)(1, 1024) * 8.0), 'w_mod': _w((lambda *s: torch.randn(*s, dtype=torch.bfloat16) * 0.2)(1024, 6 * 1024) * 1024 ** (-0.5) * 8.0)}

def reference(A_x, A_wq, A_wk, A_wv, A_wo, B_x, B_w1, B_w2, c, w_mod):

    def _A_ref(x, wq, wk, wv, wo):
        B, S, D = x.shape
        H = 32
        Dh = D // H
        q = (lambda x, *d: x.permute(*d))((x @ wq).reshape(B, S, H, Dh), 0, 2, 1, 3)
        k = x @ wk
        v = x @ wv
        scores = torch.einsum('bhqd,bkd->bhqk', q, k) * Dh ** (-0.5)
        p = _softmax(scores, axis=-1)
        o = torch.einsum('bhqk,bkd->bhqd', p, v)
        return (lambda x, *d: x.permute(*d))(o, 0, 2, 1, 3).reshape(B, S, H * Dh) @ wo

    def _B_ref(x, w1, w2):
        h = torch.einsum('bsd,df->bsf', x, w1)
        zero = torch.zeros_like(h)
        h = torch.maximum(h, zero)
        return torch.einsum('bsf,fd->bsd', h, w2)
    x = A_x
    mod = (_silu(c) @ w_mod).reshape(c.shape[0], 6, 1, -1)
    sa, ca, ga, sb, cb, gb = (mod[:, 0].clone(), mod[:, 1].clone(), mod[:, 2].clone(), mod[:, 3].clone(), mod[:, 4].clone(), mod[:, 5].clone())
    h = _layernorm(x, axis=-1) * (1 + ca) + sa
    x = x + ga * _A_ref(h, A_wq, A_wk, A_wv, A_wo)
    h = _layernorm(x, axis=-1) * (1 + cb) + sb
    x = x + gb * _B_ref(h, B_w1, B_w2)
    return x
```

```asm
; @launch grid=(256,1,1) block=(512,1,1) lds=163840
.amdgcn_target "amdgcn-amd-amdhsa--gfx950"
.text
.p2align 12
.globl adaLN_cond__grouped_kv_mqa__dense_activation_relu__prompt_kernel
.p2align 8
.type adaLN_cond__grouped_kv_mqa__dense_activation_relu__prompt_kernel,@function
adaLN_cond__grouped_kv_mqa__dense_activation_relu__prompt_kernel:
LadaLN_cond__grouped_kv_mqa__dense_activation_relu__prompt_kernel_start:
    s_cmp_ge_u32 s2, 256
    s_cbranch_scc1 LadaLN_cond__grouped_kv_mqa__dense_activation_relu__prompt_kernel_exit
    s_load_dwordx8 s[52:59], s[0:1], 64
    s_load_dwordx2 s[60:61], s[0:1], 96
    s_load_dwordx16 s[36:51], s[0:1], 0
    v_lshrrev_b32 v3, 6, v0
    v_and_b32 v2, 63, v0
    v_readfirstlane_b32 s20, v3
    v_lshlrev_b32 v1, 4, v2
    s_and_b32 s26, s2, 7
    s_lshr_b32 s27, s2, 3
    v_lshrrev_b32 v5, 2, v2
    v_mul_u32_u24 v3, 12288, v5
    v_and_b32 v6, 3, v2
    v_lshl_add_u32 v3, v6, 4, v3
    v_lshlrev_b32 v4, 1, v5
    s_lshr_b32 s28, s27, 3
    s_and_b32 s29, s27, 7
    s_lshl_b32 s30, s26, 3
    s_add_u32 s30, s30, s29
    s_lshl_b32 s31, s28, 3
    s_add_u32 s31, s31, s20
    s_mul_i32 s32, s31, 393216
    s_lshl_b32 s33, s30, 6
    s_add_u32 s32, s32, s33
    s_lshl_b32 s31, s31, 6
    s_add_u32 s33, s32, 196608
    s_lshr_b32 s21, s26, 1
    s_lshl_b32 s21, s21, 2
    s_add_u32 s21, s21, s28
    s_and_b32 s34, s26, 1
    s_lshl_b32 s22, s29, 1
    s_add_u32 s22, s22, s34
    s_lshl_b32 s34, s34, 3
    s_add_u32 s34, s34, s29
    s_lshl_b32 s35, s21, 4
    s_add_u32 s35, s35, s34
    s_lshl_b32 s68, s35, 3
    s_add_u32 s68, s68, s20
    s_lshl_b32 s68, s68, 11
    s_xor_b32 s69, s68, 0x4000
    s_and_b32 s24, s20, 3
    s_lshr_b32 s25, s20, 2
    s_lshl_b32 s66, s21, 2
    s_add_u32 s66, s66, s24
    s_and_b32 s77, s34, 1
    s_xor_b32 s77, s77, 1
    s_lshl_b32 s77, s77, 14
    s_add_u32 s77, s77, 131072
    s_waitcnt lgkmcnt(0)
    s_mov_b32 s4, s52
    s_mov_b32 s5, s53
    s_mov_b32 s6, 0x800
    s_mov_b32 s7, 0x20000
    s_mov_b32 s8, s54
    s_mov_b32 s9, s55
    s_mov_b32 s10, 0xc00000
    s_mov_b32 s11, 0x20000
    buffer_load_ushort v24, v4, s[4:7], s31 offen
    buffer_load_ushort v25, v4, s[4:7], s31 offen offset:32
    buffer_load_dwordx4 v[16:19], v3, s[8:11], s32 offen nt
    buffer_load_dwordx4 v[20:23], v3, s[8:11], s33 offen nt
    s_mov_b32 s16, s60
    s_mov_b32 s17, s61
    s_mov_b32 s18, 0x2400000
    s_mov_b32 s19, 0x20000
    buffer_load_dword v26, off, s[16:19], 0 sc1
    s_barrier
    s_bitcmp1_b32 s34, 0
    s_cselect_b32 s12, s42, s40
    s_cselect_b32 s13, s43, s41
    s_mov_b32 s14, 65536
    s_mov_b32 s15, 0x20000
    v_lshlrev_b32 v7, 7, v2
    s_lshr_b32 s70, s27, 1
    s_lshl_b32 s70, s70, 3
    s_add_u32 s70, s70, s20
    s_lshl_b32 s70, s70, 9
    s_mov_b64 exec, 15
    buffer_load_dword v165, v7, s[12:15], s70 offen
    s_mov_b64 exec, -1
    v_lshrrev_b32 v253, 3, v2
    v_lshlrev_b32 v253, 3, v253
    s_and_b32 s70, s2, 3
    s_lshl_b32 s70, s70, 3
    s_add_u32 s70, s70, s20
    s_lshl_b32 s70, s70, 6
    buffer_load_dwordx2 v[252:253], v253, s[4:7], s70 offen
    s_mov_b32 s4, s36
    s_mov_b32 s5, s37
    s_mov_b32 s6, 0x400000
    s_mov_b32 s7, 0x20000
    buffer_load_dwordx4 v[28:31], v1, s[4:7], s68 offen nt
    buffer_load_dwordx4 v[32:35], v1, s[4:7], s68 offen offset:1024 nt
    s_getpc_b64 s[72:73]
LadaLN_cond__grouped_kv_mqa__dense_activation_relu__prompt_kernel_pc:
    s_mov_b32 s74, LadaLN_cond__grouped_kv_mqa__dense_activation_relu__prompt_kernel_codeend-LadaLN_cond__grouped_kv_mqa__dense_activation_relu__prompt_kernel_pc
    s_mov_b32 s75, 0x20000
    s_lshl_b32 s70, s27, 3
    s_add_u32 s70, s70, s20
    s_mul_i32 s70, s70, 384
    s_mov_b64 exec, 7
    buffer_load_dword v167, v7, s[72:75], s70 offen
    s_mov_b64 exec, -1
    s_mov_b32 s8, s38
    s_mov_b32 s9, s39
    s_mov_b32 s10, 0x200000
    s_mov_b32 s11, 0x20000
    s_lshl_b32 s70, s2, 3
    s_add_u32 s70, s70, s20
    s_lshl_b32 s70, s70, 10
    s_mov_b64 exec, 0xff
    buffer_load_dword v166, v7, s[8:11], s70 offen
    s_mov_b64 exec, -1
    v_and_b32 v9, 15, v2
    v_lshrrev_b32 v10, 4, v2
    s_lshl_b32 s70, s20, 7
    s_add_u32 s70, s70, 8192
    s_add_u32 s70, s70, s77
    v_lshlrev_b32 v11, 5, v6
    v_lshl_add_u32 v11, v10, 3, v11
    v_add_u32 v11, s70, v11
    v_lshrrev_b32 v12, 2, v9
    v_lshl_add_u32 v12, v10, 3, v12
    v_lshlrev_b32 v12, 6, v12
    v_lshl_add_u32 v12, v6, 3, v12
    s_lshl_b32 s71, s20, 13
    v_add_u32 v12, s71, v12
    v_mov_b32 v15, 0xff
    s_cmp_lg_u32 s20, 7
    s_cbranch_scc1 LadaLN_cond__grouped_kv_mqa__dense_activation_relu__prompt_kernel_skip1
    s_call_b64 s[96:97], LadaLN_cond__grouped_kv_mqa__dense_activation_relu__prompt_kernel_stub1
LadaLN_cond__grouped_kv_mqa__dense_activation_relu__prompt_kernel_skip1:
    s_waitcnt vmcnt(9)
    v_lshlrev_b32 v24, 16, v24
    v_mul_f32 v46, 0xbfb8aa3b, v24
    v_exp_f32 v46, v46
    s_nop 0
    v_add_f32 v46, 1.0, v46
    v_rcp_f32 v46, v46
    s_nop 0
    v_mul_f32 v46, v24, v46
    v_cvt_pk_bf16_f32 v46, v46, v46
    v_and_b32 v44, 0xffff, v46
    v_and_b32 v45, 0xffff0000, v46
    v_lshlrev_b32 v25, 16, v25
    v_mul_f32 v46, 0xbfb8aa3b, v25
    v_exp_f32 v46, v46
    s_nop 0
    v_add_f32 v46, 1.0, v46
    v_rcp_f32 v46, v46
    s_nop 0
    v_mul_f32 v46, v25, v46
    v_cvt_pk_bf16_f32 v46, v46, v46
    v_and_b32 v47, 0xffff, v46
    v_and_b32 v48, 0xffff0000, v46
    s_waitcnt vmcnt(7)
    v_dot2_f32_bf16 v76, v16, v44, 0
    v_dot2_f32_bf16 v77, v16, v45, 0
    v_dot2_f32_bf16 v78, v17, v44, 0
    v_dot2_f32_bf16 v79, v17, v45, 0
    v_dot2_f32_bf16 v80, v18, v44, 0
    v_dot2_f32_bf16 v81, v18, v45, 0
    v_dot2_f32_bf16 v82, v19, v44, 0
    v_dot2_f32_bf16 v83, v19, v45, 0
    v_dot2c_f32_bf16 v76, v20, v47
    v_dot2c_f32_bf16 v77, v20, v48
    v_dot2c_f32_bf16 v78, v21, v47
    v_dot2c_f32_bf16 v79, v21, v48
    v_dot2c_f32_bf16 v80, v22, v47
    v_dot2c_f32_bf16 v81, v22, v48
    v_dot2c_f32_bf16 v82, v23, v47
    v_dot2c_f32_bf16 v83, v23, v48
    s_nop 1
    v_permlane32_swap_b32 v76, v80
    v_permlane32_swap_b32 v77, v81
    v_permlane32_swap_b32 v78, v82
    v_permlane32_swap_b32 v79, v83
    s_nop 0
    v_add_f32 v76, v76, v80
    v_add_f32 v77, v77, v81
    v_add_f32 v78, v78, v82
    v_add_f32 v79, v79, v83
    s_nop 1
    v_permlane16_swap_b32 v76, v78
    v_permlane16_swap_b32 v77, v79
    s_nop 0
    v_add_f32 v76, v76, v78
    v_add_f32 v77, v77, v79
    s_nop 0
    v_add_f32_dpp v76, v76, v76 row_ror:4 row_mask:0xf bank_mask:0xf
    v_add_f32_dpp v77, v77, v77 row_ror:4 row_mask:0xf bank_mask:0xf
    s_nop 0
    v_add_f32_dpp v76, v76, v76 row_ror:8 row_mask:0xf bank_mask:0xf
    v_add_f32_dpp v77, v77, v77 row_ror:8 row_mask:0xf bank_mask:0xf
    ds_write_b64 v11, v[76:77]
    s_waitcnt vmcnt(6)
    v_readfirstlane_b32 s23, v26
    s_waitcnt lgkmcnt(0)
    s_barrier
    s_mul_i32 s23, s23, 0x9E3779B1
    s_add_u32 s23, s23, 0x7F4A7C15
    s_bfe_u32 s62, s23, 0x80000
    s_bfe_u32 s63, s23, 0x80008
    s_bfe_u32 s64, s23, 0x80010
    s_bfe_u32 s65, s23, 0x80018
    s_cmp_lg_u32 s20, 0
    s_cbranch_scc1 LadaLN_cond__grouped_kv_mqa__dense_activation_relu__prompt_kernel_skip2
    v_and_b32 v14, 7, v2
    v_lshlrev_b32 v14, 4, v14
    v_add_u32 v13, s77, v14
    ds_read_b128 v[44:47], v13 offset:8192
    ds_read_b128 v[48:51], v13 offset:8320
    ds_read_b128 v[52:55], v13 offset:8448
    ds_read_b128 v[56:59], v13 offset:8576
    ds_read_b128 v[60:63], v13 offset:8704
    ds_read_b128 v[64:67], v13 offset:8832
    ds_read_b128 v[68:71], v13 offset:8960
    ds_read_b128 v[72:75], v13 offset:9088
    s_lshl_b32 s70, s28, 13
    s_lshl_b32 s72, s30, 7
    s_add_u32 s70, s70, s72
    s_add_u32 s70, s70, 4096
    s_waitcnt lgkmcnt(0)
    v_add_f32 v44, v44, v60
    v_add_f32 v45, v45, v61
    v_add_f32 v46, v46, v62
    v_add_f32 v47, v47, v63
    v_add_f32 v48, v48, v64
    v_add_f32 v49, v49, v65
    v_add_f32 v50, v50, v66
    v_add_f32 v51, v51, v67
    v_add_f32 v52, v52, v68
    v_add_f32 v53, v53, v69
    v_add_f32 v54, v54, v70
    v_add_f32 v55, v55, v71
    v_add_f32 v56, v56, v72
    v_add_f32 v57, v57, v73
    v_add_f32 v58, v58, v74
    v_add_f32 v59, v59, v75
    v_add_f32 v44, v44, v52
    v_add_f32 v45, v45, v53
    v_add_f32 v46, v46, v54
    v_add_f32 v47, v47, v55
    v_add_f32 v48, v48, v56
    v_add_f32 v49, v49, v57
    v_add_f32 v50, v50, v58
    v_add_f32 v51, v51, v59
    v_add_f32 v44, v44, v48
    v_add_f32 v45, v45, v49
    v_add_f32 v46, v46, v50
    v_add_f32 v47, v47, v51
    v_bfi_b32 v44, v15, s62, v44
    v_bfi_b32 v45, v15, s63, v45
    v_bfi_b32 v46, v15, s64, v46
    v_bfi_b32 v47, v15, s65, v47
    s_mov_b64 exec, 0xff
    buffer_store_dwordx4 v[44:47], v14, s[16:19], s70 offen sc1
    s_mov_b64 exec, -1
    s_nop 0
LadaLN_cond__grouped_kv_mqa__dense_activation_relu__prompt_kernel_skip2:
    s_barrier
    buffer_load_dwordx4 v[36:39], v1, s[4:7], s69 offen
    buffer_load_dwordx4 v[40:43], v1, s[4:7], s69 offen offset:1024
    s_add_u32 s70, s71, 0
    s_mov_b32 m0, s70
    s_nop 0
    buffer_load_dwordx4 v1, s[12:15], s70 offen offset:0 lds
    buffer_load_dwordx4 v1, s[12:15], s70 offen offset:1024 lds
    buffer_load_dwordx4 v1, s[12:15], s70 offen offset:2048 lds
    buffer_load_dwordx4 v1, s[12:15], s70 offen offset:3072 lds
    s_add_u32 s70, s71, 4096
    s_mov_b32 m0, s70
    s_nop 0
    buffer_load_dwordx4 v1, s[12:15], s70 offen offset:0 lds
    buffer_load_dwordx4 v1, s[12:15], s70 offen offset:1024 lds
    buffer_load_dwordx4 v1, s[12:15], s70 offen offset:2048 lds
    buffer_load_dwordx4 v1, s[12:15], s70 offen offset:3072 lds
    s_mov_b32 s8, s38
    s_mov_b32 s9, s39
    s_mov_b32 s10, 0x200000
    s_mov_b32 s11, 0x20000
    v_lshrrev_b32 v170, 3, v2
    s_mov_b32 s78, 2048
    v_mul_lo_u32 v168, v170, s78
    v_and_b32 v170, 7, v2
    v_bfe_u32 v171, v2, 4, 1
    v_lshlrev_b32 v171, 2, v171
    v_xor_b32 v170, v170, v171
    v_lshl_add_u32 v168, v170, 4, v168
    v_add_u32 v169, 15360, v168
    s_lshl_b32 s78, s22, 7
    s_lshl_b32 s79, s20, 17
    s_add_u32 s78, s78, s79
    s_waitcnt vmcnt(8)
    v_dot2_f32_bf16 v77, v28, v28, 0
    v_mov_b32 v76, 0
    v_dot2_f32_bf16 v79, v36, v36, 0
    v_mov_b32 v78, 0
    v_dot2c_f32_bf16 v76, 0x3f803f80, v28
    v_dot2c_f32_bf16 v78, 0x3f803f80, v36
    v_dot2c_f32_bf16 v76, 0x3f803f80, v29
    v_dot2c_f32_bf16 v77, v29, v29
    v_dot2c_f32_bf16 v78, 0x3f803f80, v37
    v_dot2c_f32_bf16 v79, v37, v37
    v_dot2c_f32_bf16 v76, 0x3f803f80, v30
    v_dot2c_f32_bf16 v77, v30, v30
    v_dot2c_f32_bf16 v78, 0x3f803f80, v38
    v_dot2c_f32_bf16 v79, v38, v38
    v_dot2c_f32_bf16 v76, 0x3f803f80, v31
    v_dot2c_f32_bf16 v77, v31, v31
    v_dot2c_f32_bf16 v78, 0x3f803f80, v39
    v_dot2c_f32_bf16 v79, v39, v39
    v_dot2c_f32_bf16 v76, 0x3f803f80, v32
    v_dot2c_f32_bf16 v77, v32, v32
    v_dot2c_f32_bf16 v78, 0x3f803f80, v40
    v_dot2c_f32_bf16 v79, v40, v40
    v_dot2c_f32_bf16 v76, 0x3f803f80, v33
    v_dot2c_f32_bf16 v77, v33, v33
    v_dot2c_f32_bf16 v78, 0x3f803f80, v41
    v_dot2c_f32_bf16 v79, v41, v41
    v_dot2c_f32_bf16 v76, 0x3f803f80, v34
    v_dot2c_f32_bf16 v77, v34, v34
    v_dot2c_f32_bf16 v78, 0x3f803f80, v42
    v_dot2c_f32_bf16 v79, v42, v42
    v_dot2c_f32_bf16 v76, 0x3f803f80, v35
    v_dot2c_f32_bf16 v77, v35, v35
    v_dot2c_f32_bf16 v78, 0x3f803f80, v43
    v_dot2c_f32_bf16 v79, v43, v43
    s_nop 0
    v_add_f32_dpp v76, v76, v76 quad_perm:[1,0,3,2] row_mask:0xf bank_mask:0xf
    v_add_f32_dpp v77, v77, v77 quad_perm:[1,0,3,2] row_mask:0xf bank_mask:0xf
    v_add_f32_dpp v78, v78, v78 quad_perm:[1,0,3,2] row_mask:0xf bank_mask:0xf
    v_add_f32_dpp v79, v79, v79 quad_perm:[1,0,3,2] row_mask:0xf bank_mask:0xf
    v_add_f32_dpp v76, v76, v76 quad_perm:[2,3,0,1] row_mask:0xf bank_mask:0xf
    v_add_f32_dpp v77, v77, v77 quad_perm:[2,3,0,1] row_mask:0xf bank_mask:0xf
    v_add_f32_dpp v78, v78, v78 quad_perm:[2,3,0,1] row_mask:0xf bank_mask:0xf
    v_add_f32_dpp v79, v79, v79 quad_perm:[2,3,0,1] row_mask:0xf bank_mask:0xf
    v_add_f32_dpp v76, v76, v76 row_half_mirror row_mask:0xf bank_mask:0xf
    v_add_f32_dpp v77, v77, v77 row_half_mirror row_mask:0xf bank_mask:0xf
    v_add_f32_dpp v78, v78, v78 row_half_mirror row_mask:0xf bank_mask:0xf
    v_add_f32_dpp v79, v79, v79 row_half_mirror row_mask:0xf bank_mask:0xf
    v_add_f32_dpp v76, v76, v76 row_mirror row_mask:0xf bank_mask:0xf
    v_add_f32_dpp v77, v77, v77 row_mirror row_mask:0xf bank_mask:0xf
    v_add_f32_dpp v78, v78, v78 row_mirror row_mask:0xf bank_mask:0xf
    v_add_f32_dpp v79, v79, v79 row_mirror row_mask:0xf bank_mask:0xf
    v_mov_b32 v80, v76
    v_mov_b32 v81, v77
    v_mov_b32 v82, v78
    v_mov_b32 v83, v79
    s_nop 0
    v_permlane16_swap_b32 v76, v80
    v_permlane16_swap_b32 v77, v81
    v_permlane16_swap_b32 v78, v82
    v_permlane16_swap_b32 v79, v83
    s_nop 0
    v_add_f32 v76, v76, v80
    v_add_f32 v77, v77, v81
    v_add_f32 v78, v78, v82
    v_add_f32 v79, v79, v83
    v_mov_b32 v80, v76
    v_mov_b32 v81, v77
    v_mov_b32 v82, v78
    v_mov_b32 v83, v79
    s_nop 0
    v_permlane32_swap_b32 v76, v80
    v_permlane32_swap_b32 v77, v81
    v_permlane32_swap_b32 v78, v82
    v_permlane32_swap_b32 v79, v83
    s_nop 0
    v_add_f32 v76, v76, v80
    v_add_f32 v77, v77, v81
    v_add_f32 v78, v78, v82
    v_add_f32 v79, v79, v83
    s_waitcnt vmcnt(0)
    s_add_u32 s79, s78, 1048576
    s_add_u32 m0, s71, 65536
    s_nop 0
    buffer_load_dwordx4 v168, s[8:11], s79 offen lds
    buffer_load_dwordx4 v169, s[8:11], s79 offen offset:1024 lds
    s_add_u32 s79, s79, 32768
    s_add_u32 m0, s71, 67584
    s_nop 0
    buffer_load_dwordx4 v168, s[8:11], s79 offen lds
    buffer_load_dwordx4 v169, s[8:11], s79 offen offset:1024 lds
    s_add_u32 s79, s79, 32768
    s_add_u32 m0, s71, 69632
    s_nop 0
    buffer_load_dwordx4 v168, s[8:11], s79 offen lds
    buffer_load_dwordx4 v169, s[8:11], s79 offen offset:1024 lds
    s_add_u32 s79, s79, 32768
    s_add_u32 m0, s71, 71680
    s_nop 0
    buffer_load_dwordx4 v168, s[8:11], s79 offen lds
    buffer_load_dwordx4 v169, s[8:11], s79 offen offset:1024 lds
    ds_read_b64_tr_b16 v[84:85], v12 offset:0
    ds_read_b64_tr_b16 v[86:87], v12 offset:256
    ds_read_b64_tr_b16 v[88:89], v12 offset:32
    ds_read_b64_tr_b16 v[90:91], v12 offset:288
    ds_read_b64_tr_b16 v[92:93], v12 offset:2048
    ds_read_b64_tr_b16 v[94:95], v12 offset:2304
    ds_read_b64_tr_b16 v[96:97], v12 offset:2080
    ds_read_b64_tr_b16 v[98:99], v12 offset:2336
    ds_read_b64_tr_b16 v[100:101], v12 offset:4096
    ds_read_b64_tr_b16 v[102:103], v12 offset:4352
    ds_read_b64_tr_b16 v[104:105], v12 offset:4128
    ds_read_b64_tr_b16 v[106:107], v12 offset:4384
    ds_read_b64_tr_b16 v[108:109], v12 offset:6144
    ds_read_b64_tr_b16 v[110:111], v12 offset:6400
    ds_read_b64_tr_b16 v[112:113], v12 offset:6176
    ds_read_b64_tr_b16 v[114:115], v12 offset:6432
    v_mul_f32 v76, 0x3a800000, v76
    v_mul_f32 v80, v76, v76
    v_mov_b32 v81, 0x3a800000
    v_fma_f32 v77, v77, v81, -v80
    v_max_f32 v77, 0, v77
    v_cvt_pk_bf16_f32 v77, v76, v77
    v_lshlrev_b32 v76, 16, v77
    v_and_b32 v77, 0xffff0000, v77
    v_add_f32 v77, 0x3727c5ac, v77
    v_cvt_pk_bf16_f32 v77, v77, v77
    v_and_b32 v77, 0xffff0000, v77
    v_sqrt_f32 v77, v77
    s_nop 0
    v_cvt_pk_bf16_f32 v77, v77, v77
    v_and_b32 v77, 0xffff0000, v77
    v_rcp_f32 v77, v77
    s_nop 0
    v_mul_f32 v76, v76, v77
    v_lshlrev_b32 v44, 16, v28
    v_and_b32 v45, 0xffff0000, v28
    v_lshlrev_b32 v46, 16, v29
    v_and_b32 v47, 0xffff0000, v29
    v_lshlrev_b32 v48, 16, v30
    v_and_b32 v49, 0xffff0000, v30
    v_lshlrev_b32 v50, 16, v31
    v_and_b32 v51, 0xffff0000, v31
    v_lshlrev_b32 v52, 16, v32
    v_and_b32 v53, 0xffff0000, v32
    v_lshlrev_b32 v54, 16, v33
    v_and_b32 v55, 0xffff0000, v33
    v_lshlrev_b32 v56, 16, v34
    v_and_b32 v57, 0xffff0000, v34
    v_lshlrev_b32 v58, 16, v35
    v_and_b32 v59, 0xffff0000, v35
    v_fma_f32 v44, v44, v77, -v76
    v_fma_f32 v45, v45, v77, -v76
    v_fma_f32 v46, v46, v77, -v76
    v_fma_f32 v47, v47, v77, -v76
    v_fma_f32 v48, v48, v77, -v76
    v_fma_f32 v49, v49, v77, -v76
    v_fma_f32 v50, v50, v77, -v76
    v_fma_f32 v51, v51, v77, -v76
    v_fma_f32 v52, v52, v77, -v76
    v_fma_f32 v53, v53, v77, -v76
    v_fma_f32 v54, v54, v77, -v76
    v_fma_f32 v55, v55, v77, -v76
    v_fma_f32 v56, v56, v77, -v76
    v_fma_f32 v57, v57, v77, -v76
    v_fma_f32 v58, v58, v77, -v76
    v_fma_f32 v59, v59, v77, -v76
    v_mul_f32 v78, 0x3a800000, v78
    v_mul_f32 v80, v78, v78
    v_mov_b32 v81, 0x3a800000
    v_fma_f32 v79, v79, v81, -v80
    v_max_f32 v79, 0, v79
    v_cvt_pk_bf16_f32 v79, v78, v79
    v_lshlrev_b32 v78, 16, v79
    v_and_b32 v79, 0xffff0000, v79
    v_add_f32 v79, 0x3727c5ac, v79
    v_cvt_pk_bf16_f32 v79, v79, v79
    v_and_b32 v79, 0xffff0000, v79
    v_sqrt_f32 v79, v79
    s_nop 0
    v_cvt_pk_bf16_f32 v79, v79, v79
    v_and_b32 v79, 0xffff0000, v79
    v_rcp_f32 v79, v79
    s_nop 0
    v_mul_f32 v78, v78, v79
    v_lshlrev_b32 v60, 16, v36
    v_and_b32 v61, 0xffff0000, v36
    v_lshlrev_b32 v62, 16, v37
    v_and_b32 v63, 0xffff0000, v37
    v_lshlrev_b32 v64, 16, v38
    v_and_b32 v65, 0xffff0000, v38
    v_lshlrev_b32 v66, 16, v39
    v_and_b32 v67, 0xffff0000, v39
    v_lshlrev_b32 v68, 16, v40
    v_and_b32 v69, 0xffff0000, v40
    v_lshlrev_b32 v70, 16, v41
    v_and_b32 v71, 0xffff0000, v41
    v_lshlrev_b32 v72, 16, v42
    v_and_b32 v73, 0xffff0000, v42
    v_lshlrev_b32 v74, 16, v43
    v_and_b32 v75, 0xffff0000, v43
    v_fma_f32 v60, v60, v79, -v78
    v_fma_f32 v61, v61, v79, -v78
    v_fma_f32 v62, v62, v79, -v78
    v_fma_f32 v63, v63, v79, -v78
    v_fma_f32 v64, v64, v79, -v78
    v_fma_f32 v65, v65, v79, -v78
    v_fma_f32 v66, v66, v79, -v78
    v_fma_f32 v67, v67, v79, -v78
    v_fma_f32 v68, v68, v79, -v78
    v_fma_f32 v69, v69, v79, -v78
    v_fma_f32 v70, v70, v79, -v78
    v_fma_f32 v71, v71, v79, -v78
    v_fma_f32 v72, v72, v79, -v78
    v_fma_f32 v73, v73, v79, -v78
    v_fma_f32 v74, v74, v79, -v78
    v_fma_f32 v75, v75, v79, -v78
    s_mov_b32 s80, s71
    s_lshl_b32 s70, s20, 10
    s_add_u32 s72, s70, 4096
    s_add_u32 s73, s72, 8192
    s_add_u32 s74, s72, 16384
    s_add_u32 s75, s72, 24576
    s_add_u32 s70, s70, s77
    v_add_u32 v13, s70, v1
    v_lshlrev_b32 v14, 5, v2
    v_add_u32 v14, s77, v14
    s_and_b32 s70, s34, 1
    s_lshl_b32 s70, s70, 3
    s_add_u32 s71, s70, s20
    v_xor_b32 v3, s71, v2
    v_lshlrev_b32 v3, 4, v3
    s_lshl_b32 s71, s71, 11
    s_add_u32 s71, s71, 131072
    v_add_u32 v3, s71, v3
    v_xor_b32 v4, 0x4080, v3
    v_and_b32 v5, 7, v2
    v_lshrrev_b32 v6, 3, v2
    v_lshlrev_b32 v7, 9, v6
    v_lshl_add_u32 v7, v5, 4, v7
    v_add_u32 v5, s70, v5
    v_xor_b32 v6, v6, v5
    v_lshlrev_b32 v6, 4, v6
    v_lshl_add_u32 v6, v5, 11, v6
    s_lshl_b32 s71, s24, 9
    s_add_u32 s71, s71, 131072
    v_add_u32 v5, s71, v6
    v_xor_b32 v6, 128, v5
    v_xor_b32 v8, v9, v10
    v_lshlrev_b32 v8, 4, v8
    v_lshl_add_u32 v8, v9, 11, v8
    s_lshl_b32 s71, s20, 8
    s_add_u32 s71, s71, 131072
    v_add_u32 v8, s71, v8
    s_cmp_ge_u32 s20, 4
    s_cselect_b32 s29, 1.0, 0
    buffer_load_dwordx4 v[116:119], v1, s[16:19], s72 offen sc1
    buffer_load_dwordx4 v[120:123], v1, s[16:19], s73 offen sc1
    buffer_load_dwordx4 v[124:127], v1, s[16:19], s74 offen sc1
    buffer_load_dwordx4 v[128:131], v1, s[16:19], s75 offen sc1
    s_cmp_lg_u32 s20, 0
    s_cbranch_scc1 LadaLN_cond__grouped_kv_mqa__dense_activation_relu__prompt_kernel_skip4
    s_call_b64 s[96:97], LadaLN_cond__grouped_kv_mqa__dense_activation_relu__prompt_kernel_stub2
    s_call_b64 s[96:97], LadaLN_cond__grouped_kv_mqa__dense_activation_relu__prompt_kernel_stub10
LadaLN_cond__grouped_kv_mqa__dense_activation_relu__prompt_kernel_skip4:
    s_cmp_lg_u32 s20, 1
    s_cbranch_scc1 LadaLN_cond__grouped_kv_mqa__dense_activation_relu__prompt_kernel_skip5
    s_call_b64 s[96:97], LadaLN_cond__grouped_kv_mqa__dense_activation_relu__prompt_kernel_stub3
    s_call_b64 s[96:97], LadaLN_cond__grouped_kv_mqa__dense_activation_relu__prompt_kernel_stub11
LadaLN_cond__grouped_kv_mqa__dense_activation_relu__prompt_kernel_skip5:
    s_cmp_lg_u32 s20, 2
    s_cbranch_scc1 LadaLN_cond__grouped_kv_mqa__dense_activation_relu__prompt_kernel_skip6
    s_call_b64 s[96:97], LadaLN_cond__grouped_kv_mqa__dense_activation_relu__prompt_kernel_stub4
LadaLN_cond__grouped_kv_mqa__dense_activation_relu__prompt_kernel_skip6:
    s_cmp_lg_u32 s20, 3
    s_cbranch_scc1 LadaLN_cond__grouped_kv_mqa__dense_activation_relu__prompt_kernel_skip7
    s_call_b64 s[96:97], LadaLN_cond__grouped_kv_mqa__dense_activation_relu__prompt_kernel_stub5
LadaLN_cond__grouped_kv_mqa__dense_activation_relu__prompt_kernel_skip7:
    s_cmp_lg_u32 s20, 4
    s_cbranch_scc1 LadaLN_cond__grouped_kv_mqa__dense_activation_relu__prompt_kernel_skip8
    s_call_b64 s[96:97], LadaLN_cond__grouped_kv_mqa__dense_activation_relu__prompt_kernel_stub6
LadaLN_cond__grouped_kv_mqa__dense_activation_relu__prompt_kernel_skip8:
    s_cmp_lg_u32 s20, 5
    s_cbranch_scc1 LadaLN_cond__grouped_kv_mqa__dense_activation_relu__prompt_kernel_skip9
    s_call_b64 s[96:97], LadaLN_cond__grouped_kv_mqa__dense_activation_relu__prompt_kernel_stub7
LadaLN_cond__grouped_kv_mqa__dense_activation_relu__prompt_kernel_skip9:
    s_cmp_lg_u32 s20, 6
    s_cbranch_scc1 LadaLN_cond__grouped_kv_mqa__dense_activation_relu__prompt_kernel_skip10
    s_call_b64 s[96:97], LadaLN_cond__grouped_kv_mqa__dense_activation_relu__prompt_kernel_stub8
LadaLN_cond__grouped_kv_mqa__dense_activation_relu__prompt_kernel_skip10:
    s_cmp_lg_u32 s20, 7
    s_cbranch_scc1 LadaLN_cond__grouped_kv_mqa__dense_activation_relu__prompt_kernel_skip11
    s_call_b64 s[96:97], LadaLN_cond__grouped_kv_mqa__dense_activation_relu__prompt_kernel_stub9
LadaLN_cond__grouped_kv_mqa__dense_activation_relu__prompt_kernel_skip11:
    s_waitcnt vmcnt(0)
    v_xor_b32 v116, s62, v116
    s_branch LadaLN_cond__grouped_kv_mqa__dense_activation_relu__prompt_kernel_over1
LadaLN_cond__grouped_kv_mqa__dense_activation_relu__prompt_kernel_stub1:
    s_setpc_b64 s[96:97]
LadaLN_cond__grouped_kv_mqa__dense_activation_relu__prompt_kernel_over1:
    v_xor_b32 v117, s63, v117
    v_xor_b32 v118, s64, v118
    v_xor_b32 v119, s65, v119
    v_xor_b32 v120, s62, v120
    v_xor_b32 v121, s63, v121
    v_xor_b32 v122, s64, v122
    v_xor_b32 v123, s65, v123
    v_xor_b32 v124, s62, v124
    v_xor_b32 v125, s63, v125
    v_xor_b32 v126, s64, v126
    v_xor_b32 v127, s65, v127
    v_xor_b32 v128, s62, v128
    v_xor_b32 v129, s63, v129
    v_xor_b32 v130, s64, v130
    v_xor_b32 v131, s65, v131
    v_or3_b32 v16, v116, v117, v118
    v_or3_b32 v16, v16, v119, v120
    v_or3_b32 v16, v16, v121, v122
    v_or3_b32 v16, v16, v123, v124
    v_or3_b32 v16, v16, v125, v126
    v_or3_b32 v16, v16, v127, v128
    v_or3_b32 v16, v16, v129, v130
    v_or_b32 v16, v16, v131
    v_and_b32 v16, 0xff, v16
    v_cmp_ne_u32 vcc, 0, v16
    s_nop 1
    s_cbranch_vccz LadaLN_cond__grouped_kv_mqa__dense_activation_relu__prompt_kernel_pw3
    s_mov_b32 s67, 400000
LadaLN_cond__grouped_kv_mqa__dense_activation_relu__prompt_kernel_poll12:
    buffer_load_dwordx4 v[116:119], v1, s[16:19], s72 offen sc1
    buffer_load_dwordx4 v[120:123], v1, s[16:19], s73 offen sc1
    buffer_load_dwordx4 v[124:127], v1, s[16:19], s74 offen sc1
    buffer_load_dwordx4 v[128:131], v1, s[16:19], s75 offen sc1
    s_waitcnt vmcnt(0)
    v_xor_b32 v116, s62, v116
    v_xor_b32 v117, s63, v117
    v_xor_b32 v118, s64, v118
    v_xor_b32 v119, s65, v119
    v_xor_b32 v120, s62, v120
    v_xor_b32 v121, s63, v121
    v_xor_b32 v122, s64, v122
    v_xor_b32 v123, s65, v123
    v_xor_b32 v124, s62, v124
    v_xor_b32 v125, s63, v125
    v_xor_b32 v126, s64, v126
    v_xor_b32 v127, s65, v127
    v_xor_b32 v128, s62, v128
    v_xor_b32 v129, s63, v129
    v_xor_b32 v130, s64, v130
    v_xor_b32 v131, s65, v131
    v_or3_b32 v16, v116, v117, v118
    v_or3_b32 v16, v16, v119, v120
    v_or3_b32 v16, v16, v121, v122
    v_or3_b32 v16, v16, v123, v124
    v_or3_b32 v16, v16, v125, v126
    v_or3_b32 v16, v16, v127, v128
    v_or3_b32 v16, v16, v129, v130
    v_or_b32 v16, v16, v131
    v_and_b32 v16, 0xff, v16
    v_cmp_ne_u32 vcc, 0, v16
    s_nop 1
    s_cbranch_vccz LadaLN_cond__grouped_kv_mqa__dense_activation_relu__prompt_kernel_pok13
    s_sleep 1
    s_sub_u32 s67, s67, 1
    s_cbranch_scc0 LadaLN_cond__grouped_kv_mqa__dense_activation_relu__prompt_kernel_poll12
    s_branch LadaLN_cond__grouped_kv_mqa__dense_activation_relu__prompt_kernel_exit
LadaLN_cond__grouped_kv_mqa__dense_activation_relu__prompt_kernel_pok13:
LadaLN_cond__grouped_kv_mqa__dense_activation_relu__prompt_kernel_pw3:
    v_mov_b32 v172, -1
    v_mov_b32 v173, -1
    v_mov_b32 v174, -1
    v_mov_b32 v175, -1
    s_lshl_b32 s82, s2, 3
    s_add_u32 s82, s82, s20
    s_lshr_b32 s83, s82, 5
    s_lshl_b32 s83, s83, 16
    s_and_b32 s84, s82, 31
    s_lshl_b32 s84, s84, 10
    s_add_u32 s83, s83, s84
    s_add_u32 s83, s83, 9437184
    buffer_store_dwordx4 v[172:175], v1, s[16:19], s83 offen sc1
    v_add_f32 v116, v116, v120
    v_add_f32 v124, v124, v128
    v_add_f32 v117, v117, v121
    v_add_f32 v125, v125, v129
    v_add_f32 v118, v118, v122
    v_add_f32 v126, v126, v130
    v_add_f32 v119, v119, v123
    v_add_f32 v127, v127, v131
    v_add_f32 v116, v116, v124
    v_add_f32 v117, v117, v125
    v_add_f32 v118, v118, v126
    v_add_f32 v119, v119, v127
    v_cvt_pk_bf16_f32 v117, v116, v117
    v_lshlrev_b32 v116, 16, v117
    v_and_b32 v117, 0xffff0000, v117
    v_cvt_pk_bf16_f32 v119, v118, v119
    v_lshlrev_b32 v118, 16, v119
    v_and_b32 v119, 0xffff0000, v119
    v_add_f32 v116, s29, v116
    v_add_f32 v117, s29, v117
    v_add_f32 v118, s29, v118
    v_add_f32 v119, s29, v119
    v_cvt_pk_bf16_f32 v117, v116, v117
    v_lshlrev_b32 v116, 16, v117
    v_and_b32 v117, 0xffff0000, v117
    v_cvt_pk_bf16_f32 v119, v118, v119
    v_lshlrev_b32 v118, 16, v119
    v_and_b32 v119, 0xffff0000, v119
    ds_write_b128 v13, v[116:119]
    s_waitcnt lgkmcnt(0)
    s_barrier
    ds_read_b128 v[132:135], v14 offset:0
    ds_read_b128 v[148:151], v14 offset:4096
    ds_read_b128 v[136:139], v14 offset:16
    ds_read_b128 v[152:155], v14 offset:4112
    ds_read_b128 v[140:143], v14 offset:2048
    ds_read_b128 v[156:159], v14 offset:6144
    ds_read_b128 v[144:147], v14 offset:2064
    ds_read_b128 v[160:163], v14 offset:6160
    s_waitcnt lgkmcnt(4)
    v_fma_f32 v44, v44, v148, v132
    v_fma_f32 v45, v45, v149, v133
    v_fma_f32 v46, v46, v150, v134
    v_fma_f32 v47, v47, v151, v135
    v_fma_f32 v48, v48, v152, v136
    v_fma_f32 v49, v49, v153, v137
    v_fma_f32 v50, v50, v154, v138
    v_fma_f32 v51, v51, v155, v139
    v_cvt_pk_bf16_f32 v28, v44, v45
    v_cvt_pk_bf16_f32 v29, v46, v47
    v_cvt_pk_bf16_f32 v30, v48, v49
    v_cvt_pk_bf16_f32 v31, v50, v51
    ds_write_b128 v3, v[28:31] offset:0
    s_waitcnt lgkmcnt(1)
    v_fma_f32 v52, v52, v156, v140
    v_fma_f32 v53, v53, v157, v141
    v_fma_f32 v54, v54, v158, v142
    v_fma_f32 v55, v55, v159, v143
    v_fma_f32 v56, v56, v160, v144
    v_fma_f32 v57, v57, v161, v145
    v_fma_f32 v58, v58, v162, v146
    v_fma_f32 v59, v59, v163, v147
    v_cvt_pk_bf16_f32 v32, v52, v53
    v_cvt_pk_bf16_f32 v33, v54, v55
    v_cvt_pk_bf16_f32 v34, v56, v57
    v_cvt_pk_bf16_f32 v35, v58, v59
    ds_write_b128 v3, v[32:35] offset:1024
    s_lshr_b32 s70, s35, 2
    s_lshl_b32 s70, s70, 16
    s_and_b32 s71, s34, 3
    s_lshl_b32 s71, s71, 7
    s_add_u32 s70, s70, s71
    s_lshl_b32 s71, s24, 14
    s_add_u32 s70, s70, s71
    s_add_u32 s70, s70, 1048576
    s_waitcnt lgkmcnt(0)
    s_barrier
    s_cmp_ge_u32 s20, 4
    s_cbranch_scc1 LadaLN_cond__grouped_kv_mqa__dense_activation_relu__prompt_kernel_hi14
    ds_read_b128 v[116:119], v5 offset:0
    ds_read_b128 v[120:123], v6 offset:0
    ds_read_b128 v[124:127], v5 offset:256
    ds_read_b128 v[128:131], v6 offset:256
    s_waitcnt lgkmcnt(3)
    buffer_store_dwordx4 v[116:119], v7, s[16:19], s70 offen sc1
    s_add_u32 s70, s70, 4096
    s_waitcnt lgkmcnt(2)
    buffer_store_dwordx4 v[120:123], v7, s[16:19], s70 offen sc1
    s_add_u32 s70, s70, 4096
    s_waitcnt lgkmcnt(1)
    buffer_store_dwordx4 v[124:127], v7, s[16:19], s70 offen sc1
    s_add_u32 s70, s70, 4096
    s_waitcnt lgkmcnt(0)
    buffer_store_dwordx4 v[128:131], v7, s[16:19], s70 offen sc1
LadaLN_cond__grouped_kv_mqa__dense_activation_relu__prompt_kernel_hi14:
    v_fma_f32 v60, v60, v148, v132
    v_fma_f32 v61, v61, v149, v133
    v_fma_f32 v62, v62, v150, v134
    v_fma_f32 v63, v63, v151, v135
    v_fma_f32 v64, v64, v152, v136
    v_fma_f32 v65, v65, v153, v137
    v_fma_f32 v66, v66, v154, v138
    v_fma_f32 v67, v67, v155, v139
    v_cvt_pk_bf16_f32 v36, v60, v61
    v_cvt_pk_bf16_f32 v37, v62, v63
    v_cvt_pk_bf16_f32 v38, v64, v65
    v_cvt_pk_bf16_f32 v39, v66, v67
    ds_write_b128 v4, v[36:39] offset:0
    v_fma_f32 v68, v68, v156, v140
    v_fma_f32 v69, v69, v157, v141
    v_fma_f32 v70, v70, v158, v142
    v_fma_f32 v71, v71, v159, v143
    v_fma_f32 v72, v72, v160, v144
    v_fma_f32 v73, v73, v161, v145
    v_fma_f32 v74, v74, v162, v146
    v_fma_f32 v75, v75, v163, v147
    v_cvt_pk_bf16_f32 v40, v68, v69
    v_cvt_pk_bf16_f32 v41, v70, v71
    v_cvt_pk_bf16_f32 v42, v72, v73
    v_cvt_pk_bf16_f32 v43, v74, v75
    ds_write_b128 v4, v[40:43] offset:1024
    v_xor_b32 v5, 64, v8
    v_xor_b32 v6, 128, v8
    v_xor_b32 v7, 192, v8
    s_waitcnt lgkmcnt(0)
    s_barrier
    ds_read_b128 v[132:135], v8
    ds_read_b128 v[136:139], v5
    ds_read_b128 v[140:143], v6
    ds_read_b128 v[144:147], v7
    s_bitcmp1_b32 s34, 0
    s_cbranch_scc1 LadaLN_cond__grouped_kv_mqa__dense_activation_relu__prompt_kernel_selv16
    s_waitcnt lgkmcnt(3)
    v_mfma_f32_16x16x32_bf16 v[16:19], v[84:87], v[132:135], 0
    v_mfma_f32_16x16x32_bf16 v[20:23], v[88:91], v[132:135], 0
    s_waitcnt lgkmcnt(2)
    v_mfma_f32_16x16x32_bf16 v[16:19], v[92:95], v[136:139], v[16:19]
    v_mfma_f32_16x16x32_bf16 v[20:23], v[96:99], v[136:139], v[20:23]
    s_waitcnt lgkmcnt(1)
    v_mfma_f32_16x16x32_bf16 v[16:19], v[100:103], v[140:143], v[16:19]
    v_mfma_f32_16x16x32_bf16 v[20:23], v[104:107], v[140:143], v[20:23]
    s_waitcnt lgkmcnt(0)
    v_mfma_f32_16x16x32_bf16 v[16:19], v[108:111], v[144:147], v[16:19]
    v_mfma_f32_16x16x32_bf16 v[20:23], v[112:115], v[144:147], v[20:23]
    s_branch LadaLN_cond__grouped_kv_mqa__dense_activation_relu__prompt_kernel_selj17
LadaLN_cond__grouped_kv_mqa__dense_activation_relu__prompt_kernel_selv16:
    s_waitcnt lgkmcnt(3)
    v_mfma_f32_16x16x32_bf16 v[16:19], v[132:135], v[84:87], 0
    v_mfma_f32_16x16x32_bf16 v[20:23], v[132:135], v[88:91], 0
    s_waitcnt lgkmcnt(2)
    v_mfma_f32_16x16x32_bf16 v[16:19], v[136:139], v[92:95], v[16:19]
    v_mfma_f32_16x16x32_bf16 v[20:23], v[136:139], v[96:99], v[20:23]
    s_waitcnt lgkmcnt(1)
    v_mfma_f32_16x16x32_bf16 v[16:19], v[140:143], v[100:103], v[16:19]
    v_mfma_f32_16x16x32_bf16 v[20:23], v[140:143], v[104:107], v[20:23]
    s_waitcnt lgkmcnt(0)
    v_mfma_f32_16x16x32_bf16 v[16:19], v[144:147], v[108:111], v[16:19]
    v_mfma_f32_16x16x32_bf16 v[20:23], v[144:147], v[112:115], v[20:23]
LadaLN_cond__grouped_kv_mqa__dense_activation_relu__prompt_kernel_selj17:
    s_lshl_b32 s71, s20, 11
    s_add_u32 s71, s71, 131072
    v_add_u32 v13, s71, v1
    s_lshl_b32 s71, s35, 2
    s_nop 1
    s_barrier
    ds_write_b128 v13, v[16:19]
    ds_write_b128 v13, v[20:23] offset:1024
    s_waitcnt lgkmcnt(0)
    s_barrier
    s_cmp_lg_u32 s20, 4
    s_cbranch_scc1 LadaLN_cond__grouped_kv_mqa__dense_activation_relu__prompt_kernel_skip18
    v_add_u32 v13, 131072, v1
    ds_read_b128 v[48:51], v13 offset:0
    ds_read_b128 v[52:55], v13 offset:2048
    ds_read_b128 v[56:59], v13 offset:4096
    ds_read_b128 v[60:63], v13 offset:6144
    ds_read_b128 v[64:67], v13 offset:8192
    ds_read_b128 v[68:71], v13 offset:10240
    ds_read_b128 v[72:75], v13 offset:12288
    ds_read_b128 v[76:79], v13 offset:14336
    ds_read_b128 v[80:83], v13 offset:1024
    ds_read_b128 v[84:87], v13 offset:3072
    ds_read_b128 v[88:91], v13 offset:5120
    ds_read_b128 v[92:95], v13 offset:7168
    ds_read_b128 v[96:99], v13 offset:9216
    ds_read_b128 v[100:103], v13 offset:11264
    ds_read_b128 v[104:107], v13 offset:13312
    ds_read_b128 v[108:111], v13 offset:15360
    v_and_b32 v11, 1, v10
    v_lshlrev_b32 v11, 9, v11
    v_lshl_add_u32 v11, v9, 4, v11
    v_lshrrev_b32 v12, 1, v10
    v_lshl_add_u32 v11, v12, 3, v11
    s_lshr_b32 s72, s35, 2
    s_lshl_b32 s72, s72, 12
    s_bfe_u32 s73, s35, 0x10001
    s_lshl_b32 s74, s73, 8
    s_lshl_b32 s75, s73, 10
    s_add_u32 s75, s75, 2048
    s_bitcmp1_b32 s34, 0
    s_cselect_b32 s74, s75, s74
    s_cselect_b32 s75, 1, 4
    s_lshl_b32 s75, s75, 8
    s_add_u32 s72, s72, s74
    s_add_u32 s72, s72, 524288
    s_add_u32 s73, s72, s75
    s_waitcnt lgkmcnt(8)
    v_add_f32 v48, v48, v64
    v_add_f32 v49, v49, v65
    v_add_f32 v50, v50, v66
    v_add_f32 v51, v51, v67
    v_add_f32 v52, v52, v68
    v_add_f32 v53, v53, v69
    v_add_f32 v54, v54, v70
    v_add_f32 v55, v55, v71
    v_add_f32 v56, v56, v72
    v_add_f32 v57, v57, v73
    v_add_f32 v58, v58, v74
    v_add_f32 v59, v59, v75
    v_add_f32 v60, v60, v76
    v_add_f32 v61, v61, v77
    v_add_f32 v62, v62, v78
    v_add_f32 v63, v63, v79
    v_add_f32 v48, v48, v56
    v_add_f32 v49, v49, v57
    v_add_f32 v50, v50, v58
    v_add_f32 v51, v51, v59
    v_add_f32 v52, v52, v60
    v_add_f32 v53, v53, v61
    v_add_f32 v54, v54, v62
    v_add_f32 v55, v55, v63
    v_add_f32 v48, v48, v52
    v_add_f32 v49, v49, v53
    v_add_f32 v50, v50, v54
    v_add_f32 v51, v51, v55
    v_cvt_pk_bf16_f32 v48, v48, v49
    v_cvt_pk_bf16_f32 v49, v50, v51
    buffer_store_dwordx2 v[48:49], v11, s[16:19], s72 offen sc1
    s_waitcnt lgkmcnt(0)
    v_add_f32 v80, v80, v96
    v_add_f32 v81, v81, v97
    v_add_f32 v82, v82, v98
    v_add_f32 v83, v83, v99
    v_add_f32 v84, v84, v100
    v_add_f32 v85, v85, v101
    v_add_f32 v86, v86, v102
    v_add_f32 v87, v87, v103
    v_add_f32 v88, v88, v104
    v_add_f32 v89, v89, v105
    v_add_f32 v90, v90, v106
    v_add_f32 v91, v91, v107
    v_add_f32 v92, v92, v108
    v_add_f32 v93, v93, v109
    v_add_f32 v94, v94, v110
    v_add_f32 v95, v95, v111
    v_add_f32 v80, v80, v88
    v_add_f32 v81, v81, v89
    v_add_f32 v82, v82, v90
    v_add_f32 v83, v83, v91
    v_add_f32 v84, v84, v92
    v_add_f32 v85, v85, v93
    v_add_f32 v86, v86, v94
    v_add_f32 v87, v87, v95
    v_add_f32 v80, v80, v84
    v_add_f32 v81, v81, v85
    v_add_f32 v82, v82, v86
    v_add_f32 v83, v83, v87
    v_cvt_pk_bf16_f32 v80, v80, v81
    v_cvt_pk_bf16_f32 v81, v82, v83
    buffer_store_dwordx2 v[80:81], v11, s[16:19], s73 offen sc1
LadaLN_cond__grouped_kv_mqa__dense_activation_relu__prompt_kernel_skip18:
    s_cmp_ge_u32 s20, 4
    s_cbranch_scc1 LadaLN_cond__grouped_kv_mqa__dense_activation_relu__prompt_kernel_fh19
    s_lshl_b32 s72, s35, 9
    s_lshl_b32 s73, s20, 7
    s_add_u32 s72, s72, s73
    s_add_u32 s72, s72, 786432
    s_waitcnt vmcnt(0)
    v_mov_b32 v11, s23
    s_mov_b64 exec, 1
    buffer_store_dword v11, off, s[16:19], s72 sc1
    s_mov_b64 exec, -1
LadaLN_cond__grouped_kv_mqa__dense_activation_relu__prompt_kernel_fh19:
    s_add_u32 s81, s71, 41984
    s_mov_b32 s71, s80
    s_cmp_eq_u32 s20, 4
    s_cbranch_scc1 LadaLN_cond__grouped_kv_mqa__dense_activation_relu__prompt_kernel_w420
    s_add_u32 s79, s78, 0
    s_add_u32 m0, s71, 0
    s_nop 0
    buffer_load_dwordx4 v168, s[8:11], s79 offen lds
    buffer_load_dwordx4 v169, s[8:11], s79 offen offset:1024 lds
    s_add_u32 s79, s79, 32768
    s_add_u32 m0, s71, 2048
    s_nop 0
    buffer_load_dwordx4 v168, s[8:11], s79 offen lds
    buffer_load_dwordx4 v169, s[8:11], s79 offen offset:1024 lds
    s_add_u32 s79, s79, 32768
    s_add_u32 m0, s71, 4096
    s_nop 0
    buffer_load_dwordx4 v168, s[8:11], s79 offen lds
    buffer_load_dwordx4 v169, s[8:11], s79 offen offset:1024 lds
    s_add_u32 s79, s79, 32768
    s_add_u32 m0, s71, 6144
    s_nop 0
    buffer_load_dwordx4 v168, s[8:11], s79 offen lds
    buffer_load_dwordx4 v169, s[8:11], s79 offen offset:1024 lds
    s_cmp_lg_u32 s20, 5
    s_cbranch_scc1 LadaLN_cond__grouped_kv_mqa__dense_activation_relu__prompt_kernel_skip21
    s_sub_u32 s71, s71, 8192
    s_sub_u32 s78, s78, 131072
    s_add_u32 s79, s78, 0
    s_add_u32 m0, s71, 0
    s_nop 0
    buffer_load_dwordx4 v168, s[8:11], s79 offen lds
    buffer_load_dwordx4 v169, s[8:11], s79 offen offset:1024 lds
    s_add_u32 s79, s79, 32768
    s_add_u32 m0, s71, 2048
    s_nop 0
    buffer_load_dwordx4 v168, s[8:11], s79 offen lds
    buffer_load_dwordx4 v169, s[8:11], s79 offen offset:1024 lds
    s_add_u32 s79, s79, 32768
    s_add_u32 m0, s71, 4096
    s_nop 0
    buffer_load_dwordx4 v168, s[8:11], s79 offen lds
    buffer_load_dwordx4 v169, s[8:11], s79 offen offset:1024 lds
    s_add_u32 s79, s79, 32768
    s_add_u32 m0, s71, 6144
    s_nop 0
    buffer_load_dwordx4 v168, s[8:11], s79 offen lds
    buffer_load_dwordx4 v169, s[8:11], s79 offen offset:1024 lds
LadaLN_cond__grouped_kv_mqa__dense_activation_relu__prompt_kernel_skip21:
LadaLN_cond__grouped_kv_mqa__dense_activation_relu__prompt_kernel_w420:
    s_mov_b32 s8, s44
    s_mov_b32 s9, s45
    s_mov_b32 s10, 0x200000
    s_mov_b32 s11, 0x20000
    v_lshlrev_b32 v15, 7, v2
    v_cmp_gt_u32 vcc, 8, v2
    v_mov_b32 v11, 0x40000000
    s_lshl_b32 s74, s2, 3
    s_add_u32 s74, s74, s20
    v_cndmask_b32 v15, v11, v15, vcc
    s_lshl_b32 s78, s74, 10
    v_lshrrev_b32 v11, 3, v2
    v_lshlrev_b32 v11, 11, v11
    v_and_b32 v12, 7, v2
    v_lshl_add_u32 v11, v12, 4, v11
    s_lshl_b32 s77, s66, 16
    s_lshl_b32 s75, s22, 7
    s_add_u32 s77, s77, s75
    s_lshl_b32 s76, s25, 15
    s_add_u32 s77, s77, s76
    s_mov_b32 s12, s54
    s_mov_b32 s13, s55
    s_mov_b32 s14, 0xc00000
    s_mov_b32 s15, 0x20000
    v_lshrrev_b32 v7, 3, v2
    v_mul_u32_u24 v7, 49152, v7
    v_lshl_add_u32 v12, v12, 4, v7
    s_and_b32 s76, s2, 3
    s_lshl_b32 s76, s76, 3
    s_add_u32 s76, s76, s20
    s_mul_i32 s76, s76, 393216
    s_lshr_b32 s71, s2, 2
    s_lshl_b32 s71, s71, 7
    s_add_u32 s76, s76, s71
    s_add_u32 s76, s76, 4096
    v_lshrrev_b32 v7, 3, v2
    s_mov_b32 s71, 2048
    v_mul_lo_u32 v4, v7, s71
    v_and_b32 v7, 7, v2
    v_bfe_u32 v8, v2, 4, 1
    v_lshlrev_b32 v8, 2, v8
    v_xor_b32 v7, v7, v8
    v_lshl_add_u32 v4, v7, 4, v4
    v_add_u32 v5, 15360, v4
    s_lshl_b32 s71, s24, 15
    s_add_u32 s72, s75, s71
    s_lshl_b32 s71, s25, 17
    s_add_u32 s72, s72, s71
    s_lshl_b32 s73, s24, 11
    s_lshl_b32 s71, s25, 13
    s_add_u32 s73, s73, s71
    s_cmp_lt_u32 s20, 4
    s_cselect_b32 s84, s48, s50
    s_cselect_b32 s85, s49, s51
    s_mov_b32 s86, 7340032
    s_mov_b32 s87, 0x20000
    s_lshl_b32 s83, s2, 2
    s_add_u32 s83, s83, s24
    s_mul_i32 s83, s83, 7168
    s_lshl_b32 s82, s2, 3
    s_add_u32 s82, s82, s20
    s_lshl_b32 s82, s82, 11
    s_add_u32 s82, s82, 28311552
    v_mov_b32 v92, -1
    v_mov_b32 v93, -1
    v_mov_b32 v94, -1
    v_mov_b32 v95, -1
    s_and_b32 s79, s21, 1
    s_lshl_b32 s79, s79, 4
    s_add_u32 s79, s79, s22
    s_lshl_b32 s79, s79, 3
    s_add_u32 s79, s79, s20
    s_and_b32 s71, s79, 15
    s_mul_i32 s71, s71, 2048
    s_lshr_b32 s79, s79, 4
    s_lshr_b32 s74, s21, 1
    s_lshl_b32 s74, s74, 4
    s_add_u32 s79, s79, s74
    s_mul_i32 s79, s79, 114688
    s_add_u32 s79, s79, s71
    s_add_u32 s79, s79, 13631488
    v_mov_b32 v13, 0x40000000
    s_lshl_b32 s71, s66, 4
    s_add_u32 s71, s71, s22
    s_lshl_b32 s74, s71, 1
    s_add_u32 s74, s74, s25
    s_lshl_b32 s74, s74, 7
    s_add_u32 s74, s74, 36700160
    v_writelane_b32 v13, s74, 1
    s_mov_b32 s74, s71
    s_lshl_b32 s74, s74, 7
    s_add_u32 s74, s74, 36962304
    v_writelane_b32 v13, s74, 2
    s_lshl_b32 s74, s71, 1
    s_add_u32 s74, s74, s25
    s_lshl_b32 s74, s74, 7
    s_add_u32 s74, s74, 196608
    v_writelane_b32 v13, s74, 3
    s_lshr_b32 s74, s21, 1
    s_lshl_b32 s74, s74, 2
    s_add_u32 s74, s74, s24
    s_lshl_b32 s74, s74, 1
    s_and_b32 s71, s26, 1
    s_add_u32 s74, s74, s71
    s_lshl_b32 s74, s74, 4
    s_and_b32 s71, s27, 15
    s_add_u32 s74, s74, s71
    s_lshl_b32 s74, s74, 7
    s_add_u32 s74, s74, 37093376
    v_writelane_b32 v13, s74, 4
    s_cmp_eq_u32 s20, 4
    s_cbranch_scc1 LadaLN_cond__grouped_kv_mqa__dense_activation_relu__prompt_kernel_w422
    s_waitcnt vmcnt(0)
LadaLN_cond__grouped_kv_mqa__dense_activation_relu__prompt_kernel_w422:
LadaLN_cond__grouped_kv_mqa__dense_activation_relu__prompt_kernel_bcode:
    v_and_b32 v7, 15, v2
    v_lshrrev_b32 v8, 2, v7
    v_lshlrev_b32 v3, 7, v8
    v_lshrrev_b32 v8, 3, v7
    v_lshl_add_u32 v3, v8, 6, v3
    v_and_b32 v8, 3, v7
    v_lshl_add_u32 v3, v8, 3, v3
    v_bfe_u32 v8, v2, 4, 1
    v_lshl_add_u32 v3, v8, 5, v3
    v_lshrrev_b32 v8, 5, v2
    v_lshl_add_u32 v3, v8, 10, v3
    v_xor_b32 v14, 64, v3
    s_lshl_b32 s70, s25, 16
    s_lshl_b32 s71, s25, 6
    v_add_u32 v3, s70, v3
    v_xor_b32 v3, s71, v3
    v_add_u32 v14, s70, v14
    v_xor_b32 v14, s71, v14
    v_bfe_u32 v7, v2, 1, 2
    v_and_b32 v8, 1, v2
    v_lshlrev_b32 v7, 9, v7
    v_lshl_add_u32 v7, v8, 7, v7
    s_lshl_b32 s28, s66, 11
    s_lshl_b32 s29, s25, 8
    s_add_u32 s28, s28, s29
    s_add_u32 s28, s28, 786432
    s_lshl_b32 s68, s66, 16
    s_lshl_b32 s69, s25, 15
    s_add_u32 s68, s68, s69
    s_add_u32 s68, s68, 1048576
    s_mov_b32 s29, 41984
    s_lshl_b32 s69, s20, 11
    s_add_u32 s70, s69, 98304
    s_add_u32 s69, s69, 524288
    s_barrier
    s_cmp_lg_u32 s20, 4
    s_cbranch_scc1 LadaLN_cond__grouped_kv_mqa__dense_activation_relu__prompt_kernel_skip23
    s_waitcnt vmcnt(0)
    v_mov_b32 v8, s23
    s_mov_b64 exec, 1
    buffer_store_dword v8, off, s[16:19], s81 sc1
    s_mov_b64 exec, -1
LadaLN_cond__grouped_kv_mqa__dense_activation_relu__prompt_kernel_skip23:
    s_mov_b32 s67, 400000
LadaLN_cond__grouped_kv_mqa__dense_activation_relu__prompt_kernel_poll24:
    buffer_load_dword v8, v7, s[16:19], s28 offen sc1
    s_waitcnt vmcnt(0)
    v_cmp_ne_u32 vcc, s23, v8
    s_nop 1
    s_cbranch_vccz LadaLN_cond__grouped_kv_mqa__dense_activation_relu__prompt_kernel_pok25
    s_sleep 1
    s_sub_u32 s67, s67, 1
    s_cbranch_scc0 LadaLN_cond__grouped_kv_mqa__dense_activation_relu__prompt_kernel_poll24
    s_branch LadaLN_cond__grouped_kv_mqa__dense_activation_relu__prompt_kernel_exit
LadaLN_cond__grouped_kv_mqa__dense_activation_relu__prompt_kernel_pok25:
    buffer_load_dwordx4 v[124:127], v1, s[16:19], s68 offen offset:0 sc1
    buffer_load_dwordx4 v[128:131], v1, s[16:19], s68 offen offset:1024 sc1
    buffer_load_dwordx4 v[132:135], v1, s[16:19], s68 offen offset:2048 sc1
    buffer_load_dwordx4 v[136:139], v1, s[16:19], s68 offen offset:3072 sc1
    s_add_u32 s68, s68, 4096
    buffer_load_dwordx4 v[140:143], v1, s[16:19], s68 offen offset:0 sc1
    buffer_load_dwordx4 v[144:147], v1, s[16:19], s68 offen offset:1024 sc1
    s_lshl_b32 s71, s20, 12
    v_add_u32 v7, s71, v1
    v_xor_b32 v8, 0x4000, v7
    ds_read_b64_tr_b16 v[48:49], v3 offset:0
    ds_read_b64_tr_b16 v[50:51], v3 offset:512
    ds_read_b64_tr_b16 v[52:53], v14 offset:0
    ds_read_b64_tr_b16 v[54:55], v14 offset:512
    buffer_load_dwordx4 v[148:151], v1, s[16:19], s68 offen offset:2048 sc1
    ds_read_b64_tr_b16 v[56:57], v3 offset:2048
    ds_read_b64_tr_b16 v[58:59], v3 offset:2560
    ds_read_b64_tr_b16 v[60:61], v14 offset:2048
    ds_read_b64_tr_b16 v[62:63], v14 offset:2560
    s_waitcnt vmcnt(6)
    s_waitcnt lgkmcnt(4)
    v_mfma_f32_32x32x16_bf16 v[16:31], v[48:51], v[124:127], 0
    v_mfma_f32_32x32x16_bf16 v[32:47], v[52:55], v[124:127], 0
    buffer_load_dwordx4 v[152:155], v1, s[16:19], s68 offen offset:3072 sc1
    s_add_u32 s68, s68, 4096
    ds_read_b64_tr_b16 v[48:49], v3 offset:4096
    ds_read_b64_tr_b16 v[50:51], v3 offset:4608
    ds_read_b64_tr_b16 v[52:53], v14 offset:4096
    ds_read_b64_tr_b16 v[54:55], v14 offset:4608
    s_waitcnt vmcnt(6)
    s_waitcnt lgkmcnt(4)
    v_mfma_f32_32x32x16_bf16 v[16:31], v[56:59], v[128:131], v[16:31]
    v_mfma_f32_32x32x16_bf16 v[32:47], v[60:63], v[128:131], v[32:47]
    buffer_load_dwordx4 v[156:159], v1, s[16:19], s68 offen offset:0 sc1
    ds_read_b64_tr_b16 v[56:57], v3 offset:6144
    ds_read_b64_tr_b16 v[58:59], v3 offset:6656
    ds_read_b64_tr_b16 v[60:61], v14 offset:6144
    ds_read_b64_tr_b16 v[62:63], v14 offset:6656
    s_waitcnt vmcnt(6)
    s_waitcnt lgkmcnt(4)
    v_mfma_f32_32x32x16_bf16 v[16:31], v[48:51], v[132:135], v[16:31]
    v_mfma_f32_32x32x16_bf16 v[32:47], v[52:55], v[132:135], v[32:47]
    buffer_load_dwordx4 v[160:163], v1, s[16:19], s68 offen offset:1024 sc1
    ds_read_b64_tr_b16 v[48:49], v3 offset:8192
    ds_read_b64_tr_b16 v[50:51], v3 offset:8704
    ds_read_b64_tr_b16 v[52:53], v14 offset:8192
    ds_read_b64_tr_b16 v[54:55], v14 offset:8704
    s_waitcnt vmcnt(6)
    s_waitcnt lgkmcnt(4)
    v_mfma_f32_32x32x16_bf16 v[16:31], v[56:59], v[136:139], v[16:31]
    v_mfma_f32_32x32x16_bf16 v[32:47], v[60:63], v[136:139], v[32:47]
    buffer_load_dwordx4 v[164:167], v1, s[16:19], s68 offen offset:2048 sc1
    ds_read_b64_tr_b16 v[56:57], v3 offset:10240
    ds_read_b64_tr_b16 v[58:59], v3 offset:10752
    ds_read_b64_tr_b16 v[60:61], v14 offset:10240
    ds_read_b64_tr_b16 v[62:63], v14 offset:10752
    s_waitcnt vmcnt(6)
    s_waitcnt lgkmcnt(4)
    v_mfma_f32_32x32x16_bf16 v[16:31], v[48:51], v[140:143], v[16:31]
    v_mfma_f32_32x32x16_bf16 v[32:47], v[52:55], v[140:143], v[32:47]
    buffer_load_dwordx4 v[168:171], v1, s[16:19], s68 offen offset:3072 sc1
    s_add_u32 s68, s68, 4096
    ds_read_b64_tr_b16 v[48:49], v3 offset:12288
    ds_read_b64_tr_b16 v[50:51], v3 offset:12800
    ds_read_b64_tr_b16 v[52:53], v14 offset:12288
    ds_read_b64_tr_b16 v[54:55], v14 offset:12800
    s_waitcnt vmcnt(6)
    s_waitcnt lgkmcnt(4)
    v_mfma_f32_32x32x16_bf16 v[16:31], v[56:59], v[144:147], v[16:31]
    v_mfma_f32_32x32x16_bf16 v[32:47], v[60:63], v[144:147], v[32:47]
    buffer_load_dwordx4 v[172:175], v1, s[16:19], s68 offen offset:0 sc1
    ds_read_b64_tr_b16 v[56:57], v3 offset:14336
    ds_read_b64_tr_b16 v[58:59], v3 offset:14848
    ds_read_b64_tr_b16 v[60:61], v14 offset:14336
    ds_read_b64_tr_b16 v[62:63], v14 offset:14848
    s_waitcnt vmcnt(6)
    s_waitcnt lgkmcnt(4)
    v_mfma_f32_32x32x16_bf16 v[16:31], v[48:51], v[148:151], v[16:31]
    v_mfma_f32_32x32x16_bf16 v[32:47], v[52:55], v[148:151], v[32:47]
    buffer_load_dwordx4 v[176:179], v1, s[16:19], s68 offen offset:1024 sc1
    ds_read_b64_tr_b16 v[48:49], v3 offset:16384
    ds_read_b64_tr_b16 v[50:51], v3 offset:16896
    ds_read_b64_tr_b16 v[52:53], v14 offset:16384
    ds_read_b64_tr_b16 v[54:55], v14 offset:16896
    s_waitcnt vmcnt(6)
    s_waitcnt lgkmcnt(4)
    v_mfma_f32_32x32x16_bf16 v[16:31], v[56:59], v[152:155], v[16:31]
    v_mfma_f32_32x32x16_bf16 v[32:47], v[60:63], v[152:155], v[32:47]
    buffer_load_dwordx4 v[180:183], v1, s[16:19], s68 offen offset:2048 sc1
    ds_read_b64_tr_b16 v[56:57], v3 offset:18432
    ds_read_b64_tr_b16 v[58:59], v3 offset:18944
    ds_read_b64_tr_b16 v[60:61], v14 offset:18432
    ds_read_b64_tr_b16 v[62:63], v14 offset:18944
    s_waitcnt vmcnt(6)
    s_waitcnt lgkmcnt(4)
    v_mfma_f32_32x32x16_bf16 v[16:31], v[48:51], v[156:159], v[16:31]
    v_mfma_f32_32x32x16_bf16 v[32:47], v[52:55], v[156:159], v[32:47]
    buffer_load_dwordx4 v[184:187], v1, s[16:19], s68 offen offset:3072 sc1
    s_add_u32 s68, s68, 4096
    ds_read_b64_tr_b16 v[48:49], v3 offset:20480
    ds_read_b64_tr_b16 v[50:51], v3 offset:20992
    ds_read_b64_tr_b16 v[52:53], v14 offset:20480
    ds_read_b64_tr_b16 v[54:55], v14 offset:20992
    s_waitcnt vmcnt(6)
    s_waitcnt lgkmcnt(4)
    v_mfma_f32_32x32x16_bf16 v[16:31], v[56:59], v[160:163], v[16:31]
    v_mfma_f32_32x32x16_bf16 v[32:47], v[60:63], v[160:163], v[32:47]
    buffer_load_dwordx4 v[188:191], v1, s[16:19], s68 offen offset:0 sc1
    ds_read_b64_tr_b16 v[56:57], v3 offset:22528
    ds_read_b64_tr_b16 v[58:59], v3 offset:23040
    ds_read_b64_tr_b16 v[60:61], v14 offset:22528
    ds_read_b64_tr_b16 v[62:63], v14 offset:23040
    s_waitcnt vmcnt(6)
    s_waitcnt lgkmcnt(4)
    v_mfma_f32_32x32x16_bf16 v[16:31], v[48:51], v[164:167], v[16:31]
    v_mfma_f32_32x32x16_bf16 v[32:47], v[52:55], v[164:167], v[32:47]
    buffer_load_dwordx4 v[192:195], v1, s[16:19], s68 offen offset:1024 sc1
    ds_read_b64_tr_b16 v[48:49], v3 offset:24576
    ds_read_b64_tr_b16 v[50:51], v3 offset:25088
    ds_read_b64_tr_b16 v[52:53], v14 offset:24576
    ds_read_b64_tr_b16 v[54:55], v14 offset:25088
    s_waitcnt vmcnt(6)
    s_branch LadaLN_cond__grouped_kv_mqa__dense_activation_relu__prompt_kernel_over2
LadaLN_cond__grouped_kv_mqa__dense_activation_relu__prompt_kernel_stub2:
    s_setpc_b64 s[96:97]
LadaLN_cond__grouped_kv_mqa__dense_activation_relu__prompt_kernel_over2:
    s_waitcnt lgkmcnt(4)
    v_mfma_f32_32x32x16_bf16 v[16:31], v[56:59], v[168:171], v[16:31]
    v_mfma_f32_32x32x16_bf16 v[32:47], v[60:63], v[168:171], v[32:47]
    buffer_load_dwordx4 v[196:199], v1, s[16:19], s68 offen offset:2048 sc1
    ds_read_b64_tr_b16 v[56:57], v3 offset:26624
    ds_read_b64_tr_b16 v[58:59], v3 offset:27136
    ds_read_b64_tr_b16 v[60:61], v14 offset:26624
    ds_read_b64_tr_b16 v[62:63], v14 offset:27136
    s_waitcnt vmcnt(6)
    s_waitcnt lgkmcnt(4)
    v_mfma_f32_32x32x16_bf16 v[16:31], v[48:51], v[172:175], v[16:31]
    v_mfma_f32_32x32x16_bf16 v[32:47], v[52:55], v[172:175], v[32:47]
    buffer_load_dwordx4 v[200:203], v1, s[16:19], s68 offen offset:3072 sc1
    s_add_u32 s68, s68, 4096
    ds_read_b64_tr_b16 v[48:49], v3 offset:28672
    ds_read_b64_tr_b16 v[50:51], v3 offset:29184
    ds_read_b64_tr_b16 v[52:53], v14 offset:28672
    ds_read_b64_tr_b16 v[54:55], v14 offset:29184
    s_waitcnt vmcnt(6)
    s_waitcnt lgkmcnt(4)
    v_mfma_f32_32x32x16_bf16 v[16:31], v[56:59], v[176:179], v[16:31]
    v_mfma_f32_32x32x16_bf16 v[32:47], v[60:63], v[176:179], v[32:47]
    buffer_load_dwordx4 v[204:207], v1, s[16:19], s68 offen offset:0 sc1
    ds_read_b64_tr_b16 v[56:57], v3 offset:30720
    ds_read_b64_tr_b16 v[58:59], v3 offset:31232
    ds_read_b64_tr_b16 v[60:61], v14 offset:30720
    ds_read_b64_tr_b16 v[62:63], v14 offset:31232
    s_waitcnt vmcnt(6)
    s_waitcnt lgkmcnt(4)
    v_mfma_f32_32x32x16_bf16 v[16:31], v[48:51], v[180:183], v[16:31]
    v_mfma_f32_32x32x16_bf16 v[32:47], v[52:55], v[180:183], v[32:47]
    buffer_load_dwordx4 v[208:211], v1, s[16:19], s68 offen offset:1024 sc1
    ds_read_b64_tr_b16 v[48:49], v3 offset:32768
    ds_read_b64_tr_b16 v[50:51], v3 offset:33280
    ds_read_b64_tr_b16 v[52:53], v14 offset:32768
    ds_read_b64_tr_b16 v[54:55], v14 offset:33280
    s_waitcnt vmcnt(6)
    s_waitcnt lgkmcnt(4)
    v_mfma_f32_32x32x16_bf16 v[16:31], v[56:59], v[184:187], v[16:31]
    v_mfma_f32_32x32x16_bf16 v[32:47], v[60:63], v[184:187], v[32:47]
    buffer_load_dwordx4 v[212:215], v1, s[16:19], s68 offen offset:2048 sc1
    ds_read_b64_tr_b16 v[56:57], v3 offset:34816
    ds_read_b64_tr_b16 v[58:59], v3 offset:35328
    ds_read_b64_tr_b16 v[60:61], v14 offset:34816
    ds_read_b64_tr_b16 v[62:63], v14 offset:35328
    s_waitcnt vmcnt(6)
    s_waitcnt lgkmcnt(4)
    v_mfma_f32_32x32x16_bf16 v[16:31], v[48:51], v[188:191], v[16:31]
    v_mfma_f32_32x32x16_bf16 v[32:47], v[52:55], v[188:191], v[32:47]
    buffer_load_dwordx4 v[216:219], v1, s[16:19], s68 offen offset:3072 sc1
    s_add_u32 s68, s68, 4096
    ds_read_b64_tr_b16 v[48:49], v3 offset:36864
    ds_read_b64_tr_b16 v[50:51], v3 offset:37376
    ds_read_b64_tr_b16 v[52:53], v14 offset:36864
    ds_read_b64_tr_b16 v[54:55], v14 offset:37376
    s_waitcnt vmcnt(6)
    s_waitcnt lgkmcnt(4)
    v_mfma_f32_32x32x16_bf16 v[16:31], v[56:59], v[192:195], v[16:31]
    v_mfma_f32_32x32x16_bf16 v[32:47], v[60:63], v[192:195], v[32:47]
    buffer_load_dwordx4 v[220:223], v1, s[16:19], s68 offen offset:0 sc1
    buffer_load_dwordx4 v[64:67], v1, s[16:19], s29 offen sc1
    ds_read_b64_tr_b16 v[56:57], v3 offset:38912
    ds_read_b64_tr_b16 v[58:59], v3 offset:39424
    ds_read_b64_tr_b16 v[60:61], v14 offset:38912
    ds_read_b64_tr_b16 v[62:63], v14 offset:39424
    s_waitcnt vmcnt(7)
    s_waitcnt lgkmcnt(4)
    v_mfma_f32_32x32x16_bf16 v[16:31], v[48:51], v[196:199], v[16:31]
    v_mfma_f32_32x32x16_bf16 v[32:47], v[52:55], v[196:199], v[32:47]
    buffer_load_dwordx4 v[224:227], v1, s[16:19], s68 offen offset:1024 sc1
    ds_read_b64_tr_b16 v[48:49], v3 offset:40960
    ds_read_b64_tr_b16 v[50:51], v3 offset:41472
    ds_read_b64_tr_b16 v[52:53], v14 offset:40960
    ds_read_b64_tr_b16 v[54:55], v14 offset:41472
    s_waitcnt vmcnt(7)
    s_waitcnt lgkmcnt(4)
    v_mfma_f32_32x32x16_bf16 v[16:31], v[56:59], v[200:203], v[16:31]
    v_mfma_f32_32x32x16_bf16 v[32:47], v[60:63], v[200:203], v[32:47]
    buffer_load_dwordx4 v[228:231], v1, s[16:19], s68 offen offset:2048 sc1
    ds_read_b64_tr_b16 v[56:57], v3 offset:43008
    ds_read_b64_tr_b16 v[58:59], v3 offset:43520
    ds_read_b64_tr_b16 v[60:61], v14 offset:43008
    ds_read_b64_tr_b16 v[62:63], v14 offset:43520
    s_waitcnt vmcnt(7)
    s_waitcnt lgkmcnt(4)
    v_mfma_f32_32x32x16_bf16 v[16:31], v[48:51], v[204:207], v[16:31]
    v_mfma_f32_32x32x16_bf16 v[32:47], v[52:55], v[204:207], v[32:47]
    buffer_load_dwordx4 v[232:235], v1, s[16:19], s68 offen offset:3072 sc1
    s_add_u32 s68, s68, 4096
    ds_read_b64_tr_b16 v[48:49], v3 offset:45056
    ds_read_b64_tr_b16 v[50:51], v3 offset:45568
    ds_read_b64_tr_b16 v[52:53], v14 offset:45056
    ds_read_b64_tr_b16 v[54:55], v14 offset:45568
    s_waitcnt vmcnt(7)
    s_waitcnt lgkmcnt(4)
    v_mfma_f32_32x32x16_bf16 v[16:31], v[56:59], v[208:211], v[16:31]
    v_mfma_f32_32x32x16_bf16 v[32:47], v[60:63], v[208:211], v[32:47]
    buffer_load_dwordx4 v[236:239], v1, s[16:19], s68 offen offset:0 sc1
    ds_read_b64_tr_b16 v[56:57], v3 offset:47104
    ds_read_b64_tr_b16 v[58:59], v3 offset:47616
    ds_read_b64_tr_b16 v[60:61], v14 offset:47104
    ds_read_b64_tr_b16 v[62:63], v14 offset:47616
    s_waitcnt vmcnt(7)
    s_waitcnt lgkmcnt(4)
    v_mfma_f32_32x32x16_bf16 v[16:31], v[48:51], v[212:215], v[16:31]
    v_mfma_f32_32x32x16_bf16 v[32:47], v[52:55], v[212:215], v[32:47]
    buffer_load_dwordx4 v[240:243], v1, s[16:19], s68 offen offset:1024 sc1
    ds_read_b64_tr_b16 v[48:49], v3 offset:49152
    ds_read_b64_tr_b16 v[50:51], v3 offset:49664
    ds_read_b64_tr_b16 v[52:53], v14 offset:49152
    ds_read_b64_tr_b16 v[54:55], v14 offset:49664
    s_waitcnt vmcnt(7)
    s_waitcnt lgkmcnt(4)
    v_mfma_f32_32x32x16_bf16 v[16:31], v[56:59], v[216:219], v[16:31]
    v_mfma_f32_32x32x16_bf16 v[32:47], v[60:63], v[216:219], v[32:47]
    buffer_load_dwordx4 v[244:247], v1, s[16:19], s68 offen offset:2048 sc1
    ds_read_b64_tr_b16 v[56:57], v3 offset:51200
    ds_read_b64_tr_b16 v[58:59], v3 offset:51712
    ds_read_b64_tr_b16 v[60:61], v14 offset:51200
    ds_read_b64_tr_b16 v[62:63], v14 offset:51712
    s_waitcnt vmcnt(7)
    s_waitcnt lgkmcnt(4)
    v_mfma_f32_32x32x16_bf16 v[16:31], v[48:51], v[220:223], v[16:31]
    v_mfma_f32_32x32x16_bf16 v[32:47], v[52:55], v[220:223], v[32:47]
    buffer_load_dwordx4 v[248:251], v1, s[16:19], s68 offen offset:3072 sc1
    s_add_u32 s68, s68, 4096
    ds_read_b64_tr_b16 v[48:49], v3 offset:53248
    ds_read_b64_tr_b16 v[50:51], v3 offset:53760
    ds_read_b64_tr_b16 v[52:53], v14 offset:53248
    ds_read_b64_tr_b16 v[54:55], v14 offset:53760
    s_waitcnt vmcnt(6)
    s_waitcnt lgkmcnt(4)
    v_mfma_f32_32x32x16_bf16 v[16:31], v[56:59], v[224:227], v[16:31]
    v_mfma_f32_32x32x16_bf16 v[32:47], v[60:63], v[224:227], v[32:47]
    v_xor_b32 v64, s23, v64
    v_xor_b32 v65, s23, v65
    v_xor_b32 v66, s23, v66
    v_xor_b32 v67, s23, v67
    v_or3_b32 v64, v64, v65, v66
    v_or_b32 v64, v64, v67
    v_cmp_ne_u32 vcc, 0, v64
    s_nop 1
    s_cbranch_vccz LadaLN_cond__grouped_kv_mqa__dense_activation_relu__prompt_kernel_kvok26
    s_mov_b32 s67, 400000
LadaLN_cond__grouped_kv_mqa__dense_activation_relu__prompt_kernel_poll27:
    buffer_load_dwordx4 v[64:67], v1, s[16:19], s29 offen sc1
    s_waitcnt vmcnt(0)
    v_xor_b32 v64, s23, v64
    v_xor_b32 v65, s23, v65
    v_xor_b32 v66, s23, v66
    v_xor_b32 v67, s23, v67
    v_or3_b32 v64, v64, v65, v66
    v_or_b32 v64, v64, v67
    v_cmp_ne_u32 vcc, 0, v64
    s_nop 1
    s_cbranch_vccz LadaLN_cond__grouped_kv_mqa__dense_activation_relu__prompt_kernel_pok28
    s_sleep 1
    s_sub_u32 s67, s67, 1
    s_cbranch_scc0 LadaLN_cond__grouped_kv_mqa__dense_activation_relu__prompt_kernel_poll27
    s_branch LadaLN_cond__grouped_kv_mqa__dense_activation_relu__prompt_kernel_exit
LadaLN_cond__grouped_kv_mqa__dense_activation_relu__prompt_kernel_pok28:
LadaLN_cond__grouped_kv_mqa__dense_activation_relu__prompt_kernel_kvok26:
    s_add_u32 m0, s70, 32768
    s_nop 0
    buffer_load_dwordx4 v1, s[16:19], s69 offen sc1 lds
    buffer_load_dwordx4 v1, s[16:19], s69 offen offset:1024 sc1 lds
    s_add_u32 s69, s69, 16384
    s_add_u32 m0, s70, 49152
    s_nop 0
    buffer_load_dwordx4 v1, s[16:19], s69 offen sc1 lds
    buffer_load_dwordx4 v1, s[16:19], s69 offen offset:1024 sc1 lds
    s_add_u32 s69, s69, 16384
    ds_read_b64_tr_b16 v[56:57], v3 offset:55296
    ds_read_b64_tr_b16 v[58:59], v3 offset:55808
    ds_read_b64_tr_b16 v[60:61], v14 offset:55296
    ds_read_b64_tr_b16 v[62:63], v14 offset:55808
    s_waitcnt vmcnt(9)
    s_waitcnt lgkmcnt(4)
    v_mfma_f32_32x32x16_bf16 v[16:31], v[48:51], v[228:231], v[16:31]
    v_mfma_f32_32x32x16_bf16 v[32:47], v[52:55], v[228:231], v[32:47]
    ds_read_b64_tr_b16 v[48:49], v3 offset:57344
    ds_read_b64_tr_b16 v[50:51], v3 offset:57856
    ds_read_b64_tr_b16 v[52:53], v14 offset:57344
    ds_read_b64_tr_b16 v[54:55], v14 offset:57856
    s_waitcnt vmcnt(8)
    s_waitcnt lgkmcnt(4)
    v_mfma_f32_32x32x16_bf16 v[16:31], v[56:59], v[232:235], v[16:31]
    v_mfma_f32_32x32x16_bf16 v[32:47], v[60:63], v[232:235], v[32:47]
    ds_read_b64_tr_b16 v[56:57], v3 offset:59392
    ds_read_b64_tr_b16 v[58:59], v3 offset:59904
    ds_read_b64_tr_b16 v[60:61], v14 offset:59392
    ds_read_b64_tr_b16 v[62:63], v14 offset:59904
    s_waitcnt vmcnt(7)
    s_waitcnt lgkmcnt(4)
    v_mfma_f32_32x32x16_bf16 v[16:31], v[48:51], v[236:239], v[16:31]
    v_mfma_f32_32x32x16_bf16 v[32:47], v[52:55], v[236:239], v[32:47]
    ds_read_b64_tr_b16 v[48:49], v3 offset:61440
    ds_read_b64_tr_b16 v[50:51], v3 offset:61952
    ds_read_b64_tr_b16 v[52:53], v14 offset:61440
    ds_read_b64_tr_b16 v[54:55], v14 offset:61952
    s_waitcnt vmcnt(6)
    s_waitcnt lgkmcnt(4)
    v_mfma_f32_32x32x16_bf16 v[16:31], v[56:59], v[240:243], v[16:31]
    v_mfma_f32_32x32x16_bf16 v[32:47], v[60:63], v[240:243], v[32:47]
    ds_read_b64_tr_b16 v[56:57], v3 offset:63488
    ds_read_b64_tr_b16 v[58:59], v3 offset:64000
    ds_read_b64_tr_b16 v[60:61], v14 offset:63488
    ds_read_b64_tr_b16 v[62:63], v14 offset:64000
    s_waitcnt vmcnt(5)
    s_waitcnt lgkmcnt(4)
    v_mfma_f32_32x32x16_bf16 v[16:31], v[48:51], v[244:247], v[16:31]
    v_mfma_f32_32x32x16_bf16 v[32:47], v[52:55], v[244:247], v[32:47]
    s_waitcnt vmcnt(4)
    s_waitcnt lgkmcnt(0)
    v_mfma_f32_32x32x16_bf16 v[16:31], v[56:59], v[248:251], v[16:31]
    v_mfma_f32_32x32x16_bf16 v[32:47], v[60:63], v[248:251], v[32:47]
    s_or_b32 s71, s2, s20
    s_cmp_lg_u32 s71, 0
    s_cbranch_scc1 LadaLN_cond__grouped_kv_mqa__dense_activation_relu__prompt_kernel_nn29
    s_mov_b32 s71, 0
    v_mov_b32 v64, s23
    s_mov_b64 exec, 1
    buffer_store_dword v64, off, s[16:19], s71 sc1
    s_mov_b64 exec, -1
LadaLN_cond__grouped_kv_mqa__dense_activation_relu__prompt_kernel_nn29:
    s_nop 7
    s_barrier
    ds_write_b128 v7, v[32:35] offset:0
    ds_write_b128 v7, v[36:39] offset:1024
    ds_write_b128 v7, v[40:43] offset:2048
    ds_write_b128 v7, v[44:47] offset:3072
    s_add_u32 m0, s70, 0
    s_nop 0
    buffer_load_dwordx4 v1, s[16:19], s69 offen sc1 lds
    buffer_load_dwordx4 v1, s[16:19], s69 offen offset:1024 sc1 lds
    s_add_u32 s69, s69, 16384
    s_waitcnt vmcnt(2) lgkmcnt(0)
    s_barrier
    ds_read_b128 v[32:35], v8 offset:0
    ds_read_b128 v[36:39], v8 offset:1024
    ds_read_b128 v[40:43], v8 offset:2048
    ds_read_b128 v[44:47], v8 offset:3072
    v_add_u32 v6, 98304, v1
    ds_read_b128 v[144:147], v6 offset:32768
    ds_read_b128 v[148:151], v6 offset:33792
    v_and_b32 v8, 1, v2
    v_cmp_eq_u32 vcc, 0, v8
    v_mov_b32 v7, 0x3f803f80
    v_and_b32 v8, 2, v2
    v_cndmask_b32 v60, 0, v7, vcc
    v_cndmask_b32 v61, 0, v7, vcc
    v_xor_b32 v62, v60, v7
    v_xor_b32 v63, v61, v7
    v_mul_u32_u24 v8, 0x5555, v8
    v_add_u32 v192, 0x4444, v8
    v_mov_b32 v56, 0
    v_mov_b32 v57, 0
    v_mov_b32 v58, 0
    v_mov_b32 v59, 0
    s_mov_b32 s71, 0x3e8293ee
    s_waitcnt lgkmcnt(5)
    v_add_f32 v16, v16, v32
    v_add_f32 v17, v17, v33
    v_add_f32 v18, v18, v34
    v_add_f32 v19, v19, v35
    v_mul_f32 v16, s71, v16
    v_mul_f32 v17, s71, v17
    v_mul_f32 v18, s71, v18
    v_mul_f32 v19, s71, v19
    v_cvt_pk_bf16_f32 v160, v16, v17
    v_cvt_pk_bf16_f32 v161, v18, v19
    s_waitcnt lgkmcnt(4)
    v_add_f32 v20, v20, v36
    v_add_f32 v21, v21, v37
    v_add_f32 v22, v22, v38
    v_add_f32 v23, v23, v39
    v_mul_f32 v20, s71, v20
    v_mul_f32 v21, s71, v21
    v_mul_f32 v22, s71, v22
    v_mul_f32 v23, s71, v23
    v_cvt_pk_bf16_f32 v162, v20, v21
    v_cvt_pk_bf16_f32 v163, v22, v23
    s_waitcnt lgkmcnt(3)
    v_add_f32 v24, v24, v40
    v_add_f32 v25, v25, v41
    v_add_f32 v26, v26, v42
    v_add_f32 v27, v27, v43
    v_mul_f32 v24, s71, v24
    v_mul_f32 v25, s71, v25
    v_mul_f32 v26, s71, v26
    v_mul_f32 v27, s71, v27
    v_cvt_pk_bf16_f32 v164, v24, v25
    v_cvt_pk_bf16_f32 v165, v26, v27
    s_waitcnt lgkmcnt(2)
    v_add_f32 v28, v28, v44
    v_add_f32 v29, v29, v45
    v_add_f32 v30, v30, v46
    v_add_f32 v31, v31, v47
    v_mul_f32 v28, s71, v28
    v_mul_f32 v29, s71, v29
    v_mul_f32 v30, s71, v30
    v_mul_f32 v31, s71, v31
    v_cvt_pk_bf16_f32 v166, v28, v29
    v_cvt_pk_bf16_f32 v167, v30, v31
LadaLN_cond__grouped_kv_mqa__dense_activation_relu__prompt_kernel_ccode:
    s_waitcnt lgkmcnt(0)
    v_mfma_f32_32x32x16_bf16 v[32:47], v[144:147], v[160:163], 0
    v_mfma_f32_32x32x16_bf16 v[32:47], v[148:151], v[164:167], v[32:47]
    s_nop 11
    v_max3_f32 v8, v32, v33, v34
    v_max3_f32 v8, v8, v35, v36
    v_max3_f32 v8, v8, v37, v38
    v_max3_f32 v8, v8, v39, v40
    v_max3_f32 v8, v8, v41, v42
    v_max3_f32 v8, v8, v43, v44
    v_max3_f32 v8, v8, v45, v46
    v_max_f32 v8, v8, v47
    v_mov_b32 v7, v8
    s_nop 1
    v_permlane32_swap_b32 v8, v7
    s_nop 0
    v_max_f32 v8, v8, v7
    v_sub_f32 v168, 0xc1c00000, v8
    v_mov_b32 v169, v168
    v_mov_b32 v170, v168
    v_mov_b32 v171, v168
    v_mov_b32 v172, v168
    v_mov_b32 v173, v168
    v_mov_b32 v174, v168
    v_mov_b32 v175, v168
    v_mov_b32 v176, v168
    v_mov_b32 v177, v168
    v_mov_b32 v178, v168
    v_mov_b32 v179, v168
    v_mov_b32 v180, v168
    v_mov_b32 v181, v168
    v_mov_b32 v182, v168
    v_mov_b32 v183, v168
    s_nop 1
    v_mfma_f32_32x32x16_bf16 v[16:31], v[144:147], v[160:163], v[168:183]
    v_mfma_f32_32x32x16_bf16 v[16:31], v[148:151], v[164:167], v[16:31]
    ds_read_b128 v[144:147], v6 offset:36864
    ds_read_b128 v[156:159], v6 offset:35840
    ds_read_b128 v[148:151], v6 offset:37888
    ds_read_b128 v[152:155], v6 offset:34816
    s_cmp_lt_u32 s20, 4
    s_cbranch_scc1 LadaLN_cond__grouped_kv_mqa__dense_activation_relu__prompt_kernel_pr30
    s_setprio 1
LadaLN_cond__grouped_kv_mqa__dense_activation_relu__prompt_kernel_pr30:
    s_nop 7
    s_waitcnt lgkmcnt(3)
    v_mfma_f32_32x32x16_bf16 v[32:47], v[144:147], v[160:163], v[168:183]
    ds_read_b128 v[144:147], v6 offset:40960
    v_exp_f32 v16, v16
    v_exp_f32 v17, v17
    v_exp_f32 v18, v18
    v_exp_f32 v19, v19
    s_waitcnt lgkmcnt(3)
    ds_read_b128 v[156:159], v6 offset:35840
    s_barrier
    s_add_u32 m0, s70, 16384
    v_cvt_pk_bf16_f32 v184, v16, v17
    v_cvt_pk_bf16_f32 v185, v18, v19
    v_exp_f32 v20, v20
    v_exp_f32 v21, v21
    buffer_load_dwordx4 v1, s[16:19], s69 offen sc1 lds
    buffer_load_dwordx4 v1, s[16:19], s69 offen offset:1024 sc1 lds
    s_add_u32 s69, s69, 16384
    s_waitcnt lgkmcnt(3)
    v_mfma_f32_32x32x16_bf16 v[32:47], v[148:151], v[164:167], v[32:47]
    ds_read_b128 v[148:151], v6 offset:41984
    v_exp_f32 v22, v22
    v_exp_f32 v23, v23
    v_cvt_pk_bf16_f32 v186, v20, v21
    v_cvt_pk_bf16_f32 v187, v22, v23
    v_exp_f32 v24, v24
    v_exp_f32 v25, v25
    v_exp_f32 v26, v26
    v_exp_f32 v27, v27
    s_waitcnt lgkmcnt(3)
    v_mfma_f32_32x32x16_bf16 v[128:143], v[152:155], v[184:187], 0
    ds_read_b128 v[152:155], v6 offset:38912
    v_cvt_pk_bf16_f32 v188, v24, v25
    v_cvt_pk_bf16_f32 v189, v26, v27
    v_exp_f32 v28, v28
    v_exp_f32 v29, v29
    v_exp_f32 v30, v30
    v_exp_f32 v31, v31
    v_cvt_pk_bf16_f32 v190, v28, v29
    v_cvt_pk_bf16_f32 v191, v30, v31
    s_waitcnt lgkmcnt(3)
    v_mfma_f32_32x32x16_bf16 v[16:31], v[144:147], v[160:163], v[168:183]
    ds_read_b128 v[144:147], v6 offset:45056
    v_exp_f32 v32, v32
    v_exp_f32 v33, v33
    v_exp_f32 v34, v34
    v_exp_f32 v35, v35
    s_waitcnt lgkmcnt(3)
    v_mfma_f32_32x32x16_bf16 v[128:143], v[156:159], v[188:191], v[128:143]
    ds_read_b128 v[156:159], v6 offset:39936
    v_cvt_pk_bf16_f32 v48, v32, v33
    v_cvt_pk_bf16_f32 v49, v34, v35
    v_exp_f32 v36, v36
    v_exp_f32 v37, v37
    buffer_load_dword v64, v15, s[8:11], s78 offen
    s_waitcnt lgkmcnt(3)
    v_mfma_f32_32x32x16_bf16 v[16:31], v[148:151], v[164:167], v[16:31]
    ds_read_b128 v[148:151], v6 offset:46080
    v_exp_f32 v38, v38
    v_exp_f32 v39, v39
    v_cvt_pk_bf16_f32 v50, v36, v37
    v_cvt_pk_bf16_f32 v51, v38, v39
    v_smfmac_f32_16x16x64_bf16 v[56:59], v[60:63], v[184:191], v192
    v_exp_f32 v40, v40
    v_exp_f32 v41, v41
    v_exp_f32 v42, v42
    v_exp_f32 v43, v43
    s_waitcnt lgkmcnt(3)
    v_mfma_f32_32x32x16_bf16 v[128:143], v[152:155], v[48:51], v[128:143]
    ds_read_b128 v[152:155], v6 offset:43008
    v_cvt_pk_bf16_f32 v52, v40, v41
    v_cvt_pk_bf16_f32 v53, v42, v43
    v_exp_f32 v44, v44
    v_exp_f32 v45, v45
    v_exp_f32 v46, v46
    v_exp_f32 v47, v47
    v_cvt_pk_bf16_f32 v54, v44, v45
    v_cvt_pk_bf16_f32 v55, v46, v47
    s_waitcnt lgkmcnt(3)
    v_mfma_f32_32x32x16_bf16 v[32:47], v[144:147], v[160:163], v[168:183]
    ds_read_b128 v[144:147], v6 offset:49152
    v_exp_f32 v16, v16
    v_exp_f32 v17, v17
    v_exp_f32 v18, v18
    v_exp_f32 v19, v19
    s_waitcnt lgkmcnt(3)
    v_mfma_f32_32x32x16_bf16 v[128:143], v[156:159], v[52:55], v[128:143]
    ds_read_b128 v[156:159], v6 offset:44032
    v_cvt_pk_bf16_f32 v184, v16, v17
    v_cvt_pk_bf16_f32 v185, v18, v19
    v_exp_f32 v20, v20
    v_exp_f32 v21, v21
    buffer_load_dword v65, v15, s[84:87], s83 offen
    s_add_u32 s83, s83, 1024
    s_waitcnt lgkmcnt(3)
    v_mfma_f32_32x32x16_bf16 v[32:47], v[148:151], v[164:167], v[32:47]
    ds_read_b128 v[148:151], v6 offset:50176
    v_exp_f32 v22, v22
    v_exp_f32 v23, v23
    v_cvt_pk_bf16_f32 v186, v20, v21
    v_cvt_pk_bf16_f32 v187, v22, v23
    v_smfmac_f32_16x16x64_bf16 v[56:59], v[60:63], v[48:55], v192
    v_exp_f32 v24, v24
    v_exp_f32 v25, v25
    v_exp_f32 v26, v26
    v_exp_f32 v27, v27
    s_waitcnt lgkmcnt(3)
    v_mfma_f32_32x32x16_bf16 v[128:143], v[152:155], v[184:187], v[128:143]
    ds_read_b128 v[152:155], v6 offset:47104
    v_cvt_pk_bf16_f32 v188, v24, v25
    v_cvt_pk_bf16_f32 v189, v26, v27
    v_exp_f32 v28, v28
    v_exp_f32 v29, v29
    v_exp_f32 v30, v30
    v_exp_f32 v31, v31
    v_cvt_pk_bf16_f32 v190, v28, v29
    v_cvt_pk_bf16_f32 v191, v30, v31
    s_waitcnt lgkmcnt(3)
    v_mfma_f32_32x32x16_bf16 v[16:31], v[144:147], v[160:163], v[168:183]
    ds_read_b128 v[144:147], v6 offset:53248
    v_exp_f32 v32, v32
    v_exp_f32 v33, v33
    v_exp_f32 v34, v34
    v_exp_f32 v35, v35
    s_waitcnt lgkmcnt(3)
    v_mfma_f32_32x32x16_bf16 v[128:143], v[156:159], v[188:191], v[128:143]
    ds_read_b128 v[156:159], v6 offset:48128
    v_cvt_pk_bf16_f32 v48, v32, v33
    v_cvt_pk_bf16_f32 v49, v34, v35
    v_exp_f32 v36, v36
    v_exp_f32 v37, v37
    s_waitcnt lgkmcnt(3)
    v_mfma_f32_32x32x16_bf16 v[16:31], v[148:151], v[164:167], v[16:31]
    ds_read_b128 v[148:151], v6 offset:54272
    v_exp_f32 v38, v38
    v_exp_f32 v39, v39
    v_cvt_pk_bf16_f32 v50, v36, v37
    v_cvt_pk_bf16_f32 v51, v38, v39
    v_smfmac_f32_16x16x64_bf16 v[56:59], v[60:63], v[184:191], v192
    v_exp_f32 v40, v40
    v_exp_f32 v41, v41
    v_exp_f32 v42, v42
    v_exp_f32 v43, v43
    s_waitcnt lgkmcnt(3)
    v_mfma_f32_32x32x16_bf16 v[128:143], v[152:155], v[48:51], v[128:143]
    ds_read_b128 v[152:155], v6 offset:51200
    v_cvt_pk_bf16_f32 v52, v40, v41
    v_cvt_pk_bf16_f32 v53, v42, v43
    v_exp_f32 v44, v44
    v_exp_f32 v45, v45
    v_exp_f32 v46, v46
    v_exp_f32 v47, v47
    v_cvt_pk_bf16_f32 v54, v44, v45
    v_cvt_pk_bf16_f32 v55, v46, v47
    s_waitcnt lgkmcnt(3)
    v_mfma_f32_32x32x16_bf16 v[32:47], v[144:147], v[160:163], v[168:183]
    ds_read_b128 v[144:147], v6 offset:57344
    v_exp_f32 v16, v16
    v_exp_f32 v17, v17
    v_exp_f32 v18, v18
    v_exp_f32 v19, v19
    s_waitcnt lgkmcnt(3)
    v_mfma_f32_32x32x16_bf16 v[128:143], v[156:159], v[52:55], v[128:143]
    ds_read_b128 v[156:159], v6 offset:52224
    s_waitcnt vmcnt(4)
    s_barrier
    s_add_u32 m0, s70, 32768
    v_cvt_pk_bf16_f32 v184, v16, v17
    v_cvt_pk_bf16_f32 v185, v18, v19
    v_exp_f32 v20, v20
    v_exp_f32 v21, v21
    buffer_load_dwordx4 v1, s[16:19], s69 offen sc1 lds
    buffer_load_dwordx4 v1, s[16:19], s69 offen offset:1024 sc1 lds
    s_add_u32 s69, s69, 16384
    s_waitcnt lgkmcnt(3)
    v_mfma_f32_32x32x16_bf16 v[32:47], v[148:151], v[164:167], v[32:47]
    ds_read_b128 v[148:151], v6 offset:58368
    v_exp_f32 v22, v22
    v_exp_f32 v23, v23
    v_cvt_pk_bf16_f32 v186, v20, v21
    v_cvt_pk_bf16_f32 v187, v22, v23
    v_smfmac_f32_16x16x64_bf16 v[56:59], v[60:63], v[48:55], v192
    v_exp_f32 v24, v24
    v_exp_f32 v25, v25
    v_exp_f32 v26, v26
    v_exp_f32 v27, v27
    s_waitcnt lgkmcnt(3)
    v_mfma_f32_32x32x16_bf16 v[128:143], v[152:155], v[184:187], v[128:143]
    ds_read_b128 v[152:155], v6 offset:55296
    v_cvt_pk_bf16_f32 v188, v24, v25
    v_cvt_pk_bf16_f32 v189, v26, v27
    v_exp_f32 v28, v28
    v_exp_f32 v29, v29
    v_exp_f32 v30, v30
    v_exp_f32 v31, v31
    v_cvt_pk_bf16_f32 v190, v28, v29
    v_cvt_pk_bf16_f32 v191, v30, v31
    s_waitcnt lgkmcnt(3)
    v_mfma_f32_32x32x16_bf16 v[16:31], v[144:147], v[160:163], v[168:183]
    ds_read_b128 v[144:147], v6 offset:61440
    v_exp_f32 v32, v32
    v_exp_f32 v33, v33
    v_exp_f32 v34, v34
    v_exp_f32 v35, v35
    s_waitcnt lgkmcnt(3)
    v_mfma_f32_32x32x16_bf16 v[128:143], v[156:159], v[188:191], v[128:143]
    ds_read_b128 v[156:159], v6 offset:56320
    v_cvt_pk_bf16_f32 v48, v32, v33
    v_cvt_pk_bf16_f32 v49, v34, v35
    v_exp_f32 v36, v36
    v_exp_f32 v37, v37
    buffer_load_dword v90, v13, s[16:19], 0 offen
    s_waitcnt lgkmcnt(3)
    v_mfma_f32_32x32x16_bf16 v[16:31], v[148:151], v[164:167], v[16:31]
    ds_read_b128 v[148:151], v6 offset:62464
    v_exp_f32 v38, v38
    v_exp_f32 v39, v39
    v_cvt_pk_bf16_f32 v50, v36, v37
    v_cvt_pk_bf16_f32 v51, v38, v39
    v_smfmac_f32_16x16x64_bf16 v[56:59], v[60:63], v[184:191], v192
    v_exp_f32 v40, v40
    v_exp_f32 v41, v41
    v_exp_f32 v42, v42
    v_exp_f32 v43, v43
    s_waitcnt lgkmcnt(3)
    v_mfma_f32_32x32x16_bf16 v[128:143], v[152:155], v[48:51], v[128:143]
    ds_read_b128 v[152:155], v6 offset:59392
    v_cvt_pk_bf16_f32 v52, v40, v41
    v_cvt_pk_bf16_f32 v53, v42, v43
    v_exp_f32 v44, v44
    v_exp_f32 v45, v45
    v_exp_f32 v46, v46
    v_exp_f32 v47, v47
    v_cvt_pk_bf16_f32 v54, v44, v45
    v_cvt_pk_bf16_f32 v55, v46, v47
    s_waitcnt lgkmcnt(3)
    v_mfma_f32_32x32x16_bf16 v[32:47], v[144:147], v[160:163], v[168:183]
    ds_read_b128 v[144:147], v6 offset:0
    v_exp_f32 v16, v16
    v_exp_f32 v17, v17
    v_exp_f32 v18, v18
    v_exp_f32 v19, v19
    s_waitcnt lgkmcnt(3)
    v_mfma_f32_32x32x16_bf16 v[128:143], v[156:159], v[52:55], v[128:143]
    ds_read_b128 v[156:159], v6 offset:60416
    v_cvt_pk_bf16_f32 v184, v16, v17
    v_cvt_pk_bf16_f32 v185, v18, v19
    v_exp_f32 v20, v20
    v_exp_f32 v21, v21
    buffer_store_dwordx4 v[92:95], v1, s[16:19], s82 offen offset:0 sc1
    s_waitcnt lgkmcnt(3)
    v_mfma_f32_32x32x16_bf16 v[32:47], v[148:151], v[164:167], v[32:47]
    ds_read_b128 v[148:151], v6 offset:1024
    v_exp_f32 v22, v22
    v_exp_f32 v23, v23
    v_cvt_pk_bf16_f32 v186, v20, v21
    v_cvt_pk_bf16_f32 v187, v22, v23
    v_smfmac_f32_16x16x64_bf16 v[56:59], v[60:63], v[48:55], v192
    v_exp_f32 v24, v24
    v_exp_f32 v25, v25
    v_exp_f32 v26, v26
    v_exp_f32 v27, v27
    s_waitcnt lgkmcnt(3)
    v_mfma_f32_32x32x16_bf16 v[128:143], v[152:155], v[184:187], v[128:143]
    ds_read_b128 v[152:155], v6 offset:63488
    v_cvt_pk_bf16_f32 v188, v24, v25
    v_cvt_pk_bf16_f32 v189, v26, v27
    v_exp_f32 v28, v28
    v_exp_f32 v29, v29
    v_exp_f32 v30, v30
    v_exp_f32 v31, v31
    v_cvt_pk_bf16_f32 v190, v28, v29
    v_cvt_pk_bf16_f32 v191, v30, v31
    s_waitcnt lgkmcnt(3)
    v_mfma_f32_32x32x16_bf16 v[16:31], v[144:147], v[160:163], v[168:183]
    ds_read_b128 v[144:147], v6 offset:4096
    v_exp_f32 v32, v32
    v_exp_f32 v33, v33
    v_exp_f32 v34, v34
    v_exp_f32 v35, v35
    s_waitcnt lgkmcnt(3)
    v_mfma_f32_32x32x16_bf16 v[128:143], v[156:159], v[188:191], v[128:143]
    ds_read_b128 v[156:159], v6 offset:64512
    v_cvt_pk_bf16_f32 v48, v32, v33
    v_cvt_pk_bf16_f32 v49, v34, v35
    v_exp_f32 v36, v36
    v_exp_f32 v37, v37
    buffer_load_dword v66, v15, s[84:87], s83 offen
    s_add_u32 s83, s83, 1024
    s_waitcnt lgkmcnt(3)
    v_mfma_f32_32x32x16_bf16 v[16:31], v[148:151], v[164:167], v[16:31]
    ds_read_b128 v[148:151], v6 offset:5120
    v_exp_f32 v38, v38
    v_exp_f32 v39, v39
    v_cvt_pk_bf16_f32 v50, v36, v37
    v_cvt_pk_bf16_f32 v51, v38, v39
    v_smfmac_f32_16x16x64_bf16 v[56:59], v[60:63], v[184:191], v192
    v_exp_f32 v40, v40
    v_exp_f32 v41, v41
    v_exp_f32 v42, v42
    v_exp_f32 v43, v43
    s_waitcnt lgkmcnt(3)
    v_mfma_f32_32x32x16_bf16 v[128:143], v[152:155], v[48:51], v[128:143]
    ds_read_b128 v[152:155], v6 offset:2048
    v_cvt_pk_bf16_f32 v52, v40, v41
    v_cvt_pk_bf16_f32 v53, v42, v43
    v_exp_f32 v44, v44
    v_exp_f32 v45, v45
    v_exp_f32 v46, v46
    v_exp_f32 v47, v47
    v_cvt_pk_bf16_f32 v54, v44, v45
    v_cvt_pk_bf16_f32 v55, v46, v47
    s_waitcnt lgkmcnt(3)
    v_mfma_f32_32x32x16_bf16 v[32:47], v[144:147], v[160:163], v[168:183]
    ds_read_b128 v[144:147], v6 offset:8192
    v_exp_f32 v16, v16
    v_exp_f32 v17, v17
    v_exp_f32 v18, v18
    v_exp_f32 v19, v19
    s_waitcnt lgkmcnt(3)
    v_mfma_f32_32x32x16_bf16 v[128:143], v[156:159], v[52:55], v[128:143]
    ds_read_b128 v[156:159], v6 offset:3072
    s_waitcnt vmcnt(7)
    s_barrier
    s_add_u32 m0, s70, 49152
    v_cvt_pk_bf16_f32 v184, v16, v17
    v_cvt_pk_bf16_f32 v185, v18, v19
    v_exp_f32 v20, v20
    v_exp_f32 v21, v21
    buffer_load_dwordx4 v1, s[16:19], s69 offen sc1 lds
    s_branch LadaLN_cond__grouped_kv_mqa__dense_activation_relu__prompt_kernel_over3
LadaLN_cond__grouped_kv_mqa__dense_activation_relu__prompt_kernel_stub3:
    s_setpc_b64 s[96:97]
LadaLN_cond__grouped_kv_mqa__dense_activation_relu__prompt_kernel_over3:
    buffer_load_dwordx4 v1, s[16:19], s69 offen offset:1024 sc1 lds
    s_add_u32 s69, s69, 16384
    s_waitcnt lgkmcnt(3)
    v_mfma_f32_32x32x16_bf16 v[32:47], v[148:151], v[164:167], v[32:47]
    ds_read_b128 v[148:151], v6 offset:9216
    v_exp_f32 v22, v22
    v_exp_f32 v23, v23
    v_cvt_pk_bf16_f32 v186, v20, v21
    v_cvt_pk_bf16_f32 v187, v22, v23
    v_smfmac_f32_16x16x64_bf16 v[56:59], v[60:63], v[48:55], v192
    v_exp_f32 v24, v24
    v_exp_f32 v25, v25
    v_exp_f32 v26, v26
    v_exp_f32 v27, v27
    s_waitcnt lgkmcnt(3)
    v_mfma_f32_32x32x16_bf16 v[128:143], v[152:155], v[184:187], v[128:143]
    ds_read_b128 v[152:155], v6 offset:6144
    v_cvt_pk_bf16_f32 v188, v24, v25
    v_cvt_pk_bf16_f32 v189, v26, v27
    v_exp_f32 v28, v28
    v_exp_f32 v29, v29
    v_exp_f32 v30, v30
    v_exp_f32 v31, v31
    v_cvt_pk_bf16_f32 v190, v28, v29
    v_cvt_pk_bf16_f32 v191, v30, v31
    s_waitcnt lgkmcnt(3)
    v_mfma_f32_32x32x16_bf16 v[16:31], v[144:147], v[160:163], v[168:183]
    ds_read_b128 v[144:147], v6 offset:12288
    v_exp_f32 v32, v32
    v_exp_f32 v33, v33
    v_exp_f32 v34, v34
    v_exp_f32 v35, v35
    s_waitcnt lgkmcnt(3)
    v_mfma_f32_32x32x16_bf16 v[128:143], v[156:159], v[188:191], v[128:143]
    ds_read_b128 v[156:159], v6 offset:7168
    v_cvt_pk_bf16_f32 v48, v32, v33
    v_cvt_pk_bf16_f32 v49, v34, v35
    v_exp_f32 v36, v36
    v_exp_f32 v37, v37
    buffer_load_dwordx4 v[96:99], v12, s[12:15], s76 offen nt
    s_add_u32 s76, s76, 12288
    s_waitcnt lgkmcnt(3)
    v_mfma_f32_32x32x16_bf16 v[16:31], v[148:151], v[164:167], v[16:31]
    ds_read_b128 v[148:151], v6 offset:13312
    v_exp_f32 v38, v38
    v_exp_f32 v39, v39
    v_cvt_pk_bf16_f32 v50, v36, v37
    v_cvt_pk_bf16_f32 v51, v38, v39
    v_smfmac_f32_16x16x64_bf16 v[56:59], v[60:63], v[184:191], v192
    v_exp_f32 v40, v40
    v_exp_f32 v41, v41
    v_exp_f32 v42, v42
    v_exp_f32 v43, v43
    s_waitcnt lgkmcnt(3)
    v_mfma_f32_32x32x16_bf16 v[128:143], v[152:155], v[48:51], v[128:143]
    ds_read_b128 v[152:155], v6 offset:10240
    v_cvt_pk_bf16_f32 v52, v40, v41
    v_cvt_pk_bf16_f32 v53, v42, v43
    v_exp_f32 v44, v44
    v_exp_f32 v45, v45
    v_exp_f32 v46, v46
    v_exp_f32 v47, v47
    v_cvt_pk_bf16_f32 v54, v44, v45
    v_cvt_pk_bf16_f32 v55, v46, v47
    s_waitcnt lgkmcnt(3)
    v_mfma_f32_32x32x16_bf16 v[32:47], v[144:147], v[160:163], v[168:183]
    ds_read_b128 v[144:147], v6 offset:16384
    v_exp_f32 v16, v16
    v_exp_f32 v17, v17
    v_exp_f32 v18, v18
    v_exp_f32 v19, v19
    s_waitcnt lgkmcnt(3)
    v_mfma_f32_32x32x16_bf16 v[128:143], v[156:159], v[52:55], v[128:143]
    ds_read_b128 v[156:159], v6 offset:11264
    v_cvt_pk_bf16_f32 v184, v16, v17
    v_cvt_pk_bf16_f32 v185, v18, v19
    v_exp_f32 v20, v20
    v_exp_f32 v21, v21
    buffer_load_dword v67, v15, s[84:87], s83 offen
    s_add_u32 s83, s83, 1024
    s_waitcnt lgkmcnt(3)
    v_mfma_f32_32x32x16_bf16 v[32:47], v[148:151], v[164:167], v[32:47]
    ds_read_b128 v[148:151], v6 offset:17408
    v_exp_f32 v22, v22
    v_exp_f32 v23, v23
    v_cvt_pk_bf16_f32 v186, v20, v21
    v_cvt_pk_bf16_f32 v187, v22, v23
    v_smfmac_f32_16x16x64_bf16 v[56:59], v[60:63], v[48:55], v192
    v_exp_f32 v24, v24
    v_exp_f32 v25, v25
    v_exp_f32 v26, v26
    v_exp_f32 v27, v27
    s_waitcnt lgkmcnt(3)
    v_mfma_f32_32x32x16_bf16 v[128:143], v[152:155], v[184:187], v[128:143]
    ds_read_b128 v[152:155], v6 offset:14336
    v_cvt_pk_bf16_f32 v188, v24, v25
    v_cvt_pk_bf16_f32 v189, v26, v27
    v_exp_f32 v28, v28
    v_exp_f32 v29, v29
    v_exp_f32 v30, v30
    v_exp_f32 v31, v31
    v_cvt_pk_bf16_f32 v190, v28, v29
    v_cvt_pk_bf16_f32 v191, v30, v31
    s_waitcnt lgkmcnt(3)
    v_mfma_f32_32x32x16_bf16 v[16:31], v[144:147], v[160:163], v[168:183]
    ds_read_b128 v[144:147], v6 offset:20480
    v_exp_f32 v32, v32
    v_exp_f32 v33, v33
    v_exp_f32 v34, v34
    v_exp_f32 v35, v35
    s_waitcnt lgkmcnt(3)
    v_mfma_f32_32x32x16_bf16 v[128:143], v[156:159], v[188:191], v[128:143]
    ds_read_b128 v[156:159], v6 offset:15360
    v_cvt_pk_bf16_f32 v48, v32, v33
    v_cvt_pk_bf16_f32 v49, v34, v35
    v_exp_f32 v36, v36
    v_exp_f32 v37, v37
    s_waitcnt lgkmcnt(3)
    v_mfma_f32_32x32x16_bf16 v[16:31], v[148:151], v[164:167], v[16:31]
    ds_read_b128 v[148:151], v6 offset:21504
    v_exp_f32 v38, v38
    v_exp_f32 v39, v39
    v_cvt_pk_bf16_f32 v50, v36, v37
    v_cvt_pk_bf16_f32 v51, v38, v39
    v_smfmac_f32_16x16x64_bf16 v[56:59], v[60:63], v[184:191], v192
    v_exp_f32 v40, v40
    v_exp_f32 v41, v41
    v_exp_f32 v42, v42
    v_exp_f32 v43, v43
    s_waitcnt lgkmcnt(3)
    v_mfma_f32_32x32x16_bf16 v[128:143], v[152:155], v[48:51], v[128:143]
    ds_read_b128 v[152:155], v6 offset:18432
    v_cvt_pk_bf16_f32 v52, v40, v41
    v_cvt_pk_bf16_f32 v53, v42, v43
    v_exp_f32 v44, v44
    v_exp_f32 v45, v45
    v_exp_f32 v46, v46
    v_exp_f32 v47, v47
    v_cvt_pk_bf16_f32 v54, v44, v45
    v_cvt_pk_bf16_f32 v55, v46, v47
    s_waitcnt lgkmcnt(3)
    v_mfma_f32_32x32x16_bf16 v[32:47], v[144:147], v[160:163], v[168:183]
    ds_read_b128 v[144:147], v6 offset:24576
    v_exp_f32 v16, v16
    v_exp_f32 v17, v17
    v_exp_f32 v18, v18
    v_exp_f32 v19, v19
    s_waitcnt lgkmcnt(3)
    v_mfma_f32_32x32x16_bf16 v[128:143], v[156:159], v[52:55], v[128:143]
    ds_read_b128 v[156:159], v6 offset:19456
    s_waitcnt vmcnt(7)
    s_barrier
    s_add_u32 m0, s70, 0
    v_cvt_pk_bf16_f32 v184, v16, v17
    v_cvt_pk_bf16_f32 v185, v18, v19
    v_exp_f32 v20, v20
    v_exp_f32 v21, v21
    buffer_load_dwordx4 v1, s[16:19], s69 offen sc1 lds
    buffer_load_dwordx4 v1, s[16:19], s69 offen offset:1024 sc1 lds
    s_add_u32 s69, s69, 16384
    s_waitcnt lgkmcnt(3)
    v_mfma_f32_32x32x16_bf16 v[32:47], v[148:151], v[164:167], v[32:47]
    ds_read_b128 v[148:151], v6 offset:25600
    v_exp_f32 v22, v22
    v_exp_f32 v23, v23
    v_cvt_pk_bf16_f32 v186, v20, v21
    v_cvt_pk_bf16_f32 v187, v22, v23
    v_smfmac_f32_16x16x64_bf16 v[56:59], v[60:63], v[48:55], v192
    v_exp_f32 v24, v24
    v_exp_f32 v25, v25
    v_exp_f32 v26, v26
    v_exp_f32 v27, v27
    s_waitcnt lgkmcnt(3)
    v_mfma_f32_32x32x16_bf16 v[128:143], v[152:155], v[184:187], v[128:143]
    ds_read_b128 v[152:155], v6 offset:22528
    v_cvt_pk_bf16_f32 v188, v24, v25
    v_cvt_pk_bf16_f32 v189, v26, v27
    v_exp_f32 v28, v28
    v_exp_f32 v29, v29
    v_exp_f32 v30, v30
    v_exp_f32 v31, v31
    v_cvt_pk_bf16_f32 v190, v28, v29
    v_cvt_pk_bf16_f32 v191, v30, v31
    s_waitcnt lgkmcnt(3)
    v_mfma_f32_32x32x16_bf16 v[16:31], v[144:147], v[160:163], v[168:183]
    ds_read_b128 v[144:147], v6 offset:28672
    v_exp_f32 v32, v32
    v_exp_f32 v33, v33
    v_exp_f32 v34, v34
    v_exp_f32 v35, v35
    s_waitcnt lgkmcnt(3)
    v_mfma_f32_32x32x16_bf16 v[128:143], v[156:159], v[188:191], v[128:143]
    ds_read_b128 v[156:159], v6 offset:23552
    v_cvt_pk_bf16_f32 v48, v32, v33
    v_cvt_pk_bf16_f32 v49, v34, v35
    v_exp_f32 v36, v36
    v_exp_f32 v37, v37
    buffer_load_dword v68, v15, s[84:87], s83 offen
    s_add_u32 s83, s83, 1024
    s_waitcnt lgkmcnt(3)
    v_mfma_f32_32x32x16_bf16 v[16:31], v[148:151], v[164:167], v[16:31]
    ds_read_b128 v[148:151], v6 offset:29696
    v_exp_f32 v38, v38
    v_exp_f32 v39, v39
    v_cvt_pk_bf16_f32 v50, v36, v37
    v_cvt_pk_bf16_f32 v51, v38, v39
    v_smfmac_f32_16x16x64_bf16 v[56:59], v[60:63], v[184:191], v192
    v_exp_f32 v40, v40
    v_exp_f32 v41, v41
    v_exp_f32 v42, v42
    v_exp_f32 v43, v43
    s_waitcnt lgkmcnt(3)
    v_mfma_f32_32x32x16_bf16 v[128:143], v[152:155], v[48:51], v[128:143]
    ds_read_b128 v[152:155], v6 offset:26624
    v_cvt_pk_bf16_f32 v52, v40, v41
    v_cvt_pk_bf16_f32 v53, v42, v43
    v_exp_f32 v44, v44
    v_exp_f32 v45, v45
    v_exp_f32 v46, v46
    v_exp_f32 v47, v47
    v_cvt_pk_bf16_f32 v54, v44, v45
    v_cvt_pk_bf16_f32 v55, v46, v47
    s_waitcnt lgkmcnt(3)
    v_mfma_f32_32x32x16_bf16 v[32:47], v[144:147], v[160:163], v[168:183]
    ds_read_b128 v[144:147], v6 offset:32768
    v_exp_f32 v16, v16
    v_exp_f32 v17, v17
    v_exp_f32 v18, v18
    v_exp_f32 v19, v19
    s_waitcnt lgkmcnt(3)
    v_mfma_f32_32x32x16_bf16 v[128:143], v[156:159], v[52:55], v[128:143]
    ds_read_b128 v[156:159], v6 offset:27648
    v_cvt_pk_bf16_f32 v184, v16, v17
    v_cvt_pk_bf16_f32 v185, v18, v19
    v_exp_f32 v20, v20
    v_exp_f32 v21, v21
    s_mov_b32 m0, s73
    s_add_u32 s73, s73, 16384
    buffer_load_dwordx4 v4, s[8:11], s72 offen lds
    buffer_load_dwordx4 v5, s[8:11], s72 offen offset:1024 lds
    s_add_u32 s72, s72, 262144
    s_waitcnt lgkmcnt(3)
    v_mfma_f32_32x32x16_bf16 v[32:47], v[148:151], v[164:167], v[32:47]
    ds_read_b128 v[148:151], v6 offset:33792
    v_exp_f32 v22, v22
    v_exp_f32 v23, v23
    v_cvt_pk_bf16_f32 v186, v20, v21
    v_cvt_pk_bf16_f32 v187, v22, v23
    v_smfmac_f32_16x16x64_bf16 v[56:59], v[60:63], v[48:55], v192
    v_exp_f32 v24, v24
    v_exp_f32 v25, v25
    v_exp_f32 v26, v26
    v_exp_f32 v27, v27
    s_waitcnt lgkmcnt(3)
    v_mfma_f32_32x32x16_bf16 v[128:143], v[152:155], v[184:187], v[128:143]
    ds_read_b128 v[152:155], v6 offset:30720
    v_cvt_pk_bf16_f32 v188, v24, v25
    v_cvt_pk_bf16_f32 v189, v26, v27
    v_exp_f32 v28, v28
    v_exp_f32 v29, v29
    v_exp_f32 v30, v30
    v_exp_f32 v31, v31
    v_cvt_pk_bf16_f32 v190, v28, v29
    v_cvt_pk_bf16_f32 v191, v30, v31
    s_waitcnt lgkmcnt(3)
    v_mfma_f32_32x32x16_bf16 v[16:31], v[144:147], v[160:163], v[168:183]
    ds_read_b128 v[144:147], v6 offset:36864
    v_exp_f32 v32, v32
    v_exp_f32 v33, v33
    v_exp_f32 v34, v34
    v_exp_f32 v35, v35
    s_waitcnt lgkmcnt(3)
    v_mfma_f32_32x32x16_bf16 v[128:143], v[156:159], v[188:191], v[128:143]
    ds_read_b128 v[156:159], v6 offset:31744
    v_cvt_pk_bf16_f32 v48, v32, v33
    v_cvt_pk_bf16_f32 v49, v34, v35
    v_exp_f32 v36, v36
    v_exp_f32 v37, v37
    s_waitcnt lgkmcnt(3)
    v_mfma_f32_32x32x16_bf16 v[16:31], v[148:151], v[164:167], v[16:31]
    ds_read_b128 v[148:151], v6 offset:37888
    v_exp_f32 v38, v38
    v_exp_f32 v39, v39
    v_cvt_pk_bf16_f32 v50, v36, v37
    v_cvt_pk_bf16_f32 v51, v38, v39
    v_smfmac_f32_16x16x64_bf16 v[56:59], v[60:63], v[184:191], v192
    v_exp_f32 v40, v40
    v_exp_f32 v41, v41
    v_exp_f32 v42, v42
    v_exp_f32 v43, v43
    s_waitcnt lgkmcnt(3)
    v_mfma_f32_32x32x16_bf16 v[128:143], v[152:155], v[48:51], v[128:143]
    ds_read_b128 v[152:155], v6 offset:34816
    v_cvt_pk_bf16_f32 v52, v40, v41
    v_cvt_pk_bf16_f32 v53, v42, v43
    v_exp_f32 v44, v44
    v_exp_f32 v45, v45
    v_exp_f32 v46, v46
    v_exp_f32 v47, v47
    v_cvt_pk_bf16_f32 v54, v44, v45
    v_cvt_pk_bf16_f32 v55, v46, v47
    s_waitcnt lgkmcnt(3)
    v_mfma_f32_32x32x16_bf16 v[32:47], v[144:147], v[160:163], v[168:183]
    ds_read_b128 v[144:147], v6 offset:40960
    v_exp_f32 v16, v16
    v_exp_f32 v17, v17
    v_exp_f32 v18, v18
    v_exp_f32 v19, v19
    s_waitcnt lgkmcnt(3)
    v_mfma_f32_32x32x16_bf16 v[128:143], v[156:159], v[52:55], v[128:143]
    ds_read_b128 v[156:159], v6 offset:35840
    s_waitcnt vmcnt(7)
    s_barrier
    s_add_u32 m0, s70, 16384
    v_cvt_pk_bf16_f32 v184, v16, v17
    v_cvt_pk_bf16_f32 v185, v18, v19
    v_exp_f32 v20, v20
    v_exp_f32 v21, v21
    buffer_load_dwordx4 v1, s[16:19], s69 offen sc1 lds
    buffer_load_dwordx4 v1, s[16:19], s69 offen offset:1024 sc1 lds
    s_add_u32 s69, s69, 16384
    s_waitcnt lgkmcnt(3)
    v_mfma_f32_32x32x16_bf16 v[32:47], v[148:151], v[164:167], v[32:47]
    ds_read_b128 v[148:151], v6 offset:41984
    v_exp_f32 v22, v22
    v_exp_f32 v23, v23
    v_cvt_pk_bf16_f32 v186, v20, v21
    v_cvt_pk_bf16_f32 v187, v22, v23
    v_smfmac_f32_16x16x64_bf16 v[56:59], v[60:63], v[48:55], v192
    v_exp_f32 v24, v24
    v_exp_f32 v25, v25
    v_exp_f32 v26, v26
    v_exp_f32 v27, v27
    s_waitcnt lgkmcnt(3)
    v_mfma_f32_32x32x16_bf16 v[128:143], v[152:155], v[184:187], v[128:143]
    ds_read_b128 v[152:155], v6 offset:38912
    v_cvt_pk_bf16_f32 v188, v24, v25
    v_cvt_pk_bf16_f32 v189, v26, v27
    v_exp_f32 v28, v28
    v_exp_f32 v29, v29
    v_exp_f32 v30, v30
    v_exp_f32 v31, v31
    v_cvt_pk_bf16_f32 v190, v28, v29
    v_cvt_pk_bf16_f32 v191, v30, v31
    s_waitcnt lgkmcnt(3)
    v_mfma_f32_32x32x16_bf16 v[16:31], v[144:147], v[160:163], v[168:183]
    ds_read_b128 v[144:147], v6 offset:45056
    v_exp_f32 v32, v32
    v_exp_f32 v33, v33
    v_exp_f32 v34, v34
    v_exp_f32 v35, v35
    s_waitcnt lgkmcnt(3)
    v_mfma_f32_32x32x16_bf16 v[128:143], v[156:159], v[188:191], v[128:143]
    ds_read_b128 v[156:159], v6 offset:39936
    v_cvt_pk_bf16_f32 v48, v32, v33
    v_cvt_pk_bf16_f32 v49, v34, v35
    v_exp_f32 v36, v36
    v_exp_f32 v37, v37
    buffer_load_dwordx4 v[100:103], v12, s[12:15], s76 offen nt
    s_add_u32 s76, s76, 12288
    s_waitcnt lgkmcnt(3)
    v_mfma_f32_32x32x16_bf16 v[16:31], v[148:151], v[164:167], v[16:31]
    ds_read_b128 v[148:151], v6 offset:46080
    v_exp_f32 v38, v38
    v_exp_f32 v39, v39
    v_cvt_pk_bf16_f32 v50, v36, v37
    v_cvt_pk_bf16_f32 v51, v38, v39
    v_smfmac_f32_16x16x64_bf16 v[56:59], v[60:63], v[184:191], v192
    v_exp_f32 v40, v40
    v_exp_f32 v41, v41
    v_exp_f32 v42, v42
    v_exp_f32 v43, v43
    s_waitcnt lgkmcnt(3)
    v_mfma_f32_32x32x16_bf16 v[128:143], v[152:155], v[48:51], v[128:143]
    ds_read_b128 v[152:155], v6 offset:43008
    v_cvt_pk_bf16_f32 v52, v40, v41
    v_cvt_pk_bf16_f32 v53, v42, v43
    v_exp_f32 v44, v44
    v_exp_f32 v45, v45
    v_exp_f32 v46, v46
    v_exp_f32 v47, v47
    v_cvt_pk_bf16_f32 v54, v44, v45
    v_cvt_pk_bf16_f32 v55, v46, v47
    s_waitcnt lgkmcnt(3)
    v_mfma_f32_32x32x16_bf16 v[32:47], v[144:147], v[160:163], v[168:183]
    ds_read_b128 v[144:147], v6 offset:49152
    v_exp_f32 v16, v16
    v_exp_f32 v17, v17
    v_exp_f32 v18, v18
    v_exp_f32 v19, v19
    s_waitcnt lgkmcnt(3)
    v_mfma_f32_32x32x16_bf16 v[128:143], v[156:159], v[52:55], v[128:143]
    ds_read_b128 v[156:159], v6 offset:44032
    v_cvt_pk_bf16_f32 v184, v16, v17
    v_cvt_pk_bf16_f32 v185, v18, v19
    v_exp_f32 v20, v20
    v_exp_f32 v21, v21
    buffer_store_dwordx4 v[92:95], v1, s[16:19], s82 offen offset:1024 sc1
    s_waitcnt lgkmcnt(3)
    v_mfma_f32_32x32x16_bf16 v[32:47], v[148:151], v[164:167], v[32:47]
    ds_read_b128 v[148:151], v6 offset:50176
    v_exp_f32 v22, v22
    v_exp_f32 v23, v23
    v_cvt_pk_bf16_f32 v186, v20, v21
    v_cvt_pk_bf16_f32 v187, v22, v23
    v_smfmac_f32_16x16x64_bf16 v[56:59], v[60:63], v[48:55], v192
    v_exp_f32 v24, v24
    v_exp_f32 v25, v25
    v_exp_f32 v26, v26
    v_exp_f32 v27, v27
    s_waitcnt lgkmcnt(3)
    v_mfma_f32_32x32x16_bf16 v[128:143], v[152:155], v[184:187], v[128:143]
    ds_read_b128 v[152:155], v6 offset:47104
    v_cvt_pk_bf16_f32 v188, v24, v25
    v_cvt_pk_bf16_f32 v189, v26, v27
    v_exp_f32 v28, v28
    v_exp_f32 v29, v29
    v_exp_f32 v30, v30
    v_exp_f32 v31, v31
    v_cvt_pk_bf16_f32 v190, v28, v29
    v_cvt_pk_bf16_f32 v191, v30, v31
    s_waitcnt lgkmcnt(3)
    v_mfma_f32_32x32x16_bf16 v[16:31], v[144:147], v[160:163], v[168:183]
    ds_read_b128 v[144:147], v6 offset:53248
    v_exp_f32 v32, v32
    v_exp_f32 v33, v33
    v_exp_f32 v34, v34
    v_exp_f32 v35, v35
    s_waitcnt lgkmcnt(3)
    v_mfma_f32_32x32x16_bf16 v[128:143], v[156:159], v[188:191], v[128:143]
    ds_read_b128 v[156:159], v6 offset:48128
    v_cvt_pk_bf16_f32 v48, v32, v33
    v_cvt_pk_bf16_f32 v49, v34, v35
    v_exp_f32 v36, v36
    v_exp_f32 v37, v37
    buffer_load_dword v69, v15, s[84:87], s83 offen
    s_add_u32 s83, s83, 1024
    s_waitcnt lgkmcnt(3)
    v_mfma_f32_32x32x16_bf16 v[16:31], v[148:151], v[164:167], v[16:31]
    ds_read_b128 v[148:151], v6 offset:54272
    v_exp_f32 v38, v38
    v_exp_f32 v39, v39
    v_cvt_pk_bf16_f32 v50, v36, v37
    v_cvt_pk_bf16_f32 v51, v38, v39
    v_smfmac_f32_16x16x64_bf16 v[56:59], v[60:63], v[184:191], v192
    v_exp_f32 v40, v40
    v_exp_f32 v41, v41
    v_exp_f32 v42, v42
    v_exp_f32 v43, v43
    s_waitcnt lgkmcnt(3)
    v_mfma_f32_32x32x16_bf16 v[128:143], v[152:155], v[48:51], v[128:143]
    ds_read_b128 v[152:155], v6 offset:51200
    v_cvt_pk_bf16_f32 v52, v40, v41
    v_cvt_pk_bf16_f32 v53, v42, v43
    v_exp_f32 v44, v44
    v_exp_f32 v45, v45
    v_exp_f32 v46, v46
    v_exp_f32 v47, v47
    v_cvt_pk_bf16_f32 v54, v44, v45
    v_cvt_pk_bf16_f32 v55, v46, v47
    s_waitcnt lgkmcnt(3)
    v_mfma_f32_32x32x16_bf16 v[32:47], v[144:147], v[160:163], v[168:183]
    ds_read_b128 v[144:147], v6 offset:57344
    v_exp_f32 v16, v16
    v_exp_f32 v17, v17
    v_exp_f32 v18, v18
    v_exp_f32 v19, v19
    s_waitcnt lgkmcnt(3)
    v_mfma_f32_32x32x16_bf16 v[128:143], v[156:159], v[52:55], v[128:143]
    ds_read_b128 v[156:159], v6 offset:52224
    s_waitcnt vmcnt(8)
    s_barrier
    s_add_u32 m0, s70, 32768
    v_cvt_pk_bf16_f32 v184, v16, v17
    v_cvt_pk_bf16_f32 v185, v18, v19
    v_exp_f32 v20, v20
    v_exp_f32 v21, v21
    buffer_load_dwordx4 v1, s[16:19], s69 offen sc1 lds
    buffer_load_dwordx4 v1, s[16:19], s69 offen offset:1024 sc1 lds
    s_add_u32 s69, s69, 16384
    s_waitcnt lgkmcnt(3)
    v_mfma_f32_32x32x16_bf16 v[32:47], v[148:151], v[164:167], v[32:47]
    ds_read_b128 v[148:151], v6 offset:58368
    v_exp_f32 v22, v22
    v_exp_f32 v23, v23
    v_cvt_pk_bf16_f32 v186, v20, v21
    v_cvt_pk_bf16_f32 v187, v22, v23
    v_smfmac_f32_16x16x64_bf16 v[56:59], v[60:63], v[48:55], v192
    v_exp_f32 v24, v24
    v_exp_f32 v25, v25
    v_exp_f32 v26, v26
    v_exp_f32 v27, v27
    s_waitcnt lgkmcnt(3)
    v_mfma_f32_32x32x16_bf16 v[128:143], v[152:155], v[184:187], v[128:143]
    ds_read_b128 v[152:155], v6 offset:55296
    v_cvt_pk_bf16_f32 v188, v24, v25
    v_cvt_pk_bf16_f32 v189, v26, v27
    v_exp_f32 v28, v28
    v_exp_f32 v29, v29
    v_exp_f32 v30, v30
    v_exp_f32 v31, v31
    v_cvt_pk_bf16_f32 v190, v28, v29
    v_cvt_pk_bf16_f32 v191, v30, v31
    s_waitcnt lgkmcnt(3)
    v_mfma_f32_32x32x16_bf16 v[16:31], v[144:147], v[160:163], v[168:183]
    ds_read_b128 v[144:147], v6 offset:61440
    v_exp_f32 v32, v32
    v_exp_f32 v33, v33
    v_exp_f32 v34, v34
    v_exp_f32 v35, v35
    s_waitcnt lgkmcnt(3)
    v_mfma_f32_32x32x16_bf16 v[128:143], v[156:159], v[188:191], v[128:143]
    ds_read_b128 v[156:159], v6 offset:56320
    v_cvt_pk_bf16_f32 v48, v32, v33
    v_cvt_pk_bf16_f32 v49, v34, v35
    v_exp_f32 v36, v36
    v_exp_f32 v37, v37
    buffer_load_dword v70, v15, s[84:87], s83 offen
    s_add_u32 s83, s83, 1024
    s_waitcnt lgkmcnt(3)
    v_mfma_f32_32x32x16_bf16 v[16:31], v[148:151], v[164:167], v[16:31]
    ds_read_b128 v[148:151], v6 offset:62464
    v_exp_f32 v38, v38
    v_exp_f32 v39, v39
    v_cvt_pk_bf16_f32 v50, v36, v37
    v_cvt_pk_bf16_f32 v51, v38, v39
    v_smfmac_f32_16x16x64_bf16 v[56:59], v[60:63], v[184:191], v192
    v_exp_f32 v40, v40
    v_exp_f32 v41, v41
    v_exp_f32 v42, v42
    v_exp_f32 v43, v43
    s_waitcnt lgkmcnt(3)
    v_mfma_f32_32x32x16_bf16 v[128:143], v[152:155], v[48:51], v[128:143]
    ds_read_b128 v[152:155], v6 offset:59392
    v_cvt_pk_bf16_f32 v52, v40, v41
    v_cvt_pk_bf16_f32 v53, v42, v43
    v_exp_f32 v44, v44
    v_exp_f32 v45, v45
    v_exp_f32 v46, v46
    v_exp_f32 v47, v47
    v_cvt_pk_bf16_f32 v54, v44, v45
    v_cvt_pk_bf16_f32 v55, v46, v47
    s_waitcnt lgkmcnt(3)
    v_mfma_f32_32x32x16_bf16 v[32:47], v[144:147], v[160:163], v[168:183]
    ds_read_b128 v[144:147], v6 offset:0
    v_exp_f32 v16, v16
    v_exp_f32 v17, v17
    v_exp_f32 v18, v18
    v_exp_f32 v19, v19
    s_waitcnt lgkmcnt(3)
    v_mfma_f32_32x32x16_bf16 v[128:143], v[156:159], v[52:55], v[128:143]
    ds_read_b128 v[156:159], v6 offset:60416
    v_cvt_pk_bf16_f32 v184, v16, v17
    v_cvt_pk_bf16_f32 v185, v18, v19
    v_exp_f32 v20, v20
    v_exp_f32 v21, v21
    s_mov_b32 m0, s73
    s_add_u32 s73, s73, 16384
    buffer_load_dwordx4 v4, s[8:11], s72 offen lds
    buffer_load_dwordx4 v5, s[8:11], s72 offen offset:1024 lds
    s_add_u32 s72, s72, 262144
    s_waitcnt lgkmcnt(3)
    v_mfma_f32_32x32x16_bf16 v[32:47], v[148:151], v[164:167], v[32:47]
    ds_read_b128 v[148:151], v6 offset:1024
    v_exp_f32 v22, v22
    v_exp_f32 v23, v23
    v_cvt_pk_bf16_f32 v186, v20, v21
    v_cvt_pk_bf16_f32 v187, v22, v23
    v_smfmac_f32_16x16x64_bf16 v[56:59], v[60:63], v[48:55], v192
    v_exp_f32 v24, v24
    v_exp_f32 v25, v25
    v_exp_f32 v26, v26
    v_exp_f32 v27, v27
    s_waitcnt lgkmcnt(3)
    v_mfma_f32_32x32x16_bf16 v[128:143], v[152:155], v[184:187], v[128:143]
    ds_read_b128 v[152:155], v6 offset:63488
    v_cvt_pk_bf16_f32 v188, v24, v25
    v_cvt_pk_bf16_f32 v189, v26, v27
    v_exp_f32 v28, v28
    v_exp_f32 v29, v29
    v_exp_f32 v30, v30
    v_exp_f32 v31, v31
    v_cvt_pk_bf16_f32 v190, v28, v29
    v_cvt_pk_bf16_f32 v191, v30, v31
    s_waitcnt lgkmcnt(3)
    v_mfma_f32_32x32x16_bf16 v[16:31], v[144:147], v[160:163], v[168:183]
    ds_read_b128 v[144:147], v6 offset:4096
    v_exp_f32 v32, v32
    v_exp_f32 v33, v33
    v_exp_f32 v34, v34
    v_exp_f32 v35, v35
    s_waitcnt lgkmcnt(3)
    v_mfma_f32_32x32x16_bf16 v[128:143], v[156:159], v[188:191], v[128:143]
    ds_read_b128 v[156:159], v6 offset:64512
    v_cvt_pk_bf16_f32 v48, v32, v33
    v_cvt_pk_bf16_f32 v49, v34, v35
    v_exp_f32 v36, v36
    v_exp_f32 v37, v37
    s_waitcnt lgkmcnt(3)
    v_mfma_f32_32x32x16_bf16 v[16:31], v[148:151], v[164:167], v[16:31]
    ds_read_b128 v[148:151], v6 offset:5120
    v_exp_f32 v38, v38
    v_exp_f32 v39, v39
    v_cvt_pk_bf16_f32 v50, v36, v37
    v_cvt_pk_bf16_f32 v51, v38, v39
    v_smfmac_f32_16x16x64_bf16 v[56:59], v[60:63], v[184:191], v192
    v_exp_f32 v40, v40
    v_exp_f32 v41, v41
    v_exp_f32 v42, v42
    v_exp_f32 v43, v43
    s_waitcnt lgkmcnt(3)
    v_mfma_f32_32x32x16_bf16 v[128:143], v[152:155], v[48:51], v[128:143]
    ds_read_b128 v[152:155], v6 offset:2048
    v_cvt_pk_bf16_f32 v52, v40, v41
    v_cvt_pk_bf16_f32 v53, v42, v43
    v_exp_f32 v44, v44
    v_exp_f32 v45, v45
    v_exp_f32 v46, v46
    v_exp_f32 v47, v47
    v_cvt_pk_bf16_f32 v54, v44, v45
    v_cvt_pk_bf16_f32 v55, v46, v47
    s_waitcnt lgkmcnt(3)
    v_mfma_f32_32x32x16_bf16 v[32:47], v[144:147], v[160:163], v[168:183]
    ds_read_b128 v[144:147], v6 offset:8192
    v_exp_f32 v16, v16
    v_exp_f32 v17, v17
    v_exp_f32 v18, v18
    v_exp_f32 v19, v19
    s_waitcnt lgkmcnt(3)
    v_mfma_f32_32x32x16_bf16 v[128:143], v[156:159], v[52:55], v[128:143]
    ds_read_b128 v[156:159], v6 offset:3072
    s_waitcnt vmcnt(8)
    s_barrier
    s_add_u32 m0, s70, 49152
    v_cvt_pk_bf16_f32 v184, v16, v17
    v_cvt_pk_bf16_f32 v185, v18, v19
    v_exp_f32 v20, v20
    v_exp_f32 v21, v21
    buffer_load_dwordx4 v1, s[16:19], s69 offen sc1 lds
    buffer_load_dwordx4 v1, s[16:19], s69 offen offset:1024 sc1 lds
    s_add_u32 s69, s69, 16384
    s_waitcnt lgkmcnt(3)
    v_mfma_f32_32x32x16_bf16 v[32:47], v[148:151], v[164:167], v[32:47]
    ds_read_b128 v[148:151], v6 offset:9216
    v_exp_f32 v22, v22
    v_exp_f32 v23, v23
    v_cvt_pk_bf16_f32 v186, v20, v21
    v_cvt_pk_bf16_f32 v187, v22, v23
    v_smfmac_f32_16x16x64_bf16 v[56:59], v[60:63], v[48:55], v192
    v_exp_f32 v24, v24
    v_exp_f32 v25, v25
    v_exp_f32 v26, v26
    v_exp_f32 v27, v27
    s_waitcnt lgkmcnt(3)
    v_mfma_f32_32x32x16_bf16 v[128:143], v[152:155], v[184:187], v[128:143]
    ds_read_b128 v[152:155], v6 offset:6144
    v_cvt_pk_bf16_f32 v188, v24, v25
    v_cvt_pk_bf16_f32 v189, v26, v27
    v_exp_f32 v28, v28
    v_exp_f32 v29, v29
    v_exp_f32 v30, v30
    v_exp_f32 v31, v31
    v_cvt_pk_bf16_f32 v190, v28, v29
    v_cvt_pk_bf16_f32 v191, v30, v31
    s_waitcnt lgkmcnt(3)
    v_mfma_f32_32x32x16_bf16 v[16:31], v[144:147], v[160:163], v[168:183]
    ds_read_b128 v[144:147], v6 offset:12288
    v_exp_f32 v32, v32
    v_exp_f32 v33, v33
    v_exp_f32 v34, v34
    v_exp_f32 v35, v35
    s_waitcnt lgkmcnt(3)
    v_mfma_f32_32x32x16_bf16 v[128:143], v[156:159], v[188:191], v[128:143]
    ds_read_b128 v[156:159], v6 offset:7168
    v_cvt_pk_bf16_f32 v48, v32, v33
    v_cvt_pk_bf16_f32 v49, v34, v35
    v_exp_f32 v36, v36
    v_exp_f32 v37, v37
    buffer_load_dwordx4 v[104:107], v12, s[12:15], s76 offen nt
    s_add_u32 s76, s76, 12288
    s_waitcnt lgkmcnt(3)
    v_mfma_f32_32x32x16_bf16 v[16:31], v[148:151], v[164:167], v[16:31]
    ds_read_b128 v[148:151], v6 offset:13312
    v_exp_f32 v38, v38
    v_exp_f32 v39, v39
    v_cvt_pk_bf16_f32 v50, v36, v37
    v_cvt_pk_bf16_f32 v51, v38, v39
    v_smfmac_f32_16x16x64_bf16 v[56:59], v[60:63], v[184:191], v192
    s_branch LadaLN_cond__grouped_kv_mqa__dense_activation_relu__prompt_kernel_over4
LadaLN_cond__grouped_kv_mqa__dense_activation_relu__prompt_kernel_stub4:
    s_setpc_b64 s[96:97]
LadaLN_cond__grouped_kv_mqa__dense_activation_relu__prompt_kernel_over4:
    v_exp_f32 v40, v40
    v_exp_f32 v41, v41
    v_exp_f32 v42, v42
    v_exp_f32 v43, v43
    s_waitcnt lgkmcnt(3)
    v_mfma_f32_32x32x16_bf16 v[128:143], v[152:155], v[48:51], v[128:143]
    ds_read_b128 v[152:155], v6 offset:10240
    v_cvt_pk_bf16_f32 v52, v40, v41
    v_cvt_pk_bf16_f32 v53, v42, v43
    v_exp_f32 v44, v44
    v_exp_f32 v45, v45
    v_exp_f32 v46, v46
    v_exp_f32 v47, v47
    v_cvt_pk_bf16_f32 v54, v44, v45
    v_cvt_pk_bf16_f32 v55, v46, v47
    s_waitcnt lgkmcnt(3)
    v_mfma_f32_32x32x16_bf16 v[32:47], v[144:147], v[160:163], v[168:183]
    ds_read_b128 v[144:147], v6 offset:16384
    v_exp_f32 v16, v16
    v_exp_f32 v17, v17
    v_exp_f32 v18, v18
    v_exp_f32 v19, v19
    s_waitcnt lgkmcnt(3)
    v_mfma_f32_32x32x16_bf16 v[128:143], v[156:159], v[52:55], v[128:143]
    ds_read_b128 v[156:159], v6 offset:11264
    v_cvt_pk_bf16_f32 v184, v16, v17
    v_cvt_pk_bf16_f32 v185, v18, v19
    v_exp_f32 v20, v20
    v_exp_f32 v21, v21
    buffer_load_dword v71, v15, s[84:87], s83 offen
    s_add_u32 s83, s83, 1024
    s_waitcnt lgkmcnt(3)
    v_mfma_f32_32x32x16_bf16 v[32:47], v[148:151], v[164:167], v[32:47]
    ds_read_b128 v[148:151], v6 offset:17408
    v_exp_f32 v22, v22
    v_exp_f32 v23, v23
    v_cvt_pk_bf16_f32 v186, v20, v21
    v_cvt_pk_bf16_f32 v187, v22, v23
    v_smfmac_f32_16x16x64_bf16 v[56:59], v[60:63], v[48:55], v192
    v_exp_f32 v24, v24
    v_exp_f32 v25, v25
    v_exp_f32 v26, v26
    v_exp_f32 v27, v27
    s_waitcnt lgkmcnt(3)
    v_mfma_f32_32x32x16_bf16 v[128:143], v[152:155], v[184:187], v[128:143]
    ds_read_b128 v[152:155], v6 offset:14336
    v_cvt_pk_bf16_f32 v188, v24, v25
    v_cvt_pk_bf16_f32 v189, v26, v27
    v_exp_f32 v28, v28
    v_exp_f32 v29, v29
    v_exp_f32 v30, v30
    v_exp_f32 v31, v31
    v_cvt_pk_bf16_f32 v190, v28, v29
    v_cvt_pk_bf16_f32 v191, v30, v31
    s_waitcnt lgkmcnt(3)
    v_mfma_f32_32x32x16_bf16 v[16:31], v[144:147], v[160:163], v[168:183]
    ds_read_b128 v[144:147], v6 offset:20480
    v_exp_f32 v32, v32
    v_exp_f32 v33, v33
    v_exp_f32 v34, v34
    v_exp_f32 v35, v35
    s_waitcnt lgkmcnt(3)
    v_mfma_f32_32x32x16_bf16 v[128:143], v[156:159], v[188:191], v[128:143]
    ds_read_b128 v[156:159], v6 offset:15360
    v_cvt_pk_bf16_f32 v48, v32, v33
    v_cvt_pk_bf16_f32 v49, v34, v35
    v_exp_f32 v36, v36
    v_exp_f32 v37, v37
    s_waitcnt lgkmcnt(3)
    v_mfma_f32_32x32x16_bf16 v[16:31], v[148:151], v[164:167], v[16:31]
    ds_read_b128 v[148:151], v6 offset:21504
    v_exp_f32 v38, v38
    v_exp_f32 v39, v39
    v_cvt_pk_bf16_f32 v50, v36, v37
    v_cvt_pk_bf16_f32 v51, v38, v39
    v_smfmac_f32_16x16x64_bf16 v[56:59], v[60:63], v[184:191], v192
    v_exp_f32 v40, v40
    v_exp_f32 v41, v41
    v_exp_f32 v42, v42
    v_exp_f32 v43, v43
    s_waitcnt lgkmcnt(3)
    v_mfma_f32_32x32x16_bf16 v[128:143], v[152:155], v[48:51], v[128:143]
    ds_read_b128 v[152:155], v6 offset:18432
    v_cvt_pk_bf16_f32 v52, v40, v41
    v_cvt_pk_bf16_f32 v53, v42, v43
    v_exp_f32 v44, v44
    v_exp_f32 v45, v45
    v_exp_f32 v46, v46
    v_exp_f32 v47, v47
    v_cvt_pk_bf16_f32 v54, v44, v45
    v_cvt_pk_bf16_f32 v55, v46, v47
    s_waitcnt lgkmcnt(3)
    v_mfma_f32_32x32x16_bf16 v[32:47], v[144:147], v[160:163], v[168:183]
    ds_read_b128 v[144:147], v6 offset:24576
    v_exp_f32 v16, v16
    v_exp_f32 v17, v17
    v_exp_f32 v18, v18
    v_exp_f32 v19, v19
    s_waitcnt lgkmcnt(3)
    v_mfma_f32_32x32x16_bf16 v[128:143], v[156:159], v[52:55], v[128:143]
    ds_read_b128 v[156:159], v6 offset:19456
    s_waitcnt vmcnt(7)
    s_barrier
    s_add_u32 m0, s70, 0
    v_cvt_pk_bf16_f32 v184, v16, v17
    v_cvt_pk_bf16_f32 v185, v18, v19
    v_exp_f32 v20, v20
    v_exp_f32 v21, v21
    buffer_load_dwordx4 v1, s[16:19], s69 offen sc1 lds
    buffer_load_dwordx4 v1, s[16:19], s69 offen offset:1024 sc1 lds
    s_add_u32 s69, s69, 16384
    s_waitcnt lgkmcnt(3)
    v_mfma_f32_32x32x16_bf16 v[32:47], v[148:151], v[164:167], v[32:47]
    ds_read_b128 v[148:151], v6 offset:25600
    v_exp_f32 v22, v22
    v_exp_f32 v23, v23
    v_cvt_pk_bf16_f32 v186, v20, v21
    v_cvt_pk_bf16_f32 v187, v22, v23
    v_smfmac_f32_16x16x64_bf16 v[56:59], v[60:63], v[48:55], v192
    v_exp_f32 v24, v24
    v_exp_f32 v25, v25
    v_exp_f32 v26, v26
    v_exp_f32 v27, v27
    s_waitcnt lgkmcnt(3)
    v_mfma_f32_32x32x16_bf16 v[128:143], v[152:155], v[184:187], v[128:143]
    ds_read_b128 v[152:155], v6 offset:22528
    v_cvt_pk_bf16_f32 v188, v24, v25
    v_cvt_pk_bf16_f32 v189, v26, v27
    v_exp_f32 v28, v28
    v_exp_f32 v29, v29
    v_exp_f32 v30, v30
    v_exp_f32 v31, v31
    v_cvt_pk_bf16_f32 v190, v28, v29
    v_cvt_pk_bf16_f32 v191, v30, v31
    s_waitcnt lgkmcnt(3)
    v_mfma_f32_32x32x16_bf16 v[16:31], v[144:147], v[160:163], v[168:183]
    ds_read_b128 v[144:147], v6 offset:28672
    v_exp_f32 v32, v32
    v_exp_f32 v33, v33
    v_exp_f32 v34, v34
    v_exp_f32 v35, v35
    s_waitcnt lgkmcnt(3)
    v_mfma_f32_32x32x16_bf16 v[128:143], v[156:159], v[188:191], v[128:143]
    ds_read_b128 v[156:159], v6 offset:23552
    v_cvt_pk_bf16_f32 v48, v32, v33
    v_cvt_pk_bf16_f32 v49, v34, v35
    v_exp_f32 v36, v36
    v_exp_f32 v37, v37
    buffer_store_dwordx4 v[92:95], v1, s[16:19], s79 offen offset:0 sc1
    s_waitcnt lgkmcnt(3)
    v_mfma_f32_32x32x16_bf16 v[16:31], v[148:151], v[164:167], v[16:31]
    ds_read_b128 v[148:151], v6 offset:29696
    v_exp_f32 v38, v38
    v_exp_f32 v39, v39
    v_cvt_pk_bf16_f32 v50, v36, v37
    v_cvt_pk_bf16_f32 v51, v38, v39
    v_smfmac_f32_16x16x64_bf16 v[56:59], v[60:63], v[184:191], v192
    v_exp_f32 v40, v40
    v_exp_f32 v41, v41
    v_exp_f32 v42, v42
    v_exp_f32 v43, v43
    s_waitcnt lgkmcnt(3)
    v_mfma_f32_32x32x16_bf16 v[128:143], v[152:155], v[48:51], v[128:143]
    ds_read_b128 v[152:155], v6 offset:26624
    v_cvt_pk_bf16_f32 v52, v40, v41
    v_cvt_pk_bf16_f32 v53, v42, v43
    v_exp_f32 v44, v44
    v_exp_f32 v45, v45
    v_exp_f32 v46, v46
    v_exp_f32 v47, v47
    v_cvt_pk_bf16_f32 v54, v44, v45
    v_cvt_pk_bf16_f32 v55, v46, v47
    s_waitcnt lgkmcnt(3)
    v_mfma_f32_32x32x16_bf16 v[32:47], v[144:147], v[160:163], v[168:183]
    ds_read_b128 v[144:147], v6 offset:32768
    v_exp_f32 v16, v16
    v_exp_f32 v17, v17
    v_exp_f32 v18, v18
    v_exp_f32 v19, v19
    s_waitcnt lgkmcnt(3)
    v_mfma_f32_32x32x16_bf16 v[128:143], v[156:159], v[52:55], v[128:143]
    ds_read_b128 v[156:159], v6 offset:27648
    v_cvt_pk_bf16_f32 v184, v16, v17
    v_cvt_pk_bf16_f32 v185, v18, v19
    v_exp_f32 v20, v20
    v_exp_f32 v21, v21
    s_mov_b32 m0, s73
    s_add_u32 s73, s73, 16384
    buffer_load_dwordx4 v4, s[8:11], s72 offen lds
    buffer_load_dwordx4 v5, s[8:11], s72 offen offset:1024 lds
    s_add_u32 s72, s72, 262144
    s_waitcnt lgkmcnt(3)
    v_mfma_f32_32x32x16_bf16 v[32:47], v[148:151], v[164:167], v[32:47]
    ds_read_b128 v[148:151], v6 offset:33792
    v_exp_f32 v22, v22
    v_exp_f32 v23, v23
    v_cvt_pk_bf16_f32 v186, v20, v21
    v_cvt_pk_bf16_f32 v187, v22, v23
    v_smfmac_f32_16x16x64_bf16 v[56:59], v[60:63], v[48:55], v192
    v_exp_f32 v24, v24
    v_exp_f32 v25, v25
    v_exp_f32 v26, v26
    v_exp_f32 v27, v27
    s_waitcnt lgkmcnt(3)
    v_mfma_f32_32x32x16_bf16 v[128:143], v[152:155], v[184:187], v[128:143]
    ds_read_b128 v[152:155], v6 offset:30720
    v_cvt_pk_bf16_f32 v188, v24, v25
    v_cvt_pk_bf16_f32 v189, v26, v27
    v_exp_f32 v28, v28
    v_exp_f32 v29, v29
    v_exp_f32 v30, v30
    v_exp_f32 v31, v31
    v_cvt_pk_bf16_f32 v190, v28, v29
    v_cvt_pk_bf16_f32 v191, v30, v31
    s_waitcnt lgkmcnt(3)
    v_mfma_f32_32x32x16_bf16 v[16:31], v[144:147], v[160:163], v[168:183]
    ds_read_b128 v[144:147], v6 offset:36864
    v_exp_f32 v32, v32
    v_exp_f32 v33, v33
    v_exp_f32 v34, v34
    v_exp_f32 v35, v35
    s_waitcnt lgkmcnt(3)
    v_mfma_f32_32x32x16_bf16 v[128:143], v[156:159], v[188:191], v[128:143]
    ds_read_b128 v[156:159], v6 offset:31744
    v_cvt_pk_bf16_f32 v48, v32, v33
    v_cvt_pk_bf16_f32 v49, v34, v35
    v_exp_f32 v36, v36
    v_exp_f32 v37, v37
    s_waitcnt lgkmcnt(3)
    v_mfma_f32_32x32x16_bf16 v[16:31], v[148:151], v[164:167], v[16:31]
    ds_read_b128 v[148:151], v6 offset:37888
    v_exp_f32 v38, v38
    v_exp_f32 v39, v39
    v_cvt_pk_bf16_f32 v50, v36, v37
    v_cvt_pk_bf16_f32 v51, v38, v39
    v_smfmac_f32_16x16x64_bf16 v[56:59], v[60:63], v[184:191], v192
    v_exp_f32 v40, v40
    v_exp_f32 v41, v41
    v_exp_f32 v42, v42
    v_exp_f32 v43, v43
    s_waitcnt lgkmcnt(3)
    v_mfma_f32_32x32x16_bf16 v[128:143], v[152:155], v[48:51], v[128:143]
    ds_read_b128 v[152:155], v6 offset:34816
    v_cvt_pk_bf16_f32 v52, v40, v41
    v_cvt_pk_bf16_f32 v53, v42, v43
    v_exp_f32 v44, v44
    v_exp_f32 v45, v45
    v_exp_f32 v46, v46
    v_exp_f32 v47, v47
    v_cvt_pk_bf16_f32 v54, v44, v45
    v_cvt_pk_bf16_f32 v55, v46, v47
    s_waitcnt lgkmcnt(3)
    v_mfma_f32_32x32x16_bf16 v[32:47], v[144:147], v[160:163], v[168:183]
    ds_read_b128 v[144:147], v6 offset:40960
    v_exp_f32 v16, v16
    v_exp_f32 v17, v17
    v_exp_f32 v18, v18
    v_exp_f32 v19, v19
    s_waitcnt lgkmcnt(3)
    v_mfma_f32_32x32x16_bf16 v[128:143], v[156:159], v[52:55], v[128:143]
    ds_read_b128 v[156:159], v6 offset:35840
    s_waitcnt vmcnt(7)
    s_barrier
    s_add_u32 m0, s70, 16384
    v_cvt_pk_bf16_f32 v184, v16, v17
    v_cvt_pk_bf16_f32 v185, v18, v19
    v_exp_f32 v20, v20
    v_exp_f32 v21, v21
    buffer_load_dwordx4 v1, s[16:19], s69 offen sc1 lds
    buffer_load_dwordx4 v1, s[16:19], s69 offen offset:1024 sc1 lds
    s_add_u32 s69, s69, 16384
    s_waitcnt lgkmcnt(3)
    v_mfma_f32_32x32x16_bf16 v[32:47], v[148:151], v[164:167], v[32:47]
    ds_read_b128 v[148:151], v6 offset:41984
    v_exp_f32 v22, v22
    v_exp_f32 v23, v23
    v_cvt_pk_bf16_f32 v186, v20, v21
    v_cvt_pk_bf16_f32 v187, v22, v23
    v_smfmac_f32_16x16x64_bf16 v[56:59], v[60:63], v[48:55], v192
    v_exp_f32 v24, v24
    v_exp_f32 v25, v25
    v_exp_f32 v26, v26
    v_exp_f32 v27, v27
    s_waitcnt lgkmcnt(3)
    v_mfma_f32_32x32x16_bf16 v[128:143], v[152:155], v[184:187], v[128:143]
    ds_read_b128 v[152:155], v6 offset:38912
    v_cvt_pk_bf16_f32 v188, v24, v25
    v_cvt_pk_bf16_f32 v189, v26, v27
    v_exp_f32 v28, v28
    v_exp_f32 v29, v29
    v_exp_f32 v30, v30
    v_exp_f32 v31, v31
    v_cvt_pk_bf16_f32 v190, v28, v29
    v_cvt_pk_bf16_f32 v191, v30, v31
    s_waitcnt lgkmcnt(3)
    v_mfma_f32_32x32x16_bf16 v[16:31], v[144:147], v[160:163], v[168:183]
    ds_read_b128 v[144:147], v6 offset:45056
    v_exp_f32 v32, v32
    v_exp_f32 v33, v33
    v_exp_f32 v34, v34
    v_exp_f32 v35, v35
    s_waitcnt lgkmcnt(3)
    v_mfma_f32_32x32x16_bf16 v[128:143], v[156:159], v[188:191], v[128:143]
    ds_read_b128 v[156:159], v6 offset:39936
    v_cvt_pk_bf16_f32 v48, v32, v33
    v_cvt_pk_bf16_f32 v49, v34, v35
    v_exp_f32 v36, v36
    v_exp_f32 v37, v37
    s_waitcnt lgkmcnt(3)
    v_mfma_f32_32x32x16_bf16 v[16:31], v[148:151], v[164:167], v[16:31]
    ds_read_b128 v[148:151], v6 offset:46080
    v_exp_f32 v38, v38
    v_exp_f32 v39, v39
    v_cvt_pk_bf16_f32 v50, v36, v37
    v_cvt_pk_bf16_f32 v51, v38, v39
    v_smfmac_f32_16x16x64_bf16 v[56:59], v[60:63], v[184:191], v192
    v_exp_f32 v40, v40
    v_exp_f32 v41, v41
    v_exp_f32 v42, v42
    v_exp_f32 v43, v43
    s_waitcnt lgkmcnt(3)
    v_mfma_f32_32x32x16_bf16 v[128:143], v[152:155], v[48:51], v[128:143]
    ds_read_b128 v[152:155], v6 offset:43008
    v_cvt_pk_bf16_f32 v52, v40, v41
    v_cvt_pk_bf16_f32 v53, v42, v43
    v_exp_f32 v44, v44
    v_exp_f32 v45, v45
    v_exp_f32 v46, v46
    v_exp_f32 v47, v47
    v_cvt_pk_bf16_f32 v54, v44, v45
    v_cvt_pk_bf16_f32 v55, v46, v47
    s_waitcnt lgkmcnt(3)
    v_mfma_f32_32x32x16_bf16 v[32:47], v[144:147], v[160:163], v[168:183]
    ds_read_b128 v[144:147], v6 offset:49152
    v_exp_f32 v16, v16
    v_exp_f32 v17, v17
    v_exp_f32 v18, v18
    v_exp_f32 v19, v19
    s_waitcnt lgkmcnt(3)
    v_mfma_f32_32x32x16_bf16 v[128:143], v[156:159], v[52:55], v[128:143]
    ds_read_b128 v[156:159], v6 offset:44032
    v_cvt_pk_bf16_f32 v184, v16, v17
    v_cvt_pk_bf16_f32 v185, v18, v19
    v_exp_f32 v20, v20
    v_exp_f32 v21, v21
    buffer_load_dwordx4 v[108:111], v12, s[12:15], s76 offen nt
    s_waitcnt lgkmcnt(3)
    v_mfma_f32_32x32x16_bf16 v[32:47], v[148:151], v[164:167], v[32:47]
    ds_read_b128 v[148:151], v6 offset:50176
    v_exp_f32 v22, v22
    v_exp_f32 v23, v23
    v_cvt_pk_bf16_f32 v186, v20, v21
    v_cvt_pk_bf16_f32 v187, v22, v23
    v_smfmac_f32_16x16x64_bf16 v[56:59], v[60:63], v[48:55], v192
    v_exp_f32 v24, v24
    v_exp_f32 v25, v25
    v_exp_f32 v26, v26
    v_exp_f32 v27, v27
    s_waitcnt lgkmcnt(3)
    v_mfma_f32_32x32x16_bf16 v[128:143], v[152:155], v[184:187], v[128:143]
    ds_read_b128 v[152:155], v6 offset:47104
    v_cvt_pk_bf16_f32 v188, v24, v25
    v_cvt_pk_bf16_f32 v189, v26, v27
    v_exp_f32 v28, v28
    v_exp_f32 v29, v29
    v_exp_f32 v30, v30
    v_exp_f32 v31, v31
    v_cvt_pk_bf16_f32 v190, v28, v29
    v_cvt_pk_bf16_f32 v191, v30, v31
    s_waitcnt lgkmcnt(3)
    v_mfma_f32_32x32x16_bf16 v[16:31], v[144:147], v[160:163], v[168:183]
    ds_read_b128 v[144:147], v6 offset:53248
    v_exp_f32 v32, v32
    v_exp_f32 v33, v33
    v_exp_f32 v34, v34
    v_exp_f32 v35, v35
    s_waitcnt lgkmcnt(3)
    v_mfma_f32_32x32x16_bf16 v[128:143], v[156:159], v[188:191], v[128:143]
    ds_read_b128 v[156:159], v6 offset:48128
    v_cvt_pk_bf16_f32 v48, v32, v33
    v_cvt_pk_bf16_f32 v49, v34, v35
    v_exp_f32 v36, v36
    v_exp_f32 v37, v37
    s_waitcnt lgkmcnt(3)
    v_mfma_f32_32x32x16_bf16 v[16:31], v[148:151], v[164:167], v[16:31]
    ds_read_b128 v[148:151], v6 offset:54272
    v_exp_f32 v38, v38
    v_exp_f32 v39, v39
    v_cvt_pk_bf16_f32 v50, v36, v37
    v_cvt_pk_bf16_f32 v51, v38, v39
    v_smfmac_f32_16x16x64_bf16 v[56:59], v[60:63], v[184:191], v192
    v_exp_f32 v40, v40
    v_exp_f32 v41, v41
    v_exp_f32 v42, v42
    v_exp_f32 v43, v43
    s_waitcnt lgkmcnt(3)
    v_mfma_f32_32x32x16_bf16 v[128:143], v[152:155], v[48:51], v[128:143]
    ds_read_b128 v[152:155], v6 offset:51200
    v_cvt_pk_bf16_f32 v52, v40, v41
    v_cvt_pk_bf16_f32 v53, v42, v43
    v_exp_f32 v44, v44
    v_exp_f32 v45, v45
    v_exp_f32 v46, v46
    v_exp_f32 v47, v47
    v_cvt_pk_bf16_f32 v54, v44, v45
    v_cvt_pk_bf16_f32 v55, v46, v47
    s_waitcnt lgkmcnt(3)
    v_mfma_f32_32x32x16_bf16 v[32:47], v[144:147], v[160:163], v[168:183]
    ds_read_b128 v[144:147], v6 offset:57344
    v_exp_f32 v16, v16
    v_exp_f32 v17, v17
    v_exp_f32 v18, v18
    v_exp_f32 v19, v19
    s_waitcnt lgkmcnt(3)
    v_mfma_f32_32x32x16_bf16 v[128:143], v[156:159], v[52:55], v[128:143]
    ds_read_b128 v[156:159], v6 offset:52224
    s_waitcnt vmcnt(6)
    s_barrier
    s_add_u32 m0, s70, 32768
    v_cvt_pk_bf16_f32 v184, v16, v17
    v_cvt_pk_bf16_f32 v185, v18, v19
    v_exp_f32 v20, v20
    v_exp_f32 v21, v21
    buffer_load_dwordx4 v1, s[16:19], s69 offen sc1 lds
    buffer_load_dwordx4 v1, s[16:19], s69 offen offset:1024 sc1 lds
    s_add_u32 s69, s69, 16384
    s_waitcnt lgkmcnt(3)
    v_mfma_f32_32x32x16_bf16 v[32:47], v[148:151], v[164:167], v[32:47]
    ds_read_b128 v[148:151], v6 offset:58368
    v_exp_f32 v22, v22
    v_exp_f32 v23, v23
    v_cvt_pk_bf16_f32 v186, v20, v21
    v_cvt_pk_bf16_f32 v187, v22, v23
    v_smfmac_f32_16x16x64_bf16 v[56:59], v[60:63], v[48:55], v192
    v_exp_f32 v24, v24
    v_exp_f32 v25, v25
    v_exp_f32 v26, v26
    v_exp_f32 v27, v27
    s_waitcnt lgkmcnt(3)
    v_mfma_f32_32x32x16_bf16 v[128:143], v[152:155], v[184:187], v[128:143]
    ds_read_b128 v[152:155], v6 offset:55296
    v_cvt_pk_bf16_f32 v188, v24, v25
    v_cvt_pk_bf16_f32 v189, v26, v27
    v_exp_f32 v28, v28
    v_exp_f32 v29, v29
    v_exp_f32 v30, v30
    v_exp_f32 v31, v31
    v_cvt_pk_bf16_f32 v190, v28, v29
    v_cvt_pk_bf16_f32 v191, v30, v31
    s_waitcnt lgkmcnt(3)
    v_mfma_f32_32x32x16_bf16 v[16:31], v[144:147], v[160:163], v[168:183]
    ds_read_b128 v[144:147], v6 offset:61440
    v_exp_f32 v32, v32
    v_exp_f32 v33, v33
    v_exp_f32 v34, v34
    v_exp_f32 v35, v35
    s_waitcnt lgkmcnt(3)
    v_mfma_f32_32x32x16_bf16 v[128:143], v[156:159], v[188:191], v[128:143]
    ds_read_b128 v[156:159], v6 offset:56320
    v_cvt_pk_bf16_f32 v48, v32, v33
    v_cvt_pk_bf16_f32 v49, v34, v35
    v_exp_f32 v36, v36
    v_exp_f32 v37, v37
    s_waitcnt lgkmcnt(3)
    v_mfma_f32_32x32x16_bf16 v[16:31], v[148:151], v[164:167], v[16:31]
    ds_read_b128 v[148:151], v6 offset:62464
    v_exp_f32 v38, v38
    v_exp_f32 v39, v39
    v_cvt_pk_bf16_f32 v50, v36, v37
    v_cvt_pk_bf16_f32 v51, v38, v39
    v_smfmac_f32_16x16x64_bf16 v[56:59], v[60:63], v[184:191], v192
    v_exp_f32 v40, v40
    v_exp_f32 v41, v41
    v_exp_f32 v42, v42
    v_exp_f32 v43, v43
    s_waitcnt lgkmcnt(3)
    v_mfma_f32_32x32x16_bf16 v[128:143], v[152:155], v[48:51], v[128:143]
    ds_read_b128 v[152:155], v6 offset:59392
    v_cvt_pk_bf16_f32 v52, v40, v41
    v_cvt_pk_bf16_f32 v53, v42, v43
    v_exp_f32 v44, v44
    v_exp_f32 v45, v45
    v_exp_f32 v46, v46
    v_exp_f32 v47, v47
    v_cvt_pk_bf16_f32 v54, v44, v45
    v_cvt_pk_bf16_f32 v55, v46, v47
    s_waitcnt lgkmcnt(3)
    v_mfma_f32_32x32x16_bf16 v[32:47], v[144:147], v[160:163], v[168:183]
    ds_read_b128 v[144:147], v6 offset:0
    v_exp_f32 v16, v16
    v_exp_f32 v17, v17
    v_exp_f32 v18, v18
    v_exp_f32 v19, v19
    s_waitcnt lgkmcnt(3)
    v_mfma_f32_32x32x16_bf16 v[128:143], v[156:159], v[52:55], v[128:143]
    ds_read_b128 v[156:159], v6 offset:60416
    v_cvt_pk_bf16_f32 v184, v16, v17
    v_cvt_pk_bf16_f32 v185, v18, v19
    v_exp_f32 v20, v20
    v_exp_f32 v21, v21
    s_mov_b32 m0, s73
    s_add_u32 s73, s73, 16384
    buffer_load_dwordx4 v4, s[8:11], s72 offen lds
    buffer_load_dwordx4 v5, s[8:11], s72 offen offset:1024 lds
    s_add_u32 s72, s72, 262144
    s_waitcnt lgkmcnt(3)
    v_mfma_f32_32x32x16_bf16 v[32:47], v[148:151], v[164:167], v[32:47]
    ds_read_b128 v[148:151], v6 offset:1024
    v_exp_f32 v22, v22
    v_exp_f32 v23, v23
    v_cvt_pk_bf16_f32 v186, v20, v21
    v_cvt_pk_bf16_f32 v187, v22, v23
    v_smfmac_f32_16x16x64_bf16 v[56:59], v[60:63], v[48:55], v192
    v_exp_f32 v24, v24
    v_exp_f32 v25, v25
    v_exp_f32 v26, v26
    v_exp_f32 v27, v27
    s_waitcnt lgkmcnt(3)
    v_mfma_f32_32x32x16_bf16 v[128:143], v[152:155], v[184:187], v[128:143]
    ds_read_b128 v[152:155], v6 offset:63488
    v_cvt_pk_bf16_f32 v188, v24, v25
    v_cvt_pk_bf16_f32 v189, v26, v27
    v_exp_f32 v28, v28
    v_exp_f32 v29, v29
    v_exp_f32 v30, v30
    v_exp_f32 v31, v31
    v_cvt_pk_bf16_f32 v190, v28, v29
    v_cvt_pk_bf16_f32 v191, v30, v31
    s_waitcnt lgkmcnt(3)
    v_mfma_f32_32x32x16_bf16 v[16:31], v[144:147], v[160:163], v[168:183]
    ds_read_b128 v[144:147], v6 offset:4096
    v_exp_f32 v32, v32
    v_exp_f32 v33, v33
    v_exp_f32 v34, v34
    v_exp_f32 v35, v35
    s_waitcnt lgkmcnt(3)
    v_mfma_f32_32x32x16_bf16 v[128:143], v[156:159], v[188:191], v[128:143]
    ds_read_b128 v[156:159], v6 offset:64512
    v_cvt_pk_bf16_f32 v48, v32, v33
    v_cvt_pk_bf16_f32 v49, v34, v35
    v_exp_f32 v36, v36
    v_exp_f32 v37, v37
    s_waitcnt lgkmcnt(3)
    v_mfma_f32_32x32x16_bf16 v[16:31], v[148:151], v[164:167], v[16:31]
    ds_read_b128 v[148:151], v6 offset:5120
    v_exp_f32 v38, v38
    v_exp_f32 v39, v39
    v_cvt_pk_bf16_f32 v50, v36, v37
    v_cvt_pk_bf16_f32 v51, v38, v39
    v_smfmac_f32_16x16x64_bf16 v[56:59], v[60:63], v[184:191], v192
    v_exp_f32 v40, v40
    v_exp_f32 v41, v41
    v_exp_f32 v42, v42
    v_exp_f32 v43, v43
    s_waitcnt lgkmcnt(3)
    v_mfma_f32_32x32x16_bf16 v[128:143], v[152:155], v[48:51], v[128:143]
    ds_read_b128 v[152:155], v6 offset:2048
    v_cvt_pk_bf16_f32 v52, v40, v41
    v_cvt_pk_bf16_f32 v53, v42, v43
    v_exp_f32 v44, v44
    v_exp_f32 v45, v45
    v_exp_f32 v46, v46
    v_exp_f32 v47, v47
    v_cvt_pk_bf16_f32 v54, v44, v45
    v_cvt_pk_bf16_f32 v55, v46, v47
    s_waitcnt lgkmcnt(3)
    v_mfma_f32_32x32x16_bf16 v[32:47], v[144:147], v[160:163], v[168:183]
    ds_read_b128 v[144:147], v6 offset:8192
    v_exp_f32 v16, v16
    v_exp_f32 v17, v17
    v_exp_f32 v18, v18
    v_exp_f32 v19, v19
    s_waitcnt lgkmcnt(3)
    v_mfma_f32_32x32x16_bf16 v[128:143], v[156:159], v[52:55], v[128:143]
    ds_read_b128 v[156:159], v6 offset:3072
    s_waitcnt vmcnt(5)
    s_barrier
    s_add_u32 m0, s70, 49152
    v_cvt_pk_bf16_f32 v184, v16, v17
    v_cvt_pk_bf16_f32 v185, v18, v19
    v_exp_f32 v20, v20
    v_exp_f32 v21, v21
    buffer_load_dwordx4 v1, s[16:19], s69 offen sc1 lds
    buffer_load_dwordx4 v1, s[16:19], s69 offen offset:1024 sc1 lds
    s_add_u32 s69, s69, 16384
    s_waitcnt lgkmcnt(3)
    v_mfma_f32_32x32x16_bf16 v[32:47], v[148:151], v[164:167], v[32:47]
    ds_read_b128 v[148:151], v6 offset:9216
    v_exp_f32 v22, v22
    v_exp_f32 v23, v23
    v_cvt_pk_bf16_f32 v186, v20, v21
    v_cvt_pk_bf16_f32 v187, v22, v23
    v_smfmac_f32_16x16x64_bf16 v[56:59], v[60:63], v[48:55], v192
    v_exp_f32 v24, v24
    v_exp_f32 v25, v25
    v_exp_f32 v26, v26
    v_exp_f32 v27, v27
    s_waitcnt lgkmcnt(3)
    v_mfma_f32_32x32x16_bf16 v[128:143], v[152:155], v[184:187], v[128:143]
    ds_read_b128 v[152:155], v6 offset:6144
    v_cvt_pk_bf16_f32 v188, v24, v25
    v_cvt_pk_bf16_f32 v189, v26, v27
    v_exp_f32 v28, v28
    v_exp_f32 v29, v29
    v_exp_f32 v30, v30
    v_exp_f32 v31, v31
    v_cvt_pk_bf16_f32 v190, v28, v29
    v_cvt_pk_bf16_f32 v191, v30, v31
    s_waitcnt lgkmcnt(3)
    v_mfma_f32_32x32x16_bf16 v[16:31], v[144:147], v[160:163], v[168:183]
    ds_read_b128 v[144:147], v6 offset:12288
    v_exp_f32 v32, v32
    v_exp_f32 v33, v33
    v_exp_f32 v34, v34
    v_exp_f32 v35, v35
    s_waitcnt lgkmcnt(3)
    v_mfma_f32_32x32x16_bf16 v[128:143], v[156:159], v[188:191], v[128:143]
    ds_read_b128 v[156:159], v6 offset:7168
    v_cvt_pk_bf16_f32 v48, v32, v33
    v_cvt_pk_bf16_f32 v49, v34, v35
    v_exp_f32 v36, v36
    v_exp_f32 v37, v37
    buffer_load_dwordx4 v[116:119], v11, s[4:7], s77 offen
    s_add_u32 s77, s77, 16384
    s_waitcnt lgkmcnt(3)
    v_mfma_f32_32x32x16_bf16 v[16:31], v[148:151], v[164:167], v[16:31]
    ds_read_b128 v[148:151], v6 offset:13312
    v_exp_f32 v38, v38
    v_exp_f32 v39, v39
    v_cvt_pk_bf16_f32 v50, v36, v37
    v_cvt_pk_bf16_f32 v51, v38, v39
    v_smfmac_f32_16x16x64_bf16 v[56:59], v[60:63], v[184:191], v192
    v_exp_f32 v40, v40
    v_exp_f32 v41, v41
    v_exp_f32 v42, v42
    v_exp_f32 v43, v43
    s_waitcnt lgkmcnt(3)
    v_mfma_f32_32x32x16_bf16 v[128:143], v[152:155], v[48:51], v[128:143]
    ds_read_b128 v[152:155], v6 offset:10240
    v_cvt_pk_bf16_f32 v52, v40, v41
    v_cvt_pk_bf16_f32 v53, v42, v43
    v_exp_f32 v44, v44
    v_exp_f32 v45, v45
    v_exp_f32 v46, v46
    v_exp_f32 v47, v47
    v_cvt_pk_bf16_f32 v54, v44, v45
    v_cvt_pk_bf16_f32 v55, v46, v47
    s_waitcnt lgkmcnt(3)
    v_mfma_f32_32x32x16_bf16 v[32:47], v[144:147], v[160:163], v[168:183]
    ds_read_b128 v[144:147], v6 offset:16384
    v_exp_f32 v16, v16
    v_exp_f32 v17, v17
    v_exp_f32 v18, v18
    v_exp_f32 v19, v19
    s_waitcnt lgkmcnt(3)
    v_mfma_f32_32x32x16_bf16 v[128:143], v[156:159], v[52:55], v[128:143]
    ds_read_b128 v[156:159], v6 offset:11264
    v_cvt_pk_bf16_f32 v184, v16, v17
    v_cvt_pk_bf16_f32 v185, v18, v19
    v_exp_f32 v20, v20
    v_exp_f32 v21, v21
    buffer_load_dwordx4 v[120:123], v11, s[4:7], s77 offen
    s_waitcnt lgkmcnt(3)
    v_mfma_f32_32x32x16_bf16 v[32:47], v[148:151], v[164:167], v[32:47]
    ds_read_b128 v[148:151], v6 offset:17408
    v_exp_f32 v22, v22
    v_exp_f32 v23, v23
    v_cvt_pk_bf16_f32 v186, v20, v21
    v_cvt_pk_bf16_f32 v187, v22, v23
    v_smfmac_f32_16x16x64_bf16 v[56:59], v[60:63], v[48:55], v192
    v_exp_f32 v24, v24
    v_exp_f32 v25, v25
    v_exp_f32 v26, v26
    v_exp_f32 v27, v27
    s_waitcnt lgkmcnt(3)
    v_mfma_f32_32x32x16_bf16 v[128:143], v[152:155], v[184:187], v[128:143]
    ds_read_b128 v[152:155], v6 offset:14336
    v_cvt_pk_bf16_f32 v188, v24, v25
    v_cvt_pk_bf16_f32 v189, v26, v27
    v_exp_f32 v28, v28
    v_exp_f32 v29, v29
    v_exp_f32 v30, v30
    v_exp_f32 v31, v31
    v_cvt_pk_bf16_f32 v190, v28, v29
    v_cvt_pk_bf16_f32 v191, v30, v31
    s_waitcnt lgkmcnt(3)
    v_mfma_f32_32x32x16_bf16 v[16:31], v[144:147], v[160:163], v[168:183]
    ds_read_b128 v[144:147], v6 offset:20480
    v_exp_f32 v32, v32
    v_exp_f32 v33, v33
    v_exp_f32 v34, v34
    v_exp_f32 v35, v35
    s_waitcnt lgkmcnt(3)
    v_mfma_f32_32x32x16_bf16 v[128:143], v[156:159], v[188:191], v[128:143]
    s_branch LadaLN_cond__grouped_kv_mqa__dense_activation_relu__prompt_kernel_over5
LadaLN_cond__grouped_kv_mqa__dense_activation_relu__prompt_kernel_stub5:
    s_setpc_b64 s[96:97]
LadaLN_cond__grouped_kv_mqa__dense_activation_relu__prompt_kernel_over5:
    ds_read_b128 v[156:159], v6 offset:15360
    v_cvt_pk_bf16_f32 v48, v32, v33
    v_cvt_pk_bf16_f32 v49, v34, v35
    v_exp_f32 v36, v36
    v_exp_f32 v37, v37
    buffer_store_dwordx4 v[92:95], v1, s[16:19], s79 offen offset:1024 sc1
    s_waitcnt lgkmcnt(3)
    v_mfma_f32_32x32x16_bf16 v[16:31], v[148:151], v[164:167], v[16:31]
    ds_read_b128 v[148:151], v6 offset:21504
    v_exp_f32 v38, v38
    v_exp_f32 v39, v39
    v_cvt_pk_bf16_f32 v50, v36, v37
    v_cvt_pk_bf16_f32 v51, v38, v39
    v_smfmac_f32_16x16x64_bf16 v[56:59], v[60:63], v[184:191], v192
    v_exp_f32 v40, v40
    v_exp_f32 v41, v41
    v_exp_f32 v42, v42
    v_exp_f32 v43, v43
    s_waitcnt lgkmcnt(3)
    v_mfma_f32_32x32x16_bf16 v[128:143], v[152:155], v[48:51], v[128:143]
    ds_read_b128 v[152:155], v6 offset:18432
    v_cvt_pk_bf16_f32 v52, v40, v41
    v_cvt_pk_bf16_f32 v53, v42, v43
    v_exp_f32 v44, v44
    v_exp_f32 v45, v45
    v_exp_f32 v46, v46
    v_exp_f32 v47, v47
    v_cvt_pk_bf16_f32 v54, v44, v45
    v_cvt_pk_bf16_f32 v55, v46, v47
    s_waitcnt lgkmcnt(3)
    v_mfma_f32_32x32x16_bf16 v[32:47], v[144:147], v[160:163], v[168:183]
    ds_read_b128 v[144:147], v6 offset:24576
    v_exp_f32 v16, v16
    v_exp_f32 v17, v17
    v_exp_f32 v18, v18
    v_exp_f32 v19, v19
    s_waitcnt lgkmcnt(3)
    v_mfma_f32_32x32x16_bf16 v[128:143], v[156:159], v[52:55], v[128:143]
    ds_read_b128 v[156:159], v6 offset:19456
    s_waitcnt vmcnt(7)
    s_barrier
    s_add_u32 m0, s70, 0
    v_cvt_pk_bf16_f32 v184, v16, v17
    v_cvt_pk_bf16_f32 v185, v18, v19
    v_exp_f32 v20, v20
    v_exp_f32 v21, v21
    buffer_load_dwordx4 v1, s[16:19], s69 offen sc1 lds
    buffer_load_dwordx4 v1, s[16:19], s69 offen offset:1024 sc1 lds
    s_add_u32 s69, s69, 16384
    s_waitcnt lgkmcnt(3)
    v_mfma_f32_32x32x16_bf16 v[32:47], v[148:151], v[164:167], v[32:47]
    ds_read_b128 v[148:151], v6 offset:25600
    v_exp_f32 v22, v22
    v_exp_f32 v23, v23
    v_cvt_pk_bf16_f32 v186, v20, v21
    v_cvt_pk_bf16_f32 v187, v22, v23
    v_smfmac_f32_16x16x64_bf16 v[56:59], v[60:63], v[48:55], v192
    v_exp_f32 v24, v24
    v_exp_f32 v25, v25
    v_exp_f32 v26, v26
    v_exp_f32 v27, v27
    s_waitcnt lgkmcnt(3)
    v_mfma_f32_32x32x16_bf16 v[128:143], v[152:155], v[184:187], v[128:143]
    ds_read_b128 v[152:155], v6 offset:22528
    v_cvt_pk_bf16_f32 v188, v24, v25
    v_cvt_pk_bf16_f32 v189, v26, v27
    v_exp_f32 v28, v28
    v_exp_f32 v29, v29
    v_exp_f32 v30, v30
    v_exp_f32 v31, v31
    v_cvt_pk_bf16_f32 v190, v28, v29
    v_cvt_pk_bf16_f32 v191, v30, v31
    s_waitcnt lgkmcnt(3)
    v_mfma_f32_32x32x16_bf16 v[16:31], v[144:147], v[160:163], v[168:183]
    ds_read_b128 v[144:147], v6 offset:28672
    v_exp_f32 v32, v32
    v_exp_f32 v33, v33
    v_exp_f32 v34, v34
    v_exp_f32 v35, v35
    s_waitcnt lgkmcnt(3)
    v_mfma_f32_32x32x16_bf16 v[128:143], v[156:159], v[188:191], v[128:143]
    ds_read_b128 v[156:159], v6 offset:23552
    v_cvt_pk_bf16_f32 v48, v32, v33
    v_cvt_pk_bf16_f32 v49, v34, v35
    v_exp_f32 v36, v36
    v_exp_f32 v37, v37
    s_waitcnt lgkmcnt(3)
    v_mfma_f32_32x32x16_bf16 v[16:31], v[148:151], v[164:167], v[16:31]
    ds_read_b128 v[148:151], v6 offset:29696
    v_exp_f32 v38, v38
    v_exp_f32 v39, v39
    v_cvt_pk_bf16_f32 v50, v36, v37
    v_cvt_pk_bf16_f32 v51, v38, v39
    v_smfmac_f32_16x16x64_bf16 v[56:59], v[60:63], v[184:191], v192
    v_exp_f32 v40, v40
    v_exp_f32 v41, v41
    v_exp_f32 v42, v42
    v_exp_f32 v43, v43
    s_waitcnt lgkmcnt(3)
    v_mfma_f32_32x32x16_bf16 v[128:143], v[152:155], v[48:51], v[128:143]
    ds_read_b128 v[152:155], v6 offset:26624
    v_cvt_pk_bf16_f32 v52, v40, v41
    v_cvt_pk_bf16_f32 v53, v42, v43
    v_exp_f32 v44, v44
    v_exp_f32 v45, v45
    v_exp_f32 v46, v46
    v_exp_f32 v47, v47
    v_cvt_pk_bf16_f32 v54, v44, v45
    v_cvt_pk_bf16_f32 v55, v46, v47
    s_waitcnt lgkmcnt(3)
    v_mfma_f32_32x32x16_bf16 v[32:47], v[144:147], v[160:163], v[168:183]
    ds_read_b128 v[144:147], v6 offset:32768
    v_exp_f32 v16, v16
    v_exp_f32 v17, v17
    v_exp_f32 v18, v18
    v_exp_f32 v19, v19
    s_waitcnt lgkmcnt(3)
    v_mfma_f32_32x32x16_bf16 v[128:143], v[156:159], v[52:55], v[128:143]
    ds_read_b128 v[156:159], v6 offset:27648
    v_cvt_pk_bf16_f32 v184, v16, v17
    v_cvt_pk_bf16_f32 v185, v18, v19
    v_exp_f32 v20, v20
    v_exp_f32 v21, v21
    s_mov_b32 m0, s73
    s_add_u32 s73, s73, 16384
    buffer_load_dwordx4 v4, s[8:11], s72 offen lds
    buffer_load_dwordx4 v5, s[8:11], s72 offen offset:1024 lds
    s_add_u32 s72, s72, 262144
    s_waitcnt lgkmcnt(3)
    v_mfma_f32_32x32x16_bf16 v[32:47], v[148:151], v[164:167], v[32:47]
    ds_read_b128 v[148:151], v6 offset:33792
    v_exp_f32 v22, v22
    v_exp_f32 v23, v23
    v_cvt_pk_bf16_f32 v186, v20, v21
    v_cvt_pk_bf16_f32 v187, v22, v23
    v_smfmac_f32_16x16x64_bf16 v[56:59], v[60:63], v[48:55], v192
    v_exp_f32 v24, v24
    v_exp_f32 v25, v25
    v_exp_f32 v26, v26
    v_exp_f32 v27, v27
    s_waitcnt lgkmcnt(3)
    v_mfma_f32_32x32x16_bf16 v[128:143], v[152:155], v[184:187], v[128:143]
    ds_read_b128 v[152:155], v6 offset:30720
    v_cvt_pk_bf16_f32 v188, v24, v25
    v_cvt_pk_bf16_f32 v189, v26, v27
    v_exp_f32 v28, v28
    v_exp_f32 v29, v29
    v_exp_f32 v30, v30
    v_exp_f32 v31, v31
    v_cvt_pk_bf16_f32 v190, v28, v29
    v_cvt_pk_bf16_f32 v191, v30, v31
    s_waitcnt lgkmcnt(3)
    v_mfma_f32_32x32x16_bf16 v[16:31], v[144:147], v[160:163], v[168:183]
    ds_read_b128 v[144:147], v6 offset:36864
    v_exp_f32 v32, v32
    v_exp_f32 v33, v33
    v_exp_f32 v34, v34
    v_exp_f32 v35, v35
    s_waitcnt lgkmcnt(3)
    v_mfma_f32_32x32x16_bf16 v[128:143], v[156:159], v[188:191], v[128:143]
    ds_read_b128 v[156:159], v6 offset:31744
    v_cvt_pk_bf16_f32 v48, v32, v33
    v_cvt_pk_bf16_f32 v49, v34, v35
    v_exp_f32 v36, v36
    v_exp_f32 v37, v37
    s_waitcnt lgkmcnt(3)
    v_mfma_f32_32x32x16_bf16 v[16:31], v[148:151], v[164:167], v[16:31]
    ds_read_b128 v[148:151], v6 offset:37888
    v_exp_f32 v38, v38
    v_exp_f32 v39, v39
    v_cvt_pk_bf16_f32 v50, v36, v37
    v_cvt_pk_bf16_f32 v51, v38, v39
    v_smfmac_f32_16x16x64_bf16 v[56:59], v[60:63], v[184:191], v192
    v_exp_f32 v40, v40
    v_exp_f32 v41, v41
    v_exp_f32 v42, v42
    v_exp_f32 v43, v43
    s_waitcnt lgkmcnt(3)
    v_mfma_f32_32x32x16_bf16 v[128:143], v[152:155], v[48:51], v[128:143]
    ds_read_b128 v[152:155], v6 offset:34816
    v_cvt_pk_bf16_f32 v52, v40, v41
    v_cvt_pk_bf16_f32 v53, v42, v43
    v_exp_f32 v44, v44
    v_exp_f32 v45, v45
    v_exp_f32 v46, v46
    v_exp_f32 v47, v47
    v_cvt_pk_bf16_f32 v54, v44, v45
    v_cvt_pk_bf16_f32 v55, v46, v47
    s_waitcnt lgkmcnt(3)
    v_mfma_f32_32x32x16_bf16 v[32:47], v[144:147], v[160:163], v[168:183]
    ds_read_b128 v[144:147], v6 offset:40960
    v_exp_f32 v16, v16
    v_exp_f32 v17, v17
    v_exp_f32 v18, v18
    v_exp_f32 v19, v19
    s_waitcnt lgkmcnt(3)
    v_mfma_f32_32x32x16_bf16 v[128:143], v[156:159], v[52:55], v[128:143]
    ds_read_b128 v[156:159], v6 offset:35840
    s_waitcnt vmcnt(7)
    s_barrier
    s_add_u32 m0, s70, 16384
    v_cvt_pk_bf16_f32 v184, v16, v17
    v_cvt_pk_bf16_f32 v185, v18, v19
    v_exp_f32 v20, v20
    v_exp_f32 v21, v21
    buffer_load_dwordx4 v1, s[16:19], s69 offen sc1 lds
    buffer_load_dwordx4 v1, s[16:19], s69 offen offset:1024 sc1 lds
    s_add_u32 s69, s69, 16384
    s_waitcnt lgkmcnt(3)
    v_mfma_f32_32x32x16_bf16 v[32:47], v[148:151], v[164:167], v[32:47]
    ds_read_b128 v[148:151], v6 offset:41984
    v_exp_f32 v22, v22
    v_exp_f32 v23, v23
    v_cvt_pk_bf16_f32 v186, v20, v21
    v_cvt_pk_bf16_f32 v187, v22, v23
    v_smfmac_f32_16x16x64_bf16 v[56:59], v[60:63], v[48:55], v192
    v_exp_f32 v24, v24
    v_exp_f32 v25, v25
    v_exp_f32 v26, v26
    v_exp_f32 v27, v27
    s_waitcnt lgkmcnt(3)
    v_mfma_f32_32x32x16_bf16 v[128:143], v[152:155], v[184:187], v[128:143]
    ds_read_b128 v[152:155], v6 offset:38912
    v_cvt_pk_bf16_f32 v188, v24, v25
    v_cvt_pk_bf16_f32 v189, v26, v27
    v_exp_f32 v28, v28
    v_exp_f32 v29, v29
    v_exp_f32 v30, v30
    v_exp_f32 v31, v31
    v_cvt_pk_bf16_f32 v190, v28, v29
    v_cvt_pk_bf16_f32 v191, v30, v31
    s_waitcnt lgkmcnt(3)
    v_mfma_f32_32x32x16_bf16 v[16:31], v[144:147], v[160:163], v[168:183]
    ds_read_b128 v[144:147], v6 offset:45056
    v_exp_f32 v32, v32
    v_exp_f32 v33, v33
    v_exp_f32 v34, v34
    v_exp_f32 v35, v35
    s_waitcnt lgkmcnt(3)
    v_mfma_f32_32x32x16_bf16 v[128:143], v[156:159], v[188:191], v[128:143]
    ds_read_b128 v[156:159], v6 offset:39936
    v_cvt_pk_bf16_f32 v48, v32, v33
    v_cvt_pk_bf16_f32 v49, v34, v35
    v_exp_f32 v36, v36
    v_exp_f32 v37, v37
    s_waitcnt lgkmcnt(3)
    v_mfma_f32_32x32x16_bf16 v[16:31], v[148:151], v[164:167], v[16:31]
    ds_read_b128 v[148:151], v6 offset:46080
    v_exp_f32 v38, v38
    v_exp_f32 v39, v39
    v_cvt_pk_bf16_f32 v50, v36, v37
    v_cvt_pk_bf16_f32 v51, v38, v39
    v_smfmac_f32_16x16x64_bf16 v[56:59], v[60:63], v[184:191], v192
    v_exp_f32 v40, v40
    v_exp_f32 v41, v41
    v_exp_f32 v42, v42
    v_exp_f32 v43, v43
    s_waitcnt lgkmcnt(3)
    v_mfma_f32_32x32x16_bf16 v[128:143], v[152:155], v[48:51], v[128:143]
    ds_read_b128 v[152:155], v6 offset:43008
    v_cvt_pk_bf16_f32 v52, v40, v41
    v_cvt_pk_bf16_f32 v53, v42, v43
    v_exp_f32 v44, v44
    v_exp_f32 v45, v45
    v_exp_f32 v46, v46
    v_exp_f32 v47, v47
    v_cvt_pk_bf16_f32 v54, v44, v45
    v_cvt_pk_bf16_f32 v55, v46, v47
    s_waitcnt lgkmcnt(3)
    v_mfma_f32_32x32x16_bf16 v[32:47], v[144:147], v[160:163], v[168:183]
    ds_read_b128 v[144:147], v6 offset:49152
    v_exp_f32 v16, v16
    v_exp_f32 v17, v17
    v_exp_f32 v18, v18
    v_exp_f32 v19, v19
    s_waitcnt lgkmcnt(3)
    v_mfma_f32_32x32x16_bf16 v[128:143], v[156:159], v[52:55], v[128:143]
    ds_read_b128 v[156:159], v6 offset:44032
    v_cvt_pk_bf16_f32 v184, v16, v17
    v_cvt_pk_bf16_f32 v185, v18, v19
    v_exp_f32 v20, v20
    v_exp_f32 v21, v21
    s_mov_b32 m0, s73
    s_add_u32 s73, s73, 16384
    buffer_load_dwordx4 v4, s[8:11], s72 offen lds
    buffer_load_dwordx4 v5, s[8:11], s72 offen offset:1024 lds
    s_add_u32 s72, s72, 262144
    s_waitcnt lgkmcnt(3)
    v_mfma_f32_32x32x16_bf16 v[32:47], v[148:151], v[164:167], v[32:47]
    ds_read_b128 v[148:151], v6 offset:50176
    v_exp_f32 v22, v22
    v_exp_f32 v23, v23
    v_cvt_pk_bf16_f32 v186, v20, v21
    v_cvt_pk_bf16_f32 v187, v22, v23
    v_smfmac_f32_16x16x64_bf16 v[56:59], v[60:63], v[48:55], v192
    v_exp_f32 v24, v24
    v_exp_f32 v25, v25
    v_exp_f32 v26, v26
    v_exp_f32 v27, v27
    s_waitcnt lgkmcnt(3)
    v_mfma_f32_32x32x16_bf16 v[128:143], v[152:155], v[184:187], v[128:143]
    ds_read_b128 v[152:155], v6 offset:47104
    v_cvt_pk_bf16_f32 v188, v24, v25
    v_cvt_pk_bf16_f32 v189, v26, v27
    v_exp_f32 v28, v28
    v_exp_f32 v29, v29
    v_exp_f32 v30, v30
    v_exp_f32 v31, v31
    v_cvt_pk_bf16_f32 v190, v28, v29
    v_cvt_pk_bf16_f32 v191, v30, v31
    s_waitcnt lgkmcnt(3)
    v_mfma_f32_32x32x16_bf16 v[16:31], v[144:147], v[160:163], v[168:183]
    ds_read_b128 v[144:147], v6 offset:53248
    v_exp_f32 v32, v32
    v_exp_f32 v33, v33
    v_exp_f32 v34, v34
    v_exp_f32 v35, v35
    s_waitcnt lgkmcnt(3)
    v_mfma_f32_32x32x16_bf16 v[128:143], v[156:159], v[188:191], v[128:143]
    ds_read_b128 v[156:159], v6 offset:48128
    v_cvt_pk_bf16_f32 v48, v32, v33
    v_cvt_pk_bf16_f32 v49, v34, v35
    v_exp_f32 v36, v36
    v_exp_f32 v37, v37
    s_waitcnt lgkmcnt(3)
    v_mfma_f32_32x32x16_bf16 v[16:31], v[148:151], v[164:167], v[16:31]
    ds_read_b128 v[148:151], v6 offset:54272
    v_exp_f32 v38, v38
    v_exp_f32 v39, v39
    v_cvt_pk_bf16_f32 v50, v36, v37
    v_cvt_pk_bf16_f32 v51, v38, v39
    v_smfmac_f32_16x16x64_bf16 v[56:59], v[60:63], v[184:191], v192
    v_exp_f32 v40, v40
    v_exp_f32 v41, v41
    v_exp_f32 v42, v42
    v_exp_f32 v43, v43
    s_waitcnt lgkmcnt(3)
    v_mfma_f32_32x32x16_bf16 v[128:143], v[152:155], v[48:51], v[128:143]
    ds_read_b128 v[152:155], v6 offset:51200
    v_cvt_pk_bf16_f32 v52, v40, v41
    v_cvt_pk_bf16_f32 v53, v42, v43
    v_exp_f32 v44, v44
    v_exp_f32 v45, v45
    v_exp_f32 v46, v46
    v_exp_f32 v47, v47
    v_cvt_pk_bf16_f32 v54, v44, v45
    v_cvt_pk_bf16_f32 v55, v46, v47
    s_waitcnt lgkmcnt(3)
    v_mfma_f32_32x32x16_bf16 v[32:47], v[144:147], v[160:163], v[168:183]
    ds_read_b128 v[144:147], v6 offset:57344
    v_exp_f32 v16, v16
    v_exp_f32 v17, v17
    v_exp_f32 v18, v18
    v_exp_f32 v19, v19
    s_waitcnt lgkmcnt(3)
    v_mfma_f32_32x32x16_bf16 v[128:143], v[156:159], v[52:55], v[128:143]
    ds_read_b128 v[156:159], v6 offset:52224
    s_waitcnt vmcnt(6)
    s_barrier
    v_cvt_pk_bf16_f32 v184, v16, v17
    v_cvt_pk_bf16_f32 v185, v18, v19
    v_exp_f32 v20, v20
    v_exp_f32 v21, v21
    s_waitcnt lgkmcnt(3)
    v_mfma_f32_32x32x16_bf16 v[32:47], v[148:151], v[164:167], v[32:47]
    ds_read_b128 v[148:151], v6 offset:58368
    v_exp_f32 v22, v22
    v_exp_f32 v23, v23
    v_cvt_pk_bf16_f32 v186, v20, v21
    v_cvt_pk_bf16_f32 v187, v22, v23
    v_smfmac_f32_16x16x64_bf16 v[56:59], v[60:63], v[48:55], v192
    v_exp_f32 v24, v24
    v_exp_f32 v25, v25
    v_exp_f32 v26, v26
    v_exp_f32 v27, v27
    s_waitcnt lgkmcnt(3)
    v_mfma_f32_32x32x16_bf16 v[128:143], v[152:155], v[184:187], v[128:143]
    ds_read_b128 v[152:155], v6 offset:55296
    v_cvt_pk_bf16_f32 v188, v24, v25
    v_cvt_pk_bf16_f32 v189, v26, v27
    v_exp_f32 v28, v28
    v_exp_f32 v29, v29
    v_exp_f32 v30, v30
    v_exp_f32 v31, v31
    v_cvt_pk_bf16_f32 v190, v28, v29
    v_cvt_pk_bf16_f32 v191, v30, v31
    s_waitcnt lgkmcnt(3)
    v_mfma_f32_32x32x16_bf16 v[16:31], v[144:147], v[160:163], v[168:183]
    ds_read_b128 v[144:147], v6 offset:61440
    v_exp_f32 v32, v32
    v_exp_f32 v33, v33
    v_exp_f32 v34, v34
    v_exp_f32 v35, v35
    s_waitcnt lgkmcnt(3)
    v_mfma_f32_32x32x16_bf16 v[128:143], v[156:159], v[188:191], v[128:143]
    ds_read_b128 v[156:159], v6 offset:56320
    v_cvt_pk_bf16_f32 v48, v32, v33
    v_cvt_pk_bf16_f32 v49, v34, v35
    v_exp_f32 v36, v36
    v_exp_f32 v37, v37
    s_waitcnt lgkmcnt(3)
    v_mfma_f32_32x32x16_bf16 v[16:31], v[148:151], v[164:167], v[16:31]
    ds_read_b128 v[148:151], v6 offset:62464
    v_exp_f32 v38, v38
    v_exp_f32 v39, v39
    v_cvt_pk_bf16_f32 v50, v36, v37
    v_cvt_pk_bf16_f32 v51, v38, v39
    v_smfmac_f32_16x16x64_bf16 v[56:59], v[60:63], v[184:191], v192
    v_exp_f32 v40, v40
    v_exp_f32 v41, v41
    v_exp_f32 v42, v42
    v_exp_f32 v43, v43
    s_waitcnt lgkmcnt(3)
    v_mfma_f32_32x32x16_bf16 v[128:143], v[152:155], v[48:51], v[128:143]
    ds_read_b128 v[152:155], v6 offset:59392
    v_cvt_pk_bf16_f32 v52, v40, v41
    v_cvt_pk_bf16_f32 v53, v42, v43
    v_exp_f32 v44, v44
    v_exp_f32 v45, v45
    v_exp_f32 v46, v46
    v_exp_f32 v47, v47
    v_cvt_pk_bf16_f32 v54, v44, v45
    v_cvt_pk_bf16_f32 v55, v46, v47
    s_waitcnt lgkmcnt(3)
    v_mfma_f32_32x32x16_bf16 v[32:47], v[144:147], v[160:163], v[168:183]
    ds_read_b128 v[144:147], v6 offset:0
    v_exp_f32 v16, v16
    v_exp_f32 v17, v17
    v_exp_f32 v18, v18
    v_exp_f32 v19, v19
    s_waitcnt lgkmcnt(3)
    v_mfma_f32_32x32x16_bf16 v[128:143], v[156:159], v[52:55], v[128:143]
    ds_read_b128 v[156:159], v6 offset:60416
    v_cvt_pk_bf16_f32 v184, v16, v17
    v_cvt_pk_bf16_f32 v185, v18, v19
    v_exp_f32 v20, v20
    v_exp_f32 v21, v21
    s_add_u32 s73, s73, 32768
    s_mov_b32 m0, s73
    s_add_u32 s73, s73, 16384
    buffer_load_dwordx4 v4, s[8:11], s72 offen lds
    buffer_load_dwordx4 v5, s[8:11], s72 offen offset:1024 lds
    s_add_u32 s72, s72, 262144
    s_waitcnt lgkmcnt(3)
    v_mfma_f32_32x32x16_bf16 v[32:47], v[148:151], v[164:167], v[32:47]
    ds_read_b128 v[148:151], v6 offset:1024
    v_exp_f32 v22, v22
    v_exp_f32 v23, v23
    v_cvt_pk_bf16_f32 v186, v20, v21
    v_cvt_pk_bf16_f32 v187, v22, v23
    v_smfmac_f32_16x16x64_bf16 v[56:59], v[60:63], v[48:55], v192
    v_exp_f32 v24, v24
    v_exp_f32 v25, v25
    v_exp_f32 v26, v26
    v_exp_f32 v27, v27
    s_waitcnt lgkmcnt(3)
    v_mfma_f32_32x32x16_bf16 v[128:143], v[152:155], v[184:187], v[128:143]
    ds_read_b128 v[152:155], v6 offset:63488
    v_cvt_pk_bf16_f32 v188, v24, v25
    v_cvt_pk_bf16_f32 v189, v26, v27
    v_exp_f32 v28, v28
    v_exp_f32 v29, v29
    v_exp_f32 v30, v30
    v_exp_f32 v31, v31
    v_cvt_pk_bf16_f32 v190, v28, v29
    v_cvt_pk_bf16_f32 v191, v30, v31
    s_waitcnt lgkmcnt(3)
    v_mfma_f32_32x32x16_bf16 v[16:31], v[144:147], v[160:163], v[168:183]
    ds_read_b128 v[144:147], v6 offset:4096
    v_exp_f32 v32, v32
    v_exp_f32 v33, v33
    v_exp_f32 v34, v34
    v_exp_f32 v35, v35
    s_waitcnt lgkmcnt(3)
    v_mfma_f32_32x32x16_bf16 v[128:143], v[156:159], v[188:191], v[128:143]
    ds_read_b128 v[156:159], v6 offset:64512
    v_cvt_pk_bf16_f32 v48, v32, v33
    v_cvt_pk_bf16_f32 v49, v34, v35
    v_exp_f32 v36, v36
    v_exp_f32 v37, v37
    s_waitcnt lgkmcnt(3)
    v_mfma_f32_32x32x16_bf16 v[16:31], v[148:151], v[164:167], v[16:31]
    ds_read_b128 v[148:151], v6 offset:5120
    v_exp_f32 v38, v38
    v_exp_f32 v39, v39
    v_cvt_pk_bf16_f32 v50, v36, v37
    v_cvt_pk_bf16_f32 v51, v38, v39
    v_smfmac_f32_16x16x64_bf16 v[56:59], v[60:63], v[184:191], v192
    v_exp_f32 v40, v40
    v_exp_f32 v41, v41
    v_exp_f32 v42, v42
    v_exp_f32 v43, v43
    s_waitcnt lgkmcnt(3)
    v_mfma_f32_32x32x16_bf16 v[128:143], v[152:155], v[48:51], v[128:143]
    ds_read_b128 v[152:155], v6 offset:2048
    v_cvt_pk_bf16_f32 v52, v40, v41
    v_cvt_pk_bf16_f32 v53, v42, v43
    v_exp_f32 v44, v44
    v_exp_f32 v45, v45
    v_exp_f32 v46, v46
    v_exp_f32 v47, v47
    v_cvt_pk_bf16_f32 v54, v44, v45
    v_cvt_pk_bf16_f32 v55, v46, v47
    s_waitcnt lgkmcnt(3)
    v_mfma_f32_32x32x16_bf16 v[32:47], v[144:147], v[160:163], v[168:183]
    ds_read_b128 v[144:147], v6 offset:8192
    v_exp_f32 v16, v16
    v_exp_f32 v17, v17
    v_exp_f32 v18, v18
    v_exp_f32 v19, v19
    s_waitcnt lgkmcnt(3)
    v_mfma_f32_32x32x16_bf16 v[128:143], v[156:159], v[52:55], v[128:143]
    ds_read_b128 v[156:159], v6 offset:3072
    s_waitcnt vmcnt(4)
    s_barrier
    v_cvt_pk_bf16_f32 v184, v16, v17
    v_cvt_pk_bf16_f32 v185, v18, v19
    v_exp_f32 v20, v20
    v_exp_f32 v21, v21
    s_waitcnt lgkmcnt(3)
    v_mfma_f32_32x32x16_bf16 v[32:47], v[148:151], v[164:167], v[32:47]
    ds_read_b128 v[148:151], v6 offset:9216
    v_exp_f32 v22, v22
    v_exp_f32 v23, v23
    v_cvt_pk_bf16_f32 v186, v20, v21
    v_cvt_pk_bf16_f32 v187, v22, v23
    v_smfmac_f32_16x16x64_bf16 v[56:59], v[60:63], v[48:55], v192
    v_exp_f32 v24, v24
    v_exp_f32 v25, v25
    v_exp_f32 v26, v26
    v_exp_f32 v27, v27
    s_waitcnt lgkmcnt(3)
    v_mfma_f32_32x32x16_bf16 v[128:143], v[152:155], v[184:187], v[128:143]
    ds_read_b128 v[152:155], v6 offset:6144
    v_cvt_pk_bf16_f32 v188, v24, v25
    v_cvt_pk_bf16_f32 v189, v26, v27
    v_exp_f32 v28, v28
    v_exp_f32 v29, v29
    v_exp_f32 v30, v30
    v_exp_f32 v31, v31
    v_cvt_pk_bf16_f32 v190, v28, v29
    v_cvt_pk_bf16_f32 v191, v30, v31
    s_waitcnt lgkmcnt(3)
    v_mfma_f32_32x32x16_bf16 v[16:31], v[144:147], v[160:163], v[168:183]
    ds_read_b128 v[144:147], v6 offset:12288
    v_exp_f32 v32, v32
    v_exp_f32 v33, v33
    v_exp_f32 v34, v34
    v_exp_f32 v35, v35
    s_waitcnt lgkmcnt(3)
    v_mfma_f32_32x32x16_bf16 v[128:143], v[156:159], v[188:191], v[128:143]
    ds_read_b128 v[156:159], v6 offset:7168
    v_cvt_pk_bf16_f32 v48, v32, v33
    v_cvt_pk_bf16_f32 v49, v34, v35
    v_exp_f32 v36, v36
    v_exp_f32 v37, v37
    s_waitcnt lgkmcnt(3)
    v_mfma_f32_32x32x16_bf16 v[16:31], v[148:151], v[164:167], v[16:31]
    ds_read_b128 v[148:151], v6 offset:13312
    v_exp_f32 v38, v38
    v_exp_f32 v39, v39
    v_cvt_pk_bf16_f32 v50, v36, v37
    v_cvt_pk_bf16_f32 v51, v38, v39
    v_smfmac_f32_16x16x64_bf16 v[56:59], v[60:63], v[184:191], v192
    v_exp_f32 v40, v40
    v_exp_f32 v41, v41
    v_exp_f32 v42, v42
    v_exp_f32 v43, v43
    s_waitcnt lgkmcnt(3)
    v_mfma_f32_32x32x16_bf16 v[128:143], v[152:155], v[48:51], v[128:143]
    ds_read_b128 v[152:155], v6 offset:10240
    v_cvt_pk_bf16_f32 v52, v40, v41
    v_cvt_pk_bf16_f32 v53, v42, v43
    v_exp_f32 v44, v44
    v_exp_f32 v45, v45
    v_exp_f32 v46, v46
    v_exp_f32 v47, v47
    v_cvt_pk_bf16_f32 v54, v44, v45
    v_cvt_pk_bf16_f32 v55, v46, v47
    s_waitcnt lgkmcnt(3)
    v_mfma_f32_32x32x16_bf16 v[32:47], v[144:147], v[160:163], v[168:183]
    ds_read_b128 v[144:147], v6 offset:16384
    v_exp_f32 v16, v16
    v_exp_f32 v17, v17
    v_exp_f32 v18, v18
    v_exp_f32 v19, v19
    s_waitcnt lgkmcnt(3)
    v_mfma_f32_32x32x16_bf16 v[128:143], v[156:159], v[52:55], v[128:143]
    ds_read_b128 v[156:159], v6 offset:11264
    v_cvt_pk_bf16_f32 v184, v16, v17
    v_cvt_pk_bf16_f32 v185, v18, v19
    v_exp_f32 v20, v20
    v_exp_f32 v21, v21
    s_mov_b32 m0, s73
    s_add_u32 s73, s73, 16384
    buffer_load_dwordx4 v4, s[8:11], s72 offen lds
    buffer_load_dwordx4 v5, s[8:11], s72 offen offset:1024 lds
    s_add_u32 s72, s72, 262144
    s_waitcnt lgkmcnt(3)
    v_mfma_f32_32x32x16_bf16 v[32:47], v[148:151], v[164:167], v[32:47]
    ds_read_b128 v[148:151], v6 offset:17408
    v_exp_f32 v22, v22
    v_exp_f32 v23, v23
    v_cvt_pk_bf16_f32 v186, v20, v21
    v_cvt_pk_bf16_f32 v187, v22, v23
    v_smfmac_f32_16x16x64_bf16 v[56:59], v[60:63], v[48:55], v192
    v_exp_f32 v24, v24
    v_exp_f32 v25, v25
    v_exp_f32 v26, v26
    v_exp_f32 v27, v27
    s_waitcnt lgkmcnt(3)
    v_mfma_f32_32x32x16_bf16 v[128:143], v[152:155], v[184:187], v[128:143]
    ds_read_b128 v[152:155], v6 offset:14336
    v_cvt_pk_bf16_f32 v188, v24, v25
    v_cvt_pk_bf16_f32 v189, v26, v27
    v_exp_f32 v28, v28
    v_exp_f32 v29, v29
    v_exp_f32 v30, v30
    v_exp_f32 v31, v31
    v_cvt_pk_bf16_f32 v190, v28, v29
    v_cvt_pk_bf16_f32 v191, v30, v31
    s_waitcnt lgkmcnt(3)
    v_mfma_f32_32x32x16_bf16 v[16:31], v[144:147], v[160:163], v[168:183]
    ds_read_b128 v[144:147], v6 offset:20480
    v_exp_f32 v32, v32
    v_exp_f32 v33, v33
    v_exp_f32 v34, v34
    v_exp_f32 v35, v35
    s_waitcnt lgkmcnt(3)
    v_mfma_f32_32x32x16_bf16 v[128:143], v[156:159], v[188:191], v[128:143]
    ds_read_b128 v[156:159], v6 offset:15360
    v_cvt_pk_bf16_f32 v48, v32, v33
    v_cvt_pk_bf16_f32 v49, v34, v35
    v_exp_f32 v36, v36
    v_exp_f32 v37, v37
    s_waitcnt lgkmcnt(3)
    v_mfma_f32_32x32x16_bf16 v[16:31], v[148:151], v[164:167], v[16:31]
    ds_read_b128 v[148:151], v6 offset:21504
    v_exp_f32 v38, v38
    v_exp_f32 v39, v39
    v_cvt_pk_bf16_f32 v50, v36, v37
    v_cvt_pk_bf16_f32 v51, v38, v39
    v_smfmac_f32_16x16x64_bf16 v[56:59], v[60:63], v[184:191], v192
    v_exp_f32 v40, v40
    v_exp_f32 v41, v41
    v_exp_f32 v42, v42
    v_exp_f32 v43, v43
    s_waitcnt lgkmcnt(3)
    v_mfma_f32_32x32x16_bf16 v[128:143], v[152:155], v[48:51], v[128:143]
    ds_read_b128 v[152:155], v6 offset:18432
    v_cvt_pk_bf16_f32 v52, v40, v41
    v_cvt_pk_bf16_f32 v53, v42, v43
    v_exp_f32 v44, v44
    v_exp_f32 v45, v45
    v_exp_f32 v46, v46
    v_exp_f32 v47, v47
    v_cvt_pk_bf16_f32 v54, v44, v45
    v_cvt_pk_bf16_f32 v55, v46, v47
    s_waitcnt lgkmcnt(3)
    v_mfma_f32_32x32x16_bf16 v[32:47], v[144:147], v[160:163], v[168:183]
    ds_read_b128 v[144:147], v6 offset:24576
    v_exp_f32 v16, v16
    v_exp_f32 v17, v17
    v_exp_f32 v18, v18
    v_exp_f32 v19, v19
    s_waitcnt lgkmcnt(3)
    v_mfma_f32_32x32x16_bf16 v[128:143], v[156:159], v[52:55], v[128:143]
    ds_read_b128 v[156:159], v6 offset:19456
    s_barrier
    v_cvt_pk_bf16_f32 v184, v16, v17
    v_cvt_pk_bf16_f32 v185, v18, v19
    v_exp_f32 v20, v20
    v_exp_f32 v21, v21
    s_waitcnt lgkmcnt(3)
    v_mfma_f32_32x32x16_bf16 v[32:47], v[148:151], v[164:167], v[32:47]
    ds_read_b128 v[148:151], v6 offset:25600
    v_exp_f32 v22, v22
    v_exp_f32 v23, v23
    v_cvt_pk_bf16_f32 v186, v20, v21
    v_cvt_pk_bf16_f32 v187, v22, v23
    v_smfmac_f32_16x16x64_bf16 v[56:59], v[60:63], v[48:55], v192
    v_exp_f32 v24, v24
    v_exp_f32 v25, v25
    v_exp_f32 v26, v26
    v_exp_f32 v27, v27
    s_waitcnt lgkmcnt(3)
    v_mfma_f32_32x32x16_bf16 v[128:143], v[152:155], v[184:187], v[128:143]
    ds_read_b128 v[152:155], v6 offset:22528
    v_cvt_pk_bf16_f32 v188, v24, v25
    v_cvt_pk_bf16_f32 v189, v26, v27
    v_exp_f32 v28, v28
    v_exp_f32 v29, v29
    v_exp_f32 v30, v30
    v_exp_f32 v31, v31
    v_cvt_pk_bf16_f32 v190, v28, v29
    s_branch LadaLN_cond__grouped_kv_mqa__dense_activation_relu__prompt_kernel_over6
LadaLN_cond__grouped_kv_mqa__dense_activation_relu__prompt_kernel_stub6:
    s_setpc_b64 s[96:97]
LadaLN_cond__grouped_kv_mqa__dense_activation_relu__prompt_kernel_over6:
    v_cvt_pk_bf16_f32 v191, v30, v31
    s_waitcnt lgkmcnt(3)
    v_mfma_f32_32x32x16_bf16 v[16:31], v[144:147], v[160:163], v[168:183]
    ds_read_b128 v[144:147], v6 offset:28672
    v_exp_f32 v32, v32
    v_exp_f32 v33, v33
    v_exp_f32 v34, v34
    v_exp_f32 v35, v35
    s_waitcnt lgkmcnt(3)
    v_mfma_f32_32x32x16_bf16 v[128:143], v[156:159], v[188:191], v[128:143]
    ds_read_b128 v[156:159], v6 offset:23552
    v_cvt_pk_bf16_f32 v48, v32, v33
    v_cvt_pk_bf16_f32 v49, v34, v35
    v_exp_f32 v36, v36
    v_exp_f32 v37, v37
    s_waitcnt lgkmcnt(3)
    v_mfma_f32_32x32x16_bf16 v[16:31], v[148:151], v[164:167], v[16:31]
    ds_read_b128 v[148:151], v6 offset:29696
    v_exp_f32 v38, v38
    v_exp_f32 v39, v39
    v_cvt_pk_bf16_f32 v50, v36, v37
    v_cvt_pk_bf16_f32 v51, v38, v39
    v_smfmac_f32_16x16x64_bf16 v[56:59], v[60:63], v[184:191], v192
    v_exp_f32 v40, v40
    v_exp_f32 v41, v41
    v_exp_f32 v42, v42
    v_exp_f32 v43, v43
    s_waitcnt lgkmcnt(3)
    v_mfma_f32_32x32x16_bf16 v[128:143], v[152:155], v[48:51], v[128:143]
    ds_read_b128 v[152:155], v6 offset:26624
    v_cvt_pk_bf16_f32 v52, v40, v41
    v_cvt_pk_bf16_f32 v53, v42, v43
    v_exp_f32 v44, v44
    v_exp_f32 v45, v45
    v_exp_f32 v46, v46
    v_exp_f32 v47, v47
    v_cvt_pk_bf16_f32 v54, v44, v45
    v_cvt_pk_bf16_f32 v55, v46, v47
    s_waitcnt lgkmcnt(3)
    v_mfma_f32_32x32x16_bf16 v[32:47], v[144:147], v[160:163], v[168:183]
    ds_read_b128 v[144:147], v6 offset:32768
    v_exp_f32 v16, v16
    v_exp_f32 v17, v17
    v_exp_f32 v18, v18
    v_exp_f32 v19, v19
    s_waitcnt lgkmcnt(3)
    v_mfma_f32_32x32x16_bf16 v[128:143], v[156:159], v[52:55], v[128:143]
    ds_read_b128 v[156:159], v6 offset:27648
    v_cvt_pk_bf16_f32 v184, v16, v17
    v_cvt_pk_bf16_f32 v185, v18, v19
    v_exp_f32 v20, v20
    v_exp_f32 v21, v21
    s_waitcnt lgkmcnt(3)
    v_mfma_f32_32x32x16_bf16 v[32:47], v[148:151], v[164:167], v[32:47]
    ds_read_b128 v[148:151], v6 offset:33792
    v_exp_f32 v22, v22
    v_exp_f32 v23, v23
    v_cvt_pk_bf16_f32 v186, v20, v21
    v_cvt_pk_bf16_f32 v187, v22, v23
    v_smfmac_f32_16x16x64_bf16 v[56:59], v[60:63], v[48:55], v192
    v_exp_f32 v24, v24
    v_exp_f32 v25, v25
    v_exp_f32 v26, v26
    v_exp_f32 v27, v27
    s_waitcnt lgkmcnt(3)
    v_mfma_f32_32x32x16_bf16 v[128:143], v[152:155], v[184:187], v[128:143]
    ds_read_b128 v[152:155], v6 offset:30720
    v_cvt_pk_bf16_f32 v188, v24, v25
    v_cvt_pk_bf16_f32 v189, v26, v27
    v_exp_f32 v28, v28
    v_exp_f32 v29, v29
    v_exp_f32 v30, v30
    v_exp_f32 v31, v31
    v_cvt_pk_bf16_f32 v190, v28, v29
    v_cvt_pk_bf16_f32 v191, v30, v31
    s_waitcnt lgkmcnt(3)
    v_mfma_f32_32x32x16_bf16 v[16:31], v[144:147], v[160:163], v[168:183]
    ds_read_b128 v[144:147], v6 offset:36864
    v_exp_f32 v32, v32
    v_exp_f32 v33, v33
    v_exp_f32 v34, v34
    v_exp_f32 v35, v35
    s_waitcnt lgkmcnt(3)
    v_mfma_f32_32x32x16_bf16 v[128:143], v[156:159], v[188:191], v[128:143]
    ds_read_b128 v[156:159], v6 offset:31744
    v_cvt_pk_bf16_f32 v48, v32, v33
    v_cvt_pk_bf16_f32 v49, v34, v35
    v_exp_f32 v36, v36
    v_exp_f32 v37, v37
    s_waitcnt lgkmcnt(3)
    v_mfma_f32_32x32x16_bf16 v[16:31], v[148:151], v[164:167], v[16:31]
    ds_read_b128 v[148:151], v6 offset:37888
    v_exp_f32 v38, v38
    v_exp_f32 v39, v39
    v_cvt_pk_bf16_f32 v50, v36, v37
    v_cvt_pk_bf16_f32 v51, v38, v39
    v_smfmac_f32_16x16x64_bf16 v[56:59], v[60:63], v[184:191], v192
    v_exp_f32 v40, v40
    v_exp_f32 v41, v41
    v_exp_f32 v42, v42
    v_exp_f32 v43, v43
    s_waitcnt lgkmcnt(3)
    v_mfma_f32_32x32x16_bf16 v[128:143], v[152:155], v[48:51], v[128:143]
    ds_read_b128 v[152:155], v6 offset:34816
    v_cvt_pk_bf16_f32 v52, v40, v41
    v_cvt_pk_bf16_f32 v53, v42, v43
    v_exp_f32 v44, v44
    v_exp_f32 v45, v45
    v_exp_f32 v46, v46
    v_exp_f32 v47, v47
    v_cvt_pk_bf16_f32 v54, v44, v45
    v_cvt_pk_bf16_f32 v55, v46, v47
    s_waitcnt lgkmcnt(0)
    s_nop 0
    v_mfma_f32_32x32x16_bf16 v[128:143], v[156:159], v[52:55], v[128:143]
    v_smfmac_f32_16x16x64_bf16 v[56:59], v[60:63], v[48:55], v192
    s_setprio 0
    v_and_b32 v8, 16, v2
    v_cmp_eq_u32 s[74:75], 0, v8
    v_mov_b32 v11, 0
    s_nop 9
    v_add_f32 v56, v56, v58
    v_add_f32 v57, v57, v59
    v_cndmask_b32 v7, v57, v56, s[74:75]
    v_mov_b32 v8, v7
    v_rcp_f32 v7, v7
    s_lshl_b32 s76, s66, 16
    s_lshl_b32 s77, s22, 12
    s_add_u32 s76, s76, s77
    s_lshl_b32 s77, s25, 11
    s_add_u32 s76, s76, s77
    s_add_u32 s76, s76, 5242880
    v_mul_f32 v128, v128, v7
    v_mul_f32 v129, v129, v7
    v_mul_f32 v130, v130, v7
    v_mul_f32 v131, v131, v7
    v_mul_f32 v132, v132, v7
    v_mul_f32 v133, v133, v7
    v_mul_f32 v134, v134, v7
    v_mul_f32 v135, v135, v7
    v_cvt_pk_bf16_f32 v48, v128, v129
    v_cvt_pk_bf16_f32 v49, v130, v131
    v_cvt_pk_bf16_f32 v50, v132, v133
    v_cvt_pk_bf16_f32 v51, v134, v135
    buffer_store_dwordx4 v[48:51], v1, s[16:19], s76 offen offset:0 sc1
    v_mul_f32 v136, v136, v7
    v_mul_f32 v137, v137, v7
    v_mul_f32 v138, v138, v7
    v_mul_f32 v139, v139, v7
    v_mul_f32 v140, v140, v7
    v_mul_f32 v141, v141, v7
    v_mul_f32 v142, v142, v7
    v_mul_f32 v143, v143, v7
    v_cvt_pk_bf16_f32 v52, v136, v137
    v_cvt_pk_bf16_f32 v53, v138, v139
    v_cvt_pk_bf16_f32 v54, v140, v141
    v_cvt_pk_bf16_f32 v55, v142, v143
    buffer_store_dwordx4 v[52:55], v1, s[16:19], s76 offen offset:1024 sc1
    v_fmac_f32 v8, v128, v11
    v_fmac_f32 v8, v129, v11
    v_fmac_f32 v8, v130, v11
    v_fmac_f32 v8, v131, v11
    v_fmac_f32 v8, v132, v11
    v_fmac_f32 v8, v133, v11
    v_fmac_f32 v8, v134, v11
    v_fmac_f32 v8, v135, v11
    v_fmac_f32 v8, v136, v11
    v_fmac_f32 v8, v137, v11
    v_fmac_f32 v8, v138, v11
    v_fmac_f32 v8, v139, v11
    v_fmac_f32 v8, v140, v11
    v_fmac_f32 v8, v141, v11
    v_fmac_f32 v8, v142, v11
    v_fmac_f32 v8, v143, v11
    v_cmp_ngt_f32 vcc, 0x76800000, v8
    s_nop 4
    s_cbranch_vccnz LadaLN_cond__grouped_kv_mqa__dense_activation_relu__prompt_kernel_slow32
LadaLN_cond__grouped_kv_mqa__dense_activation_relu__prompt_kernel_epi31:
    v_mov_b32 v16, v252
    v_lshrrev_b32 v17, 16, v252
    v_mov_b32 v18, v253
    v_lshrrev_b32 v19, 16, v253
    v_lshlrev_b32 v16, 16, v16
    v_mul_f32 v28, 0xbfb8aa3b, v16
    v_exp_f32 v28, v28
    s_nop 0
    v_add_f32 v28, 1.0, v28
    v_rcp_f32 v28, v28
    s_nop 0
    v_mul_f32 v28, v16, v28
    v_cvt_pk_bf16_f32 v28, v28, v28
    v_and_b32 v20, 0xffff, v28
    v_and_b32 v21, 0xffff0000, v28
    v_lshlrev_b32 v17, 16, v17
    v_mul_f32 v28, 0xbfb8aa3b, v17
    v_exp_f32 v28, v28
    s_nop 0
    v_add_f32 v28, 1.0, v28
    v_rcp_f32 v28, v28
    s_nop 0
    v_mul_f32 v28, v17, v28
    v_cvt_pk_bf16_f32 v28, v28, v28
    v_and_b32 v22, 0xffff, v28
    v_and_b32 v23, 0xffff0000, v28
    v_lshlrev_b32 v18, 16, v18
    v_mul_f32 v28, 0xbfb8aa3b, v18
    v_exp_f32 v28, v28
    s_nop 0
    v_add_f32 v28, 1.0, v28
    v_rcp_f32 v28, v28
    s_nop 0
    v_mul_f32 v28, v18, v28
    v_cvt_pk_bf16_f32 v28, v28, v28
    v_and_b32 v24, 0xffff, v28
    v_and_b32 v25, 0xffff0000, v28
    v_lshlrev_b32 v19, 16, v19
    v_mul_f32 v28, 0xbfb8aa3b, v19
    v_exp_f32 v28, v28
    s_nop 0
    v_add_f32 v28, 1.0, v28
    v_rcp_f32 v28, v28
    s_nop 0
    v_mul_f32 v28, v19, v28
    v_cvt_pk_bf16_f32 v28, v28, v28
    v_and_b32 v26, 0xffff, v28
    v_and_b32 v27, 0xffff0000, v28
    v_dot2_f32_bf16 v32, v96, v20, 0
    v_dot2_f32_bf16 v33, v96, v21, 0
    v_dot2_f32_bf16 v34, v97, v20, 0
    v_dot2_f32_bf16 v35, v97, v21, 0
    v_dot2_f32_bf16 v36, v98, v20, 0
    v_dot2_f32_bf16 v37, v98, v21, 0
    v_dot2_f32_bf16 v38, v99, v20, 0
    v_dot2_f32_bf16 v39, v99, v21, 0
    v_dot2c_f32_bf16 v32, v100, v22
    v_dot2c_f32_bf16 v33, v100, v23
    v_dot2c_f32_bf16 v34, v101, v22
    v_dot2c_f32_bf16 v35, v101, v23
    v_dot2c_f32_bf16 v36, v102, v22
    v_dot2c_f32_bf16 v37, v102, v23
    v_dot2c_f32_bf16 v38, v103, v22
    v_dot2c_f32_bf16 v39, v103, v23
    v_dot2c_f32_bf16 v32, v104, v24
    v_dot2c_f32_bf16 v33, v104, v25
    v_dot2c_f32_bf16 v34, v105, v24
    v_dot2c_f32_bf16 v35, v105, v25
    v_dot2c_f32_bf16 v36, v106, v24
    v_dot2c_f32_bf16 v37, v106, v25
    v_dot2c_f32_bf16 v38, v107, v24
    v_dot2c_f32_bf16 v39, v107, v25
    v_dot2c_f32_bf16 v32, v108, v26
    v_dot2c_f32_bf16 v33, v108, v27
    v_dot2c_f32_bf16 v34, v109, v26
    v_dot2c_f32_bf16 v35, v109, v27
    v_dot2c_f32_bf16 v36, v110, v26
    v_dot2c_f32_bf16 v37, v110, v27
    v_dot2c_f32_bf16 v38, v111, v26
    v_dot2c_f32_bf16 v39, v111, v27
    s_nop 1
    v_permlane32_swap_b32 v32, v36
    v_permlane32_swap_b32 v33, v37
    v_permlane32_swap_b32 v34, v38
    v_permlane32_swap_b32 v35, v39
    s_nop 0
    v_add_f32 v32, v32, v36
    v_add_f32 v33, v33, v37
    v_add_f32 v34, v34, v38
    v_add_f32 v35, v35, v39
    s_nop 1
    v_permlane16_swap_b32 v32, v34
    v_permlane16_swap_b32 v33, v35
    s_nop 0
    v_add_f32 v32, v32, v34
    v_add_f32 v33, v33, v35
    s_nop 0
    v_add_f32_dpp v32, v32, v32 row_ror:8 row_mask:0xf bank_mask:0xf
    v_add_f32_dpp v33, v33, v33 row_ror:8 row_mask:0xf bank_mask:0xf
    v_and_b32 v11, 7, v2
    v_lshlrev_b32 v11, 5, v11
    v_lshl_add_u32 v11, v10, 3, v11
    s_lshl_b32 s74, s20, 8
    s_add_u32 s74, s74, 110592
    v_add_u32 v11, s74, v11
    ds_write_b64 v11, v[32:33]
    s_lshl_b32 s74, s66, 5
    s_lshl_b32 s75, s22, 1
    s_add_u32 s74, s74, s75
    s_add_u32 s74, s74, s25
    s_lshl_b32 s74, s74, 7
    s_add_u32 s74, s74, 36700160
    s_waitcnt vmcnt(0)
    v_mov_b32 v12, s23
    s_mov_b64 exec, 1
    buffer_store_dword v12, off, s[16:19], s74 sc1
    s_mov_b64 exec, -1
    s_waitcnt lgkmcnt(0)
    s_barrier
    s_cmp_lg_u32 s20, 3
    s_cbranch_scc1 LadaLN_cond__grouped_kv_mqa__dense_activation_relu__prompt_kernel_skip33
    v_lshlrev_b32 v11, 4, v9
    v_add_u32 v12, 110592, v11
    ds_read_b128 v[16:19], v12 offset:0
    ds_read_b128 v[20:23], v12 offset:256
    ds_read_b128 v[24:27], v12 offset:512
    ds_read_b128 v[28:31], v12 offset:768
    ds_read_b128 v[32:35], v12 offset:1024
    ds_read_b128 v[36:39], v12 offset:1280
    ds_read_b128 v[40:43], v12 offset:1536
    ds_read_b128 v[44:47], v12 offset:1792
    s_and_b32 s74, s2, 3
    s_lshl_b32 s74, s74, 14
    s_lshr_b32 s75, s2, 2
    s_lshl_b32 s75, s75, 8
    s_add_u32 s74, s74, s75
    s_add_u32 s74, s74, 37224448
    v_mov_b32 v15, 0xff
    s_waitcnt lgkmcnt(0)
    v_add_f32 v16, v16, v32
    v_add_f32 v17, v17, v33
    v_add_f32 v18, v18, v34
    v_add_f32 v19, v19, v35
    v_add_f32 v20, v20, v36
    v_add_f32 v21, v21, v37
    v_add_f32 v22, v22, v38
    v_add_f32 v23, v23, v39
    v_add_f32 v24, v24, v40
    v_add_f32 v25, v25, v41
    v_add_f32 v26, v26, v42
    v_add_f32 v27, v27, v43
    v_add_f32 v28, v28, v44
    v_add_f32 v29, v29, v45
    v_add_f32 v30, v30, v46
    v_add_f32 v31, v31, v47
    v_add_f32 v16, v16, v24
    v_add_f32 v17, v17, v25
    v_add_f32 v18, v18, v26
    v_add_f32 v19, v19, v27
    v_add_f32 v20, v20, v28
    v_add_f32 v21, v21, v29
    v_add_f32 v22, v22, v30
    v_add_f32 v23, v23, v31
    v_add_f32 v16, v16, v20
    v_add_f32 v17, v17, v21
    v_add_f32 v18, v18, v22
    v_add_f32 v19, v19, v23
    v_bfi_b32 v16, v15, s62, v16
    v_bfi_b32 v17, v15, s63, v17
    v_bfi_b32 v18, v15, s64, v18
    v_bfi_b32 v19, v15, s65, v19
    s_mov_b64 exec, 0xffff
    buffer_store_dwordx4 v[16:19], v11, s[16:19], s74 offen sc1
    s_mov_b64 exec, -1
    s_nop 0
LadaLN_cond__grouped_kv_mqa__dense_activation_relu__prompt_kernel_skip33:
LadaLN_cond__grouped_kv_mqa__dense_activation_relu__prompt_kernel_dcode:
    v_lshrrev_b32 v8, 3, v2
    v_xor_b32 v11, v8, v2
    v_and_b32 v11, 7, v11
    v_lshlrev_b32 v11, 4, v11
    v_lshl_add_u32 v8, v8, 7, v11
    s_lshl_b32 s71, s24, 12
    s_add_u32 s71, s71, 114688
    s_lshl_b32 s73, s25, 11
    s_add_u32 s73, s73, s71
    v_add_u32 v8, s73, v8
    ds_write_b128 v8, v[116:119] offset:0
    ds_write_b128 v8, v[120:123] offset:1024
    s_lshl_b32 s73, s25, 2
    v_xor_b32 v11, s73, v2
    v_and_b32 v11, 7, v11
    v_lshlrev_b32 v11, 4, v11
    v_and_b32 v14, 31, v2
    v_lshl_add_u32 v11, v14, 7, v11
    v_lshrrev_b32 v14, 5, v2
    v_lshl_add_u32 v11, v14, 3, v11
    v_add_u32 v11, s71, v11
    v_xor_b32 v12, 16, v11
    v_xor_b32 v13, 32, v11
    v_xor_b32 v14, 48, v11
    s_waitcnt lgkmcnt(0)
    s_barrier
    ds_read_b64 v[116:117], v11
    ds_read_b64 v[118:119], v12
    ds_read_b64 v[120:121], v13
    ds_read_b64 v[122:123], v14
    v_and_b32 v5, 15, v2
    v_lshrrev_b32 v6, 2, v5
    v_lshlrev_b32 v3, 7, v6
    v_lshrrev_b32 v6, 3, v5
    v_lshl_add_u32 v3, v6, 6, v3
    v_and_b32 v6, 3, v5
    v_lshl_add_u32 v3, v6, 3, v3
    v_bfe_u32 v6, v2, 4, 1
    v_lshl_add_u32 v3, v6, 5, v3
    v_lshrrev_b32 v6, 5, v2
    v_lshl_add_u32 v3, v6, 9, v3
    v_xor_b32 v4, 64, v3
    s_lshl_b32 s71, s25, 6
    s_lshl_b32 s76, s25, 16
    v_xor_b32 v3, s71, v3
    v_add_u32 v3, s76, v3
    v_xor_b32 v4, s71, v4
    v_add_u32 v4, s76, v4
    s_lshl_b32 s76, s25, 15
    s_lshl_b32 s72, s66, 12
    s_lshl_b32 s73, s25, 11
    s_add_u32 s72, s72, s73
    s_add_u32 s72, s72, 36700160
    s_lshl_b32 s68, s66, 16
    s_add_u32 s68, s68, s76
    s_add_u32 s68, s68, 5242880
    s_waitcnt lgkmcnt(0)
    v_lshlrev_b32 v11, 7, v9
    v_min_u32 v12, 2, v10
    v_lshlrev_b32 v13, 12, v12
    v_min_u32 v12, 1, v12
    v_lshl_add_u32 v13, v12, 12, v13
    v_lshl_add_u32 v13, v9, 4, v13
    s_lshl_b32 s84, s22, 8
    s_add_u32 s84, s84, 37224448
    s_cmp_eq_u32 s20, 3
    s_cselect_b32 s84, s84, 0x40000000
    s_add_u32 s85, s84, 16384
    s_add_u32 s86, s84, 32768
    s_add_u32 s87, s84, 49152
    s_lshr_b32 s74, s24, 1
    s_and_b32 s75, s24, 1
    s_lshl_b32 s74, s74, 12
    s_sub_u32 s28, 37232640, s74
    s_lshl_b32 s75, s75, 11
    s_add_u32 s28, s28, s75
    s_cmp_ge_u32 s20, 4
    s_cselect_b32 s28, s28, 0x40000000
    s_add_u32 s29, s28, 16384
    s_add_u32 s30, s28, 32768
    s_add_u32 s31, s28, 49152
    s_lshr_b32 s88, s21, 1
    s_and_b32 s90, s26, 1
    s_and_b32 s89, s27, 15
    s_lshl_b32 s73, s90, 4
    s_add_u32 s89, s89, s73
    s_and_b32 s91, s27, 7
    s_mov_b32 s8, s48
    s_mov_b32 s9, s49
    s_mov_b32 s10, 0x700000
    s_mov_b32 s11, 0x20000
    s_lshl_b32 s74, s24, 7
    v_add_u32 v12, s74, v2
    v_mul_u32_u24 v5, 4682, v12
    v_lshrrev_b32 v5, 16, v5
    v_mul_u32_u24 v14, 14, v5
    v_sub_u32 v12, v12, v14
    v_mul_u32_u24 v252, 7168, v5
    v_lshl_add_u32 v252, v12, 4, v252
    v_add_u32 v12, s74, v2
    v_add_u32 v12, 64, v12
    v_mul_u32_u24 v5, 4682, v12
    v_lshrrev_b32 v5, 16, v5
    v_mul_u32_u24 v14, 14, v5
    v_sub_u32 v12, v12, v14
    v_mul_u32_u24 v253, 7168, v5
    v_lshl_add_u32 v253, v12, 4, v253
    s_mul_i32 s74, s89, 224
    v_add_u32 v252, s74, v252
    s_sub_u32 s74, s74, 1024
    s_cmp_eq_u32 s24, 3
    s_cselect_b32 s74, 0x40000000, s74
    v_add_u32 v253, s74, v253
    s_mov_b32 s82, 0
    s_lshl_b32 s83, s24, 11
    s_lshl_b32 s71, s20, 12
    s_add_u32 s71, s71, 98304
    v_add_u32 v5, s71, v1
    v_xor_b32 v6, 0x4000, v5
    v_lshrrev_b32 v7, 5, v2
    v_lshlrev_b32 v7, 4, v7
    s_lshl_b32 s71, s25, 7
    s_add_u32 s71, s71, 147456
    v_add_u32 v7, s71, v7
    v_and_b32 v8, 31, v2
    v_lshlrev_b32 v8, 3, v8
    s_lshl_b32 s71, s66, 4
    s_add_u32 s71, s71, s22
    s_lshl_b32 s70, s71, 12
    s_add_u32 s70, s70, 9437184
    s_lshl_b32 s73, s71, 8
    s_add_u32 s73, s73, 196608
    s_lshl_b32 s71, s71, 7
    s_add_u32 s71, s71, 36962304
    buffer_load_dword v12, v11, s[16:19], s72 offen sc1
    s_cmp_lg_u32 s20, 0
    s_cbranch_scc1 LadaLN_cond__grouped_kv_mqa__dense_activation_relu__prompt_kernel_skip35
    s_call_b64 s[96:97], LadaLN_cond__grouped_kv_mqa__dense_activation_relu__prompt_kernel_stub12
LadaLN_cond__grouped_kv_mqa__dense_activation_relu__prompt_kernel_skip35:
    s_cmp_lg_u32 s20, 1
    s_cbranch_scc1 LadaLN_cond__grouped_kv_mqa__dense_activation_relu__prompt_kernel_skip36
    s_call_b64 s[96:97], LadaLN_cond__grouped_kv_mqa__dense_activation_relu__prompt_kernel_stub13
LadaLN_cond__grouped_kv_mqa__dense_activation_relu__prompt_kernel_skip36:
    s_cmp_lg_u32 s20, 2
    s_cbranch_scc1 LadaLN_cond__grouped_kv_mqa__dense_activation_relu__prompt_kernel_skip37
    s_call_b64 s[96:97], LadaLN_cond__grouped_kv_mqa__dense_activation_relu__prompt_kernel_stub14
LadaLN_cond__grouped_kv_mqa__dense_activation_relu__prompt_kernel_skip37:
    s_cmp_lg_u32 s20, 3
    s_cbranch_scc1 LadaLN_cond__grouped_kv_mqa__dense_activation_relu__prompt_kernel_skip38
    s_call_b64 s[96:97], LadaLN_cond__grouped_kv_mqa__dense_activation_relu__prompt_kernel_stub15
LadaLN_cond__grouped_kv_mqa__dense_activation_relu__prompt_kernel_skip38:
    s_cmp_lg_u32 s20, 4
    s_cbranch_scc1 LadaLN_cond__grouped_kv_mqa__dense_activation_relu__prompt_kernel_skip39
    s_call_b64 s[96:97], LadaLN_cond__grouped_kv_mqa__dense_activation_relu__prompt_kernel_stub16
LadaLN_cond__grouped_kv_mqa__dense_activation_relu__prompt_kernel_skip39:
    s_cmp_lg_u32 s20, 5
    s_cbranch_scc1 LadaLN_cond__grouped_kv_mqa__dense_activation_relu__prompt_kernel_skip40
    s_call_b64 s[96:97], LadaLN_cond__grouped_kv_mqa__dense_activation_relu__prompt_kernel_stub17
LadaLN_cond__grouped_kv_mqa__dense_activation_relu__prompt_kernel_skip40:
    s_cmp_lg_u32 s20, 6
    s_cbranch_scc1 LadaLN_cond__grouped_kv_mqa__dense_activation_relu__prompt_kernel_skip41
    s_call_b64 s[96:97], LadaLN_cond__grouped_kv_mqa__dense_activation_relu__prompt_kernel_stub18
LadaLN_cond__grouped_kv_mqa__dense_activation_relu__prompt_kernel_skip41:
    s_cmp_lg_u32 s20, 7
    s_cbranch_scc1 LadaLN_cond__grouped_kv_mqa__dense_activation_relu__prompt_kernel_skip42
LadaLN_cond__grouped_kv_mqa__dense_activation_relu__prompt_kernel_skip42:
    s_waitcnt vmcnt(0)
    v_cmp_ne_u32 vcc, s23, v12
    s_nop 1
    s_cbranch_vccz LadaLN_cond__grouped_kv_mqa__dense_activation_relu__prompt_kernel_pw34
    s_mov_b32 s67, 400000
LadaLN_cond__grouped_kv_mqa__dense_activation_relu__prompt_kernel_poll43:
    buffer_load_dword v12, v11, s[16:19], s72 offen sc1
    s_waitcnt vmcnt(0)
    v_cmp_ne_u32 vcc, s23, v12
    s_nop 1
    s_cbranch_vccz LadaLN_cond__grouped_kv_mqa__dense_activation_relu__prompt_kernel_pok44
    s_sleep 1
    s_sub_u32 s67, s67, 1
    s_cbranch_scc0 LadaLN_cond__grouped_kv_mqa__dense_activation_relu__prompt_kernel_poll43
    s_branch LadaLN_cond__grouped_kv_mqa__dense_activation_relu__prompt_kernel_exit
LadaLN_cond__grouped_kv_mqa__dense_activation_relu__prompt_kernel_pok44:
LadaLN_cond__grouped_kv_mqa__dense_activation_relu__prompt_kernel_pw34:
    buffer_load_dwordx4 v[124:127], v1, s[16:19], s68 offen offset:0 sc1
    buffer_load_dwordx4 v[128:131], v1, s[16:19], s68 offen offset:1024 sc1
    buffer_load_dwordx4 v[132:135], v1, s[16:19], s68 offen offset:2048 sc1
    buffer_load_dwordx4 v[136:139], v1, s[16:19], s68 offen offset:3072 sc1
    s_add_u32 s68, s68, 4096
    buffer_load_dwordx4 v[140:143], v1, s[16:19], s68 offen offset:0 sc1
    buffer_load_dwordx4 v[144:147], v1, s[16:19], s68 offen offset:1024 sc1
    ds_read_b64_tr_b16 v[48:49], v3 offset:0
    ds_read_b64_tr_b16 v[50:51], v3 offset:1024
    ds_read_b64_tr_b16 v[52:53], v4 offset:0
    ds_read_b64_tr_b16 v[54:55], v4 offset:1024
    buffer_load_dwordx4 v[148:151], v1, s[16:19], s68 offen offset:2048 sc1
    ds_read_b64_tr_b16 v[56:57], v3 offset:2048
    ds_read_b64_tr_b16 v[58:59], v3 offset:3072
    ds_read_b64_tr_b16 v[60:61], v4 offset:2048
    ds_read_b64_tr_b16 v[62:63], v4 offset:3072
    s_waitcnt vmcnt(6)
    s_waitcnt lgkmcnt(4)
    v_mfma_f32_32x32x16_bf16 v[16:31], v[48:51], v[124:127], 0
    v_mfma_f32_32x32x16_bf16 v[32:47], v[52:55], v[124:127], 0
    buffer_load_dwordx4 v[152:155], v1, s[16:19], s68 offen offset:3072 sc1
    s_add_u32 s68, s68, 4096
    ds_read_b64_tr_b16 v[48:49], v3 offset:4096
    ds_read_b64_tr_b16 v[50:51], v3 offset:5120
    ds_read_b64_tr_b16 v[52:53], v4 offset:4096
    ds_read_b64_tr_b16 v[54:55], v4 offset:5120
    s_waitcnt vmcnt(6)
    s_waitcnt lgkmcnt(4)
    v_mfma_f32_32x32x16_bf16 v[16:31], v[56:59], v[128:131], v[16:31]
    v_mfma_f32_32x32x16_bf16 v[32:47], v[60:63], v[128:131], v[32:47]
    buffer_load_dwordx4 v[156:159], v1, s[16:19], s68 offen offset:0 sc1
    ds_read_b64_tr_b16 v[56:57], v3 offset:6144
    ds_read_b64_tr_b16 v[58:59], v3 offset:7168
    ds_read_b64_tr_b16 v[60:61], v4 offset:6144
    ds_read_b64_tr_b16 v[62:63], v4 offset:7168
    s_waitcnt vmcnt(6)
    s_waitcnt lgkmcnt(4)
    v_mfma_f32_32x32x16_bf16 v[16:31], v[48:51], v[132:135], v[16:31]
    v_mfma_f32_32x32x16_bf16 v[32:47], v[52:55], v[132:135], v[32:47]
    buffer_load_dwordx4 v[160:163], v1, s[16:19], s68 offen offset:1024 sc1
    ds_read_b64_tr_b16 v[48:49], v3 offset:8192
    ds_read_b64_tr_b16 v[50:51], v3 offset:9216
    ds_read_b64_tr_b16 v[52:53], v4 offset:8192
    ds_read_b64_tr_b16 v[54:55], v4 offset:9216
    s_waitcnt vmcnt(6)
    s_waitcnt lgkmcnt(4)
    v_mfma_f32_32x32x16_bf16 v[16:31], v[56:59], v[136:139], v[16:31]
    v_mfma_f32_32x32x16_bf16 v[32:47], v[60:63], v[136:139], v[32:47]
    buffer_load_dwordx4 v[164:167], v1, s[16:19], s68 offen offset:2048 sc1
    ds_read_b64_tr_b16 v[56:57], v3 offset:10240
    ds_read_b64_tr_b16 v[58:59], v3 offset:11264
    ds_read_b64_tr_b16 v[60:61], v4 offset:10240
    ds_read_b64_tr_b16 v[62:63], v4 offset:11264
    s_waitcnt vmcnt(6)
    s_waitcnt lgkmcnt(4)
    v_mfma_f32_32x32x16_bf16 v[16:31], v[48:51], v[140:143], v[16:31]
    v_mfma_f32_32x32x16_bf16 v[32:47], v[52:55], v[140:143], v[32:47]
    buffer_load_dwordx4 v[168:171], v1, s[16:19], s68 offen offset:3072 sc1
    s_add_u32 s68, s68, 4096
    ds_read_b64_tr_b16 v[48:49], v3 offset:12288
    ds_read_b64_tr_b16 v[50:51], v3 offset:13312
    ds_read_b64_tr_b16 v[52:53], v4 offset:12288
    ds_read_b64_tr_b16 v[54:55], v4 offset:13312
    s_waitcnt vmcnt(6)
    s_waitcnt lgkmcnt(4)
    v_mfma_f32_32x32x16_bf16 v[16:31], v[56:59], v[144:147], v[16:31]
    v_mfma_f32_32x32x16_bf16 v[32:47], v[60:63], v[144:147], v[32:47]
    buffer_load_dwordx4 v[172:175], v1, s[16:19], s68 offen offset:0 sc1
    ds_read_b64_tr_b16 v[56:57], v3 offset:14336
    ds_read_b64_tr_b16 v[58:59], v3 offset:15360
    ds_read_b64_tr_b16 v[60:61], v4 offset:14336
    ds_read_b64_tr_b16 v[62:63], v4 offset:15360
    s_waitcnt vmcnt(6)
    s_waitcnt lgkmcnt(4)
    v_mfma_f32_32x32x16_bf16 v[16:31], v[48:51], v[148:151], v[16:31]
    v_mfma_f32_32x32x16_bf16 v[32:47], v[52:55], v[148:151], v[32:47]
    buffer_load_dwordx4 v[176:179], v1, s[16:19], s68 offen offset:1024 sc1
    ds_read_b64_tr_b16 v[48:49], v3 offset:16384
    ds_read_b64_tr_b16 v[50:51], v3 offset:17408
    ds_read_b64_tr_b16 v[52:53], v4 offset:16384
    ds_read_b64_tr_b16 v[54:55], v4 offset:17408
    s_waitcnt vmcnt(6)
    s_waitcnt lgkmcnt(4)
    v_mfma_f32_32x32x16_bf16 v[16:31], v[56:59], v[152:155], v[16:31]
    v_mfma_f32_32x32x16_bf16 v[32:47], v[60:63], v[152:155], v[32:47]
    buffer_load_dwordx4 v[180:183], v1, s[16:19], s68 offen offset:2048 sc1
    ds_read_b64_tr_b16 v[56:57], v3 offset:18432
    ds_read_b64_tr_b16 v[58:59], v3 offset:19456
    ds_read_b64_tr_b16 v[60:61], v4 offset:18432
    ds_read_b64_tr_b16 v[62:63], v4 offset:19456
    s_waitcnt vmcnt(6)
    s_waitcnt lgkmcnt(4)
    v_mfma_f32_32x32x16_bf16 v[16:31], v[48:51], v[156:159], v[16:31]
    v_mfma_f32_32x32x16_bf16 v[32:47], v[52:55], v[156:159], v[32:47]
    buffer_load_dwordx4 v[184:187], v1, s[16:19], s68 offen offset:3072 sc1
    s_add_u32 s68, s68, 4096
    ds_read_b64_tr_b16 v[48:49], v3 offset:20480
    ds_read_b64_tr_b16 v[50:51], v3 offset:21504
    ds_read_b64_tr_b16 v[52:53], v4 offset:20480
    ds_read_b64_tr_b16 v[54:55], v4 offset:21504
    s_waitcnt vmcnt(6)
    s_waitcnt lgkmcnt(4)
    v_mfma_f32_32x32x16_bf16 v[16:31], v[56:59], v[160:163], v[16:31]
    v_mfma_f32_32x32x16_bf16 v[32:47], v[60:63], v[160:163], v[32:47]
    buffer_load_dwordx4 v[188:191], v1, s[16:19], s68 offen offset:0 sc1
    ds_read_b64_tr_b16 v[56:57], v3 offset:22528
    ds_read_b64_tr_b16 v[58:59], v3 offset:23552
    ds_read_b64_tr_b16 v[60:61], v4 offset:22528
    ds_read_b64_tr_b16 v[62:63], v4 offset:23552
    s_waitcnt vmcnt(6)
    s_waitcnt lgkmcnt(4)
    v_mfma_f32_32x32x16_bf16 v[16:31], v[48:51], v[164:167], v[16:31]
    v_mfma_f32_32x32x16_bf16 v[32:47], v[52:55], v[164:167], v[32:47]
    buffer_load_dwordx4 v[192:195], v1, s[16:19], s68 offen offset:1024 sc1
    ds_read_b64_tr_b16 v[48:49], v3 offset:24576
    ds_read_b64_tr_b16 v[50:51], v3 offset:25600
    ds_read_b64_tr_b16 v[52:53], v4 offset:24576
    ds_read_b64_tr_b16 v[54:55], v4 offset:25600
    s_waitcnt vmcnt(6)
    s_waitcnt lgkmcnt(4)
    v_mfma_f32_32x32x16_bf16 v[16:31], v[56:59], v[168:171], v[16:31]
    v_mfma_f32_32x32x16_bf16 v[32:47], v[60:63], v[168:171], v[32:47]
    buffer_load_dwordx4 v[196:199], v1, s[16:19], s68 offen offset:2048 sc1
    ds_read_b64_tr_b16 v[56:57], v3 offset:26624
    ds_read_b64_tr_b16 v[58:59], v3 offset:27648
    ds_read_b64_tr_b16 v[60:61], v4 offset:26624
    ds_read_b64_tr_b16 v[62:63], v4 offset:27648
    s_waitcnt vmcnt(6)
    s_waitcnt lgkmcnt(4)
    v_mfma_f32_32x32x16_bf16 v[16:31], v[48:51], v[172:175], v[16:31]
    v_mfma_f32_32x32x16_bf16 v[32:47], v[52:55], v[172:175], v[32:47]
    buffer_load_dwordx4 v[200:203], v1, s[16:19], s68 offen offset:3072 sc1
    s_add_u32 s68, s68, 4096
    ds_read_b64_tr_b16 v[48:49], v3 offset:28672
    ds_read_b64_tr_b16 v[50:51], v3 offset:29696
    ds_read_b64_tr_b16 v[52:53], v4 offset:28672
    ds_read_b64_tr_b16 v[54:55], v4 offset:29696
    s_waitcnt vmcnt(6)
    s_waitcnt lgkmcnt(4)
    v_mfma_f32_32x32x16_bf16 v[16:31], v[56:59], v[176:179], v[16:31]
    v_mfma_f32_32x32x16_bf16 v[32:47], v[60:63], v[176:179], v[32:47]
    buffer_load_dwordx4 v[204:207], v1, s[16:19], s68 offen offset:0 sc1
    ds_read_b64_tr_b16 v[56:57], v3 offset:30720
    ds_read_b64_tr_b16 v[58:59], v3 offset:31744
    ds_read_b64_tr_b16 v[60:61], v4 offset:30720
    ds_read_b64_tr_b16 v[62:63], v4 offset:31744
    s_waitcnt vmcnt(6)
    s_waitcnt lgkmcnt(4)
    v_mfma_f32_32x32x16_bf16 v[16:31], v[48:51], v[180:183], v[16:31]
    v_mfma_f32_32x32x16_bf16 v[32:47], v[52:55], v[180:183], v[32:47]
    buffer_load_dwordx4 v[208:211], v1, s[16:19], s68 offen offset:1024 sc1
    v_add_u32 v3, s76, v3
    v_add_u32 v4, s76, v4
    ds_read_b64_tr_b16 v[48:49], v3 offset:32768
    ds_read_b64_tr_b16 v[50:51], v3 offset:33792
    ds_read_b64_tr_b16 v[52:53], v4 offset:32768
    ds_read_b64_tr_b16 v[54:55], v4 offset:33792
    s_waitcnt vmcnt(6)
    s_waitcnt lgkmcnt(4)
    v_mfma_f32_32x32x16_bf16 v[16:31], v[56:59], v[184:187], v[16:31]
    v_mfma_f32_32x32x16_bf16 v[32:47], v[60:63], v[184:187], v[32:47]
    buffer_load_dwordx4 v[212:215], v1, s[16:19], s68 offen offset:2048 sc1
    ds_read_b64_tr_b16 v[56:57], v3 offset:34816
    ds_read_b64_tr_b16 v[58:59], v3 offset:35840
    ds_read_b64_tr_b16 v[60:61], v4 offset:34816
    ds_read_b64_tr_b16 v[62:63], v4 offset:35840
    s_waitcnt vmcnt(6)
    s_waitcnt lgkmcnt(4)
    v_mfma_f32_32x32x16_bf16 v[16:31], v[48:51], v[188:191], v[16:31]
    v_mfma_f32_32x32x16_bf16 v[32:47], v[52:55], v[188:191], v[32:47]
    buffer_load_dwordx4 v[216:219], v1, s[16:19], s68 offen offset:3072 sc1
    s_add_u32 s68, s68, 4096
    ds_read_b64_tr_b16 v[48:49], v3 offset:36864
    ds_read_b64_tr_b16 v[50:51], v3 offset:37888
    ds_read_b64_tr_b16 v[52:53], v4 offset:36864
    ds_read_b64_tr_b16 v[54:55], v4 offset:37888
    s_waitcnt vmcnt(6)
    s_waitcnt lgkmcnt(4)
    v_mfma_f32_32x32x16_bf16 v[16:31], v[56:59], v[192:195], v[16:31]
    v_mfma_f32_32x32x16_bf16 v[32:47], v[60:63], v[192:195], v[32:47]
    buffer_load_dwordx4 v[220:223], v1, s[16:19], s68 offen offset:0 sc1
    ds_read_b64_tr_b16 v[56:57], v3 offset:38912
    ds_read_b64_tr_b16 v[58:59], v3 offset:39936
    ds_read_b64_tr_b16 v[60:61], v4 offset:38912
    ds_read_b64_tr_b16 v[62:63], v4 offset:39936
    s_waitcnt vmcnt(6)
    s_waitcnt lgkmcnt(4)
    v_mfma_f32_32x32x16_bf16 v[16:31], v[48:51], v[196:199], v[16:31]
    s_branch LadaLN_cond__grouped_kv_mqa__dense_activation_relu__prompt_kernel_over7
LadaLN_cond__grouped_kv_mqa__dense_activation_relu__prompt_kernel_stub7:
    s_setpc_b64 s[96:97]
LadaLN_cond__grouped_kv_mqa__dense_activation_relu__prompt_kernel_over7:
    v_mfma_f32_32x32x16_bf16 v[32:47], v[52:55], v[196:199], v[32:47]
    buffer_load_dwordx4 v[224:227], v1, s[16:19], s68 offen offset:1024 sc1
    ds_read_b64_tr_b16 v[48:49], v3 offset:40960
    ds_read_b64_tr_b16 v[50:51], v3 offset:41984
    ds_read_b64_tr_b16 v[52:53], v4 offset:40960
    ds_read_b64_tr_b16 v[54:55], v4 offset:41984
    s_waitcnt vmcnt(6)
    s_waitcnt lgkmcnt(4)
    v_mfma_f32_32x32x16_bf16 v[16:31], v[56:59], v[200:203], v[16:31]
    v_mfma_f32_32x32x16_bf16 v[32:47], v[60:63], v[200:203], v[32:47]
    buffer_load_dwordx4 v[228:231], v1, s[16:19], s68 offen offset:2048 sc1
    ds_read_b64_tr_b16 v[56:57], v3 offset:43008
    ds_read_b64_tr_b16 v[58:59], v3 offset:44032
    ds_read_b64_tr_b16 v[60:61], v4 offset:43008
    ds_read_b64_tr_b16 v[62:63], v4 offset:44032
    s_waitcnt vmcnt(6)
    s_waitcnt lgkmcnt(4)
    v_mfma_f32_32x32x16_bf16 v[16:31], v[48:51], v[204:207], v[16:31]
    v_mfma_f32_32x32x16_bf16 v[32:47], v[52:55], v[204:207], v[32:47]
    buffer_load_dwordx4 v[232:235], v1, s[16:19], s68 offen offset:3072 sc1
    s_add_u32 s68, s68, 4096
    ds_read_b64_tr_b16 v[48:49], v3 offset:45056
    ds_read_b64_tr_b16 v[50:51], v3 offset:46080
    ds_read_b64_tr_b16 v[52:53], v4 offset:45056
    ds_read_b64_tr_b16 v[54:55], v4 offset:46080
    s_waitcnt vmcnt(6)
    s_waitcnt lgkmcnt(4)
    v_mfma_f32_32x32x16_bf16 v[16:31], v[56:59], v[208:211], v[16:31]
    v_mfma_f32_32x32x16_bf16 v[32:47], v[60:63], v[208:211], v[32:47]
    buffer_load_dwordx4 v[236:239], v1, s[16:19], s68 offen offset:0 sc1
    ds_read_b64_tr_b16 v[56:57], v3 offset:47104
    ds_read_b64_tr_b16 v[58:59], v3 offset:48128
    ds_read_b64_tr_b16 v[60:61], v4 offset:47104
    ds_read_b64_tr_b16 v[62:63], v4 offset:48128
    s_waitcnt vmcnt(6)
    s_waitcnt lgkmcnt(4)
    v_mfma_f32_32x32x16_bf16 v[16:31], v[48:51], v[212:215], v[16:31]
    v_mfma_f32_32x32x16_bf16 v[32:47], v[52:55], v[212:215], v[32:47]
    buffer_load_dwordx4 v[240:243], v1, s[16:19], s68 offen offset:1024 sc1
    ds_read_b64_tr_b16 v[48:49], v3 offset:49152
    ds_read_b64_tr_b16 v[50:51], v3 offset:50176
    ds_read_b64_tr_b16 v[52:53], v4 offset:49152
    ds_read_b64_tr_b16 v[54:55], v4 offset:50176
    s_waitcnt vmcnt(6)
    s_waitcnt lgkmcnt(4)
    v_mfma_f32_32x32x16_bf16 v[16:31], v[56:59], v[216:219], v[16:31]
    v_mfma_f32_32x32x16_bf16 v[32:47], v[60:63], v[216:219], v[32:47]
    buffer_load_dwordx4 v[244:247], v1, s[16:19], s68 offen offset:2048 sc1
    ds_read_b64_tr_b16 v[56:57], v3 offset:51200
    ds_read_b64_tr_b16 v[58:59], v3 offset:52224
    ds_read_b64_tr_b16 v[60:61], v4 offset:51200
    ds_read_b64_tr_b16 v[62:63], v4 offset:52224
    s_waitcnt vmcnt(6)
    s_waitcnt lgkmcnt(4)
    v_mfma_f32_32x32x16_bf16 v[16:31], v[48:51], v[220:223], v[16:31]
    v_mfma_f32_32x32x16_bf16 v[32:47], v[52:55], v[220:223], v[32:47]
    buffer_load_dwordx4 v[248:251], v1, s[16:19], s68 offen offset:3072 sc1
    s_add_u32 s68, s68, 4096
    buffer_load_dwordx4 v[64:67], v13, s[16:19], s84 offen sc1
    buffer_load_dwordx4 v[68:71], v13, s[16:19], s85 offen sc1
    buffer_load_dwordx4 v[72:75], v13, s[16:19], s86 offen sc1
    buffer_load_dwordx4 v[76:79], v13, s[16:19], s87 offen sc1
    buffer_load_dwordx4 v[124:127], v1, s[16:19], s28 offen offset:0 sc1
    buffer_load_dwordx4 v[128:131], v1, s[16:19], s29 offen offset:0 sc1
    buffer_load_dwordx4 v[132:135], v1, s[16:19], s30 offen offset:0 sc1
    buffer_load_dwordx4 v[136:139], v1, s[16:19], s31 offen offset:0 sc1
    buffer_load_dwordx4 v[140:143], v1, s[16:19], s28 offen offset:1024 sc1
    buffer_load_dwordx4 v[144:147], v1, s[16:19], s29 offen offset:1024 sc1
    buffer_load_dwordx4 v[148:151], v1, s[16:19], s30 offen offset:1024 sc1
    buffer_load_dwordx4 v[152:155], v1, s[16:19], s31 offen offset:1024 sc1
    ds_read_b64_tr_b16 v[48:49], v3 offset:53248
    ds_read_b64_tr_b16 v[50:51], v3 offset:54272
    ds_read_b64_tr_b16 v[52:53], v4 offset:53248
    ds_read_b64_tr_b16 v[54:55], v4 offset:54272
    s_waitcnt vmcnt(18)
    s_waitcnt lgkmcnt(4)
    v_mfma_f32_32x32x16_bf16 v[16:31], v[56:59], v[224:227], v[16:31]
    v_mfma_f32_32x32x16_bf16 v[32:47], v[60:63], v[224:227], v[32:47]
    ds_read_b64_tr_b16 v[56:57], v3 offset:55296
    ds_read_b64_tr_b16 v[58:59], v3 offset:56320
    ds_read_b64_tr_b16 v[60:61], v4 offset:55296
    ds_read_b64_tr_b16 v[62:63], v4 offset:56320
    s_waitcnt vmcnt(17)
    s_waitcnt lgkmcnt(4)
    v_mfma_f32_32x32x16_bf16 v[16:31], v[48:51], v[228:231], v[16:31]
    v_mfma_f32_32x32x16_bf16 v[32:47], v[52:55], v[228:231], v[32:47]
    ds_read_b64_tr_b16 v[48:49], v3 offset:57344
    ds_read_b64_tr_b16 v[50:51], v3 offset:58368
    ds_read_b64_tr_b16 v[52:53], v4 offset:57344
    ds_read_b64_tr_b16 v[54:55], v4 offset:58368
    s_waitcnt vmcnt(16)
    s_waitcnt lgkmcnt(4)
    v_mfma_f32_32x32x16_bf16 v[16:31], v[56:59], v[232:235], v[16:31]
    v_mfma_f32_32x32x16_bf16 v[32:47], v[60:63], v[232:235], v[32:47]
    ds_read_b64_tr_b16 v[56:57], v3 offset:59392
    ds_read_b64_tr_b16 v[58:59], v3 offset:60416
    ds_read_b64_tr_b16 v[60:61], v4 offset:59392
    ds_read_b64_tr_b16 v[62:63], v4 offset:60416
    s_waitcnt vmcnt(15)
    s_waitcnt lgkmcnt(4)
    v_mfma_f32_32x32x16_bf16 v[16:31], v[48:51], v[236:239], v[16:31]
    v_mfma_f32_32x32x16_bf16 v[32:47], v[52:55], v[236:239], v[32:47]
    ds_read_b64_tr_b16 v[48:49], v3 offset:61440
    ds_read_b64_tr_b16 v[50:51], v3 offset:62464
    ds_read_b64_tr_b16 v[52:53], v4 offset:61440
    ds_read_b64_tr_b16 v[54:55], v4 offset:62464
    s_waitcnt vmcnt(14)
    s_waitcnt lgkmcnt(4)
    v_mfma_f32_32x32x16_bf16 v[16:31], v[56:59], v[240:243], v[16:31]
    v_mfma_f32_32x32x16_bf16 v[32:47], v[60:63], v[240:243], v[32:47]
    ds_read_b64_tr_b16 v[56:57], v3 offset:63488
    ds_read_b64_tr_b16 v[58:59], v3 offset:64512
    ds_read_b64_tr_b16 v[60:61], v4 offset:63488
    ds_read_b64_tr_b16 v[62:63], v4 offset:64512
    s_waitcnt vmcnt(13)
    s_waitcnt lgkmcnt(4)
    v_mfma_f32_32x32x16_bf16 v[16:31], v[48:51], v[244:247], v[16:31]
    v_mfma_f32_32x32x16_bf16 v[32:47], v[52:55], v[244:247], v[32:47]
    s_waitcnt vmcnt(12)
    s_waitcnt lgkmcnt(0)
    v_mfma_f32_32x32x16_bf16 v[16:31], v[56:59], v[248:251], v[16:31]
    v_mfma_f32_32x32x16_bf16 v[32:47], v[60:63], v[248:251], v[32:47]
    s_waitcnt vmcnt(0)
    s_cmp_lg_u32 s20, 3
    s_cbranch_scc1 LadaLN_cond__grouped_kv_mqa__dense_activation_relu__prompt_kernel_skip45
    v_xor_b32 v64, s62, v64
    v_xor_b32 v65, s63, v65
    v_xor_b32 v66, s64, v66
    v_xor_b32 v67, s65, v67
    v_xor_b32 v68, s62, v68
    v_xor_b32 v69, s63, v69
    v_xor_b32 v70, s64, v70
    v_xor_b32 v71, s65, v71
    v_xor_b32 v72, s62, v72
    v_xor_b32 v73, s63, v73
    v_xor_b32 v74, s64, v74
    v_xor_b32 v75, s65, v75
    v_xor_b32 v76, s62, v76
    v_xor_b32 v77, s63, v77
    v_xor_b32 v78, s64, v78
    v_xor_b32 v79, s65, v79
    v_or3_b32 v12, v64, v65, v66
    v_or3_b32 v12, v12, v67, v68
    v_or3_b32 v12, v12, v69, v70
    v_or3_b32 v12, v12, v71, v72
    v_or3_b32 v12, v12, v73, v74
    v_or3_b32 v12, v12, v75, v76
    v_or3_b32 v12, v12, v77, v78
    v_or_b32 v12, v12, v79
    v_and_b32 v12, 0xff, v12
    v_cmp_ne_u32 vcc, 0, v12
    s_nop 1
    s_cbranch_vccz LadaLN_cond__grouped_kv_mqa__dense_activation_relu__prompt_kernel_ok46
    s_mov_b32 s67, 400000
LadaLN_cond__grouped_kv_mqa__dense_activation_relu__prompt_kernel_poll47:
    buffer_load_dwordx4 v[64:67], v13, s[16:19], s84 offen sc1
    buffer_load_dwordx4 v[68:71], v13, s[16:19], s85 offen sc1
    buffer_load_dwordx4 v[72:75], v13, s[16:19], s86 offen sc1
    buffer_load_dwordx4 v[76:79], v13, s[16:19], s87 offen sc1
    s_waitcnt vmcnt(0)
    v_xor_b32 v64, s62, v64
    v_xor_b32 v65, s63, v65
    v_xor_b32 v66, s64, v66
    v_xor_b32 v67, s65, v67
    v_xor_b32 v68, s62, v68
    v_xor_b32 v69, s63, v69
    v_xor_b32 v70, s64, v70
    v_xor_b32 v71, s65, v71
    v_xor_b32 v72, s62, v72
    v_xor_b32 v73, s63, v73
    v_xor_b32 v74, s64, v74
    v_xor_b32 v75, s65, v75
    v_xor_b32 v76, s62, v76
    v_xor_b32 v77, s63, v77
    v_xor_b32 v78, s64, v78
    v_xor_b32 v79, s65, v79
    v_or3_b32 v12, v64, v65, v66
    v_or3_b32 v12, v12, v67, v68
    v_or3_b32 v12, v12, v69, v70
    v_or3_b32 v12, v12, v71, v72
    v_or3_b32 v12, v12, v73, v74
    v_or3_b32 v12, v12, v75, v76
    v_or3_b32 v12, v12, v77, v78
    v_or_b32 v12, v12, v79
    v_and_b32 v12, 0xff, v12
    v_cmp_ne_u32 vcc, 0, v12
    s_nop 1
    s_cbranch_vccz LadaLN_cond__grouped_kv_mqa__dense_activation_relu__prompt_kernel_pok48
    s_sleep 1
    s_sub_u32 s67, s67, 1
    s_cbranch_scc0 LadaLN_cond__grouped_kv_mqa__dense_activation_relu__prompt_kernel_poll47
    s_branch LadaLN_cond__grouped_kv_mqa__dense_activation_relu__prompt_kernel_exit
LadaLN_cond__grouped_kv_mqa__dense_activation_relu__prompt_kernel_pok48:
LadaLN_cond__grouped_kv_mqa__dense_activation_relu__prompt_kernel_ok46:
    v_add_f32 v64, v64, v68
    v_add_f32 v72, v72, v76
    v_add_f32 v65, v65, v69
    v_add_f32 v73, v73, v77
    v_add_f32 v66, v66, v70
    v_add_f32 v74, v74, v78
    v_add_f32 v67, v67, v71
    v_add_f32 v75, v75, v79
    v_cmp_eq_u32 vcc, 1, v10
    v_add_f32 v64, v64, v72
    v_add_f32 v65, v65, v73
    v_add_f32 v66, v66, v74
    v_add_f32 v67, v67, v75
    v_cndmask_b32 v12, 0, 1.0, vcc
    v_cvt_pk_bf16_f32 v65, v64, v65
    v_lshlrev_b32 v64, 16, v65
    v_and_b32 v65, 0xffff0000, v65
    v_cvt_pk_bf16_f32 v67, v66, v67
    v_lshlrev_b32 v66, 16, v67
    v_and_b32 v67, 0xffff0000, v67
    v_add_f32 v64, v12, v64
    v_add_f32 v65, v12, v65
    v_add_f32 v66, v12, v66
    v_add_f32 v67, v12, v67
    v_cvt_pk_bf16_f32 v65, v64, v65
    v_lshlrev_b32 v64, 16, v65
    v_and_b32 v65, 0xffff0000, v65
    v_cvt_pk_bf16_f32 v67, v66, v67
    v_lshlrev_b32 v66, 16, v67
    v_and_b32 v67, 0xffff0000, v67
    v_add_u32 v12, 147456, v1
LadaLN_cond__grouped_kv_mqa__dense_activation_relu__prompt_kernel_skip45:
    s_nop 7
    s_barrier
    ds_write_b128 v5, v[32:35] offset:0
    ds_write_b128 v5, v[36:39] offset:1024
    ds_write_b128 v5, v[40:43] offset:2048
    ds_write_b128 v5, v[44:47] offset:3072
    s_cmp_lg_u32 s20, 3
    s_cbranch_scc1 LadaLN_cond__grouped_kv_mqa__dense_activation_relu__prompt_kernel_skip49
    ds_write_b128 v12, v[64:67]
LadaLN_cond__grouped_kv_mqa__dense_activation_relu__prompt_kernel_skip49:
    s_cmp_lt_u32 s20, 4
    s_cbranch_scc1 LadaLN_cond__grouped_kv_mqa__dense_activation_relu__prompt_kernel_hs50
    s_add_u32 m0, s83, 0
    s_nop 0
    buffer_load_dwordx4 v252, s[8:11], s82 offen lds
    buffer_load_dwordx4 v253, s[8:11], s82 offen offset:1024 lds
    s_add_u32 s82, s82, 229376
    s_add_u32 m0, s83, 8192
    s_nop 0
    buffer_load_dwordx4 v252, s[8:11], s82 offen lds
    buffer_load_dwordx4 v253, s[8:11], s82 offen offset:1024 lds
    s_add_u32 s82, s82, 229376
    s_add_u32 m0, s83, 16384
    s_nop 0
    buffer_load_dwordx4 v252, s[8:11], s82 offen lds
    buffer_load_dwordx4 v253, s[8:11], s82 offen offset:1024 lds
    s_add_u32 s82, s82, 229376
LadaLN_cond__grouped_kv_mqa__dense_activation_relu__prompt_kernel_hs50:
    s_waitcnt lgkmcnt(0)
    s_barrier
    ds_read_b128 v[32:35], v6 offset:0
    ds_read_b128 v[64:67], v7 offset:0
    ds_read_b128 v[80:83], v7 offset:256
    ds_read_b128 v[36:39], v6 offset:1024
    ds_read_b128 v[68:71], v7 offset:32
    ds_read_b128 v[84:87], v7 offset:288
    ds_read_b128 v[40:43], v6 offset:2048
    ds_read_b128 v[72:75], v7 offset:64
    ds_read_b128 v[88:91], v7 offset:320
    ds_read_b128 v[44:47], v6 offset:3072
    ds_read_b128 v[76:79], v7 offset:96
    ds_read_b128 v[92:95], v7 offset:352
    s_cmp_lt_u32 s20, 4
    s_cbranch_scc1 LadaLN_cond__grouped_kv_mqa__dense_activation_relu__prompt_kernel_hs51
    s_add_u32 m0, s83, 24576
    s_nop 0
    buffer_load_dwordx4 v252, s[8:11], s82 offen lds
    buffer_load_dwordx4 v253, s[8:11], s82 offen offset:1024 lds
    s_add_u32 s82, s82, 229376
    s_add_u32 m0, s83, 32768
    s_nop 0
    buffer_load_dwordx4 v252, s[8:11], s82 offen lds
    buffer_load_dwordx4 v253, s[8:11], s82 offen offset:1024 lds
    s_add_u32 s82, s82, 229376
LadaLN_cond__grouped_kv_mqa__dense_activation_relu__prompt_kernel_hs51:
    v_mov_b32 v96, 0
    v_mov_b32 v97, 0
    v_lshlrev_b32 v98, 16, v116
    v_and_b32 v99, 0xffff0000, v116
    s_waitcnt lgkmcnt(9)
    v_add_f32 v16, v16, v32
    v_add_f32 v17, v17, v33
    v_fmac_f32 v98, v16, v64
    v_fmac_f32 v99, v17, v65
    v_cvt_pk_bf16_f32 v116, v98, v99
    v_lshlrev_b32 v98, 16, v116
    v_and_b32 v99, 0xffff0000, v116
    v_add_f32 v96, v96, v98
    v_fmac_f32 v97, v98, v98
    v_add_f32 v96, v96, v99
    v_fmac_f32 v97, v99, v99
    v_mul_f32 v98, v98, v80
    v_mul_f32 v99, v99, v81
    v_cvt_pk_bf16_f32 v48, v98, v99
    v_lshlrev_b32 v98, 16, v117
    v_and_b32 v99, 0xffff0000, v117
    v_add_f32 v18, v18, v34
    v_add_f32 v19, v19, v35
    v_fmac_f32 v98, v18, v66
    v_fmac_f32 v99, v19, v67
    v_cvt_pk_bf16_f32 v117, v98, v99
    v_lshlrev_b32 v98, 16, v117
    v_and_b32 v99, 0xffff0000, v117
    v_add_f32 v96, v96, v98
    v_fmac_f32 v97, v98, v98
    v_add_f32 v96, v96, v99
    v_fmac_f32 v97, v99, v99
    v_mul_f32 v98, v98, v82
    v_mul_f32 v99, v99, v83
    v_cvt_pk_bf16_f32 v49, v98, v99
    v_lshlrev_b32 v98, 16, v118
    v_and_b32 v99, 0xffff0000, v118
    s_waitcnt lgkmcnt(6)
    v_add_f32 v20, v20, v36
    v_add_f32 v21, v21, v37
    v_fmac_f32 v98, v20, v68
    v_fmac_f32 v99, v21, v69
    v_cvt_pk_bf16_f32 v118, v98, v99
    v_lshlrev_b32 v98, 16, v118
    v_and_b32 v99, 0xffff0000, v118
    v_add_f32 v96, v96, v98
    v_fmac_f32 v97, v98, v98
    v_add_f32 v96, v96, v99
    v_fmac_f32 v97, v99, v99
    v_mul_f32 v98, v98, v84
    v_mul_f32 v99, v99, v85
    v_cvt_pk_bf16_f32 v50, v98, v99
    v_lshlrev_b32 v98, 16, v119
    v_and_b32 v99, 0xffff0000, v119
    v_add_f32 v22, v22, v38
    v_add_f32 v23, v23, v39
    v_fmac_f32 v98, v22, v70
    v_fmac_f32 v99, v23, v71
    v_cvt_pk_bf16_f32 v119, v98, v99
    v_lshlrev_b32 v98, 16, v119
    v_and_b32 v99, 0xffff0000, v119
    v_add_f32 v96, v96, v98
    v_fmac_f32 v97, v98, v98
    v_add_f32 v96, v96, v99
    v_fmac_f32 v97, v99, v99
    v_mul_f32 v98, v98, v86
    v_mul_f32 v99, v99, v87
    v_cvt_pk_bf16_f32 v51, v98, v99
    v_lshlrev_b32 v98, 16, v120
    v_and_b32 v99, 0xffff0000, v120
    s_waitcnt lgkmcnt(3)
    v_add_f32 v24, v24, v40
    v_add_f32 v25, v25, v41
    v_fmac_f32 v98, v24, v72
    v_fmac_f32 v99, v25, v73
    v_cvt_pk_bf16_f32 v120, v98, v99
    v_lshlrev_b32 v98, 16, v120
    v_and_b32 v99, 0xffff0000, v120
    v_add_f32 v96, v96, v98
    v_fmac_f32 v97, v98, v98
    v_add_f32 v96, v96, v99
    v_fmac_f32 v97, v99, v99
    v_mul_f32 v98, v98, v88
    v_mul_f32 v99, v99, v89
    v_cvt_pk_bf16_f32 v52, v98, v99
    v_lshlrev_b32 v98, 16, v121
    v_and_b32 v99, 0xffff0000, v121
    v_add_f32 v26, v26, v42
    v_add_f32 v27, v27, v43
    v_fmac_f32 v98, v26, v74
    v_fmac_f32 v99, v27, v75
    v_cvt_pk_bf16_f32 v121, v98, v99
    v_lshlrev_b32 v98, 16, v121
    v_and_b32 v99, 0xffff0000, v121
    v_add_f32 v96, v96, v98
    v_fmac_f32 v97, v98, v98
    v_add_f32 v96, v96, v99
    v_fmac_f32 v97, v99, v99
    v_mul_f32 v98, v98, v90
    v_mul_f32 v99, v99, v91
    v_cvt_pk_bf16_f32 v53, v98, v99
    v_lshlrev_b32 v98, 16, v122
    v_and_b32 v99, 0xffff0000, v122
    s_waitcnt lgkmcnt(0)
    v_add_f32 v28, v28, v44
    v_add_f32 v29, v29, v45
    v_fmac_f32 v98, v28, v76
    v_fmac_f32 v99, v29, v77
    v_cvt_pk_bf16_f32 v122, v98, v99
    v_lshlrev_b32 v98, 16, v122
    v_and_b32 v99, 0xffff0000, v122
    v_add_f32 v96, v96, v98
    v_fmac_f32 v97, v98, v98
    v_add_f32 v96, v96, v99
    v_fmac_f32 v97, v99, v99
    v_mul_f32 v98, v98, v92
    v_mul_f32 v99, v99, v93
    v_cvt_pk_bf16_f32 v54, v98, v99
    v_lshlrev_b32 v98, 16, v123
    v_and_b32 v99, 0xffff0000, v123
    v_add_f32 v30, v30, v46
    v_add_f32 v31, v31, v47
    v_fmac_f32 v98, v30, v78
    v_fmac_f32 v99, v31, v79
    v_cvt_pk_bf16_f32 v123, v98, v99
    v_lshlrev_b32 v98, 16, v123
    v_and_b32 v99, 0xffff0000, v123
    v_add_f32 v96, v96, v98
    v_fmac_f32 v97, v98, v98
    v_add_f32 v96, v96, v99
    v_fmac_f32 v97, v99, v99
    v_mul_f32 v98, v98, v94
    v_mul_f32 v99, v99, v95
    v_cvt_pk_bf16_f32 v55, v98, v99
    v_min_u32 v48, -2, v48
    v_min_u32 v52, -2, v52
    s_cmp_ge_u32 s20, 4
    s_cbranch_scc1 LadaLN_cond__grouped_kv_mqa__dense_activation_relu__prompt_kernel_helper52
    buffer_store_dwordx4 v[48:51], v1, s[16:19], s70 offen sc1
    buffer_store_dwordx4 v[52:55], v1, s[16:19], s70 offen offset:1024 sc1
    v_mov_b32 v98, v96
    s_nop 1
    v_permlane32_swap_b32 v96, v98
    s_nop 0
    v_add_f32 v96, v96, v98
    v_mov_b32 v99, v97
    s_nop 1
    v_permlane32_swap_b32 v97, v99
    s_nop 0
    v_add_f32 v97, v97, v99
    s_barrier
    ds_read_b128 v[56:59], v5
    ds_read_b128 v[60:63], v5 offset:1024
    ds_read_b64 v[98:99], v5 offset:2048
    s_waitcnt lgkmcnt(2)
    buffer_store_dwordx4 v[56:59], v1, s[16:19], s70 offen offset:2048 sc1
    s_waitcnt lgkmcnt(1)
    buffer_store_dwordx4 v[60:63], v1, s[16:19], s70 offen offset:3072 sc1
    s_waitcnt lgkmcnt(0)
    v_add_f32 v96, v96, v98
    v_add_f32 v97, v97, v99
    s_mov_b32 exec_hi, 0
    buffer_store_dwordx2 v[96:97], v8, s[16:19], s73 offen sc1
    s_mov_b32 exec_hi, -1
LadaLN_cond__grouped_kv_mqa__dense_activation_relu__prompt_kernel_ecode:
    v_lshrrev_b32 v3, 5, v2
    v_lshlrev_b32 v3, 4, v3
    v_and_b32 v12, 1, v10
    v_lshl_add_u32 v3, v12, 2, v3
    v_lshrrev_b32 v12, 2, v9
    v_add_u32 v3, v3, v12
    v_mul_u32_u24 v3, 224, v3
    v_and_b32 v12, 3, v9
    v_lshl_add_u32 v3, v12, 3, v3
    v_lshrrev_b32 v8, 5, v2
    v_lshlrev_b32 v8, 10, v8
    v_and_b32 v12, 1, v10
    v_lshl_add_u32 v8, v12, 9, v8
    v_lshl_add_u32 v8, v9, 4, v8
    v_and_b32 v11, 31, v2
    v_lshlrev_b32 v11, 7, v11
    s_lshl_b32 s73, s88, 2
    s_add_u32 s73, s73, s20
    s_lshl_b32 s72, s73, 12
    s_add_u32 s72, s72, 36962304
    s_lshl_b32 s68, s73, 17
    s_add_u32 s68, s68, 9437184
    s_add_u32 s69, s68, 65536
    v_lshlrev_b32 v253, 3, v9
    s_lshl_b32 s74, s20, 9
    s_add_u32 s74, s74, 149504
    v_add_u32 v252, s74, v253
    v_add_u32 v253, 148480, v253
    v_cmp_gt_u32 vcc, 16, v2
    v_mov_b32 v12, 152576
    v_mov_b32 v6, 0
    v_mov_b32 v7, 0
    v_mov_b32 v14, 0
    v_mov_b32 v15, 0
    v_cndmask_b32 v253, v12, v253, vcc
    s_mul_i32 s70, s73, 458752
    s_mul_i32 s74, s89, 7168
    s_add_u32 s70, s70, s74
    s_add_u32 s74, s70, 13631488
    s_add_u32 s75, s74, 4096
    s_add_u32 s76, s74, 229376
    s_add_u32 s77, s76, 4096
    buffer_load_dwordx4 v[44:47], v8, s[16:19], s68 offen offset:0 sc1
    buffer_load_dwordx4 v[48:51], v8, s[16:19], s68 offen offset:256 sc1
    buffer_load_dwordx4 v[52:55], v8, s[16:19], s69 offen offset:0 sc1
    buffer_load_dwordx4 v[56:59], v8, s[16:19], s69 offen offset:256 sc1
    s_waitcnt vmcnt(0)
    v_mov_b32 v12, s23
    s_mov_b64 exec, 1
    buffer_store_dword v12, off, s[16:19], s71 sc1
    s_mov_b64 exec, -1
    s_lshl_b32 s71, s73, 5
    s_add_u32 s71, s71, s89
    s_lshl_b32 s71, s71, 7
    s_add_u32 s71, s71, 37093376
    buffer_load_dwordx4 v[60:63], v8, s[16:19], s68 offen offset:2048 sc1
    buffer_load_dwordx4 v[64:67], v8, s[16:19], s68 offen offset:2304 sc1
    s_add_u32 s68, s68, 4096
    buffer_load_dwordx4 v[68:71], v8, s[16:19], s69 offen offset:2048 sc1
    buffer_load_dwordx4 v[72:75], v8, s[16:19], s69 offen offset:2304 sc1
    s_add_u32 s69, s69, 4096
    buffer_load_dwordx4 v[76:79], v8, s[16:19], s68 offen offset:0 sc1
    buffer_load_dwordx4 v[80:83], v8, s[16:19], s68 offen offset:256 sc1
    buffer_load_dwordx4 v[84:87], v8, s[16:19], s69 offen offset:0 sc1
    buffer_load_dwordx4 v[88:91], v8, s[16:19], s69 offen offset:256 sc1
    buffer_load_dwordx4 v[92:95], v8, s[16:19], s68 offen offset:2048 sc1
    buffer_load_dwordx4 v[96:99], v8, s[16:19], s68 offen offset:2304 sc1
    s_add_u32 s68, s68, 4096
    buffer_load_dwordx4 v[100:103], v8, s[16:19], s69 offen offset:2048 sc1
    buffer_load_dwordx4 v[104:107], v8, s[16:19], s69 offen offset:2304 sc1
    s_add_u32 s69, s69, 4096
    s_barrier
    ds_read_b64_tr_b16 v[16:17], v3 offset:0
    ds_read_b64_tr_b16 v[18:19], v3 offset:1792
    ds_read_b64_tr_b16 v[20:21], v3 offset:32
    ds_read_b64_tr_b16 v[22:23], v3 offset:1824
    ds_read_b64_tr_b16 v[24:25], v3 offset:64
    ds_read_b64_tr_b16 v[26:27], v3 offset:1856
    ds_read_b64_tr_b16 v[28:29], v3 offset:96
    ds_read_b64_tr_b16 v[30:31], v3 offset:1888
    ds_read_b64_tr_b16 v[32:33], v3 offset:128
    ds_read_b64_tr_b16 v[34:35], v3 offset:1920
    ds_read_b64_tr_b16 v[36:37], v3 offset:160
    ds_read_b64_tr_b16 v[38:39], v3 offset:1952
    s_setprio 1
    s_waitcnt vmcnt(12)
    v_max3_u32 v5, v44, v48, v52
    v_max_u32 v5, v5, v56
    v_cmp_eq_u32 vcc, -1, v5
    s_nop 1
    s_cbranch_vccnz LadaLN_cond__grouped_kv_mqa__dense_activation_relu__prompt_kernel_efb53
LadaLN_cond__grouped_kv_mqa__dense_activation_relu__prompt_kernel_ebk54:
    s_waitcnt lgkmcnt(10)
    v_mfma_f32_16x16x32_bf16 v[128:131], v[16:19], v[44:47], 0
    ds_read_b64_tr_b16 v[40:41], v3 offset:192
    v_mfma_f32_16x16x32_bf16 v[132:135], v[16:19], v[48:51], 0
    ds_read_b64_tr_b16 v[42:43], v3 offset:1984
    v_mfma_f32_16x16x32_bf16 v[136:139], v[16:19], v[52:55], 0
    v_mfma_f32_16x16x32_bf16 v[140:143], v[16:19], v[56:59], 0
    s_waitcnt lgkmcnt(10)
    v_mfma_f32_16x16x32_bf16 v[144:147], v[20:23], v[44:47], 0
    ds_read_b64_tr_b16 v[16:17], v3 offset:8192
    v_mfma_f32_16x16x32_bf16 v[148:151], v[20:23], v[48:51], 0
    ds_read_b64_tr_b16 v[18:19], v3 offset:9984
    v_mfma_f32_16x16x32_bf16 v[152:155], v[20:23], v[52:55], 0
    buffer_load_dwordx4 v[108:111], v8, s[16:19], s68 offen offset:0 sc1
    v_mfma_f32_16x16x32_bf16 v[156:159], v[20:23], v[56:59], 0
    s_waitcnt lgkmcnt(10)
    v_mfma_f32_16x16x32_bf16 v[160:163], v[24:27], v[44:47], 0
    ds_read_b64_tr_b16 v[20:21], v3 offset:8224
    v_mfma_f32_16x16x32_bf16 v[164:167], v[24:27], v[48:51], 0
    ds_read_b64_tr_b16 v[22:23], v3 offset:10016
    v_mfma_f32_16x16x32_bf16 v[168:171], v[24:27], v[52:55], 0
    buffer_load_dwordx4 v[112:115], v8, s[16:19], s68 offen offset:256 sc1
    v_mfma_f32_16x16x32_bf16 v[172:175], v[24:27], v[56:59], 0
    s_waitcnt lgkmcnt(10)
    v_mfma_f32_16x16x32_bf16 v[176:179], v[28:31], v[44:47], 0
    ds_read_b64_tr_b16 v[24:25], v3 offset:8256
    v_mfma_f32_16x16x32_bf16 v[180:183], v[28:31], v[48:51], 0
    ds_read_b64_tr_b16 v[26:27], v3 offset:10048
    v_mfma_f32_16x16x32_bf16 v[184:187], v[28:31], v[52:55], 0
    v_mfma_f32_16x16x32_bf16 v[188:191], v[28:31], v[56:59], 0
    s_waitcnt lgkmcnt(10)
    v_mfma_f32_16x16x32_bf16 v[192:195], v[32:35], v[44:47], 0
    ds_read_b64_tr_b16 v[28:29], v3 offset:8288
    v_mfma_f32_16x16x32_bf16 v[196:199], v[32:35], v[48:51], 0
    ds_read_b64_tr_b16 v[30:31], v3 offset:10080
    v_mfma_f32_16x16x32_bf16 v[200:203], v[32:35], v[52:55], 0
    buffer_load_dwordx4 v[124:127], v8, s[16:19], s69 offen offset:0 sc1
    v_mfma_f32_16x16x32_bf16 v[204:207], v[32:35], v[56:59], 0
    s_waitcnt lgkmcnt(10)
    v_mfma_f32_16x16x32_bf16 v[208:211], v[36:39], v[44:47], 0
    ds_read_b64_tr_b16 v[32:33], v3 offset:8320
    v_mfma_f32_16x16x32_bf16 v[212:215], v[36:39], v[48:51], 0
    ds_read_b64_tr_b16 v[34:35], v3 offset:10112
    v_mfma_f32_16x16x32_bf16 v[216:219], v[36:39], v[52:55], 0
    buffer_load_dwordx4 v[240:243], v8, s[16:19], s69 offen offset:256 sc1
    v_mfma_f32_16x16x32_bf16 v[220:223], v[36:39], v[56:59], 0
    s_waitcnt lgkmcnt(10)
    v_mfma_f32_16x16x32_bf16 v[224:227], v[40:43], v[44:47], 0
    ds_read_b64_tr_b16 v[36:37], v3 offset:8352
    s_waitcnt vmcnt(12)
    v_max3_u32 v5, v60, v64, v68
    v_mfma_f32_16x16x32_bf16 v[228:231], v[40:43], v[48:51], 0
    ds_read_b64_tr_b16 v[38:39], v3 offset:10144
    v_max_u32 v5, v5, v72
    v_mfma_f32_16x16x32_bf16 v[232:235], v[40:43], v[52:55], 0
    v_cmp_eq_u32 vcc, -1, v5
    v_mfma_f32_16x16x32_bf16 v[236:239], v[40:43], v[56:59], 0
    s_cbranch_vccnz LadaLN_cond__grouped_kv_mqa__dense_activation_relu__prompt_kernel_efb55
LadaLN_cond__grouped_kv_mqa__dense_activation_relu__prompt_kernel_ebk56:
    s_waitcnt lgkmcnt(10)
    v_mfma_f32_16x16x32_bf16 v[128:131], v[16:19], v[60:63], v[128:131]
    ds_read_b64_tr_b16 v[40:41], v3 offset:8384
    v_mfma_f32_16x16x32_bf16 v[132:135], v[16:19], v[64:67], v[132:135]
    ds_read_b64_tr_b16 v[42:43], v3 offset:10176
    v_mfma_f32_16x16x32_bf16 v[136:139], v[16:19], v[68:71], v[136:139]
    v_mfma_f32_16x16x32_bf16 v[140:143], v[16:19], v[72:75], v[140:143]
    s_waitcnt lgkmcnt(10)
    v_mfma_f32_16x16x32_bf16 v[144:147], v[20:23], v[60:63], v[144:147]
    ds_read_b64_tr_b16 v[16:17], v3 offset:16384
    v_mfma_f32_16x16x32_bf16 v[148:151], v[20:23], v[64:67], v[148:151]
    ds_read_b64_tr_b16 v[18:19], v3 offset:18176
    v_mfma_f32_16x16x32_bf16 v[152:155], v[20:23], v[68:71], v[152:155]
    buffer_load_dwordx4 v[44:47], v8, s[16:19], s68 offen offset:2048 sc1
    v_mfma_f32_16x16x32_bf16 v[156:159], v[20:23], v[72:75], v[156:159]
    s_waitcnt lgkmcnt(10)
    v_mfma_f32_16x16x32_bf16 v[160:163], v[24:27], v[60:63], v[160:163]
    ds_read_b64_tr_b16 v[20:21], v3 offset:16416
    v_mfma_f32_16x16x32_bf16 v[164:167], v[24:27], v[64:67], v[164:167]
    ds_read_b64_tr_b16 v[22:23], v3 offset:18208
    v_mfma_f32_16x16x32_bf16 v[168:171], v[24:27], v[68:71], v[168:171]
    buffer_load_dwordx4 v[48:51], v8, s[16:19], s68 offen offset:2304 sc1
    s_add_u32 s68, s68, 4096
    v_mfma_f32_16x16x32_bf16 v[172:175], v[24:27], v[72:75], v[172:175]
    s_waitcnt lgkmcnt(10)
    v_mfma_f32_16x16x32_bf16 v[176:179], v[28:31], v[60:63], v[176:179]
    ds_read_b64_tr_b16 v[24:25], v3 offset:16448
    v_mfma_f32_16x16x32_bf16 v[180:183], v[28:31], v[64:67], v[180:183]
    ds_read_b64_tr_b16 v[26:27], v3 offset:18240
    v_mfma_f32_16x16x32_bf16 v[184:187], v[28:31], v[68:71], v[184:187]
    v_mfma_f32_16x16x32_bf16 v[188:191], v[28:31], v[72:75], v[188:191]
    s_waitcnt lgkmcnt(10)
    v_mfma_f32_16x16x32_bf16 v[192:195], v[32:35], v[60:63], v[192:195]
    ds_read_b64_tr_b16 v[28:29], v3 offset:16480
    v_mfma_f32_16x16x32_bf16 v[196:199], v[32:35], v[64:67], v[196:199]
    ds_read_b64_tr_b16 v[30:31], v3 offset:18272
    v_mfma_f32_16x16x32_bf16 v[200:203], v[32:35], v[68:71], v[200:203]
    buffer_load_dwordx4 v[52:55], v8, s[16:19], s69 offen offset:2048 sc1
    v_mfma_f32_16x16x32_bf16 v[204:207], v[32:35], v[72:75], v[204:207]
    s_waitcnt lgkmcnt(10)
    v_mfma_f32_16x16x32_bf16 v[208:211], v[36:39], v[60:63], v[208:211]
    ds_read_b64_tr_b16 v[32:33], v3 offset:16512
    v_mfma_f32_16x16x32_bf16 v[212:215], v[36:39], v[64:67], v[212:215]
    ds_read_b64_tr_b16 v[34:35], v3 offset:18304
    v_mfma_f32_16x16x32_bf16 v[216:219], v[36:39], v[68:71], v[216:219]
    buffer_load_dwordx4 v[56:59], v8, s[16:19], s69 offen offset:2304 sc1
    s_add_u32 s69, s69, 4096
    v_mfma_f32_16x16x32_bf16 v[220:223], v[36:39], v[72:75], v[220:223]
    s_waitcnt lgkmcnt(10)
    v_mfma_f32_16x16x32_bf16 v[224:227], v[40:43], v[60:63], v[224:227]
    ds_read_b64_tr_b16 v[36:37], v3 offset:16544
    s_waitcnt vmcnt(12)
    v_max3_u32 v5, v76, v80, v84
    v_mfma_f32_16x16x32_bf16 v[228:231], v[40:43], v[64:67], v[228:231]
    ds_read_b64_tr_b16 v[38:39], v3 offset:18336
    v_max_u32 v5, v5, v88
    v_mfma_f32_16x16x32_bf16 v[232:235], v[40:43], v[68:71], v[232:235]
    v_cmp_eq_u32 vcc, -1, v5
    v_mfma_f32_16x16x32_bf16 v[236:239], v[40:43], v[72:75], v[236:239]
    s_cbranch_vccnz LadaLN_cond__grouped_kv_mqa__dense_activation_relu__prompt_kernel_efb57
LadaLN_cond__grouped_kv_mqa__dense_activation_relu__prompt_kernel_ebk58:
    s_waitcnt lgkmcnt(10)
    v_mfma_f32_16x16x32_bf16 v[128:131], v[16:19], v[76:79], v[128:131]
    ds_read_b64_tr_b16 v[40:41], v3 offset:16576
    v_mfma_f32_16x16x32_bf16 v[132:135], v[16:19], v[80:83], v[132:135]
    ds_read_b64_tr_b16 v[42:43], v3 offset:18368
    v_mfma_f32_16x16x32_bf16 v[136:139], v[16:19], v[84:87], v[136:139]
    v_mfma_f32_16x16x32_bf16 v[140:143], v[16:19], v[88:91], v[140:143]
    s_waitcnt lgkmcnt(10)
    v_mfma_f32_16x16x32_bf16 v[144:147], v[20:23], v[76:79], v[144:147]
    ds_read_b64_tr_b16 v[16:17], v3 offset:24576
    v_mfma_f32_16x16x32_bf16 v[148:151], v[20:23], v[80:83], v[148:151]
    ds_read_b64_tr_b16 v[18:19], v3 offset:26368
    v_mfma_f32_16x16x32_bf16 v[152:155], v[20:23], v[84:87], v[152:155]
    s_branch LadaLN_cond__grouped_kv_mqa__dense_activation_relu__prompt_kernel_over8
LadaLN_cond__grouped_kv_mqa__dense_activation_relu__prompt_kernel_stub8:
    s_setpc_b64 s[96:97]
LadaLN_cond__grouped_kv_mqa__dense_activation_relu__prompt_kernel_over8:
    buffer_load_dwordx4 v[60:63], v8, s[16:19], s68 offen offset:0 sc1
    v_mfma_f32_16x16x32_bf16 v[156:159], v[20:23], v[88:91], v[156:159]
    s_waitcnt lgkmcnt(10)
    v_mfma_f32_16x16x32_bf16 v[160:163], v[24:27], v[76:79], v[160:163]
    ds_read_b64_tr_b16 v[20:21], v3 offset:24608
    v_mfma_f32_16x16x32_bf16 v[164:167], v[24:27], v[80:83], v[164:167]
    ds_read_b64_tr_b16 v[22:23], v3 offset:26400
    v_mfma_f32_16x16x32_bf16 v[168:171], v[24:27], v[84:87], v[168:171]
    buffer_load_dwordx4 v[64:67], v8, s[16:19], s68 offen offset:256 sc1
    v_mfma_f32_16x16x32_bf16 v[172:175], v[24:27], v[88:91], v[172:175]
    s_waitcnt lgkmcnt(10)
    v_mfma_f32_16x16x32_bf16 v[176:179], v[28:31], v[76:79], v[176:179]
    ds_read_b64_tr_b16 v[24:25], v3 offset:24640
    v_mfma_f32_16x16x32_bf16 v[180:183], v[28:31], v[80:83], v[180:183]
    ds_read_b64_tr_b16 v[26:27], v3 offset:26432
    v_mfma_f32_16x16x32_bf16 v[184:187], v[28:31], v[84:87], v[184:187]
    v_mfma_f32_16x16x32_bf16 v[188:191], v[28:31], v[88:91], v[188:191]
    s_waitcnt lgkmcnt(10)
    v_mfma_f32_16x16x32_bf16 v[192:195], v[32:35], v[76:79], v[192:195]
    ds_read_b64_tr_b16 v[28:29], v3 offset:24672
    v_mfma_f32_16x16x32_bf16 v[196:199], v[32:35], v[80:83], v[196:199]
    ds_read_b64_tr_b16 v[30:31], v3 offset:26464
    v_mfma_f32_16x16x32_bf16 v[200:203], v[32:35], v[84:87], v[200:203]
    buffer_load_dwordx4 v[68:71], v8, s[16:19], s69 offen offset:0 sc1
    v_mfma_f32_16x16x32_bf16 v[204:207], v[32:35], v[88:91], v[204:207]
    s_waitcnt lgkmcnt(10)
    v_mfma_f32_16x16x32_bf16 v[208:211], v[36:39], v[76:79], v[208:211]
    ds_read_b64_tr_b16 v[32:33], v3 offset:24704
    v_mfma_f32_16x16x32_bf16 v[212:215], v[36:39], v[80:83], v[212:215]
    ds_read_b64_tr_b16 v[34:35], v3 offset:26496
    v_mfma_f32_16x16x32_bf16 v[216:219], v[36:39], v[84:87], v[216:219]
    buffer_load_dwordx4 v[72:75], v8, s[16:19], s69 offen offset:256 sc1
    v_mfma_f32_16x16x32_bf16 v[220:223], v[36:39], v[88:91], v[220:223]
    s_waitcnt lgkmcnt(10)
    v_mfma_f32_16x16x32_bf16 v[224:227], v[40:43], v[76:79], v[224:227]
    ds_read_b64_tr_b16 v[36:37], v3 offset:24736
    s_waitcnt vmcnt(12)
    v_max3_u32 v5, v92, v96, v100
    v_mfma_f32_16x16x32_bf16 v[228:231], v[40:43], v[80:83], v[228:231]
    ds_read_b64_tr_b16 v[38:39], v3 offset:26528
    v_max_u32 v5, v5, v104
    v_mfma_f32_16x16x32_bf16 v[232:235], v[40:43], v[84:87], v[232:235]
    v_cmp_eq_u32 vcc, -1, v5
    v_mfma_f32_16x16x32_bf16 v[236:239], v[40:43], v[88:91], v[236:239]
    s_cbranch_vccnz LadaLN_cond__grouped_kv_mqa__dense_activation_relu__prompt_kernel_efb59
LadaLN_cond__grouped_kv_mqa__dense_activation_relu__prompt_kernel_ebk60:
    s_waitcnt lgkmcnt(10)
    v_mfma_f32_16x16x32_bf16 v[128:131], v[16:19], v[92:95], v[128:131]
    ds_read_b64_tr_b16 v[40:41], v3 offset:24768
    v_mfma_f32_16x16x32_bf16 v[132:135], v[16:19], v[96:99], v[132:135]
    ds_read_b64_tr_b16 v[42:43], v3 offset:26560
    v_mfma_f32_16x16x32_bf16 v[136:139], v[16:19], v[100:103], v[136:139]
    v_mfma_f32_16x16x32_bf16 v[140:143], v[16:19], v[104:107], v[140:143]
    s_waitcnt lgkmcnt(10)
    v_mfma_f32_16x16x32_bf16 v[144:147], v[20:23], v[92:95], v[144:147]
    ds_read_b64_tr_b16 v[16:17], v3 offset:32768
    v_mfma_f32_16x16x32_bf16 v[148:151], v[20:23], v[96:99], v[148:151]
    ds_read_b64_tr_b16 v[18:19], v3 offset:34560
    v_mfma_f32_16x16x32_bf16 v[152:155], v[20:23], v[100:103], v[152:155]
    buffer_load_dwordx4 v[76:79], v8, s[16:19], s68 offen offset:2048 sc1
    v_mfma_f32_16x16x32_bf16 v[156:159], v[20:23], v[104:107], v[156:159]
    s_waitcnt lgkmcnt(10)
    v_mfma_f32_16x16x32_bf16 v[160:163], v[24:27], v[92:95], v[160:163]
    ds_read_b64_tr_b16 v[20:21], v3 offset:32800
    v_mfma_f32_16x16x32_bf16 v[164:167], v[24:27], v[96:99], v[164:167]
    ds_read_b64_tr_b16 v[22:23], v3 offset:34592
    v_mfma_f32_16x16x32_bf16 v[168:171], v[24:27], v[100:103], v[168:171]
    buffer_load_dwordx4 v[80:83], v8, s[16:19], s68 offen offset:2304 sc1
    s_add_u32 s68, s68, 4096
    v_mfma_f32_16x16x32_bf16 v[172:175], v[24:27], v[104:107], v[172:175]
    s_waitcnt lgkmcnt(10)
    v_mfma_f32_16x16x32_bf16 v[176:179], v[28:31], v[92:95], v[176:179]
    ds_read_b64_tr_b16 v[24:25], v3 offset:32832
    v_mfma_f32_16x16x32_bf16 v[180:183], v[28:31], v[96:99], v[180:183]
    ds_read_b64_tr_b16 v[26:27], v3 offset:34624
    v_mfma_f32_16x16x32_bf16 v[184:187], v[28:31], v[100:103], v[184:187]
    v_mfma_f32_16x16x32_bf16 v[188:191], v[28:31], v[104:107], v[188:191]
    s_waitcnt lgkmcnt(10)
    v_mfma_f32_16x16x32_bf16 v[192:195], v[32:35], v[92:95], v[192:195]
    ds_read_b64_tr_b16 v[28:29], v3 offset:32864
    v_mfma_f32_16x16x32_bf16 v[196:199], v[32:35], v[96:99], v[196:199]
    ds_read_b64_tr_b16 v[30:31], v3 offset:34656
    v_mfma_f32_16x16x32_bf16 v[200:203], v[32:35], v[100:103], v[200:203]
    buffer_load_dwordx4 v[84:87], v8, s[16:19], s69 offen offset:2048 sc1
    v_mfma_f32_16x16x32_bf16 v[204:207], v[32:35], v[104:107], v[204:207]
    s_waitcnt lgkmcnt(10)
    v_mfma_f32_16x16x32_bf16 v[208:211], v[36:39], v[92:95], v[208:211]
    ds_read_b64_tr_b16 v[32:33], v3 offset:32896
    v_mfma_f32_16x16x32_bf16 v[212:215], v[36:39], v[96:99], v[212:215]
    ds_read_b64_tr_b16 v[34:35], v3 offset:34688
    v_mfma_f32_16x16x32_bf16 v[216:219], v[36:39], v[100:103], v[216:219]
    buffer_load_dwordx4 v[88:91], v8, s[16:19], s69 offen offset:2304 sc1
    s_add_u32 s69, s69, 4096
    v_mfma_f32_16x16x32_bf16 v[220:223], v[36:39], v[104:107], v[220:223]
    s_waitcnt lgkmcnt(10)
    v_mfma_f32_16x16x32_bf16 v[224:227], v[40:43], v[92:95], v[224:227]
    ds_read_b64_tr_b16 v[36:37], v3 offset:32928
    s_waitcnt vmcnt(12)
    v_max3_u32 v5, v108, v112, v124
    v_mfma_f32_16x16x32_bf16 v[228:231], v[40:43], v[96:99], v[228:231]
    ds_read_b64_tr_b16 v[38:39], v3 offset:34720
    v_max_u32 v5, v5, v240
    v_mfma_f32_16x16x32_bf16 v[232:235], v[40:43], v[100:103], v[232:235]
    s_barrier
    v_cmp_eq_u32 vcc, -1, v5
    v_mfma_f32_16x16x32_bf16 v[236:239], v[40:43], v[104:107], v[236:239]
    s_cbranch_vccnz LadaLN_cond__grouped_kv_mqa__dense_activation_relu__prompt_kernel_efb61
LadaLN_cond__grouped_kv_mqa__dense_activation_relu__prompt_kernel_ebk62:
    s_waitcnt lgkmcnt(10)
    v_mfma_f32_16x16x32_bf16 v[128:131], v[16:19], v[108:111], v[128:131]
    ds_read_b64_tr_b16 v[40:41], v3 offset:32960
    v_mfma_f32_16x16x32_bf16 v[132:135], v[16:19], v[112:115], v[132:135]
    ds_read_b64_tr_b16 v[42:43], v3 offset:34752
    v_mfma_f32_16x16x32_bf16 v[136:139], v[16:19], v[124:127], v[136:139]
    v_mfma_f32_16x16x32_bf16 v[140:143], v[16:19], v[240:243], v[140:143]
    s_waitcnt lgkmcnt(10)
    v_mfma_f32_16x16x32_bf16 v[144:147], v[20:23], v[108:111], v[144:147]
    ds_read_b64_tr_b16 v[16:17], v3 offset:40960
    v_mfma_f32_16x16x32_bf16 v[148:151], v[20:23], v[112:115], v[148:151]
    ds_read_b64_tr_b16 v[18:19], v3 offset:42752
    v_mfma_f32_16x16x32_bf16 v[152:155], v[20:23], v[124:127], v[152:155]
    buffer_load_dwordx4 v[92:95], v8, s[16:19], s68 offen offset:0 sc1
    v_mfma_f32_16x16x32_bf16 v[156:159], v[20:23], v[240:243], v[156:159]
    s_waitcnt lgkmcnt(10)
    v_mfma_f32_16x16x32_bf16 v[160:163], v[24:27], v[108:111], v[160:163]
    ds_read_b64_tr_b16 v[20:21], v3 offset:40992
    v_mfma_f32_16x16x32_bf16 v[164:167], v[24:27], v[112:115], v[164:167]
    ds_read_b64_tr_b16 v[22:23], v3 offset:42784
    v_mfma_f32_16x16x32_bf16 v[168:171], v[24:27], v[124:127], v[168:171]
    buffer_load_dwordx4 v[96:99], v8, s[16:19], s68 offen offset:256 sc1
    v_mfma_f32_16x16x32_bf16 v[172:175], v[24:27], v[240:243], v[172:175]
    s_waitcnt lgkmcnt(10)
    v_mfma_f32_16x16x32_bf16 v[176:179], v[28:31], v[108:111], v[176:179]
    ds_read_b64_tr_b16 v[24:25], v3 offset:41024
    v_mfma_f32_16x16x32_bf16 v[180:183], v[28:31], v[112:115], v[180:183]
    ds_read_b64_tr_b16 v[26:27], v3 offset:42816
    v_mfma_f32_16x16x32_bf16 v[184:187], v[28:31], v[124:127], v[184:187]
    v_mfma_f32_16x16x32_bf16 v[188:191], v[28:31], v[240:243], v[188:191]
    s_waitcnt lgkmcnt(10)
    v_mfma_f32_16x16x32_bf16 v[192:195], v[32:35], v[108:111], v[192:195]
    ds_read_b64_tr_b16 v[28:29], v3 offset:41056
    v_mfma_f32_16x16x32_bf16 v[196:199], v[32:35], v[112:115], v[196:199]
    ds_read_b64_tr_b16 v[30:31], v3 offset:42848
    v_mfma_f32_16x16x32_bf16 v[200:203], v[32:35], v[124:127], v[200:203]
    buffer_load_dwordx4 v[100:103], v8, s[16:19], s69 offen offset:0 sc1
    v_mfma_f32_16x16x32_bf16 v[204:207], v[32:35], v[240:243], v[204:207]
    s_waitcnt lgkmcnt(10)
    v_mfma_f32_16x16x32_bf16 v[208:211], v[36:39], v[108:111], v[208:211]
    ds_read_b64_tr_b16 v[32:33], v3 offset:41088
    v_mfma_f32_16x16x32_bf16 v[212:215], v[36:39], v[112:115], v[212:215]
    ds_read_b64_tr_b16 v[34:35], v3 offset:42880
    v_mfma_f32_16x16x32_bf16 v[216:219], v[36:39], v[124:127], v[216:219]
    buffer_load_dwordx4 v[104:107], v8, s[16:19], s69 offen offset:256 sc1
    v_mfma_f32_16x16x32_bf16 v[220:223], v[36:39], v[240:243], v[220:223]
    s_waitcnt lgkmcnt(10)
    v_mfma_f32_16x16x32_bf16 v[224:227], v[40:43], v[108:111], v[224:227]
    ds_read_b64_tr_b16 v[36:37], v3 offset:41120
    s_waitcnt vmcnt(12)
    v_max3_u32 v5, v44, v48, v52
    v_mfma_f32_16x16x32_bf16 v[228:231], v[40:43], v[112:115], v[228:231]
    ds_read_b64_tr_b16 v[38:39], v3 offset:42912
    v_max_u32 v5, v5, v56
    v_mfma_f32_16x16x32_bf16 v[232:235], v[40:43], v[124:127], v[232:235]
    v_cmp_eq_u32 vcc, -1, v5
    v_mfma_f32_16x16x32_bf16 v[236:239], v[40:43], v[240:243], v[236:239]
    s_cbranch_vccnz LadaLN_cond__grouped_kv_mqa__dense_activation_relu__prompt_kernel_efb63
LadaLN_cond__grouped_kv_mqa__dense_activation_relu__prompt_kernel_ebk64:
    s_waitcnt lgkmcnt(10)
    v_mfma_f32_16x16x32_bf16 v[128:131], v[16:19], v[44:47], v[128:131]
    ds_read_b64_tr_b16 v[40:41], v3 offset:41152
    v_mfma_f32_16x16x32_bf16 v[132:135], v[16:19], v[48:51], v[132:135]
    ds_read_b64_tr_b16 v[42:43], v3 offset:42944
    v_mfma_f32_16x16x32_bf16 v[136:139], v[16:19], v[52:55], v[136:139]
    v_mfma_f32_16x16x32_bf16 v[140:143], v[16:19], v[56:59], v[140:143]
    s_waitcnt lgkmcnt(10)
    v_mfma_f32_16x16x32_bf16 v[144:147], v[20:23], v[44:47], v[144:147]
    ds_read_b64_tr_b16 v[16:17], v3 offset:49152
    v_mfma_f32_16x16x32_bf16 v[148:151], v[20:23], v[48:51], v[148:151]
    ds_read_b64_tr_b16 v[18:19], v3 offset:50944
    v_mfma_f32_16x16x32_bf16 v[152:155], v[20:23], v[52:55], v[152:155]
    buffer_load_dwordx4 v[108:111], v8, s[16:19], s68 offen offset:2048 sc1
    v_mfma_f32_16x16x32_bf16 v[156:159], v[20:23], v[56:59], v[156:159]
    s_waitcnt lgkmcnt(10)
    v_mfma_f32_16x16x32_bf16 v[160:163], v[24:27], v[44:47], v[160:163]
    ds_read_b64_tr_b16 v[20:21], v3 offset:49184
    v_mfma_f32_16x16x32_bf16 v[164:167], v[24:27], v[48:51], v[164:167]
    ds_read_b64_tr_b16 v[22:23], v3 offset:50976
    v_mfma_f32_16x16x32_bf16 v[168:171], v[24:27], v[52:55], v[168:171]
    buffer_load_dwordx4 v[112:115], v8, s[16:19], s68 offen offset:2304 sc1
    s_add_u32 s68, s68, 4096
    v_mfma_f32_16x16x32_bf16 v[172:175], v[24:27], v[56:59], v[172:175]
    s_waitcnt lgkmcnt(10)
    v_mfma_f32_16x16x32_bf16 v[176:179], v[28:31], v[44:47], v[176:179]
    ds_read_b64_tr_b16 v[24:25], v3 offset:49216
    v_mfma_f32_16x16x32_bf16 v[180:183], v[28:31], v[48:51], v[180:183]
    ds_read_b64_tr_b16 v[26:27], v3 offset:51008
    v_mfma_f32_16x16x32_bf16 v[184:187], v[28:31], v[52:55], v[184:187]
    v_mfma_f32_16x16x32_bf16 v[188:191], v[28:31], v[56:59], v[188:191]
    s_waitcnt lgkmcnt(10)
    v_mfma_f32_16x16x32_bf16 v[192:195], v[32:35], v[44:47], v[192:195]
    ds_read_b64_tr_b16 v[28:29], v3 offset:49248
    v_mfma_f32_16x16x32_bf16 v[196:199], v[32:35], v[48:51], v[196:199]
    ds_read_b64_tr_b16 v[30:31], v3 offset:51040
    v_mfma_f32_16x16x32_bf16 v[200:203], v[32:35], v[52:55], v[200:203]
    buffer_load_dwordx4 v[124:127], v8, s[16:19], s69 offen offset:2048 sc1
    v_mfma_f32_16x16x32_bf16 v[204:207], v[32:35], v[56:59], v[204:207]
    s_waitcnt lgkmcnt(10)
    v_mfma_f32_16x16x32_bf16 v[208:211], v[36:39], v[44:47], v[208:211]
    ds_read_b64_tr_b16 v[32:33], v3 offset:49280
    v_mfma_f32_16x16x32_bf16 v[212:215], v[36:39], v[48:51], v[212:215]
    ds_read_b64_tr_b16 v[34:35], v3 offset:51072
    v_mfma_f32_16x16x32_bf16 v[216:219], v[36:39], v[52:55], v[216:219]
    buffer_load_dwordx4 v[240:243], v8, s[16:19], s69 offen offset:2304 sc1
    s_add_u32 s69, s69, 4096
    v_mfma_f32_16x16x32_bf16 v[220:223], v[36:39], v[56:59], v[220:223]
    s_waitcnt lgkmcnt(10)
    v_mfma_f32_16x16x32_bf16 v[224:227], v[40:43], v[44:47], v[224:227]
    ds_read_b64_tr_b16 v[36:37], v3 offset:49312
    s_waitcnt vmcnt(12)
    v_max3_u32 v5, v60, v64, v68
    v_mfma_f32_16x16x32_bf16 v[228:231], v[40:43], v[48:51], v[228:231]
    ds_read_b64_tr_b16 v[38:39], v3 offset:51104
    v_max_u32 v5, v5, v72
    v_mfma_f32_16x16x32_bf16 v[232:235], v[40:43], v[52:55], v[232:235]
    v_cmp_eq_u32 vcc, -1, v5
    v_mfma_f32_16x16x32_bf16 v[236:239], v[40:43], v[56:59], v[236:239]
    s_cbranch_vccnz LadaLN_cond__grouped_kv_mqa__dense_activation_relu__prompt_kernel_efb65
LadaLN_cond__grouped_kv_mqa__dense_activation_relu__prompt_kernel_ebk66:
    s_waitcnt lgkmcnt(10)
    v_mfma_f32_16x16x32_bf16 v[128:131], v[16:19], v[60:63], v[128:131]
    ds_read_b64_tr_b16 v[40:41], v3 offset:49344
    v_mfma_f32_16x16x32_bf16 v[132:135], v[16:19], v[64:67], v[132:135]
    ds_read_b64_tr_b16 v[42:43], v3 offset:51136
    v_mfma_f32_16x16x32_bf16 v[136:139], v[16:19], v[68:71], v[136:139]
    v_mfma_f32_16x16x32_bf16 v[140:143], v[16:19], v[72:75], v[140:143]
    s_waitcnt lgkmcnt(10)
    v_mfma_f32_16x16x32_bf16 v[144:147], v[20:23], v[60:63], v[144:147]
    ds_read_b64_tr_b16 v[16:17], v3 offset:57344
    v_mfma_f32_16x16x32_bf16 v[148:151], v[20:23], v[64:67], v[148:151]
    ds_read_b64_tr_b16 v[18:19], v3 offset:59136
    v_mfma_f32_16x16x32_bf16 v[152:155], v[20:23], v[68:71], v[152:155]
    buffer_load_dwordx4 v[44:47], v8, s[16:19], s68 offen offset:0 sc1
    v_mfma_f32_16x16x32_bf16 v[156:159], v[20:23], v[72:75], v[156:159]
    s_waitcnt lgkmcnt(10)
    v_mfma_f32_16x16x32_bf16 v[160:163], v[24:27], v[60:63], v[160:163]
    ds_read_b64_tr_b16 v[20:21], v3 offset:57376
    v_mfma_f32_16x16x32_bf16 v[164:167], v[24:27], v[64:67], v[164:167]
    ds_read_b64_tr_b16 v[22:23], v3 offset:59168
    v_mfma_f32_16x16x32_bf16 v[168:171], v[24:27], v[68:71], v[168:171]
    buffer_load_dwordx4 v[48:51], v8, s[16:19], s68 offen offset:256 sc1
    v_mfma_f32_16x16x32_bf16 v[172:175], v[24:27], v[72:75], v[172:175]
    s_waitcnt lgkmcnt(10)
    v_mfma_f32_16x16x32_bf16 v[176:179], v[28:31], v[60:63], v[176:179]
    ds_read_b64_tr_b16 v[24:25], v3 offset:57408
    v_mfma_f32_16x16x32_bf16 v[180:183], v[28:31], v[64:67], v[180:183]
    ds_read_b64_tr_b16 v[26:27], v3 offset:59200
    v_mfma_f32_16x16x32_bf16 v[184:187], v[28:31], v[68:71], v[184:187]
    v_mfma_f32_16x16x32_bf16 v[188:191], v[28:31], v[72:75], v[188:191]
    s_waitcnt lgkmcnt(10)
    v_mfma_f32_16x16x32_bf16 v[192:195], v[32:35], v[60:63], v[192:195]
    ds_read_b64_tr_b16 v[28:29], v3 offset:57440
    v_mfma_f32_16x16x32_bf16 v[196:199], v[32:35], v[64:67], v[196:199]
    ds_read_b64_tr_b16 v[30:31], v3 offset:59232
    v_mfma_f32_16x16x32_bf16 v[200:203], v[32:35], v[68:71], v[200:203]
    buffer_load_dwordx4 v[52:55], v8, s[16:19], s69 offen offset:0 sc1
    v_mfma_f32_16x16x32_bf16 v[204:207], v[32:35], v[72:75], v[204:207]
    s_waitcnt lgkmcnt(10)
    v_mfma_f32_16x16x32_bf16 v[208:211], v[36:39], v[60:63], v[208:211]
    ds_read_b64_tr_b16 v[32:33], v3 offset:57472
    v_mfma_f32_16x16x32_bf16 v[212:215], v[36:39], v[64:67], v[212:215]
    ds_read_b64_tr_b16 v[34:35], v3 offset:59264
    v_mfma_f32_16x16x32_bf16 v[216:219], v[36:39], v[68:71], v[216:219]
    buffer_load_dwordx4 v[56:59], v8, s[16:19], s69 offen offset:256 sc1
    v_mfma_f32_16x16x32_bf16 v[220:223], v[36:39], v[72:75], v[220:223]
    s_waitcnt lgkmcnt(10)
    v_mfma_f32_16x16x32_bf16 v[224:227], v[40:43], v[60:63], v[224:227]
    ds_read_b64_tr_b16 v[36:37], v3 offset:57504
    s_waitcnt vmcnt(12)
    v_max3_u32 v5, v76, v80, v84
    v_mfma_f32_16x16x32_bf16 v[228:231], v[40:43], v[64:67], v[228:231]
    ds_read_b64_tr_b16 v[38:39], v3 offset:59296
    v_max_u32 v5, v5, v88
    v_mfma_f32_16x16x32_bf16 v[232:235], v[40:43], v[68:71], v[232:235]
    v_cmp_eq_u32 vcc, -1, v5
    v_mfma_f32_16x16x32_bf16 v[236:239], v[40:43], v[72:75], v[236:239]
    s_cbranch_vccnz LadaLN_cond__grouped_kv_mqa__dense_activation_relu__prompt_kernel_efb67
LadaLN_cond__grouped_kv_mqa__dense_activation_relu__prompt_kernel_ebk68:
    s_waitcnt lgkmcnt(10)
    v_mfma_f32_16x16x32_bf16 v[128:131], v[16:19], v[76:79], v[128:131]
    ds_read_b64_tr_b16 v[40:41], v3 offset:57536
    v_mfma_f32_16x16x32_bf16 v[132:135], v[16:19], v[80:83], v[132:135]
    ds_read_b64_tr_b16 v[42:43], v3 offset:59328
    v_mfma_f32_16x16x32_bf16 v[136:139], v[16:19], v[84:87], v[136:139]
    v_mfma_f32_16x16x32_bf16 v[140:143], v[16:19], v[88:91], v[140:143]
    s_waitcnt lgkmcnt(10)
    v_mfma_f32_16x16x32_bf16 v[144:147], v[20:23], v[76:79], v[144:147]
    v_add_u32 v3, 0x10000, v3
    ds_read_b64_tr_b16 v[16:17], v3 offset:0
    v_mfma_f32_16x16x32_bf16 v[148:151], v[20:23], v[80:83], v[148:151]
    ds_read_b64_tr_b16 v[18:19], v3 offset:1792
    v_mfma_f32_16x16x32_bf16 v[152:155], v[20:23], v[84:87], v[152:155]
    buffer_load_dwordx4 v[60:63], v8, s[16:19], s68 offen offset:2048 sc1
    v_mfma_f32_16x16x32_bf16 v[156:159], v[20:23], v[88:91], v[156:159]
    s_waitcnt lgkmcnt(10)
    v_mfma_f32_16x16x32_bf16 v[160:163], v[24:27], v[76:79], v[160:163]
    ds_read_b64_tr_b16 v[20:21], v3 offset:32
    v_mfma_f32_16x16x32_bf16 v[164:167], v[24:27], v[80:83], v[164:167]
    ds_read_b64_tr_b16 v[22:23], v3 offset:1824
    v_mfma_f32_16x16x32_bf16 v[168:171], v[24:27], v[84:87], v[168:171]
    buffer_load_dwordx4 v[64:67], v8, s[16:19], s68 offen offset:2304 sc1
    s_add_u32 s68, s68, 4096
    v_mfma_f32_16x16x32_bf16 v[172:175], v[24:27], v[88:91], v[172:175]
    s_waitcnt lgkmcnt(10)
    v_mfma_f32_16x16x32_bf16 v[176:179], v[28:31], v[76:79], v[176:179]
    ds_read_b64_tr_b16 v[24:25], v3 offset:64
    v_mfma_f32_16x16x32_bf16 v[180:183], v[28:31], v[80:83], v[180:183]
    ds_read_b64_tr_b16 v[26:27], v3 offset:1856
    v_mfma_f32_16x16x32_bf16 v[184:187], v[28:31], v[84:87], v[184:187]
    v_mfma_f32_16x16x32_bf16 v[188:191], v[28:31], v[88:91], v[188:191]
    s_waitcnt lgkmcnt(10)
    v_mfma_f32_16x16x32_bf16 v[192:195], v[32:35], v[76:79], v[192:195]
    ds_read_b64_tr_b16 v[28:29], v3 offset:96
    v_mfma_f32_16x16x32_bf16 v[196:199], v[32:35], v[80:83], v[196:199]
    ds_read_b64_tr_b16 v[30:31], v3 offset:1888
    v_mfma_f32_16x16x32_bf16 v[200:203], v[32:35], v[84:87], v[200:203]
    buffer_load_dwordx4 v[68:71], v8, s[16:19], s69 offen offset:2048 sc1
    v_mfma_f32_16x16x32_bf16 v[204:207], v[32:35], v[88:91], v[204:207]
    s_waitcnt lgkmcnt(10)
    v_mfma_f32_16x16x32_bf16 v[208:211], v[36:39], v[76:79], v[208:211]
    ds_read_b64_tr_b16 v[32:33], v3 offset:128
    v_mfma_f32_16x16x32_bf16 v[212:215], v[36:39], v[80:83], v[212:215]
    ds_read_b64_tr_b16 v[34:35], v3 offset:1920
    v_mfma_f32_16x16x32_bf16 v[216:219], v[36:39], v[84:87], v[216:219]
    buffer_load_dwordx4 v[72:75], v8, s[16:19], s69 offen offset:2304 sc1
    s_add_u32 s69, s69, 4096
    v_mfma_f32_16x16x32_bf16 v[220:223], v[36:39], v[88:91], v[220:223]
    s_waitcnt lgkmcnt(10)
    v_mfma_f32_16x16x32_bf16 v[224:227], v[40:43], v[76:79], v[224:227]
    ds_read_b64_tr_b16 v[36:37], v3 offset:160
    s_waitcnt vmcnt(12)
    v_max3_u32 v5, v92, v96, v100
    v_mfma_f32_16x16x32_bf16 v[228:231], v[40:43], v[80:83], v[228:231]
    ds_read_b64_tr_b16 v[38:39], v3 offset:1952
    v_max_u32 v5, v5, v104
    v_mfma_f32_16x16x32_bf16 v[232:235], v[40:43], v[84:87], v[232:235]
    s_barrier
    v_cmp_eq_u32 vcc, -1, v5
    v_mfma_f32_16x16x32_bf16 v[236:239], v[40:43], v[88:91], v[236:239]
    s_cbranch_vccnz LadaLN_cond__grouped_kv_mqa__dense_activation_relu__prompt_kernel_efb69
LadaLN_cond__grouped_kv_mqa__dense_activation_relu__prompt_kernel_ebk70:
    s_waitcnt lgkmcnt(10)
    v_mfma_f32_16x16x32_bf16 v[128:131], v[16:19], v[92:95], v[128:131]
    ds_read_b64_tr_b16 v[40:41], v3 offset:192
    v_mfma_f32_16x16x32_bf16 v[132:135], v[16:19], v[96:99], v[132:135]
    ds_read_b64_tr_b16 v[42:43], v3 offset:1984
    v_mfma_f32_16x16x32_bf16 v[136:139], v[16:19], v[100:103], v[136:139]
    v_mfma_f32_16x16x32_bf16 v[140:143], v[16:19], v[104:107], v[140:143]
    s_waitcnt lgkmcnt(10)
    v_mfma_f32_16x16x32_bf16 v[144:147], v[20:23], v[92:95], v[144:147]
    ds_read_b64_tr_b16 v[16:17], v3 offset:8192
    v_mfma_f32_16x16x32_bf16 v[148:151], v[20:23], v[96:99], v[148:151]
    ds_read_b64_tr_b16 v[18:19], v3 offset:9984
    v_mfma_f32_16x16x32_bf16 v[152:155], v[20:23], v[100:103], v[152:155]
    buffer_load_dwordx4 v[76:79], v8, s[16:19], s68 offen offset:0 sc1
    v_mfma_f32_16x16x32_bf16 v[156:159], v[20:23], v[104:107], v[156:159]
    s_waitcnt lgkmcnt(10)
    v_mfma_f32_16x16x32_bf16 v[160:163], v[24:27], v[92:95], v[160:163]
    ds_read_b64_tr_b16 v[20:21], v3 offset:8224
    v_mfma_f32_16x16x32_bf16 v[164:167], v[24:27], v[96:99], v[164:167]
    ds_read_b64_tr_b16 v[22:23], v3 offset:10016
    v_mfma_f32_16x16x32_bf16 v[168:171], v[24:27], v[100:103], v[168:171]
    buffer_load_dwordx4 v[80:83], v8, s[16:19], s68 offen offset:256 sc1
    v_mfma_f32_16x16x32_bf16 v[172:175], v[24:27], v[104:107], v[172:175]
    s_waitcnt lgkmcnt(10)
    v_mfma_f32_16x16x32_bf16 v[176:179], v[28:31], v[92:95], v[176:179]
    ds_read_b64_tr_b16 v[24:25], v3 offset:8256
    v_mfma_f32_16x16x32_bf16 v[180:183], v[28:31], v[96:99], v[180:183]
    ds_read_b64_tr_b16 v[26:27], v3 offset:10048
    v_mfma_f32_16x16x32_bf16 v[184:187], v[28:31], v[100:103], v[184:187]
    v_mfma_f32_16x16x32_bf16 v[188:191], v[28:31], v[104:107], v[188:191]
    s_waitcnt lgkmcnt(10)
    v_mfma_f32_16x16x32_bf16 v[192:195], v[32:35], v[92:95], v[192:195]
    ds_read_b64_tr_b16 v[28:29], v3 offset:8288
    v_mfma_f32_16x16x32_bf16 v[196:199], v[32:35], v[96:99], v[196:199]
    ds_read_b64_tr_b16 v[30:31], v3 offset:10080
    v_mfma_f32_16x16x32_bf16 v[200:203], v[32:35], v[100:103], v[200:203]
    buffer_load_dwordx4 v[84:87], v8, s[16:19], s69 offen offset:0 sc1
    v_mfma_f32_16x16x32_bf16 v[204:207], v[32:35], v[104:107], v[204:207]
    s_waitcnt lgkmcnt(10)
    v_mfma_f32_16x16x32_bf16 v[208:211], v[36:39], v[92:95], v[208:211]
    ds_read_b64_tr_b16 v[32:33], v3 offset:8320
    v_mfma_f32_16x16x32_bf16 v[212:215], v[36:39], v[96:99], v[212:215]
    ds_read_b64_tr_b16 v[34:35], v3 offset:10112
    v_mfma_f32_16x16x32_bf16 v[216:219], v[36:39], v[100:103], v[216:219]
    buffer_load_dwordx4 v[88:91], v8, s[16:19], s69 offen offset:256 sc1
    v_mfma_f32_16x16x32_bf16 v[220:223], v[36:39], v[104:107], v[220:223]
    s_waitcnt lgkmcnt(10)
    v_mfma_f32_16x16x32_bf16 v[224:227], v[40:43], v[92:95], v[224:227]
    ds_read_b64_tr_b16 v[36:37], v3 offset:8352
    s_waitcnt vmcnt(12)
    v_max3_u32 v5, v108, v112, v124
    v_mfma_f32_16x16x32_bf16 v[228:231], v[40:43], v[96:99], v[228:231]
    ds_read_b64_tr_b16 v[38:39], v3 offset:10144
    v_max_u32 v5, v5, v240
    v_mfma_f32_16x16x32_bf16 v[232:235], v[40:43], v[100:103], v[232:235]
    v_cmp_eq_u32 vcc, -1, v5
    v_mfma_f32_16x16x32_bf16 v[236:239], v[40:43], v[104:107], v[236:239]
    s_cbranch_vccnz LadaLN_cond__grouped_kv_mqa__dense_activation_relu__prompt_kernel_efb71
LadaLN_cond__grouped_kv_mqa__dense_activation_relu__prompt_kernel_ebk72:
    s_waitcnt lgkmcnt(10)
    v_mfma_f32_16x16x32_bf16 v[128:131], v[16:19], v[108:111], v[128:131]
    ds_read_b64_tr_b16 v[40:41], v3 offset:8384
    v_mfma_f32_16x16x32_bf16 v[132:135], v[16:19], v[112:115], v[132:135]
    ds_read_b64_tr_b16 v[42:43], v3 offset:10176
    v_mfma_f32_16x16x32_bf16 v[136:139], v[16:19], v[124:127], v[136:139]
    v_mfma_f32_16x16x32_bf16 v[140:143], v[16:19], v[240:243], v[140:143]
    s_waitcnt lgkmcnt(10)
    v_mfma_f32_16x16x32_bf16 v[144:147], v[20:23], v[108:111], v[144:147]
    ds_read_b64_tr_b16 v[16:17], v3 offset:16384
    v_mfma_f32_16x16x32_bf16 v[148:151], v[20:23], v[112:115], v[148:151]
    ds_read_b64_tr_b16 v[18:19], v3 offset:18176
    v_mfma_f32_16x16x32_bf16 v[152:155], v[20:23], v[124:127], v[152:155]
    buffer_load_dwordx4 v[92:95], v8, s[16:19], s68 offen offset:2048 sc1
    v_mfma_f32_16x16x32_bf16 v[156:159], v[20:23], v[240:243], v[156:159]
    s_waitcnt lgkmcnt(10)
    v_mfma_f32_16x16x32_bf16 v[160:163], v[24:27], v[108:111], v[160:163]
    ds_read_b64_tr_b16 v[20:21], v3 offset:16416
    v_mfma_f32_16x16x32_bf16 v[164:167], v[24:27], v[112:115], v[164:167]
    ds_read_b64_tr_b16 v[22:23], v3 offset:18208
    v_mfma_f32_16x16x32_bf16 v[168:171], v[24:27], v[124:127], v[168:171]
    buffer_load_dwordx4 v[96:99], v8, s[16:19], s68 offen offset:2304 sc1
    s_add_u32 s68, s68, 4096
    v_mfma_f32_16x16x32_bf16 v[172:175], v[24:27], v[240:243], v[172:175]
    s_waitcnt lgkmcnt(10)
    v_mfma_f32_16x16x32_bf16 v[176:179], v[28:31], v[108:111], v[176:179]
    ds_read_b64_tr_b16 v[24:25], v3 offset:16448
    v_mfma_f32_16x16x32_bf16 v[180:183], v[28:31], v[112:115], v[180:183]
    ds_read_b64_tr_b16 v[26:27], v3 offset:18240
    v_mfma_f32_16x16x32_bf16 v[184:187], v[28:31], v[124:127], v[184:187]
    v_mfma_f32_16x16x32_bf16 v[188:191], v[28:31], v[240:243], v[188:191]
    s_waitcnt lgkmcnt(10)
    v_mfma_f32_16x16x32_bf16 v[192:195], v[32:35], v[108:111], v[192:195]
    ds_read_b64_tr_b16 v[28:29], v3 offset:16480
    v_mfma_f32_16x16x32_bf16 v[196:199], v[32:35], v[112:115], v[196:199]
    ds_read_b64_tr_b16 v[30:31], v3 offset:18272
    v_mfma_f32_16x16x32_bf16 v[200:203], v[32:35], v[124:127], v[200:203]
    buffer_load_dwordx4 v[100:103], v8, s[16:19], s69 offen offset:2048 sc1
    v_mfma_f32_16x16x32_bf16 v[204:207], v[32:35], v[240:243], v[204:207]
    s_waitcnt lgkmcnt(10)
    v_mfma_f32_16x16x32_bf16 v[208:211], v[36:39], v[108:111], v[208:211]
    ds_read_b64_tr_b16 v[32:33], v3 offset:16512
    v_mfma_f32_16x16x32_bf16 v[212:215], v[36:39], v[112:115], v[212:215]
    ds_read_b64_tr_b16 v[34:35], v3 offset:18304
    v_mfma_f32_16x16x32_bf16 v[216:219], v[36:39], v[124:127], v[216:219]
    buffer_load_dwordx4 v[104:107], v8, s[16:19], s69 offen offset:2304 sc1
    s_add_u32 s69, s69, 4096
    v_mfma_f32_16x16x32_bf16 v[220:223], v[36:39], v[240:243], v[220:223]
    s_waitcnt lgkmcnt(10)
    v_mfma_f32_16x16x32_bf16 v[224:227], v[40:43], v[108:111], v[224:227]
    ds_read_b64_tr_b16 v[36:37], v3 offset:16544
    s_waitcnt vmcnt(12)
    v_max3_u32 v5, v44, v48, v52
    v_mfma_f32_16x16x32_bf16 v[228:231], v[40:43], v[112:115], v[228:231]
    ds_read_b64_tr_b16 v[38:39], v3 offset:18336
    v_max_u32 v5, v5, v56
    v_mfma_f32_16x16x32_bf16 v[232:235], v[40:43], v[124:127], v[232:235]
    v_cmp_eq_u32 vcc, -1, v5
    v_mfma_f32_16x16x32_bf16 v[236:239], v[40:43], v[240:243], v[236:239]
    s_cbranch_vccnz LadaLN_cond__grouped_kv_mqa__dense_activation_relu__prompt_kernel_efb73
LadaLN_cond__grouped_kv_mqa__dense_activation_relu__prompt_kernel_ebk74:
    s_waitcnt lgkmcnt(10)
    v_mfma_f32_16x16x32_bf16 v[128:131], v[16:19], v[44:47], v[128:131]
    ds_read_b64_tr_b16 v[40:41], v3 offset:16576
    v_mfma_f32_16x16x32_bf16 v[132:135], v[16:19], v[48:51], v[132:135]
    ds_read_b64_tr_b16 v[42:43], v3 offset:18368
    v_mfma_f32_16x16x32_bf16 v[136:139], v[16:19], v[52:55], v[136:139]
    v_mfma_f32_16x16x32_bf16 v[140:143], v[16:19], v[56:59], v[140:143]
    s_waitcnt lgkmcnt(10)
    v_mfma_f32_16x16x32_bf16 v[144:147], v[20:23], v[44:47], v[144:147]
    ds_read_b64_tr_b16 v[16:17], v3 offset:24576
    v_mfma_f32_16x16x32_bf16 v[148:151], v[20:23], v[48:51], v[148:151]
    ds_read_b64_tr_b16 v[18:19], v3 offset:26368
    v_mfma_f32_16x16x32_bf16 v[152:155], v[20:23], v[52:55], v[152:155]
    buffer_load_dwordx4 v[108:111], v8, s[16:19], s68 offen offset:0 sc1
    v_mfma_f32_16x16x32_bf16 v[156:159], v[20:23], v[56:59], v[156:159]
    s_waitcnt lgkmcnt(10)
    v_mfma_f32_16x16x32_bf16 v[160:163], v[24:27], v[44:47], v[160:163]
    ds_read_b64_tr_b16 v[20:21], v3 offset:24608
    v_mfma_f32_16x16x32_bf16 v[164:167], v[24:27], v[48:51], v[164:167]
    ds_read_b64_tr_b16 v[22:23], v3 offset:26400
    v_mfma_f32_16x16x32_bf16 v[168:171], v[24:27], v[52:55], v[168:171]
    buffer_load_dwordx4 v[112:115], v8, s[16:19], s68 offen offset:256 sc1
    v_mfma_f32_16x16x32_bf16 v[172:175], v[24:27], v[56:59], v[172:175]
    s_waitcnt lgkmcnt(10)
    v_mfma_f32_16x16x32_bf16 v[176:179], v[28:31], v[44:47], v[176:179]
    ds_read_b64_tr_b16 v[24:25], v3 offset:24640
    v_mfma_f32_16x16x32_bf16 v[180:183], v[28:31], v[48:51], v[180:183]
    ds_read_b64_tr_b16 v[26:27], v3 offset:26432
    v_mfma_f32_16x16x32_bf16 v[184:187], v[28:31], v[52:55], v[184:187]
    v_mfma_f32_16x16x32_bf16 v[188:191], v[28:31], v[56:59], v[188:191]
    s_waitcnt lgkmcnt(10)
    v_mfma_f32_16x16x32_bf16 v[192:195], v[32:35], v[44:47], v[192:195]
    ds_read_b64_tr_b16 v[28:29], v3 offset:24672
    v_mfma_f32_16x16x32_bf16 v[196:199], v[32:35], v[48:51], v[196:199]
    ds_read_b64_tr_b16 v[30:31], v3 offset:26464
    v_mfma_f32_16x16x32_bf16 v[200:203], v[32:35], v[52:55], v[200:203]
    buffer_load_dwordx4 v[124:127], v8, s[16:19], s69 offen offset:0 sc1
    v_mfma_f32_16x16x32_bf16 v[204:207], v[32:35], v[56:59], v[204:207]
    s_waitcnt lgkmcnt(10)
    v_mfma_f32_16x16x32_bf16 v[208:211], v[36:39], v[44:47], v[208:211]
    ds_read_b64_tr_b16 v[32:33], v3 offset:24704
    v_mfma_f32_16x16x32_bf16 v[212:215], v[36:39], v[48:51], v[212:215]
    ds_read_b64_tr_b16 v[34:35], v3 offset:26496
    v_mfma_f32_16x16x32_bf16 v[216:219], v[36:39], v[52:55], v[216:219]
    buffer_load_dwordx4 v[240:243], v8, s[16:19], s69 offen offset:256 sc1
    v_mfma_f32_16x16x32_bf16 v[220:223], v[36:39], v[56:59], v[220:223]
    s_waitcnt lgkmcnt(10)
    v_mfma_f32_16x16x32_bf16 v[224:227], v[40:43], v[44:47], v[224:227]
    ds_read_b64_tr_b16 v[36:37], v3 offset:24736
    s_waitcnt vmcnt(12)
    v_max3_u32 v5, v60, v64, v68
    v_mfma_f32_16x16x32_bf16 v[228:231], v[40:43], v[48:51], v[228:231]
    ds_read_b64_tr_b16 v[38:39], v3 offset:26528
    v_max_u32 v5, v5, v72
    v_mfma_f32_16x16x32_bf16 v[232:235], v[40:43], v[52:55], v[232:235]
    v_cmp_eq_u32 vcc, -1, v5
    v_mfma_f32_16x16x32_bf16 v[236:239], v[40:43], v[56:59], v[236:239]
    s_cbranch_vccnz LadaLN_cond__grouped_kv_mqa__dense_activation_relu__prompt_kernel_efb75
LadaLN_cond__grouped_kv_mqa__dense_activation_relu__prompt_kernel_ebk76:
    s_waitcnt lgkmcnt(10)
    v_mfma_f32_16x16x32_bf16 v[128:131], v[16:19], v[60:63], v[128:131]
    ds_read_b64_tr_b16 v[40:41], v3 offset:24768
    v_mfma_f32_16x16x32_bf16 v[132:135], v[16:19], v[64:67], v[132:135]
    ds_read_b64_tr_b16 v[42:43], v3 offset:26560
    v_mfma_f32_16x16x32_bf16 v[136:139], v[16:19], v[68:71], v[136:139]
    v_mfma_f32_16x16x32_bf16 v[140:143], v[16:19], v[72:75], v[140:143]
    s_waitcnt lgkmcnt(10)
    v_mfma_f32_16x16x32_bf16 v[144:147], v[20:23], v[60:63], v[144:147]
    ds_read_b64_tr_b16 v[16:17], v3 offset:32768
    v_mfma_f32_16x16x32_bf16 v[148:151], v[20:23], v[64:67], v[148:151]
    ds_read_b64_tr_b16 v[18:19], v3 offset:34560
    v_mfma_f32_16x16x32_bf16 v[152:155], v[20:23], v[68:71], v[152:155]
    buffer_load_dwordx4 v[44:47], v8, s[16:19], s68 offen offset:2048 sc1
    v_mfma_f32_16x16x32_bf16 v[156:159], v[20:23], v[72:75], v[156:159]
    s_waitcnt lgkmcnt(10)
    v_mfma_f32_16x16x32_bf16 v[160:163], v[24:27], v[60:63], v[160:163]
    ds_read_b64_tr_b16 v[20:21], v3 offset:32800
    v_mfma_f32_16x16x32_bf16 v[164:167], v[24:27], v[64:67], v[164:167]
    ds_read_b64_tr_b16 v[22:23], v3 offset:34592
    v_mfma_f32_16x16x32_bf16 v[168:171], v[24:27], v[68:71], v[168:171]
    buffer_load_dwordx4 v[48:51], v8, s[16:19], s68 offen offset:2304 sc1
    s_add_u32 s68, s68, 4096
    v_mfma_f32_16x16x32_bf16 v[172:175], v[24:27], v[72:75], v[172:175]
    s_waitcnt lgkmcnt(10)
    v_mfma_f32_16x16x32_bf16 v[176:179], v[28:31], v[60:63], v[176:179]
    ds_read_b64_tr_b16 v[24:25], v3 offset:32832
    v_mfma_f32_16x16x32_bf16 v[180:183], v[28:31], v[64:67], v[180:183]
    ds_read_b64_tr_b16 v[26:27], v3 offset:34624
    v_mfma_f32_16x16x32_bf16 v[184:187], v[28:31], v[68:71], v[184:187]
    v_mfma_f32_16x16x32_bf16 v[188:191], v[28:31], v[72:75], v[188:191]
    s_waitcnt lgkmcnt(10)
    v_mfma_f32_16x16x32_bf16 v[192:195], v[32:35], v[60:63], v[192:195]
    ds_read_b64_tr_b16 v[28:29], v3 offset:32864
    v_mfma_f32_16x16x32_bf16 v[196:199], v[32:35], v[64:67], v[196:199]
    ds_read_b64_tr_b16 v[30:31], v3 offset:34656
    v_mfma_f32_16x16x32_bf16 v[200:203], v[32:35], v[68:71], v[200:203]
    buffer_load_dwordx4 v[52:55], v8, s[16:19], s69 offen offset:2048 sc1
    v_mfma_f32_16x16x32_bf16 v[204:207], v[32:35], v[72:75], v[204:207]
    s_waitcnt lgkmcnt(10)
    v_mfma_f32_16x16x32_bf16 v[208:211], v[36:39], v[60:63], v[208:211]
    ds_read_b64_tr_b16 v[32:33], v3 offset:32896
    v_mfma_f32_16x16x32_bf16 v[212:215], v[36:39], v[64:67], v[212:215]
    s_branch LadaLN_cond__grouped_kv_mqa__dense_activation_relu__prompt_kernel_over9
LadaLN_cond__grouped_kv_mqa__dense_activation_relu__prompt_kernel_stub9:
    s_setpc_b64 s[96:97]
LadaLN_cond__grouped_kv_mqa__dense_activation_relu__prompt_kernel_over9:
    ds_read_b64_tr_b16 v[34:35], v3 offset:34688
    v_mfma_f32_16x16x32_bf16 v[216:219], v[36:39], v[68:71], v[216:219]
    buffer_load_dwordx4 v[56:59], v8, s[16:19], s69 offen offset:2304 sc1
    s_add_u32 s69, s69, 4096
    v_mfma_f32_16x16x32_bf16 v[220:223], v[36:39], v[72:75], v[220:223]
    s_waitcnt lgkmcnt(10)
    v_mfma_f32_16x16x32_bf16 v[224:227], v[40:43], v[60:63], v[224:227]
    ds_read_b64_tr_b16 v[36:37], v3 offset:32928
    v_mfma_f32_16x16x32_bf16 v[228:231], v[40:43], v[64:67], v[228:231]
    ds_read_b64_tr_b16 v[38:39], v3 offset:34720
    v_mfma_f32_16x16x32_bf16 v[232:235], v[40:43], v[68:71], v[232:235]
    s_barrier
    v_mfma_f32_16x16x32_bf16 v[236:239], v[40:43], v[72:75], v[236:239]
    s_waitcnt vmcnt(12)
    s_waitcnt lgkmcnt(10)
    v_mfma_f32_16x16x32_bf16 v[128:131], v[16:19], v[76:79], v[128:131]
    ds_read_b64_tr_b16 v[40:41], v3 offset:32960
    v_mfma_f32_16x16x32_bf16 v[132:135], v[16:19], v[80:83], v[132:135]
    ds_read_b64_tr_b16 v[42:43], v3 offset:34752
    v_mfma_f32_16x16x32_bf16 v[136:139], v[16:19], v[84:87], v[136:139]
    v_mfma_f32_16x16x32_bf16 v[140:143], v[16:19], v[88:91], v[140:143]
    s_waitcnt lgkmcnt(10)
    v_mfma_f32_16x16x32_bf16 v[144:147], v[20:23], v[76:79], v[144:147]
    ds_read_b64_tr_b16 v[16:17], v3 offset:40960
    v_mfma_f32_16x16x32_bf16 v[148:151], v[20:23], v[80:83], v[148:151]
    ds_read_b64_tr_b16 v[18:19], v3 offset:42752
    v_mfma_f32_16x16x32_bf16 v[152:155], v[20:23], v[84:87], v[152:155]
    buffer_load_dwordx4 v[60:63], v8, s[16:19], s68 offen offset:0 sc1
    v_mfma_f32_16x16x32_bf16 v[156:159], v[20:23], v[88:91], v[156:159]
    s_waitcnt lgkmcnt(10)
    v_mfma_f32_16x16x32_bf16 v[160:163], v[24:27], v[76:79], v[160:163]
    ds_read_b64_tr_b16 v[20:21], v3 offset:40992
    v_mfma_f32_16x16x32_bf16 v[164:167], v[24:27], v[80:83], v[164:167]
    ds_read_b64_tr_b16 v[22:23], v3 offset:42784
    v_mfma_f32_16x16x32_bf16 v[168:171], v[24:27], v[84:87], v[168:171]
    buffer_load_dwordx4 v[64:67], v8, s[16:19], s68 offen offset:256 sc1
    v_mfma_f32_16x16x32_bf16 v[172:175], v[24:27], v[88:91], v[172:175]
    s_waitcnt lgkmcnt(10)
    v_mfma_f32_16x16x32_bf16 v[176:179], v[28:31], v[76:79], v[176:179]
    ds_read_b64_tr_b16 v[24:25], v3 offset:41024
    v_mfma_f32_16x16x32_bf16 v[180:183], v[28:31], v[80:83], v[180:183]
    ds_read_b64_tr_b16 v[26:27], v3 offset:42816
    v_mfma_f32_16x16x32_bf16 v[184:187], v[28:31], v[84:87], v[184:187]
    v_mfma_f32_16x16x32_bf16 v[188:191], v[28:31], v[88:91], v[188:191]
    s_waitcnt lgkmcnt(10)
    v_mfma_f32_16x16x32_bf16 v[192:195], v[32:35], v[76:79], v[192:195]
    ds_read_b64_tr_b16 v[28:29], v3 offset:41056
    v_mfma_f32_16x16x32_bf16 v[196:199], v[32:35], v[80:83], v[196:199]
    ds_read_b64_tr_b16 v[30:31], v3 offset:42848
    v_mfma_f32_16x16x32_bf16 v[200:203], v[32:35], v[84:87], v[200:203]
    buffer_load_dwordx4 v[68:71], v8, s[16:19], s69 offen offset:0 sc1
    v_mfma_f32_16x16x32_bf16 v[204:207], v[32:35], v[88:91], v[204:207]
    s_waitcnt lgkmcnt(10)
    v_mfma_f32_16x16x32_bf16 v[208:211], v[36:39], v[76:79], v[208:211]
    ds_read_b64_tr_b16 v[32:33], v3 offset:41088
    v_mfma_f32_16x16x32_bf16 v[212:215], v[36:39], v[80:83], v[212:215]
    ds_read_b64_tr_b16 v[34:35], v3 offset:42880
    v_mfma_f32_16x16x32_bf16 v[216:219], v[36:39], v[84:87], v[216:219]
    buffer_load_dwordx4 v[72:75], v8, s[16:19], s69 offen offset:256 sc1
    v_mfma_f32_16x16x32_bf16 v[220:223], v[36:39], v[88:91], v[220:223]
    s_waitcnt lgkmcnt(10)
    v_mfma_f32_16x16x32_bf16 v[224:227], v[40:43], v[76:79], v[224:227]
    ds_read_b64_tr_b16 v[36:37], v3 offset:41120
    v_mfma_f32_16x16x32_bf16 v[228:231], v[40:43], v[80:83], v[228:231]
    ds_read_b64_tr_b16 v[38:39], v3 offset:42912
    v_mfma_f32_16x16x32_bf16 v[232:235], v[40:43], v[84:87], v[232:235]
    v_mfma_f32_16x16x32_bf16 v[236:239], v[40:43], v[88:91], v[236:239]
    s_waitcnt vmcnt(12)
    s_waitcnt lgkmcnt(10)
    v_mfma_f32_16x16x32_bf16 v[128:131], v[16:19], v[92:95], v[128:131]
    ds_read_b64_tr_b16 v[40:41], v3 offset:41152
    v_mfma_f32_16x16x32_bf16 v[132:135], v[16:19], v[96:99], v[132:135]
    ds_read_b64_tr_b16 v[42:43], v3 offset:42944
    v_mfma_f32_16x16x32_bf16 v[136:139], v[16:19], v[100:103], v[136:139]
    v_mfma_f32_16x16x32_bf16 v[140:143], v[16:19], v[104:107], v[140:143]
    s_waitcnt lgkmcnt(10)
    v_mfma_f32_16x16x32_bf16 v[144:147], v[20:23], v[92:95], v[144:147]
    ds_read_b64_tr_b16 v[16:17], v3 offset:49152
    v_mfma_f32_16x16x32_bf16 v[148:151], v[20:23], v[96:99], v[148:151]
    ds_read_b64_tr_b16 v[18:19], v3 offset:50944
    v_mfma_f32_16x16x32_bf16 v[152:155], v[20:23], v[100:103], v[152:155]
    buffer_load_dwordx4 v[76:79], v8, s[16:19], s68 offen offset:2048 sc1
    v_mfma_f32_16x16x32_bf16 v[156:159], v[20:23], v[104:107], v[156:159]
    s_waitcnt lgkmcnt(10)
    v_mfma_f32_16x16x32_bf16 v[160:163], v[24:27], v[92:95], v[160:163]
    ds_read_b64_tr_b16 v[20:21], v3 offset:49184
    v_mfma_f32_16x16x32_bf16 v[164:167], v[24:27], v[96:99], v[164:167]
    ds_read_b64_tr_b16 v[22:23], v3 offset:50976
    v_mfma_f32_16x16x32_bf16 v[168:171], v[24:27], v[100:103], v[168:171]
    buffer_load_dwordx4 v[80:83], v8, s[16:19], s68 offen offset:2304 sc1
    s_add_u32 s68, s68, 4096
    v_mfma_f32_16x16x32_bf16 v[172:175], v[24:27], v[104:107], v[172:175]
    s_waitcnt lgkmcnt(10)
    v_mfma_f32_16x16x32_bf16 v[176:179], v[28:31], v[92:95], v[176:179]
    ds_read_b64_tr_b16 v[24:25], v3 offset:49216
    v_mfma_f32_16x16x32_bf16 v[180:183], v[28:31], v[96:99], v[180:183]
    ds_read_b64_tr_b16 v[26:27], v3 offset:51008
    v_mfma_f32_16x16x32_bf16 v[184:187], v[28:31], v[100:103], v[184:187]
    v_mfma_f32_16x16x32_bf16 v[188:191], v[28:31], v[104:107], v[188:191]
    s_waitcnt lgkmcnt(10)
    v_mfma_f32_16x16x32_bf16 v[192:195], v[32:35], v[92:95], v[192:195]
    ds_read_b64_tr_b16 v[28:29], v3 offset:49248
    v_mfma_f32_16x16x32_bf16 v[196:199], v[32:35], v[96:99], v[196:199]
    ds_read_b64_tr_b16 v[30:31], v3 offset:51040
    v_mfma_f32_16x16x32_bf16 v[200:203], v[32:35], v[100:103], v[200:203]
    buffer_load_dwordx4 v[84:87], v8, s[16:19], s69 offen offset:2048 sc1
    v_mfma_f32_16x16x32_bf16 v[204:207], v[32:35], v[104:107], v[204:207]
    s_waitcnt lgkmcnt(10)
    v_mfma_f32_16x16x32_bf16 v[208:211], v[36:39], v[92:95], v[208:211]
    ds_read_b64_tr_b16 v[32:33], v3 offset:49280
    v_mfma_f32_16x16x32_bf16 v[212:215], v[36:39], v[96:99], v[212:215]
    ds_read_b64_tr_b16 v[34:35], v3 offset:51072
    v_mfma_f32_16x16x32_bf16 v[216:219], v[36:39], v[100:103], v[216:219]
    buffer_load_dwordx4 v[88:91], v8, s[16:19], s69 offen offset:2304 sc1
    s_add_u32 s69, s69, 4096
    v_mfma_f32_16x16x32_bf16 v[220:223], v[36:39], v[104:107], v[220:223]
    s_waitcnt lgkmcnt(10)
    v_mfma_f32_16x16x32_bf16 v[224:227], v[40:43], v[92:95], v[224:227]
    ds_read_b64_tr_b16 v[36:37], v3 offset:49312
    v_mfma_f32_16x16x32_bf16 v[228:231], v[40:43], v[96:99], v[228:231]
    ds_read_b64_tr_b16 v[38:39], v3 offset:51104
    v_mfma_f32_16x16x32_bf16 v[232:235], v[40:43], v[100:103], v[232:235]
    v_mfma_f32_16x16x32_bf16 v[236:239], v[40:43], v[104:107], v[236:239]
    s_waitcnt vmcnt(12)
    s_waitcnt lgkmcnt(10)
    v_mfma_f32_16x16x32_bf16 v[128:131], v[16:19], v[108:111], v[128:131]
    ds_read_b64_tr_b16 v[40:41], v3 offset:49344
    v_mfma_f32_16x16x32_bf16 v[132:135], v[16:19], v[112:115], v[132:135]
    ds_read_b64_tr_b16 v[42:43], v3 offset:51136
    v_mfma_f32_16x16x32_bf16 v[136:139], v[16:19], v[124:127], v[136:139]
    v_mfma_f32_16x16x32_bf16 v[140:143], v[16:19], v[240:243], v[140:143]
    s_waitcnt lgkmcnt(10)
    v_mfma_f32_16x16x32_bf16 v[144:147], v[20:23], v[108:111], v[144:147]
    ds_read_b64_tr_b16 v[16:17], v3 offset:57344
    v_mfma_f32_16x16x32_bf16 v[148:151], v[20:23], v[112:115], v[148:151]
    ds_read_b64_tr_b16 v[18:19], v3 offset:59136
    v_mfma_f32_16x16x32_bf16 v[152:155], v[20:23], v[124:127], v[152:155]
    buffer_load_dwordx4 v[92:95], v8, s[16:19], s68 offen offset:0 sc1
    v_mfma_f32_16x16x32_bf16 v[156:159], v[20:23], v[240:243], v[156:159]
    s_waitcnt lgkmcnt(10)
    v_mfma_f32_16x16x32_bf16 v[160:163], v[24:27], v[108:111], v[160:163]
    ds_read_b64_tr_b16 v[20:21], v3 offset:57376
    v_mfma_f32_16x16x32_bf16 v[164:167], v[24:27], v[112:115], v[164:167]
    ds_read_b64_tr_b16 v[22:23], v3 offset:59168
    v_mfma_f32_16x16x32_bf16 v[168:171], v[24:27], v[124:127], v[168:171]
    buffer_load_dwordx4 v[96:99], v8, s[16:19], s68 offen offset:256 sc1
    v_mfma_f32_16x16x32_bf16 v[172:175], v[24:27], v[240:243], v[172:175]
    s_waitcnt lgkmcnt(10)
    v_mfma_f32_16x16x32_bf16 v[176:179], v[28:31], v[108:111], v[176:179]
    ds_read_b64_tr_b16 v[24:25], v3 offset:57408
    v_mfma_f32_16x16x32_bf16 v[180:183], v[28:31], v[112:115], v[180:183]
    ds_read_b64_tr_b16 v[26:27], v3 offset:59200
    v_mfma_f32_16x16x32_bf16 v[184:187], v[28:31], v[124:127], v[184:187]
    v_mfma_f32_16x16x32_bf16 v[188:191], v[28:31], v[240:243], v[188:191]
    s_waitcnt lgkmcnt(10)
    v_mfma_f32_16x16x32_bf16 v[192:195], v[32:35], v[108:111], v[192:195]
    ds_read_b64_tr_b16 v[28:29], v3 offset:57440
    v_mfma_f32_16x16x32_bf16 v[196:199], v[32:35], v[112:115], v[196:199]
    ds_read_b64_tr_b16 v[30:31], v3 offset:59232
    v_mfma_f32_16x16x32_bf16 v[200:203], v[32:35], v[124:127], v[200:203]
    buffer_load_dwordx4 v[100:103], v8, s[16:19], s69 offen offset:0 sc1
    v_mfma_f32_16x16x32_bf16 v[204:207], v[32:35], v[240:243], v[204:207]
    s_waitcnt lgkmcnt(10)
    v_mfma_f32_16x16x32_bf16 v[208:211], v[36:39], v[108:111], v[208:211]
    ds_read_b64_tr_b16 v[32:33], v3 offset:57472
    v_mfma_f32_16x16x32_bf16 v[212:215], v[36:39], v[112:115], v[212:215]
    ds_read_b64_tr_b16 v[34:35], v3 offset:59264
    v_mfma_f32_16x16x32_bf16 v[216:219], v[36:39], v[124:127], v[216:219]
    buffer_load_dwordx4 v[104:107], v8, s[16:19], s69 offen offset:256 sc1
    v_mfma_f32_16x16x32_bf16 v[220:223], v[36:39], v[240:243], v[220:223]
    s_waitcnt lgkmcnt(10)
    v_mfma_f32_16x16x32_bf16 v[224:227], v[40:43], v[108:111], v[224:227]
    ds_read_b64_tr_b16 v[36:37], v3 offset:57504
    v_mfma_f32_16x16x32_bf16 v[228:231], v[40:43], v[112:115], v[228:231]
    ds_read_b64_tr_b16 v[38:39], v3 offset:59296
    v_mfma_f32_16x16x32_bf16 v[232:235], v[40:43], v[124:127], v[232:235]
    v_mfma_f32_16x16x32_bf16 v[236:239], v[40:43], v[240:243], v[236:239]
    s_waitcnt vmcnt(12)
    s_waitcnt lgkmcnt(10)
    v_mfma_f32_16x16x32_bf16 v[128:131], v[16:19], v[44:47], v[128:131]
    ds_read_b64_tr_b16 v[40:41], v3 offset:57536
    v_mfma_f32_16x16x32_bf16 v[132:135], v[16:19], v[48:51], v[132:135]
    ds_read_b64_tr_b16 v[42:43], v3 offset:59328
    v_mfma_f32_16x16x32_bf16 v[136:139], v[16:19], v[52:55], v[136:139]
    v_mfma_f32_16x16x32_bf16 v[140:143], v[16:19], v[56:59], v[140:143]
    s_waitcnt lgkmcnt(10)
    v_mfma_f32_16x16x32_bf16 v[144:147], v[20:23], v[44:47], v[144:147]
    v_add_u32 v3, 0x10000, v3
    ds_read_b64_tr_b16 v[16:17], v3 offset:0
    v_mfma_f32_16x16x32_bf16 v[148:151], v[20:23], v[48:51], v[148:151]
    ds_read_b64_tr_b16 v[18:19], v3 offset:1792
    v_mfma_f32_16x16x32_bf16 v[152:155], v[20:23], v[52:55], v[152:155]
    buffer_load_dwordx4 v[108:111], v8, s[16:19], s68 offen offset:2048 sc1
    v_mfma_f32_16x16x32_bf16 v[156:159], v[20:23], v[56:59], v[156:159]
    s_waitcnt lgkmcnt(10)
    v_mfma_f32_16x16x32_bf16 v[160:163], v[24:27], v[44:47], v[160:163]
    ds_read_b64_tr_b16 v[20:21], v3 offset:32
    v_mfma_f32_16x16x32_bf16 v[164:167], v[24:27], v[48:51], v[164:167]
    ds_read_b64_tr_b16 v[22:23], v3 offset:1824
    v_mfma_f32_16x16x32_bf16 v[168:171], v[24:27], v[52:55], v[168:171]
    buffer_load_dwordx4 v[112:115], v8, s[16:19], s68 offen offset:2304 sc1
    s_add_u32 s68, s68, 4096
    v_mfma_f32_16x16x32_bf16 v[172:175], v[24:27], v[56:59], v[172:175]
    s_waitcnt lgkmcnt(10)
    v_mfma_f32_16x16x32_bf16 v[176:179], v[28:31], v[44:47], v[176:179]
    ds_read_b64_tr_b16 v[24:25], v3 offset:64
    v_mfma_f32_16x16x32_bf16 v[180:183], v[28:31], v[48:51], v[180:183]
    ds_read_b64_tr_b16 v[26:27], v3 offset:1856
    v_mfma_f32_16x16x32_bf16 v[184:187], v[28:31], v[52:55], v[184:187]
    v_mfma_f32_16x16x32_bf16 v[188:191], v[28:31], v[56:59], v[188:191]
    s_waitcnt lgkmcnt(10)
    v_mfma_f32_16x16x32_bf16 v[192:195], v[32:35], v[44:47], v[192:195]
    ds_read_b64_tr_b16 v[28:29], v3 offset:96
    v_mfma_f32_16x16x32_bf16 v[196:199], v[32:35], v[48:51], v[196:199]
    ds_read_b64_tr_b16 v[30:31], v3 offset:1888
    v_mfma_f32_16x16x32_bf16 v[200:203], v[32:35], v[52:55], v[200:203]
    buffer_load_dwordx4 v[124:127], v8, s[16:19], s69 offen offset:2048 sc1
    v_mfma_f32_16x16x32_bf16 v[204:207], v[32:35], v[56:59], v[204:207]
    s_waitcnt lgkmcnt(10)
    v_mfma_f32_16x16x32_bf16 v[208:211], v[36:39], v[44:47], v[208:211]
    ds_read_b64_tr_b16 v[32:33], v3 offset:128
    v_mfma_f32_16x16x32_bf16 v[212:215], v[36:39], v[48:51], v[212:215]
    ds_read_b64_tr_b16 v[34:35], v3 offset:1920
    v_mfma_f32_16x16x32_bf16 v[216:219], v[36:39], v[52:55], v[216:219]
    buffer_load_dwordx4 v[240:243], v8, s[16:19], s69 offen offset:2304 sc1
    s_add_u32 s69, s69, 4096
    v_mfma_f32_16x16x32_bf16 v[220:223], v[36:39], v[56:59], v[220:223]
    s_waitcnt lgkmcnt(10)
    v_mfma_f32_16x16x32_bf16 v[224:227], v[40:43], v[44:47], v[224:227]
    ds_read_b64_tr_b16 v[36:37], v3 offset:160
    v_mfma_f32_16x16x32_bf16 v[228:231], v[40:43], v[48:51], v[228:231]
    ds_read_b64_tr_b16 v[38:39], v3 offset:1952
    v_mfma_f32_16x16x32_bf16 v[232:235], v[40:43], v[52:55], v[232:235]
    s_barrier
    v_mfma_f32_16x16x32_bf16 v[236:239], v[40:43], v[56:59], v[236:239]
    s_waitcnt vmcnt(12)
    s_waitcnt lgkmcnt(10)
    v_mfma_f32_16x16x32_bf16 v[128:131], v[16:19], v[60:63], v[128:131]
    ds_read_b64_tr_b16 v[40:41], v3 offset:192
    v_mfma_f32_16x16x32_bf16 v[132:135], v[16:19], v[64:67], v[132:135]
    ds_read_b64_tr_b16 v[42:43], v3 offset:1984
    v_mfma_f32_16x16x32_bf16 v[136:139], v[16:19], v[68:71], v[136:139]
    v_mfma_f32_16x16x32_bf16 v[140:143], v[16:19], v[72:75], v[140:143]
    s_waitcnt lgkmcnt(10)
    v_mfma_f32_16x16x32_bf16 v[144:147], v[20:23], v[60:63], v[144:147]
    ds_read_b64_tr_b16 v[16:17], v3 offset:8192
    v_mfma_f32_16x16x32_bf16 v[148:151], v[20:23], v[64:67], v[148:151]
    ds_read_b64_tr_b16 v[18:19], v3 offset:9984
    v_mfma_f32_16x16x32_bf16 v[152:155], v[20:23], v[68:71], v[152:155]
    buffer_load_dwordx4 v[44:47], v8, s[16:19], s68 offen offset:0 sc1
    v_mfma_f32_16x16x32_bf16 v[156:159], v[20:23], v[72:75], v[156:159]
    s_waitcnt lgkmcnt(10)
    v_mfma_f32_16x16x32_bf16 v[160:163], v[24:27], v[60:63], v[160:163]
    ds_read_b64_tr_b16 v[20:21], v3 offset:8224
    v_mfma_f32_16x16x32_bf16 v[164:167], v[24:27], v[64:67], v[164:167]
    ds_read_b64_tr_b16 v[22:23], v3 offset:10016
    v_mfma_f32_16x16x32_bf16 v[168:171], v[24:27], v[68:71], v[168:171]
    buffer_load_dwordx4 v[48:51], v8, s[16:19], s68 offen offset:256 sc1
    v_mfma_f32_16x16x32_bf16 v[172:175], v[24:27], v[72:75], v[172:175]
    s_waitcnt lgkmcnt(10)
    v_mfma_f32_16x16x32_bf16 v[176:179], v[28:31], v[60:63], v[176:179]
    ds_read_b64_tr_b16 v[24:25], v3 offset:8256
    v_mfma_f32_16x16x32_bf16 v[180:183], v[28:31], v[64:67], v[180:183]
    ds_read_b64_tr_b16 v[26:27], v3 offset:10048
    v_mfma_f32_16x16x32_bf16 v[184:187], v[28:31], v[68:71], v[184:187]
    v_mfma_f32_16x16x32_bf16 v[188:191], v[28:31], v[72:75], v[188:191]
    s_waitcnt lgkmcnt(10)
    v_mfma_f32_16x16x32_bf16 v[192:195], v[32:35], v[60:63], v[192:195]
    ds_read_b64_tr_b16 v[28:29], v3 offset:8288
    v_mfma_f32_16x16x32_bf16 v[196:199], v[32:35], v[64:67], v[196:199]
    ds_read_b64_tr_b16 v[30:31], v3 offset:10080
    v_mfma_f32_16x16x32_bf16 v[200:203], v[32:35], v[68:71], v[200:203]
    buffer_load_dwordx4 v[52:55], v8, s[16:19], s69 offen offset:0 sc1
    v_mfma_f32_16x16x32_bf16 v[204:207], v[32:35], v[72:75], v[204:207]
    s_waitcnt lgkmcnt(10)
    v_mfma_f32_16x16x32_bf16 v[208:211], v[36:39], v[60:63], v[208:211]
    ds_read_b64_tr_b16 v[32:33], v3 offset:8320
    v_mfma_f32_16x16x32_bf16 v[212:215], v[36:39], v[64:67], v[212:215]
    ds_read_b64_tr_b16 v[34:35], v3 offset:10112
    v_mfma_f32_16x16x32_bf16 v[216:219], v[36:39], v[68:71], v[216:219]
    buffer_load_dwordx4 v[56:59], v8, s[16:19], s69 offen offset:256 sc1
    v_mfma_f32_16x16x32_bf16 v[220:223], v[36:39], v[72:75], v[220:223]
    s_waitcnt lgkmcnt(10)
    v_mfma_f32_16x16x32_bf16 v[224:227], v[40:43], v[60:63], v[224:227]
    ds_read_b64_tr_b16 v[36:37], v3 offset:8352
    v_mfma_f32_16x16x32_bf16 v[228:231], v[40:43], v[64:67], v[228:231]
    ds_read_b64_tr_b16 v[38:39], v3 offset:10144
    v_mfma_f32_16x16x32_bf16 v[232:235], v[40:43], v[68:71], v[232:235]
    v_mfma_f32_16x16x32_bf16 v[236:239], v[40:43], v[72:75], v[236:239]
    s_waitcnt vmcnt(12)
    s_waitcnt lgkmcnt(10)
    v_mfma_f32_16x16x32_bf16 v[128:131], v[16:19], v[76:79], v[128:131]
    ds_read_b64_tr_b16 v[40:41], v3 offset:8384
    v_mfma_f32_16x16x32_bf16 v[132:135], v[16:19], v[80:83], v[132:135]
    ds_read_b64_tr_b16 v[42:43], v3 offset:10176
    v_mfma_f32_16x16x32_bf16 v[136:139], v[16:19], v[84:87], v[136:139]
    v_mfma_f32_16x16x32_bf16 v[140:143], v[16:19], v[88:91], v[140:143]
    s_waitcnt lgkmcnt(10)
    v_mfma_f32_16x16x32_bf16 v[144:147], v[20:23], v[76:79], v[144:147]
    v_add_u32 v3, 0xfffe0000, v3
    ds_read_b64_tr_b16 v[16:17], v3 offset:0
    v_mfma_f32_16x16x32_bf16 v[148:151], v[20:23], v[80:83], v[148:151]
    ds_read_b64_tr_b16 v[18:19], v3 offset:1792
    v_mfma_f32_16x16x32_bf16 v[152:155], v[20:23], v[84:87], v[152:155]
    buffer_load_dwordx4 v[60:63], v8, s[16:19], s68 offen offset:2048 sc1
    v_mfma_f32_16x16x32_bf16 v[156:159], v[20:23], v[88:91], v[156:159]
    s_waitcnt lgkmcnt(10)
    v_mfma_f32_16x16x32_bf16 v[160:163], v[24:27], v[76:79], v[160:163]
    ds_read_b64_tr_b16 v[20:21], v3 offset:32
    v_mfma_f32_16x16x32_bf16 v[164:167], v[24:27], v[80:83], v[164:167]
    ds_read_b64_tr_b16 v[22:23], v3 offset:1824
    v_mfma_f32_16x16x32_bf16 v[168:171], v[24:27], v[84:87], v[168:171]
    buffer_load_dwordx4 v[64:67], v8, s[16:19], s68 offen offset:2304 sc1
    s_add_u32 s68, s68, 4096
    v_mfma_f32_16x16x32_bf16 v[172:175], v[24:27], v[88:91], v[172:175]
    s_waitcnt lgkmcnt(10)
    v_mfma_f32_16x16x32_bf16 v[176:179], v[28:31], v[76:79], v[176:179]
    ds_read_b64_tr_b16 v[24:25], v3 offset:64
    v_mfma_f32_16x16x32_bf16 v[180:183], v[28:31], v[80:83], v[180:183]
    ds_read_b64_tr_b16 v[26:27], v3 offset:1856
    v_mfma_f32_16x16x32_bf16 v[184:187], v[28:31], v[84:87], v[184:187]
    v_mfma_f32_16x16x32_bf16 v[188:191], v[28:31], v[88:91], v[188:191]
    s_waitcnt lgkmcnt(10)
    v_mfma_f32_16x16x32_bf16 v[192:195], v[32:35], v[76:79], v[192:195]
    ds_read_b64_tr_b16 v[28:29], v3 offset:96
    v_mfma_f32_16x16x32_bf16 v[196:199], v[32:35], v[80:83], v[196:199]
    ds_read_b64_tr_b16 v[30:31], v3 offset:1888
    v_mfma_f32_16x16x32_bf16 v[200:203], v[32:35], v[84:87], v[200:203]
    buffer_load_dwordx4 v[68:71], v8, s[16:19], s69 offen offset:2048 sc1
    v_mfma_f32_16x16x32_bf16 v[204:207], v[32:35], v[88:91], v[204:207]
    s_waitcnt lgkmcnt(10)
    v_mfma_f32_16x16x32_bf16 v[208:211], v[36:39], v[76:79], v[208:211]
    ds_read_b64_tr_b16 v[32:33], v3 offset:128
    v_mfma_f32_16x16x32_bf16 v[212:215], v[36:39], v[80:83], v[212:215]
    ds_read_b64_tr_b16 v[34:35], v3 offset:1920
    v_mfma_f32_16x16x32_bf16 v[216:219], v[36:39], v[84:87], v[216:219]
    buffer_load_dwordx4 v[72:75], v8, s[16:19], s69 offen offset:2304 sc1
    s_add_u32 s69, s69, 4096
    v_mfma_f32_16x16x32_bf16 v[220:223], v[36:39], v[88:91], v[220:223]
    s_waitcnt lgkmcnt(10)
    v_mfma_f32_16x16x32_bf16 v[224:227], v[40:43], v[76:79], v[224:227]
    ds_read_b64_tr_b16 v[36:37], v3 offset:160
    v_mfma_f32_16x16x32_bf16 v[228:231], v[40:43], v[80:83], v[228:231]
    ds_read_b64_tr_b16 v[38:39], v3 offset:1952
    v_mfma_f32_16x16x32_bf16 v[232:235], v[40:43], v[84:87], v[232:235]
    v_mfma_f32_16x16x32_bf16 v[236:239], v[40:43], v[88:91], v[236:239]
    s_waitcnt vmcnt(12)
    s_waitcnt lgkmcnt(10)
    v_mfma_f32_16x16x32_bf16 v[128:131], v[16:19], v[92:95], v[128:131]
    ds_read_b64_tr_b16 v[40:41], v3 offset:192
    v_mfma_f32_16x16x32_bf16 v[132:135], v[16:19], v[96:99], v[132:135]
    ds_read_b64_tr_b16 v[42:43], v3 offset:1984
    v_mfma_f32_16x16x32_bf16 v[136:139], v[16:19], v[100:103], v[136:139]
    v_mfma_f32_16x16x32_bf16 v[140:143], v[16:19], v[104:107], v[140:143]
    s_waitcnt lgkmcnt(10)
    v_mfma_f32_16x16x32_bf16 v[144:147], v[20:23], v[92:95], v[144:147]
    ds_read_b64_tr_b16 v[16:17], v3 offset:8192
    v_mfma_f32_16x16x32_bf16 v[148:151], v[20:23], v[96:99], v[148:151]
    ds_read_b64_tr_b16 v[18:19], v3 offset:9984
    v_mfma_f32_16x16x32_bf16 v[152:155], v[20:23], v[100:103], v[152:155]
    buffer_load_dwordx4 v[76:79], v8, s[16:19], s68 offen offset:0 sc1
    v_mfma_f32_16x16x32_bf16 v[156:159], v[20:23], v[104:107], v[156:159]
    s_waitcnt lgkmcnt(10)
    v_mfma_f32_16x16x32_bf16 v[160:163], v[24:27], v[92:95], v[160:163]
    ds_read_b64_tr_b16 v[20:21], v3 offset:8224
    v_mfma_f32_16x16x32_bf16 v[164:167], v[24:27], v[96:99], v[164:167]
    ds_read_b64_tr_b16 v[22:23], v3 offset:10016
    v_mfma_f32_16x16x32_bf16 v[168:171], v[24:27], v[100:103], v[168:171]
    buffer_load_dwordx4 v[80:83], v8, s[16:19], s68 offen offset:256 sc1
    v_mfma_f32_16x16x32_bf16 v[172:175], v[24:27], v[104:107], v[172:175]
    s_waitcnt lgkmcnt(10)
    v_mfma_f32_16x16x32_bf16 v[176:179], v[28:31], v[92:95], v[176:179]
    ds_read_b64_tr_b16 v[24:25], v3 offset:8256
    v_mfma_f32_16x16x32_bf16 v[180:183], v[28:31], v[96:99], v[180:183]
    ds_read_b64_tr_b16 v[26:27], v3 offset:10048
    v_mfma_f32_16x16x32_bf16 v[184:187], v[28:31], v[100:103], v[184:187]
    v_mfma_f32_16x16x32_bf16 v[188:191], v[28:31], v[104:107], v[188:191]
    s_waitcnt lgkmcnt(10)
    v_mfma_f32_16x16x32_bf16 v[192:195], v[32:35], v[92:95], v[192:195]
    ds_read_b64_tr_b16 v[28:29], v3 offset:8288
    v_mfma_f32_16x16x32_bf16 v[196:199], v[32:35], v[96:99], v[196:199]
    ds_read_b64_tr_b16 v[30:31], v3 offset:10080
    v_mfma_f32_16x16x32_bf16 v[200:203], v[32:35], v[100:103], v[200:203]
    buffer_load_dwordx4 v[84:87], v8, s[16:19], s69 offen offset:0 sc1
    v_mfma_f32_16x16x32_bf16 v[204:207], v[32:35], v[104:107], v[204:207]
    s_waitcnt lgkmcnt(10)
    v_mfma_f32_16x16x32_bf16 v[208:211], v[36:39], v[92:95], v[208:211]
    ds_read_b64_tr_b16 v[32:33], v3 offset:8320
    v_mfma_f32_16x16x32_bf16 v[212:215], v[36:39], v[96:99], v[212:215]
    ds_read_b64_tr_b16 v[34:35], v3 offset:10112
    v_mfma_f32_16x16x32_bf16 v[216:219], v[36:39], v[100:103], v[216:219]
    buffer_load_dwordx4 v[88:91], v8, s[16:19], s69 offen offset:256 sc1
    v_mfma_f32_16x16x32_bf16 v[220:223], v[36:39], v[104:107], v[220:223]
    s_waitcnt lgkmcnt(10)
    v_mfma_f32_16x16x32_bf16 v[224:227], v[40:43], v[92:95], v[224:227]
    ds_read_b64_tr_b16 v[36:37], v3 offset:8352
    v_mfma_f32_16x16x32_bf16 v[228:231], v[40:43], v[96:99], v[228:231]
    ds_read_b64_tr_b16 v[38:39], v3 offset:10144
    v_mfma_f32_16x16x32_bf16 v[232:235], v[40:43], v[100:103], v[232:235]
    v_mfma_f32_16x16x32_bf16 v[236:239], v[40:43], v[104:107], v[236:239]
    s_waitcnt vmcnt(12)
    s_waitcnt lgkmcnt(10)
    v_mfma_f32_16x16x32_bf16 v[128:131], v[16:19], v[108:111], v[128:131]
    ds_read_b64_tr_b16 v[40:41], v3 offset:8384
    v_mfma_f32_16x16x32_bf16 v[132:135], v[16:19], v[112:115], v[132:135]
    ds_read_b64_tr_b16 v[42:43], v3 offset:10176
    v_mfma_f32_16x16x32_bf16 v[136:139], v[16:19], v[124:127], v[136:139]
    v_mfma_f32_16x16x32_bf16 v[140:143], v[16:19], v[240:243], v[140:143]
    s_waitcnt lgkmcnt(10)
    v_mfma_f32_16x16x32_bf16 v[144:147], v[20:23], v[108:111], v[144:147]
    ds_read_b64_tr_b16 v[16:17], v3 offset:16384
    v_mfma_f32_16x16x32_bf16 v[148:151], v[20:23], v[112:115], v[148:151]
    ds_read_b64_tr_b16 v[18:19], v3 offset:18176
    v_mfma_f32_16x16x32_bf16 v[152:155], v[20:23], v[124:127], v[152:155]
    buffer_load_dwordx4 v[92:95], v8, s[16:19], s68 offen offset:2048 sc1
    v_mfma_f32_16x16x32_bf16 v[156:159], v[20:23], v[240:243], v[156:159]
    s_waitcnt lgkmcnt(10)
    v_mfma_f32_16x16x32_bf16 v[160:163], v[24:27], v[108:111], v[160:163]
    ds_read_b64_tr_b16 v[20:21], v3 offset:16416
    v_mfma_f32_16x16x32_bf16 v[164:167], v[24:27], v[112:115], v[164:167]
    ds_read_b64_tr_b16 v[22:23], v3 offset:18208
    v_mfma_f32_16x16x32_bf16 v[168:171], v[24:27], v[124:127], v[168:171]
    buffer_load_dwordx4 v[96:99], v8, s[16:19], s68 offen offset:2304 sc1
    s_add_u32 s68, s68, 4096
    v_mfma_f32_16x16x32_bf16 v[172:175], v[24:27], v[240:243], v[172:175]
    s_waitcnt lgkmcnt(10)
    v_mfma_f32_16x16x32_bf16 v[176:179], v[28:31], v[108:111], v[176:179]
    ds_read_b64_tr_b16 v[24:25], v3 offset:16448
    v_mfma_f32_16x16x32_bf16 v[180:183], v[28:31], v[112:115], v[180:183]
    ds_read_b64_tr_b16 v[26:27], v3 offset:18240
    v_mfma_f32_16x16x32_bf16 v[184:187], v[28:31], v[124:127], v[184:187]
    v_mfma_f32_16x16x32_bf16 v[188:191], v[28:31], v[240:243], v[188:191]
    s_waitcnt lgkmcnt(10)
    v_mfma_f32_16x16x32_bf16 v[192:195], v[32:35], v[108:111], v[192:195]
    ds_read_b64_tr_b16 v[28:29], v3 offset:16480
    v_mfma_f32_16x16x32_bf16 v[196:199], v[32:35], v[112:115], v[196:199]
    ds_read_b64_tr_b16 v[30:31], v3 offset:18272
    v_mfma_f32_16x16x32_bf16 v[200:203], v[32:35], v[124:127], v[200:203]
    buffer_load_dwordx4 v[100:103], v8, s[16:19], s69 offen offset:2048 sc1
    v_mfma_f32_16x16x32_bf16 v[204:207], v[32:35], v[240:243], v[204:207]
    s_waitcnt lgkmcnt(10)
    v_mfma_f32_16x16x32_bf16 v[208:211], v[36:39], v[108:111], v[208:211]
    ds_read_b64_tr_b16 v[32:33], v3 offset:16512
    v_mfma_f32_16x16x32_bf16 v[212:215], v[36:39], v[112:115], v[212:215]
    ds_read_b64_tr_b16 v[34:35], v3 offset:18304
    v_mfma_f32_16x16x32_bf16 v[216:219], v[36:39], v[124:127], v[216:219]
    buffer_load_dwordx4 v[104:107], v8, s[16:19], s69 offen offset:2304 sc1
    s_add_u32 s69, s69, 4096
    v_mfma_f32_16x16x32_bf16 v[220:223], v[36:39], v[240:243], v[220:223]
    s_waitcnt lgkmcnt(10)
    v_mfma_f32_16x16x32_bf16 v[224:227], v[40:43], v[108:111], v[224:227]
    ds_read_b64_tr_b16 v[36:37], v3 offset:16544
    v_mfma_f32_16x16x32_bf16 v[228:231], v[40:43], v[112:115], v[228:231]
    ds_read_b64_tr_b16 v[38:39], v3 offset:18336
    v_mfma_f32_16x16x32_bf16 v[232:235], v[40:43], v[124:127], v[232:235]
    s_barrier
    v_mfma_f32_16x16x32_bf16 v[236:239], v[40:43], v[240:243], v[236:239]
    s_waitcnt vmcnt(12)
    s_waitcnt lgkmcnt(10)
    v_mfma_f32_16x16x32_bf16 v[128:131], v[16:19], v[44:47], v[128:131]
    ds_read_b64_tr_b16 v[40:41], v3 offset:16576
    v_mfma_f32_16x16x32_bf16 v[132:135], v[16:19], v[48:51], v[132:135]
    ds_read_b64_tr_b16 v[42:43], v3 offset:18368
    v_mfma_f32_16x16x32_bf16 v[136:139], v[16:19], v[52:55], v[136:139]
    v_mfma_f32_16x16x32_bf16 v[140:143], v[16:19], v[56:59], v[140:143]
    s_waitcnt lgkmcnt(10)
    v_mfma_f32_16x16x32_bf16 v[144:147], v[20:23], v[44:47], v[144:147]
    ds_read_b64_tr_b16 v[16:17], v3 offset:24576
    v_mfma_f32_16x16x32_bf16 v[148:151], v[20:23], v[48:51], v[148:151]
    ds_read_b64_tr_b16 v[18:19], v3 offset:26368
    v_mfma_f32_16x16x32_bf16 v[152:155], v[20:23], v[52:55], v[152:155]
    buffer_load_dwordx4 v[108:111], v8, s[16:19], s68 offen offset:0 sc1
    v_mfma_f32_16x16x32_bf16 v[156:159], v[20:23], v[56:59], v[156:159]
    s_waitcnt lgkmcnt(10)
    v_mfma_f32_16x16x32_bf16 v[160:163], v[24:27], v[44:47], v[160:163]
    ds_read_b64_tr_b16 v[20:21], v3 offset:24608
    v_mfma_f32_16x16x32_bf16 v[164:167], v[24:27], v[48:51], v[164:167]
    ds_read_b64_tr_b16 v[22:23], v3 offset:26400
    v_mfma_f32_16x16x32_bf16 v[168:171], v[24:27], v[52:55], v[168:171]
    buffer_load_dwordx4 v[112:115], v8, s[16:19], s68 offen offset:256 sc1
    v_mfma_f32_16x16x32_bf16 v[172:175], v[24:27], v[56:59], v[172:175]
    s_waitcnt lgkmcnt(10)
    v_mfma_f32_16x16x32_bf16 v[176:179], v[28:31], v[44:47], v[176:179]
    ds_read_b64_tr_b16 v[24:25], v3 offset:24640
    v_mfma_f32_16x16x32_bf16 v[180:183], v[28:31], v[48:51], v[180:183]
    ds_read_b64_tr_b16 v[26:27], v3 offset:26432
    v_mfma_f32_16x16x32_bf16 v[184:187], v[28:31], v[52:55], v[184:187]
    v_mfma_f32_16x16x32_bf16 v[188:191], v[28:31], v[56:59], v[188:191]
    s_waitcnt lgkmcnt(10)
    v_mfma_f32_16x16x32_bf16 v[192:195], v[32:35], v[44:47], v[192:195]
    ds_read_b64_tr_b16 v[28:29], v3 offset:24672
    v_mfma_f32_16x16x32_bf16 v[196:199], v[32:35], v[48:51], v[196:199]
    ds_read_b64_tr_b16 v[30:31], v3 offset:26464
    v_mfma_f32_16x16x32_bf16 v[200:203], v[32:35], v[52:55], v[200:203]
    buffer_load_dwordx4 v[124:127], v8, s[16:19], s69 offen offset:0 sc1
    v_mfma_f32_16x16x32_bf16 v[204:207], v[32:35], v[56:59], v[204:207]
    s_waitcnt lgkmcnt(10)
    v_mfma_f32_16x16x32_bf16 v[208:211], v[36:39], v[44:47], v[208:211]
    ds_read_b64_tr_b16 v[32:33], v3 offset:24704
    v_mfma_f32_16x16x32_bf16 v[212:215], v[36:39], v[48:51], v[212:215]
    ds_read_b64_tr_b16 v[34:35], v3 offset:26496
    v_mfma_f32_16x16x32_bf16 v[216:219], v[36:39], v[52:55], v[216:219]
    buffer_load_dwordx4 v[240:243], v8, s[16:19], s69 offen offset:256 sc1
    v_mfma_f32_16x16x32_bf16 v[220:223], v[36:39], v[56:59], v[220:223]
    s_waitcnt lgkmcnt(10)
    v_mfma_f32_16x16x32_bf16 v[224:227], v[40:43], v[44:47], v[224:227]
    ds_read_b64_tr_b16 v[36:37], v3 offset:24736
    v_mfma_f32_16x16x32_bf16 v[228:231], v[40:43], v[48:51], v[228:231]
    ds_read_b64_tr_b16 v[38:39], v3 offset:26528
    v_mfma_f32_16x16x32_bf16 v[232:235], v[40:43], v[52:55], v[232:235]
    v_mfma_f32_16x16x32_bf16 v[236:239], v[40:43], v[56:59], v[236:239]
    s_waitcnt vmcnt(12)
    s_waitcnt lgkmcnt(10)
    v_mfma_f32_16x16x32_bf16 v[128:131], v[16:19], v[60:63], v[128:131]
    ds_read_b64_tr_b16 v[40:41], v3 offset:24768
    v_mfma_f32_16x16x32_bf16 v[132:135], v[16:19], v[64:67], v[132:135]
    ds_read_b64_tr_b16 v[42:43], v3 offset:26560
    v_mfma_f32_16x16x32_bf16 v[136:139], v[16:19], v[68:71], v[136:139]
    v_mfma_f32_16x16x32_bf16 v[140:143], v[16:19], v[72:75], v[140:143]
    s_waitcnt lgkmcnt(10)
    v_mfma_f32_16x16x32_bf16 v[144:147], v[20:23], v[60:63], v[144:147]
    ds_read_b64_tr_b16 v[16:17], v3 offset:32768
    v_mfma_f32_16x16x32_bf16 v[148:151], v[20:23], v[64:67], v[148:151]
    ds_read_b64_tr_b16 v[18:19], v3 offset:34560
    v_mfma_f32_16x16x32_bf16 v[152:155], v[20:23], v[68:71], v[152:155]
    buffer_load_dwordx4 v[44:47], v8, s[16:19], s68 offen offset:2048 sc1
    v_mfma_f32_16x16x32_bf16 v[156:159], v[20:23], v[72:75], v[156:159]
    s_waitcnt lgkmcnt(10)
    v_mfma_f32_16x16x32_bf16 v[160:163], v[24:27], v[60:63], v[160:163]
    ds_read_b64_tr_b16 v[20:21], v3 offset:32800
    v_mfma_f32_16x16x32_bf16 v[164:167], v[24:27], v[64:67], v[164:167]
    ds_read_b64_tr_b16 v[22:23], v3 offset:34592
    v_mfma_f32_16x16x32_bf16 v[168:171], v[24:27], v[68:71], v[168:171]
    buffer_load_dwordx4 v[48:51], v8, s[16:19], s68 offen offset:2304 sc1
    s_add_u32 s68, s68, 4096
    v_mfma_f32_16x16x32_bf16 v[172:175], v[24:27], v[72:75], v[172:175]
    s_waitcnt lgkmcnt(10)
    v_mfma_f32_16x16x32_bf16 v[176:179], v[28:31], v[60:63], v[176:179]
    ds_read_b64_tr_b16 v[24:25], v3 offset:32832
    v_mfma_f32_16x16x32_bf16 v[180:183], v[28:31], v[64:67], v[180:183]
    ds_read_b64_tr_b16 v[26:27], v3 offset:34624
    v_mfma_f32_16x16x32_bf16 v[184:187], v[28:31], v[68:71], v[184:187]
    v_mfma_f32_16x16x32_bf16 v[188:191], v[28:31], v[72:75], v[188:191]
    s_waitcnt lgkmcnt(10)
    v_mfma_f32_16x16x32_bf16 v[192:195], v[32:35], v[60:63], v[192:195]
    ds_read_b64_tr_b16 v[28:29], v3 offset:32864
    v_mfma_f32_16x16x32_bf16 v[196:199], v[32:35], v[64:67], v[196:199]
    ds_read_b64_tr_b16 v[30:31], v3 offset:34656
    v_mfma_f32_16x16x32_bf16 v[200:203], v[32:35], v[68:71], v[200:203]
    buffer_load_dwordx4 v[52:55], v8, s[16:19], s69 offen offset:2048 sc1
    v_mfma_f32_16x16x32_bf16 v[204:207], v[32:35], v[72:75], v[204:207]
    s_waitcnt lgkmcnt(10)
    v_mfma_f32_16x16x32_bf16 v[208:211], v[36:39], v[60:63], v[208:211]
    s_branch LadaLN_cond__grouped_kv_mqa__dense_activation_relu__prompt_kernel_over10
LadaLN_cond__grouped_kv_mqa__dense_activation_relu__prompt_kernel_stub10:
    s_setpc_b64 s[96:97]
LadaLN_cond__grouped_kv_mqa__dense_activation_relu__prompt_kernel_over10:
    ds_read_b64_tr_b16 v[32:33], v3 offset:32896
    v_mfma_f32_16x16x32_bf16 v[212:215], v[36:39], v[64:67], v[212:215]
    ds_read_b64_tr_b16 v[34:35], v3 offset:34688
    v_mfma_f32_16x16x32_bf16 v[216:219], v[36:39], v[68:71], v[216:219]
    buffer_load_dwordx4 v[56:59], v8, s[16:19], s69 offen offset:2304 sc1
    s_add_u32 s69, s69, 4096
    v_mfma_f32_16x16x32_bf16 v[220:223], v[36:39], v[72:75], v[220:223]
    s_waitcnt lgkmcnt(10)
    v_mfma_f32_16x16x32_bf16 v[224:227], v[40:43], v[60:63], v[224:227]
    ds_read_b64_tr_b16 v[36:37], v3 offset:32928
    v_mfma_f32_16x16x32_bf16 v[228:231], v[40:43], v[64:67], v[228:231]
    ds_read_b64_tr_b16 v[38:39], v3 offset:34720
    v_mfma_f32_16x16x32_bf16 v[232:235], v[40:43], v[68:71], v[232:235]
    v_mfma_f32_16x16x32_bf16 v[236:239], v[40:43], v[72:75], v[236:239]
    s_waitcnt vmcnt(12)
    s_waitcnt lgkmcnt(10)
    v_mfma_f32_16x16x32_bf16 v[128:131], v[16:19], v[76:79], v[128:131]
    ds_read_b64_tr_b16 v[40:41], v3 offset:32960
    v_mfma_f32_16x16x32_bf16 v[132:135], v[16:19], v[80:83], v[132:135]
    ds_read_b64_tr_b16 v[42:43], v3 offset:34752
    v_mfma_f32_16x16x32_bf16 v[136:139], v[16:19], v[84:87], v[136:139]
    v_mfma_f32_16x16x32_bf16 v[140:143], v[16:19], v[88:91], v[140:143]
    s_waitcnt lgkmcnt(10)
    v_mfma_f32_16x16x32_bf16 v[144:147], v[20:23], v[76:79], v[144:147]
    ds_read_b64_tr_b16 v[16:17], v3 offset:40960
    v_mfma_f32_16x16x32_bf16 v[148:151], v[20:23], v[80:83], v[148:151]
    ds_read_b64_tr_b16 v[18:19], v3 offset:42752
    v_mfma_f32_16x16x32_bf16 v[152:155], v[20:23], v[84:87], v[152:155]
    buffer_load_dwordx4 v[60:63], v8, s[16:19], s68 offen offset:0 sc1
    v_mfma_f32_16x16x32_bf16 v[156:159], v[20:23], v[88:91], v[156:159]
    s_waitcnt lgkmcnt(10)
    v_mfma_f32_16x16x32_bf16 v[160:163], v[24:27], v[76:79], v[160:163]
    ds_read_b64_tr_b16 v[20:21], v3 offset:40992
    v_mfma_f32_16x16x32_bf16 v[164:167], v[24:27], v[80:83], v[164:167]
    ds_read_b64_tr_b16 v[22:23], v3 offset:42784
    v_mfma_f32_16x16x32_bf16 v[168:171], v[24:27], v[84:87], v[168:171]
    buffer_load_dwordx4 v[64:67], v8, s[16:19], s68 offen offset:256 sc1
    v_mfma_f32_16x16x32_bf16 v[172:175], v[24:27], v[88:91], v[172:175]
    s_waitcnt lgkmcnt(10)
    v_mfma_f32_16x16x32_bf16 v[176:179], v[28:31], v[76:79], v[176:179]
    ds_read_b64_tr_b16 v[24:25], v3 offset:41024
    v_mfma_f32_16x16x32_bf16 v[180:183], v[28:31], v[80:83], v[180:183]
    ds_read_b64_tr_b16 v[26:27], v3 offset:42816
    v_mfma_f32_16x16x32_bf16 v[184:187], v[28:31], v[84:87], v[184:187]
    v_mfma_f32_16x16x32_bf16 v[188:191], v[28:31], v[88:91], v[188:191]
    s_waitcnt lgkmcnt(10)
    v_mfma_f32_16x16x32_bf16 v[192:195], v[32:35], v[76:79], v[192:195]
    ds_read_b64_tr_b16 v[28:29], v3 offset:41056
    v_mfma_f32_16x16x32_bf16 v[196:199], v[32:35], v[80:83], v[196:199]
    ds_read_b64_tr_b16 v[30:31], v3 offset:42848
    v_mfma_f32_16x16x32_bf16 v[200:203], v[32:35], v[84:87], v[200:203]
    buffer_load_dwordx4 v[68:71], v8, s[16:19], s69 offen offset:0 sc1
    v_mfma_f32_16x16x32_bf16 v[204:207], v[32:35], v[88:91], v[204:207]
    s_waitcnt lgkmcnt(10)
    v_mfma_f32_16x16x32_bf16 v[208:211], v[36:39], v[76:79], v[208:211]
    ds_read_b64_tr_b16 v[32:33], v3 offset:41088
    v_mfma_f32_16x16x32_bf16 v[212:215], v[36:39], v[80:83], v[212:215]
    ds_read_b64_tr_b16 v[34:35], v3 offset:42880
    v_mfma_f32_16x16x32_bf16 v[216:219], v[36:39], v[84:87], v[216:219]
    buffer_load_dwordx4 v[72:75], v8, s[16:19], s69 offen offset:256 sc1
    v_mfma_f32_16x16x32_bf16 v[220:223], v[36:39], v[88:91], v[220:223]
    s_waitcnt lgkmcnt(10)
    v_mfma_f32_16x16x32_bf16 v[224:227], v[40:43], v[76:79], v[224:227]
    ds_read_b64_tr_b16 v[36:37], v3 offset:41120
    v_mfma_f32_16x16x32_bf16 v[228:231], v[40:43], v[80:83], v[228:231]
    ds_read_b64_tr_b16 v[38:39], v3 offset:42912
    v_mfma_f32_16x16x32_bf16 v[232:235], v[40:43], v[84:87], v[232:235]
    v_mfma_f32_16x16x32_bf16 v[236:239], v[40:43], v[88:91], v[236:239]
    s_waitcnt vmcnt(12)
    s_waitcnt lgkmcnt(10)
    v_mfma_f32_16x16x32_bf16 v[128:131], v[16:19], v[92:95], v[128:131]
    ds_read_b64_tr_b16 v[40:41], v3 offset:41152
    v_mfma_f32_16x16x32_bf16 v[132:135], v[16:19], v[96:99], v[132:135]
    ds_read_b64_tr_b16 v[42:43], v3 offset:42944
    v_mfma_f32_16x16x32_bf16 v[136:139], v[16:19], v[100:103], v[136:139]
    v_mfma_f32_16x16x32_bf16 v[140:143], v[16:19], v[104:107], v[140:143]
    s_waitcnt lgkmcnt(10)
    v_mfma_f32_16x16x32_bf16 v[144:147], v[20:23], v[92:95], v[144:147]
    ds_read_b64_tr_b16 v[16:17], v3 offset:49152
    v_mfma_f32_16x16x32_bf16 v[148:151], v[20:23], v[96:99], v[148:151]
    ds_read_b64_tr_b16 v[18:19], v3 offset:50944
    v_mfma_f32_16x16x32_bf16 v[152:155], v[20:23], v[100:103], v[152:155]
    buffer_load_dwordx4 v[76:79], v8, s[16:19], s68 offen offset:2048 sc1
    v_mfma_f32_16x16x32_bf16 v[156:159], v[20:23], v[104:107], v[156:159]
    s_waitcnt lgkmcnt(10)
    v_mfma_f32_16x16x32_bf16 v[160:163], v[24:27], v[92:95], v[160:163]
    ds_read_b64_tr_b16 v[20:21], v3 offset:49184
    v_mfma_f32_16x16x32_bf16 v[164:167], v[24:27], v[96:99], v[164:167]
    ds_read_b64_tr_b16 v[22:23], v3 offset:50976
    v_mfma_f32_16x16x32_bf16 v[168:171], v[24:27], v[100:103], v[168:171]
    buffer_load_dwordx4 v[80:83], v8, s[16:19], s68 offen offset:2304 sc1
    s_add_u32 s68, s68, 4096
    v_mfma_f32_16x16x32_bf16 v[172:175], v[24:27], v[104:107], v[172:175]
    s_waitcnt lgkmcnt(10)
    v_mfma_f32_16x16x32_bf16 v[176:179], v[28:31], v[92:95], v[176:179]
    ds_read_b64_tr_b16 v[24:25], v3 offset:49216
    v_mfma_f32_16x16x32_bf16 v[180:183], v[28:31], v[96:99], v[180:183]
    ds_read_b64_tr_b16 v[26:27], v3 offset:51008
    v_mfma_f32_16x16x32_bf16 v[184:187], v[28:31], v[100:103], v[184:187]
    v_mfma_f32_16x16x32_bf16 v[188:191], v[28:31], v[104:107], v[188:191]
    s_waitcnt lgkmcnt(10)
    v_mfma_f32_16x16x32_bf16 v[192:195], v[32:35], v[92:95], v[192:195]
    ds_read_b64_tr_b16 v[28:29], v3 offset:49248
    v_mfma_f32_16x16x32_bf16 v[196:199], v[32:35], v[96:99], v[196:199]
    ds_read_b64_tr_b16 v[30:31], v3 offset:51040
    v_mfma_f32_16x16x32_bf16 v[200:203], v[32:35], v[100:103], v[200:203]
    buffer_load_dwordx4 v[84:87], v8, s[16:19], s69 offen offset:2048 sc1
    v_mfma_f32_16x16x32_bf16 v[204:207], v[32:35], v[104:107], v[204:207]
    s_waitcnt lgkmcnt(10)
    v_mfma_f32_16x16x32_bf16 v[208:211], v[36:39], v[92:95], v[208:211]
    ds_read_b64_tr_b16 v[32:33], v3 offset:49280
    v_mfma_f32_16x16x32_bf16 v[212:215], v[36:39], v[96:99], v[212:215]
    ds_read_b64_tr_b16 v[34:35], v3 offset:51072
    v_mfma_f32_16x16x32_bf16 v[216:219], v[36:39], v[100:103], v[216:219]
    buffer_load_dwordx4 v[88:91], v8, s[16:19], s69 offen offset:2304 sc1
    s_add_u32 s69, s69, 4096
    v_mfma_f32_16x16x32_bf16 v[220:223], v[36:39], v[104:107], v[220:223]
    s_waitcnt lgkmcnt(10)
    v_mfma_f32_16x16x32_bf16 v[224:227], v[40:43], v[92:95], v[224:227]
    ds_read_b64_tr_b16 v[36:37], v3 offset:49312
    v_mfma_f32_16x16x32_bf16 v[228:231], v[40:43], v[96:99], v[228:231]
    ds_read_b64_tr_b16 v[38:39], v3 offset:51104
    v_mfma_f32_16x16x32_bf16 v[232:235], v[40:43], v[100:103], v[232:235]
    s_barrier
    v_mfma_f32_16x16x32_bf16 v[236:239], v[40:43], v[104:107], v[236:239]
    s_waitcnt vmcnt(12)
    s_waitcnt lgkmcnt(10)
    v_mfma_f32_16x16x32_bf16 v[128:131], v[16:19], v[108:111], v[128:131]
    ds_read_b64_tr_b16 v[40:41], v3 offset:49344
    v_mfma_f32_16x16x32_bf16 v[132:135], v[16:19], v[112:115], v[132:135]
    ds_read_b64_tr_b16 v[42:43], v3 offset:51136
    v_mfma_f32_16x16x32_bf16 v[136:139], v[16:19], v[124:127], v[136:139]
    buffer_load_dwordx4 v[92:95], v8, s[16:19], s68 offen offset:0 sc1
    v_mfma_f32_16x16x32_bf16 v[140:143], v[16:19], v[240:243], v[140:143]
    s_waitcnt lgkmcnt(10)
    v_mfma_f32_16x16x32_bf16 v[144:147], v[20:23], v[108:111], v[144:147]
    ds_read_b64_tr_b16 v[16:17], v3 offset:57344
    v_mfma_f32_16x16x32_bf16 v[148:151], v[20:23], v[112:115], v[148:151]
    ds_read_b64_tr_b16 v[18:19], v3 offset:59136
    v_mfma_f32_16x16x32_bf16 v[152:155], v[20:23], v[124:127], v[152:155]
    buffer_load_dwordx4 v[96:99], v8, s[16:19], s68 offen offset:256 sc1
    v_mfma_f32_16x16x32_bf16 v[156:159], v[20:23], v[240:243], v[156:159]
    s_waitcnt lgkmcnt(10)
    v_mfma_f32_16x16x32_bf16 v[160:163], v[24:27], v[108:111], v[160:163]
    ds_read_b64_tr_b16 v[20:21], v3 offset:57376
    v_mfma_f32_16x16x32_bf16 v[164:167], v[24:27], v[112:115], v[164:167]
    ds_read_b64_tr_b16 v[22:23], v3 offset:59168
    v_mfma_f32_16x16x32_bf16 v[168:171], v[24:27], v[124:127], v[168:171]
    buffer_load_dwordx4 v[100:103], v8, s[16:19], s69 offen offset:0 sc1
    v_mfma_f32_16x16x32_bf16 v[172:175], v[24:27], v[240:243], v[172:175]
    s_waitcnt lgkmcnt(10)
    v_mfma_f32_16x16x32_bf16 v[176:179], v[28:31], v[108:111], v[176:179]
    ds_read_b64_tr_b16 v[24:25], v3 offset:57408
    v_mfma_f32_16x16x32_bf16 v[180:183], v[28:31], v[112:115], v[180:183]
    ds_read_b64_tr_b16 v[26:27], v3 offset:59200
    v_mfma_f32_16x16x32_bf16 v[184:187], v[28:31], v[124:127], v[184:187]
    buffer_load_dwordx4 v[104:107], v8, s[16:19], s69 offen offset:256 sc1
    v_mfma_f32_16x16x32_bf16 v[188:191], v[28:31], v[240:243], v[188:191]
    s_waitcnt lgkmcnt(10)
    v_mfma_f32_16x16x32_bf16 v[192:195], v[32:35], v[108:111], v[192:195]
    ds_read_b64_tr_b16 v[28:29], v3 offset:57440
    v_mfma_f32_16x16x32_bf16 v[196:199], v[32:35], v[112:115], v[196:199]
    ds_read_b64_tr_b16 v[30:31], v3 offset:59232
    v_mfma_f32_16x16x32_bf16 v[200:203], v[32:35], v[124:127], v[200:203]
    v_mfma_f32_16x16x32_bf16 v[204:207], v[32:35], v[240:243], v[204:207]
    s_waitcnt lgkmcnt(10)
    v_mfma_f32_16x16x32_bf16 v[208:211], v[36:39], v[108:111], v[208:211]
    ds_read_b64_tr_b16 v[32:33], v3 offset:57472
    v_mfma_f32_16x16x32_bf16 v[212:215], v[36:39], v[112:115], v[212:215]
    ds_read_b64_tr_b16 v[34:35], v3 offset:59264
    v_mfma_f32_16x16x32_bf16 v[216:219], v[36:39], v[124:127], v[216:219]
    v_mfma_f32_16x16x32_bf16 v[220:223], v[36:39], v[240:243], v[220:223]
    s_waitcnt lgkmcnt(10)
    v_mfma_f32_16x16x32_bf16 v[224:227], v[40:43], v[108:111], v[224:227]
    ds_read_b64_tr_b16 v[36:37], v3 offset:57504
    v_mfma_f32_16x16x32_bf16 v[228:231], v[40:43], v[112:115], v[228:231]
    ds_read_b64_tr_b16 v[38:39], v3 offset:59296
    v_mfma_f32_16x16x32_bf16 v[232:235], v[40:43], v[124:127], v[232:235]
    v_mfma_f32_16x16x32_bf16 v[236:239], v[40:43], v[240:243], v[236:239]
    s_waitcnt vmcnt(12)
    s_waitcnt lgkmcnt(10)
    v_mfma_f32_16x16x32_bf16 v[128:131], v[16:19], v[44:47], v[128:131]
    ds_read_b64_tr_b16 v[40:41], v3 offset:57536
    v_mfma_f32_16x16x32_bf16 v[132:135], v[16:19], v[48:51], v[132:135]
    ds_read_b64_tr_b16 v[42:43], v3 offset:59328
    v_mfma_f32_16x16x32_bf16 v[136:139], v[16:19], v[52:55], v[136:139]
    buffer_load_dwordx4 v[108:111], v8, s[16:19], s68 offen offset:2048 sc1
    v_mfma_f32_16x16x32_bf16 v[140:143], v[16:19], v[56:59], v[140:143]
    s_waitcnt lgkmcnt(10)
    v_mfma_f32_16x16x32_bf16 v[144:147], v[20:23], v[44:47], v[144:147]
    v_add_u32 v3, 0x10000, v3
    ds_read_b64_tr_b16 v[16:17], v3 offset:0
    v_mfma_f32_16x16x32_bf16 v[148:151], v[20:23], v[48:51], v[148:151]
    ds_read_b64_tr_b16 v[18:19], v3 offset:1792
    v_mfma_f32_16x16x32_bf16 v[152:155], v[20:23], v[52:55], v[152:155]
    buffer_load_dwordx4 v[112:115], v8, s[16:19], s68 offen offset:2304 sc1
    s_add_u32 s68, s68, 4096
    v_mfma_f32_16x16x32_bf16 v[156:159], v[20:23], v[56:59], v[156:159]
    s_waitcnt lgkmcnt(10)
    v_mfma_f32_16x16x32_bf16 v[160:163], v[24:27], v[44:47], v[160:163]
    ds_read_b64_tr_b16 v[20:21], v3 offset:32
    v_mfma_f32_16x16x32_bf16 v[164:167], v[24:27], v[48:51], v[164:167]
    ds_read_b64_tr_b16 v[22:23], v3 offset:1824
    v_mfma_f32_16x16x32_bf16 v[168:171], v[24:27], v[52:55], v[168:171]
    buffer_load_dwordx4 v[124:127], v8, s[16:19], s69 offen offset:2048 sc1
    v_mfma_f32_16x16x32_bf16 v[172:175], v[24:27], v[56:59], v[172:175]
    s_waitcnt lgkmcnt(10)
    v_mfma_f32_16x16x32_bf16 v[176:179], v[28:31], v[44:47], v[176:179]
    ds_read_b64_tr_b16 v[24:25], v3 offset:64
    v_mfma_f32_16x16x32_bf16 v[180:183], v[28:31], v[48:51], v[180:183]
    ds_read_b64_tr_b16 v[26:27], v3 offset:1856
    v_mfma_f32_16x16x32_bf16 v[184:187], v[28:31], v[52:55], v[184:187]
    buffer_load_dwordx4 v[240:243], v8, s[16:19], s69 offen offset:2304 sc1
    s_add_u32 s69, s69, 4096
    v_mfma_f32_16x16x32_bf16 v[188:191], v[28:31], v[56:59], v[188:191]
    s_waitcnt lgkmcnt(10)
    v_mfma_f32_16x16x32_bf16 v[192:195], v[32:35], v[44:47], v[192:195]
    ds_read_b64_tr_b16 v[28:29], v3 offset:96
    v_mfma_f32_16x16x32_bf16 v[196:199], v[32:35], v[48:51], v[196:199]
    ds_read_b64_tr_b16 v[30:31], v3 offset:1888
    v_mfma_f32_16x16x32_bf16 v[200:203], v[32:35], v[52:55], v[200:203]
    v_mfma_f32_16x16x32_bf16 v[204:207], v[32:35], v[56:59], v[204:207]
    s_waitcnt lgkmcnt(10)
    v_mfma_f32_16x16x32_bf16 v[208:211], v[36:39], v[44:47], v[208:211]
    ds_read_b64_tr_b16 v[32:33], v3 offset:128
    v_mfma_f32_16x16x32_bf16 v[212:215], v[36:39], v[48:51], v[212:215]
    ds_read_b64_tr_b16 v[34:35], v3 offset:1920
    v_mfma_f32_16x16x32_bf16 v[216:219], v[36:39], v[52:55], v[216:219]
    v_mfma_f32_16x16x32_bf16 v[220:223], v[36:39], v[56:59], v[220:223]
    s_waitcnt lgkmcnt(10)
    v_mfma_f32_16x16x32_bf16 v[224:227], v[40:43], v[44:47], v[224:227]
    ds_read_b64_tr_b16 v[36:37], v3 offset:160
    v_mfma_f32_16x16x32_bf16 v[228:231], v[40:43], v[48:51], v[228:231]
    ds_read_b64_tr_b16 v[38:39], v3 offset:1952
    v_mfma_f32_16x16x32_bf16 v[232:235], v[40:43], v[52:55], v[232:235]
    v_mfma_f32_16x16x32_bf16 v[236:239], v[40:43], v[56:59], v[236:239]
    s_waitcnt vmcnt(12)
    s_waitcnt lgkmcnt(10)
    v_mfma_f32_16x16x32_bf16 v[128:131], v[16:19], v[60:63], v[128:131]
    ds_read_b64_tr_b16 v[40:41], v3 offset:192
    v_mfma_f32_16x16x32_bf16 v[132:135], v[16:19], v[64:67], v[132:135]
    ds_read_b64_tr_b16 v[42:43], v3 offset:1984
    v_mfma_f32_16x16x32_bf16 v[136:139], v[16:19], v[68:71], v[136:139]
    buffer_load_dwordx4 v[44:47], v8, s[16:19], s68 offen offset:0 sc1
    v_mfma_f32_16x16x32_bf16 v[140:143], v[16:19], v[72:75], v[140:143]
    s_waitcnt lgkmcnt(10)
    v_mfma_f32_16x16x32_bf16 v[144:147], v[20:23], v[60:63], v[144:147]
    ds_read_b64_tr_b16 v[16:17], v3 offset:8192
    v_mfma_f32_16x16x32_bf16 v[148:151], v[20:23], v[64:67], v[148:151]
    ds_read_b64_tr_b16 v[18:19], v3 offset:9984
    v_mfma_f32_16x16x32_bf16 v[152:155], v[20:23], v[68:71], v[152:155]
    buffer_load_dwordx4 v[48:51], v8, s[16:19], s68 offen offset:256 sc1
    v_mfma_f32_16x16x32_bf16 v[156:159], v[20:23], v[72:75], v[156:159]
    s_waitcnt lgkmcnt(10)
    v_mfma_f32_16x16x32_bf16 v[160:163], v[24:27], v[60:63], v[160:163]
    ds_read_b64_tr_b16 v[20:21], v3 offset:8224
    v_mfma_f32_16x16x32_bf16 v[164:167], v[24:27], v[64:67], v[164:167]
    ds_read_b64_tr_b16 v[22:23], v3 offset:10016
    v_mfma_f32_16x16x32_bf16 v[168:171], v[24:27], v[68:71], v[168:171]
    buffer_load_dwordx4 v[52:55], v8, s[16:19], s69 offen offset:0 sc1
    v_mfma_f32_16x16x32_bf16 v[172:175], v[24:27], v[72:75], v[172:175]
    s_waitcnt lgkmcnt(10)
    v_mfma_f32_16x16x32_bf16 v[176:179], v[28:31], v[60:63], v[176:179]
    ds_read_b64_tr_b16 v[24:25], v3 offset:8256
    v_mfma_f32_16x16x32_bf16 v[180:183], v[28:31], v[64:67], v[180:183]
    ds_read_b64_tr_b16 v[26:27], v3 offset:10048
    v_mfma_f32_16x16x32_bf16 v[184:187], v[28:31], v[68:71], v[184:187]
    buffer_load_dwordx4 v[56:59], v8, s[16:19], s69 offen offset:256 sc1
    v_mfma_f32_16x16x32_bf16 v[188:191], v[28:31], v[72:75], v[188:191]
    s_waitcnt lgkmcnt(10)
    v_mfma_f32_16x16x32_bf16 v[192:195], v[32:35], v[60:63], v[192:195]
    ds_read_b64_tr_b16 v[28:29], v3 offset:8288
    v_mfma_f32_16x16x32_bf16 v[196:199], v[32:35], v[64:67], v[196:199]
    ds_read_b64_tr_b16 v[30:31], v3 offset:10080
    v_mfma_f32_16x16x32_bf16 v[200:203], v[32:35], v[68:71], v[200:203]
    v_mfma_f32_16x16x32_bf16 v[204:207], v[32:35], v[72:75], v[204:207]
    s_waitcnt lgkmcnt(10)
    v_mfma_f32_16x16x32_bf16 v[208:211], v[36:39], v[60:63], v[208:211]
    ds_read_b64_tr_b16 v[32:33], v3 offset:8320
    v_mfma_f32_16x16x32_bf16 v[212:215], v[36:39], v[64:67], v[212:215]
    ds_read_b64_tr_b16 v[34:35], v3 offset:10112
    v_mfma_f32_16x16x32_bf16 v[216:219], v[36:39], v[68:71], v[216:219]
    v_mfma_f32_16x16x32_bf16 v[220:223], v[36:39], v[72:75], v[220:223]
    s_waitcnt lgkmcnt(10)
    v_mfma_f32_16x16x32_bf16 v[224:227], v[40:43], v[60:63], v[224:227]
    ds_read_b64_tr_b16 v[36:37], v3 offset:8352
    v_mfma_f32_16x16x32_bf16 v[228:231], v[40:43], v[64:67], v[228:231]
    ds_read_b64_tr_b16 v[38:39], v3 offset:10144
    v_mfma_f32_16x16x32_bf16 v[232:235], v[40:43], v[68:71], v[232:235]
    v_mfma_f32_16x16x32_bf16 v[236:239], v[40:43], v[72:75], v[236:239]
    s_waitcnt vmcnt(12)
    s_waitcnt lgkmcnt(10)
    v_mfma_f32_16x16x32_bf16 v[128:131], v[16:19], v[76:79], v[128:131]
    ds_read_b64_tr_b16 v[40:41], v3 offset:8384
    v_mfma_f32_16x16x32_bf16 v[132:135], v[16:19], v[80:83], v[132:135]
    ds_read_b64_tr_b16 v[42:43], v3 offset:10176
    v_mfma_f32_16x16x32_bf16 v[136:139], v[16:19], v[84:87], v[136:139]
    buffer_load_dwordx4 v[60:63], v8, s[16:19], s68 offen offset:2048 sc1
    v_mfma_f32_16x16x32_bf16 v[140:143], v[16:19], v[88:91], v[140:143]
    s_waitcnt lgkmcnt(10)
    v_mfma_f32_16x16x32_bf16 v[144:147], v[20:23], v[76:79], v[144:147]
    ds_read_b64_tr_b16 v[16:17], v3 offset:16384
    v_mfma_f32_16x16x32_bf16 v[148:151], v[20:23], v[80:83], v[148:151]
    ds_read_b64_tr_b16 v[18:19], v3 offset:18176
    v_mfma_f32_16x16x32_bf16 v[152:155], v[20:23], v[84:87], v[152:155]
    buffer_load_dwordx4 v[64:67], v8, s[16:19], s68 offen offset:2304 sc1
    s_add_u32 s68, s68, 4096
    v_mfma_f32_16x16x32_bf16 v[156:159], v[20:23], v[88:91], v[156:159]
    s_waitcnt lgkmcnt(10)
    v_mfma_f32_16x16x32_bf16 v[160:163], v[24:27], v[76:79], v[160:163]
    ds_read_b64_tr_b16 v[20:21], v3 offset:24576
    v_mfma_f32_16x16x32_bf16 v[164:167], v[24:27], v[80:83], v[164:167]
    ds_read_b64_tr_b16 v[22:23], v3 offset:26368
    v_mfma_f32_16x16x32_bf16 v[168:171], v[24:27], v[84:87], v[168:171]
    buffer_load_dwordx4 v[68:71], v8, s[16:19], s69 offen offset:2048 sc1
    v_mfma_f32_16x16x32_bf16 v[172:175], v[24:27], v[88:91], v[172:175]
    s_waitcnt lgkmcnt(10)
    v_mfma_f32_16x16x32_bf16 v[176:179], v[28:31], v[76:79], v[176:179]
    ds_read_b64_tr_b16 v[24:25], v3 offset:32768
    v_mfma_f32_16x16x32_bf16 v[180:183], v[28:31], v[80:83], v[180:183]
    ds_read_b64_tr_b16 v[26:27], v3 offset:34560
    v_mfma_f32_16x16x32_bf16 v[184:187], v[28:31], v[84:87], v[184:187]
    buffer_load_dwordx4 v[72:75], v8, s[16:19], s69 offen offset:2304 sc1
    s_add_u32 s69, s69, 4096
    v_mfma_f32_16x16x32_bf16 v[188:191], v[28:31], v[88:91], v[188:191]
    s_waitcnt lgkmcnt(10)
    v_mfma_f32_16x16x32_bf16 v[192:195], v[32:35], v[76:79], v[192:195]
    ds_read_b64_tr_b16 v[28:29], v3 offset:16416
    v_mfma_f32_16x16x32_bf16 v[196:199], v[32:35], v[80:83], v[196:199]
    ds_read_b64_tr_b16 v[30:31], v3 offset:18208
    v_mfma_f32_16x16x32_bf16 v[200:203], v[32:35], v[84:87], v[200:203]
    v_mfma_f32_16x16x32_bf16 v[204:207], v[32:35], v[88:91], v[204:207]
    s_waitcnt lgkmcnt(10)
    v_mfma_f32_16x16x32_bf16 v[208:211], v[36:39], v[76:79], v[208:211]
    ds_read_b64_tr_b16 v[32:33], v3 offset:24608
    v_mfma_f32_16x16x32_bf16 v[212:215], v[36:39], v[80:83], v[212:215]
    ds_read_b64_tr_b16 v[34:35], v3 offset:26400
    v_mfma_f32_16x16x32_bf16 v[216:219], v[36:39], v[84:87], v[216:219]
    v_mfma_f32_16x16x32_bf16 v[220:223], v[36:39], v[88:91], v[220:223]
    s_waitcnt lgkmcnt(10)
    v_mfma_f32_16x16x32_bf16 v[224:227], v[40:43], v[76:79], v[224:227]
    ds_read_b64_tr_b16 v[36:37], v3 offset:32800
    v_mfma_f32_16x16x32_bf16 v[228:231], v[40:43], v[80:83], v[228:231]
    ds_read_b64_tr_b16 v[38:39], v3 offset:34592
    v_mfma_f32_16x16x32_bf16 v[232:235], v[40:43], v[84:87], v[232:235]
    s_barrier
    ds_read_b64 v[244:245], v252 offset:0
    ds_read_b64 v[246:247], v252 offset:128
    ds_read_b64 v[248:249], v252 offset:256
    ds_read_b64 v[250:251], v252 offset:384
    ds_read_b64 v[12:13], v253 offset:0
    ds_read_b64 v[4:5], v253 offset:128
    v_mfma_f32_16x16x32_bf16 v[236:239], v[40:43], v[88:91], v[236:239]
    s_waitcnt vmcnt(12)
    s_waitcnt lgkmcnt(15)
    v_mfma_f32_16x16x32_bf16 v[128:131], v[16:19], v[92:95], v[128:131]
    ds_read_b64_tr_b16 v[40:41], v3 offset:40960
    v_mfma_f32_16x16x32_bf16 v[132:135], v[16:19], v[96:99], v[132:135]
    ds_read_b64_tr_b16 v[42:43], v3 offset:42752
    v_mfma_f32_16x16x32_bf16 v[136:139], v[16:19], v[100:103], v[136:139]
    v_mfma_f32_16x16x32_bf16 v[140:143], v[16:19], v[104:107], v[140:143]
    s_waitcnt vmcnt(8)
    s_waitcnt lgkmcnt(15)
    v_mfma_f32_16x16x32_bf16 v[128:131], v[20:23], v[108:111], v[128:131]
    ds_read_b64_tr_b16 v[16:17], v3 offset:40992
    v_mfma_f32_16x16x32_bf16 v[132:135], v[20:23], v[112:115], v[132:135]
    ds_read_b64_tr_b16 v[18:19], v3 offset:42784
    v_mfma_f32_16x16x32_bf16 v[136:139], v[20:23], v[124:127], v[136:139]
    v_mfma_f32_16x16x32_bf16 v[140:143], v[20:23], v[240:243], v[140:143]
    s_waitcnt vmcnt(4)
    s_waitcnt lgkmcnt(15)
    v_mfma_f32_16x16x32_bf16 v[128:131], v[24:27], v[44:47], v[128:131]
    ds_read_b64_tr_b16 v[20:21], v3 offset:16448
    v_mfma_f32_16x16x32_bf16 v[132:135], v[24:27], v[48:51], v[132:135]
    ds_read_b64_tr_b16 v[22:23], v3 offset:18240
    v_mfma_f32_16x16x32_bf16 v[136:139], v[24:27], v[52:55], v[136:139]
    v_mfma_f32_16x16x32_bf16 v[140:143], v[24:27], v[56:59], v[140:143]
    s_waitcnt lgkmcnt(15)
    v_mfma_f32_16x16x32_bf16 v[144:147], v[28:31], v[92:95], v[144:147]
    ds_read_b64_tr_b16 v[24:25], v3 offset:24640
    v_mfma_f32_16x16x32_bf16 v[148:151], v[28:31], v[96:99], v[148:151]
    ds_read_b64_tr_b16 v[26:27], v3 offset:26432
    v_mfma_f32_16x16x32_bf16 v[152:155], v[28:31], v[100:103], v[152:155]
    v_mfma_f32_16x16x32_bf16 v[156:159], v[28:31], v[104:107], v[156:159]
    s_waitcnt lgkmcnt(15)
    v_mfma_f32_16x16x32_bf16 v[144:147], v[32:35], v[108:111], v[144:147]
    ds_read_b64_tr_b16 v[28:29], v3 offset:32832
    v_mfma_f32_16x16x32_bf16 v[148:151], v[32:35], v[112:115], v[148:151]
    ds_read_b64_tr_b16 v[30:31], v3 offset:34624
    v_mfma_f32_16x16x32_bf16 v[152:155], v[32:35], v[124:127], v[152:155]
    v_mfma_f32_16x16x32_bf16 v[156:159], v[32:35], v[240:243], v[156:159]
    s_waitcnt lgkmcnt(15)
    v_mfma_f32_16x16x32_bf16 v[144:147], v[36:39], v[44:47], v[144:147]
    ds_read_b64_tr_b16 v[32:33], v3 offset:41024
    v_mfma_f32_16x16x32_bf16 v[148:151], v[36:39], v[48:51], v[148:151]
    ds_read_b64_tr_b16 v[34:35], v3 offset:42816
    v_mfma_f32_16x16x32_bf16 v[152:155], v[36:39], v[52:55], v[152:155]
    v_mfma_f32_16x16x32_bf16 v[156:159], v[36:39], v[56:59], v[156:159]
    s_waitcnt vmcnt(0)
    s_waitcnt lgkmcnt(10)
    v_mfma_f32_16x16x32_bf16 v[128:131], v[40:43], v[60:63], v[128:131]
    ds_read_b64_tr_b16 v[36:37], v3 offset:16480
    v_mfma_f32_16x16x32_bf16 v[132:135], v[40:43], v[64:67], v[132:135]
    ds_read_b64_tr_b16 v[38:39], v3 offset:18272
    v_mfma_f32_16x16x32_bf16 v[136:139], v[40:43], v[68:71], v[136:139]
    v_mfma_f32_16x16x32_bf16 v[140:143], v[40:43], v[72:75], v[140:143]
    s_waitcnt lgkmcnt(10)
    v_mfma_f32_16x16x32_bf16 v[128:131], v[12:15], v[244:247], v[128:131]
    v_mfma_f32_16x16x32_bf16 v[132:135], v[12:15], v[246:249], v[132:135]
    v_mfma_f32_16x16x32_bf16 v[136:139], v[12:15], v[248:251], v[136:139]
    v_mfma_f32_16x16x32_bf16 v[140:143], v[12:15], v[250:253], v[140:143]
    ds_read_b64 v[12:13], v253 offset:256
    v_mfma_f32_16x16x32_bf16 v[144:147], v[16:19], v[60:63], v[144:147]
    ds_read_b64_tr_b16 v[40:41], v3 offset:24672
    v_mfma_f32_16x16x32_bf16 v[148:151], v[16:19], v[64:67], v[148:151]
    ds_read_b64_tr_b16 v[42:43], v3 offset:26464
    v_mfma_f32_16x16x32_bf16 v[152:155], v[16:19], v[68:71], v[152:155]
    v_cvt_pk_bf16_f32 v128, v128, v129
    v_cvt_pk_bf16_f32 v129, v130, v131
    v_cvt_pk_bf16_f32 v130, v132, v133
    v_mfma_f32_16x16x32_bf16 v[156:159], v[16:19], v[72:75], v[156:159]
    v_cvt_pk_bf16_f32 v131, v134, v135
    v_cvt_pk_bf16_f32 v136, v136, v137
    s_waitcnt lgkmcnt(11)
    v_mfma_f32_16x16x32_bf16 v[144:147], v[4:7], v[244:247], v[144:147]
    v_cvt_pk_bf16_f32 v137, v138, v139
    v_cvt_pk_bf16_f32 v138, v140, v141
    v_cvt_pk_bf16_f32 v139, v142, v143
    v_mfma_f32_16x16x32_bf16 v[148:151], v[4:7], v[246:249], v[148:151]
    v_pk_max_i16 v128, v128, 0
    v_pk_max_i16 v129, v129, 0
    v_pk_max_i16 v130, v130, 0
    v_mfma_f32_16x16x32_bf16 v[152:155], v[4:7], v[248:251], v[152:155]
    v_pk_max_i16 v131, v131, 0
    v_pk_max_i16 v136, v136, 0
    v_pk_max_i16 v137, v137, 0
    v_mfma_f32_16x16x32_bf16 v[156:159], v[4:7], v[250:253], v[156:159]
    ds_read_b64 v[4:5], v253 offset:384
    v_mfma_f32_16x16x32_bf16 v[160:163], v[20:23], v[92:95], v[160:163]
    v_pk_max_i16 v138, v138, 0
    v_pk_max_i16 v139, v139, 0
    ds_read_b64_tr_b16 v[16:17], v3 offset:32864
    v_mfma_f32_16x16x32_bf16 v[164:167], v[20:23], v[96:99], v[164:167]
    v_permlane16_swap_b32 v128, v130
    v_permlane16_swap_b32 v129, v131
    ds_read_b64_tr_b16 v[18:19], v3 offset:34656
    v_mfma_f32_16x16x32_bf16 v[168:171], v[20:23], v[100:103], v[168:171]
    v_permlane16_swap_b32 v136, v138
    v_permlane16_swap_b32 v137, v139
    buffer_store_dwordx4 v[128:131], v1, s[16:19], s74 offen offset:0 sc1
    v_mfma_f32_16x16x32_bf16 v[172:175], v[20:23], v[104:107], v[172:175]
    buffer_store_dwordx4 v[136:139], v1, s[16:19], s76 offen offset:0 sc1
    v_cvt_pk_bf16_f32 v144, v144, v145
    s_waitcnt lgkmcnt(12)
    v_mfma_f32_16x16x32_bf16 v[160:163], v[24:27], v[108:111], v[160:163]
    v_cvt_pk_bf16_f32 v145, v146, v147
    v_cvt_pk_bf16_f32 v146, v148, v149
    ds_read_b64_tr_b16 v[20:21], v3 offset:41056
    v_mfma_f32_16x16x32_bf16 v[164:167], v[24:27], v[112:115], v[164:167]
    v_cvt_pk_bf16_f32 v147, v150, v151
    v_cvt_pk_bf16_f32 v152, v152, v153
    ds_read_b64_tr_b16 v[22:23], v3 offset:42848
    v_mfma_f32_16x16x32_bf16 v[168:171], v[24:27], v[124:127], v[168:171]
    v_cvt_pk_bf16_f32 v153, v154, v155
    v_cvt_pk_bf16_f32 v154, v156, v157
    v_cvt_pk_bf16_f32 v155, v158, v159
    v_mfma_f32_16x16x32_bf16 v[172:175], v[24:27], v[240:243], v[172:175]
    v_pk_max_i16 v144, v144, 0
    v_pk_max_i16 v145, v145, 0
    s_waitcnt lgkmcnt(12)
    v_mfma_f32_16x16x32_bf16 v[160:163], v[28:31], v[44:47], v[160:163]
    v_pk_max_i16 v146, v146, 0
    v_pk_max_i16 v147, v147, 0
    ds_read_b64_tr_b16 v[24:25], v3 offset:16512
    v_mfma_f32_16x16x32_bf16 v[164:167], v[28:31], v[48:51], v[164:167]
    v_pk_max_i16 v152, v152, 0
    v_pk_max_i16 v153, v153, 0
    ds_read_b64_tr_b16 v[26:27], v3 offset:18304
    v_mfma_f32_16x16x32_bf16 v[168:171], v[28:31], v[52:55], v[168:171]
    v_pk_max_i16 v154, v154, 0
    v_pk_max_i16 v155, v155, 0
    v_permlane16_swap_b32 v144, v146
    v_mfma_f32_16x16x32_bf16 v[172:175], v[28:31], v[56:59], v[172:175]
    v_permlane16_swap_b32 v145, v147
    v_permlane16_swap_b32 v152, v154
    s_waitcnt lgkmcnt(12)
    v_mfma_f32_16x16x32_bf16 v[160:163], v[32:35], v[60:63], v[160:163]
    v_permlane16_swap_b32 v153, v155
    buffer_store_dwordx4 v[144:147], v1, s[16:19], s74 offen offset:1024 sc1
    ds_read_b64_tr_b16 v[28:29], v3 offset:24704
    v_mfma_f32_16x16x32_bf16 v[164:167], v[32:35], v[64:67], v[164:167]
    buffer_store_dwordx4 v[152:155], v1, s[16:19], s76 offen offset:1024 sc1
    ds_read_b64_tr_b16 v[30:31], v3 offset:26496
    v_mfma_f32_16x16x32_bf16 v[168:171], v[32:35], v[68:71], v[168:171]
    v_mfma_f32_16x16x32_bf16 v[172:175], v[32:35], v[72:75], v[172:175]
    s_waitcnt lgkmcnt(12)
    s_waitcnt lgkmcnt(11)
    v_mfma_f32_16x16x32_bf16 v[160:163], v[12:15], v[244:247], v[160:163]
    v_mfma_f32_16x16x32_bf16 v[164:167], v[12:15], v[246:249], v[164:167]
    v_mfma_f32_16x16x32_bf16 v[168:171], v[12:15], v[248:251], v[168:171]
    v_mfma_f32_16x16x32_bf16 v[172:175], v[12:15], v[250:253], v[172:175]
    ds_read_b64 v[12:13], v253 offset:512
    v_mfma_f32_16x16x32_bf16 v[176:179], v[36:39], v[92:95], v[176:179]
    ds_read_b64_tr_b16 v[32:33], v3 offset:32896
    v_mfma_f32_16x16x32_bf16 v[180:183], v[36:39], v[96:99], v[180:183]
    ds_read_b64_tr_b16 v[34:35], v3 offset:34688
    v_mfma_f32_16x16x32_bf16 v[184:187], v[36:39], v[100:103], v[184:187]
    v_cvt_pk_bf16_f32 v160, v160, v161
    v_cvt_pk_bf16_f32 v161, v162, v163
    v_cvt_pk_bf16_f32 v162, v164, v165
    v_mfma_f32_16x16x32_bf16 v[188:191], v[36:39], v[104:107], v[188:191]
    v_cvt_pk_bf16_f32 v163, v166, v167
    v_cvt_pk_bf16_f32 v168, v168, v169
    s_waitcnt lgkmcnt(12)
    v_mfma_f32_16x16x32_bf16 v[176:179], v[40:43], v[108:111], v[176:179]
    v_cvt_pk_bf16_f32 v169, v170, v171
    v_cvt_pk_bf16_f32 v170, v172, v173
    ds_read_b64_tr_b16 v[36:37], v3 offset:41088
    v_mfma_f32_16x16x32_bf16 v[180:183], v[40:43], v[112:115], v[180:183]
    v_cvt_pk_bf16_f32 v171, v174, v175
    v_pk_max_i16 v160, v160, 0
    ds_read_b64_tr_b16 v[38:39], v3 offset:42880
    v_mfma_f32_16x16x32_bf16 v[184:187], v[40:43], v[124:127], v[184:187]
    v_pk_max_i16 v161, v161, 0
    v_pk_max_i16 v162, v162, 0
    v_pk_max_i16 v163, v163, 0
    v_mfma_f32_16x16x32_bf16 v[188:191], v[40:43], v[240:243], v[188:191]
    v_pk_max_i16 v168, v168, 0
    v_pk_max_i16 v169, v169, 0
    s_waitcnt lgkmcnt(11)
    v_mfma_f32_16x16x32_bf16 v[176:179], v[16:19], v[44:47], v[176:179]
    v_pk_max_i16 v170, v170, 0
    v_pk_max_i16 v171, v171, 0
    ds_read_b64_tr_b16 v[40:41], v3 offset:16544
    v_mfma_f32_16x16x32_bf16 v[180:183], v[16:19], v[48:51], v[180:183]
    v_permlane16_swap_b32 v160, v162
    v_permlane16_swap_b32 v161, v163
    ds_read_b64_tr_b16 v[42:43], v3 offset:18336
    v_mfma_f32_16x16x32_bf16 v[184:187], v[16:19], v[52:55], v[184:187]
    v_permlane16_swap_b32 v168, v170
    v_permlane16_swap_b32 v169, v171
    buffer_store_dwordx4 v[160:163], v1, s[16:19], s74 offen offset:2048 sc1
    v_mfma_f32_16x16x32_bf16 v[188:191], v[16:19], v[56:59], v[188:191]
    buffer_store_dwordx4 v[168:171], v1, s[16:19], s76 offen offset:2048 sc1
    s_waitcnt lgkmcnt(11)
    v_mfma_f32_16x16x32_bf16 v[176:179], v[20:23], v[60:63], v[176:179]
    ds_read_b64_tr_b16 v[16:17], v3 offset:24736
    v_mfma_f32_16x16x32_bf16 v[180:183], v[20:23], v[64:67], v[180:183]
    ds_read_b64_tr_b16 v[18:19], v3 offset:26528
    v_mfma_f32_16x16x32_bf16 v[184:187], v[20:23], v[68:71], v[184:187]
    v_mfma_f32_16x16x32_bf16 v[188:191], v[20:23], v[72:75], v[188:191]
    s_waitcnt lgkmcnt(11)
    v_mfma_f32_16x16x32_bf16 v[176:179], v[4:7], v[244:247], v[176:179]
    s_branch LadaLN_cond__grouped_kv_mqa__dense_activation_relu__prompt_kernel_over11
LadaLN_cond__grouped_kv_mqa__dense_activation_relu__prompt_kernel_stub11:
    s_setpc_b64 s[96:97]
LadaLN_cond__grouped_kv_mqa__dense_activation_relu__prompt_kernel_over11:
    v_mfma_f32_16x16x32_bf16 v[180:183], v[4:7], v[246:249], v[180:183]
    v_mfma_f32_16x16x32_bf16 v[184:187], v[4:7], v[248:251], v[184:187]
    v_mfma_f32_16x16x32_bf16 v[188:191], v[4:7], v[250:253], v[188:191]
    ds_read_b64 v[4:5], v253 offset:640
    v_mfma_f32_16x16x32_bf16 v[192:195], v[24:27], v[92:95], v[192:195]
    ds_read_b64_tr_b16 v[20:21], v3 offset:32928
    v_mfma_f32_16x16x32_bf16 v[196:199], v[24:27], v[96:99], v[196:199]
    ds_read_b64_tr_b16 v[22:23], v3 offset:34720
    v_mfma_f32_16x16x32_bf16 v[200:203], v[24:27], v[100:103], v[200:203]
    v_cvt_pk_bf16_f32 v176, v176, v177
    v_cvt_pk_bf16_f32 v177, v178, v179
    v_cvt_pk_bf16_f32 v178, v180, v181
    v_mfma_f32_16x16x32_bf16 v[204:207], v[24:27], v[104:107], v[204:207]
    v_cvt_pk_bf16_f32 v179, v182, v183
    v_cvt_pk_bf16_f32 v184, v184, v185
    s_waitcnt lgkmcnt(12)
    v_mfma_f32_16x16x32_bf16 v[192:195], v[28:31], v[108:111], v[192:195]
    v_cvt_pk_bf16_f32 v185, v186, v187
    v_cvt_pk_bf16_f32 v186, v188, v189
    ds_read_b64_tr_b16 v[24:25], v3 offset:41120
    v_mfma_f32_16x16x32_bf16 v[196:199], v[28:31], v[112:115], v[196:199]
    v_cvt_pk_bf16_f32 v187, v190, v191
    v_pk_max_i16 v176, v176, 0
    ds_read_b64_tr_b16 v[26:27], v3 offset:42912
    v_mfma_f32_16x16x32_bf16 v[200:203], v[28:31], v[124:127], v[200:203]
    v_pk_max_i16 v177, v177, 0
    v_pk_max_i16 v178, v178, 0
    v_pk_max_i16 v179, v179, 0
    v_mfma_f32_16x16x32_bf16 v[204:207], v[28:31], v[240:243], v[204:207]
    v_pk_max_i16 v184, v184, 0
    v_pk_max_i16 v185, v185, 0
    s_waitcnt lgkmcnt(11)
    v_mfma_f32_16x16x32_bf16 v[192:195], v[32:35], v[44:47], v[192:195]
    v_pk_max_i16 v186, v186, 0
    v_pk_max_i16 v187, v187, 0
    ds_read_b64_tr_b16 v[28:29], v3 offset:16576
    v_mfma_f32_16x16x32_bf16 v[196:199], v[32:35], v[48:51], v[196:199]
    v_permlane16_swap_b32 v176, v178
    v_permlane16_swap_b32 v177, v179
    ds_read_b64_tr_b16 v[30:31], v3 offset:18368
    v_mfma_f32_16x16x32_bf16 v[200:203], v[32:35], v[52:55], v[200:203]
    v_permlane16_swap_b32 v184, v186
    v_permlane16_swap_b32 v185, v187
    buffer_store_dwordx4 v[176:179], v1, s[16:19], s74 offen offset:3072 sc1
    v_mfma_f32_16x16x32_bf16 v[204:207], v[32:35], v[56:59], v[204:207]
    buffer_store_dwordx4 v[184:187], v1, s[16:19], s76 offen offset:3072 sc1
    s_waitcnt lgkmcnt(11)
    v_mfma_f32_16x16x32_bf16 v[192:195], v[36:39], v[60:63], v[192:195]
    ds_read_b64_tr_b16 v[32:33], v3 offset:24768
    v_mfma_f32_16x16x32_bf16 v[196:199], v[36:39], v[64:67], v[196:199]
    ds_read_b64_tr_b16 v[34:35], v3 offset:26560
    v_mfma_f32_16x16x32_bf16 v[200:203], v[36:39], v[68:71], v[200:203]
    v_mfma_f32_16x16x32_bf16 v[204:207], v[36:39], v[72:75], v[204:207]
    s_waitcnt lgkmcnt(11)
    v_mfma_f32_16x16x32_bf16 v[192:195], v[12:15], v[244:247], v[192:195]
    v_mfma_f32_16x16x32_bf16 v[196:199], v[12:15], v[246:249], v[196:199]
    v_mfma_f32_16x16x32_bf16 v[200:203], v[12:15], v[248:251], v[200:203]
    v_mfma_f32_16x16x32_bf16 v[204:207], v[12:15], v[250:253], v[204:207]
    ds_read_b64 v[12:13], v253 offset:768
    v_mfma_f32_16x16x32_bf16 v[208:211], v[40:43], v[92:95], v[208:211]
    ds_read_b64_tr_b16 v[36:37], v3 offset:32960
    v_mfma_f32_16x16x32_bf16 v[212:215], v[40:43], v[96:99], v[212:215]
    ds_read_b64_tr_b16 v[38:39], v3 offset:34752
    v_mfma_f32_16x16x32_bf16 v[216:219], v[40:43], v[100:103], v[216:219]
    v_cvt_pk_bf16_f32 v192, v192, v193
    v_cvt_pk_bf16_f32 v193, v194, v195
    v_cvt_pk_bf16_f32 v194, v196, v197
    v_mfma_f32_16x16x32_bf16 v[220:223], v[40:43], v[104:107], v[220:223]
    v_cvt_pk_bf16_f32 v195, v198, v199
    v_cvt_pk_bf16_f32 v200, v200, v201
    s_waitcnt lgkmcnt(12)
    v_mfma_f32_16x16x32_bf16 v[208:211], v[16:19], v[108:111], v[208:211]
    v_cvt_pk_bf16_f32 v201, v202, v203
    v_cvt_pk_bf16_f32 v202, v204, v205
    ds_read_b64_tr_b16 v[40:41], v3 offset:41152
    v_mfma_f32_16x16x32_bf16 v[212:215], v[16:19], v[112:115], v[212:215]
    v_cvt_pk_bf16_f32 v203, v206, v207
    v_pk_max_i16 v192, v192, 0
    ds_read_b64_tr_b16 v[42:43], v3 offset:42944
    v_mfma_f32_16x16x32_bf16 v[216:219], v[16:19], v[124:127], v[216:219]
    v_pk_max_i16 v193, v193, 0
    v_pk_max_i16 v194, v194, 0
    v_pk_max_i16 v195, v195, 0
    v_mfma_f32_16x16x32_bf16 v[220:223], v[16:19], v[240:243], v[220:223]
    v_pk_max_i16 v200, v200, 0
    v_pk_max_i16 v201, v201, 0
    s_waitcnt lgkmcnt(11)
    v_mfma_f32_16x16x32_bf16 v[208:211], v[20:23], v[44:47], v[208:211]
    v_pk_max_i16 v202, v202, 0
    v_pk_max_i16 v203, v203, 0
    v_permlane16_swap_b32 v192, v194
    v_mfma_f32_16x16x32_bf16 v[212:215], v[20:23], v[48:51], v[212:215]
    v_permlane16_swap_b32 v193, v195
    v_permlane16_swap_b32 v200, v202
    v_permlane16_swap_b32 v201, v203
    v_mfma_f32_16x16x32_bf16 v[216:219], v[20:23], v[52:55], v[216:219]
    buffer_store_dwordx4 v[192:195], v1, s[16:19], s75 offen offset:0 sc1
    buffer_store_dwordx4 v[200:203], v1, s[16:19], s77 offen offset:0 sc1
    v_mfma_f32_16x16x32_bf16 v[220:223], v[20:23], v[56:59], v[220:223]
    s_waitcnt lgkmcnt(9)
    v_mfma_f32_16x16x32_bf16 v[208:211], v[24:27], v[60:63], v[208:211]
    v_mfma_f32_16x16x32_bf16 v[212:215], v[24:27], v[64:67], v[212:215]
    v_mfma_f32_16x16x32_bf16 v[216:219], v[24:27], v[68:71], v[216:219]
    v_mfma_f32_16x16x32_bf16 v[220:223], v[24:27], v[72:75], v[220:223]
    s_waitcnt lgkmcnt(7)
    v_mfma_f32_16x16x32_bf16 v[208:211], v[4:7], v[244:247], v[208:211]
    v_mfma_f32_16x16x32_bf16 v[212:215], v[4:7], v[246:249], v[212:215]
    v_mfma_f32_16x16x32_bf16 v[216:219], v[4:7], v[248:251], v[216:219]
    v_mfma_f32_16x16x32_bf16 v[220:223], v[4:7], v[250:253], v[220:223]
    v_mfma_f32_16x16x32_bf16 v[224:227], v[28:31], v[92:95], v[224:227]
    v_mfma_f32_16x16x32_bf16 v[228:231], v[28:31], v[96:99], v[228:231]
    v_mfma_f32_16x16x32_bf16 v[232:235], v[28:31], v[100:103], v[232:235]
    v_mfma_f32_16x16x32_bf16 v[236:239], v[28:31], v[104:107], v[236:239]
    s_waitcnt lgkmcnt(5)
    v_mfma_f32_16x16x32_bf16 v[224:227], v[32:35], v[108:111], v[224:227]
    v_cvt_pk_bf16_f32 v208, v208, v209
    v_cvt_pk_bf16_f32 v209, v210, v211
    v_cvt_pk_bf16_f32 v210, v212, v213
    v_mfma_f32_16x16x32_bf16 v[228:231], v[32:35], v[112:115], v[228:231]
    v_cvt_pk_bf16_f32 v211, v214, v215
    v_cvt_pk_bf16_f32 v216, v216, v217
    v_cvt_pk_bf16_f32 v217, v218, v219
    v_mfma_f32_16x16x32_bf16 v[232:235], v[32:35], v[124:127], v[232:235]
    v_cvt_pk_bf16_f32 v218, v220, v221
    v_cvt_pk_bf16_f32 v219, v222, v223
    v_pk_max_i16 v208, v208, 0
    v_mfma_f32_16x16x32_bf16 v[236:239], v[32:35], v[240:243], v[236:239]
    v_pk_max_i16 v209, v209, 0
    v_pk_max_i16 v210, v210, 0
    s_waitcnt lgkmcnt(2)
    v_mfma_f32_16x16x32_bf16 v[224:227], v[36:39], v[44:47], v[224:227]
    v_pk_max_i16 v211, v211, 0
    v_pk_max_i16 v216, v216, 0
    v_pk_max_i16 v217, v217, 0
    v_mfma_f32_16x16x32_bf16 v[228:231], v[36:39], v[48:51], v[228:231]
    v_pk_max_i16 v218, v218, 0
    v_pk_max_i16 v219, v219, 0
    v_permlane16_swap_b32 v208, v210
    v_mfma_f32_16x16x32_bf16 v[232:235], v[36:39], v[52:55], v[232:235]
    v_permlane16_swap_b32 v209, v211
    v_permlane16_swap_b32 v216, v218
    v_permlane16_swap_b32 v217, v219
    v_mfma_f32_16x16x32_bf16 v[236:239], v[36:39], v[56:59], v[236:239]
    buffer_store_dwordx4 v[208:211], v1, s[16:19], s75 offen offset:1024 sc1
    buffer_store_dwordx4 v[216:219], v1, s[16:19], s77 offen offset:1024 sc1
    s_waitcnt lgkmcnt(0)
    v_mfma_f32_16x16x32_bf16 v[224:227], v[40:43], v[60:63], v[224:227]
    v_mfma_f32_16x16x32_bf16 v[228:231], v[40:43], v[64:67], v[228:231]
    v_mfma_f32_16x16x32_bf16 v[232:235], v[40:43], v[68:71], v[232:235]
    v_mfma_f32_16x16x32_bf16 v[236:239], v[40:43], v[72:75], v[236:239]
    v_mfma_f32_16x16x32_bf16 v[224:227], v[12:15], v[244:247], v[224:227]
    v_mfma_f32_16x16x32_bf16 v[228:231], v[12:15], v[246:249], v[228:231]
    v_mfma_f32_16x16x32_bf16 v[232:235], v[12:15], v[248:251], v[232:235]
    v_mfma_f32_16x16x32_bf16 v[236:239], v[12:15], v[250:253], v[236:239]
    s_nop 5
    v_cvt_pk_bf16_f32 v224, v224, v225
    s_nop 3
    v_cvt_pk_bf16_f32 v225, v226, v227
    s_nop 1
    v_cvt_pk_bf16_f32 v226, v228, v229
    v_cvt_pk_bf16_f32 v227, v230, v231
    s_nop 0
    v_cvt_pk_bf16_f32 v232, v232, v233
    v_cvt_pk_bf16_f32 v233, v234, v235
    v_cvt_pk_bf16_f32 v234, v236, v237
    v_cvt_pk_bf16_f32 v235, v238, v239
    v_pk_max_i16 v224, v224, 0
    v_pk_max_i16 v225, v225, 0
    v_pk_max_i16 v226, v226, 0
    v_pk_max_i16 v227, v227, 0
    v_pk_max_i16 v232, v232, 0
    v_pk_max_i16 v233, v233, 0
    v_pk_max_i16 v234, v234, 0
    v_pk_max_i16 v235, v235, 0
    v_permlane16_swap_b32 v224, v226
    v_permlane16_swap_b32 v225, v227
    v_permlane16_swap_b32 v232, v234
    v_permlane16_swap_b32 v233, v235
    buffer_store_dwordx4 v[224:227], v1, s[16:19], s75 offen offset:2048 sc1
    buffer_store_dwordx4 v[232:235], v1, s[16:19], s77 offen offset:2048 sc1
    s_setprio 0
    s_barrier
LadaLN_cond__grouped_kv_mqa__dense_activation_relu__prompt_kernel_fcode:
    s_mul_i32 s68, s66, 229376
    s_mul_i32 s73, s90, 114688
    s_add_u32 s68, s68, s73
    s_add_u32 s68, s68, 13631488
    buffer_load_dwordx4 v[48:51], v8, s[16:19], s68 offen offset:0 sc1
    buffer_load_dwordx4 v[52:55], v8, s[16:19], s68 offen offset:256 sc1
    buffer_load_dwordx4 v[56:59], v8, s[16:19], s68 offen offset:2048 sc1
    buffer_load_dwordx4 v[60:63], v8, s[16:19], s68 offen offset:2304 sc1
    s_add_u32 s68, s68, 4096
    buffer_load_dwordx4 v[64:67], v8, s[16:19], s68 offen offset:0 sc1
    buffer_load_dwordx4 v[68:71], v8, s[16:19], s68 offen offset:256 sc1
    buffer_load_dwordx4 v[72:75], v8, s[16:19], s68 offen offset:2048 sc1
    buffer_load_dwordx4 v[76:79], v8, s[16:19], s68 offen offset:2304 sc1
    s_add_u32 s68, s68, 4096
    buffer_load_dwordx4 v[80:83], v8, s[16:19], s68 offen offset:0 sc1
    buffer_load_dwordx4 v[84:87], v8, s[16:19], s68 offen offset:256 sc1
    buffer_load_dwordx4 v[88:91], v8, s[16:19], s68 offen offset:2048 sc1
    buffer_load_dwordx4 v[92:95], v8, s[16:19], s68 offen offset:2304 sc1
    s_add_u32 s68, s68, 4096
    v_lshrrev_b32 v12, 2, v9
    v_mul_u32_u24 v192, 320, v12
    v_and_b32 v12, 3, v9
    v_lshl_add_u32 v192, v12, 3, v192
    v_and_b32 v12, 1, v10
    v_lshl_add_u32 v192, v12, 5, v192
    v_lshl_add_u32 v192, v10, 11, v192
    s_lshl_b32 s72, s90, 7
    v_xor_b32 v192, s72, v192
    v_xor_b32 v193, 32, v192
    v_xor_b32 v194, 64, v192
    v_xor_b32 v195, 96, v192
    v_xor_b32 v196, 128, v192
    v_xor_b32 v197, 160, v192
    v_xor_b32 v198, 192, v192
    v_xor_b32 v199, 224, v192
    v_permlane32_swap_b32 v116, v118
    v_permlane32_swap_b32 v117, v119
    v_permlane32_swap_b32 v120, v122
    v_permlane32_swap_b32 v121, v123
    s_nop 0
    v_permlane16_swap_b32 v116, v118
    v_permlane16_swap_b32 v117, v119
    v_permlane16_swap_b32 v120, v122
    v_permlane16_swap_b32 v121, v123
    s_nop 0
    s_waitcnt vmcnt(0)
    v_mov_b32 v12, s23
    s_mov_b64 exec, 1
    buffer_store_dword v12, off, s[16:19], s71 sc1
    s_mov_b64 exec, -1
    s_barrier
    s_lshl_b32 s72, s2, 14
    s_lshl_b32 s73, s24, 12
    v_add_u32 v13, s73, v1
    s_add_u32 s72, s72, s73
    s_add_u32 s72, s72, 28311552
    v_add_u32 v192, 0x10000, v192
    v_add_u32 v193, 0x10000, v193
    v_add_u32 v194, 0x10000, v194
    v_add_u32 v195, 0x10000, v195
    v_add_u32 v196, 0x10000, v196
    v_add_u32 v197, 0x10000, v197
    v_add_u32 v198, 0x10000, v198
    v_add_u32 v199, 0x10000, v199
    ds_read_b64_tr_b16 v[16:17], v192 offset:49152
    ds_read_b64_tr_b16 v[18:19], v192 offset:50176
    ds_read_b64_tr_b16 v[20:21], v193 offset:49152
    ds_read_b64_tr_b16 v[22:23], v193 offset:50176
    ds_read_b64_tr_b16 v[24:25], v194 offset:49152
    ds_read_b64_tr_b16 v[26:27], v194 offset:50176
    ds_read_b64_tr_b16 v[28:29], v195 offset:49152
    ds_read_b64_tr_b16 v[30:31], v195 offset:50176
    ds_read_b64_tr_b16 v[32:33], v196 offset:49152
    ds_read_b64_tr_b16 v[34:35], v196 offset:50176
    ds_read_b64_tr_b16 v[36:37], v197 offset:49152
    ds_read_b64_tr_b16 v[38:39], v197 offset:50176
    ds_read_b64_tr_b16 v[40:41], v198 offset:49152
    ds_read_b64_tr_b16 v[42:43], v198 offset:50176
    s_setprio 1
    s_waitcnt vmcnt(10)
    v_max_u32 v200, v48, v52
    v_cmp_eq_u32 vcc, -1, v200
    s_nop 1
    s_cbranch_vccnz LadaLN_cond__grouped_kv_mqa__dense_activation_relu__prompt_kernel_ffb77
LadaLN_cond__grouped_kv_mqa__dense_activation_relu__prompt_kernel_fbk78:
    s_waitcnt lgkmcnt(12)
    v_mfma_f32_16x16x32_bf16 v[128:131], v[16:19], v[48:51], 0
    ds_read_b64_tr_b16 v[44:45], v199 offset:49152
    v_mfma_f32_16x16x32_bf16 v[132:135], v[16:19], v[52:55], 0
    ds_read_b64_tr_b16 v[46:47], v199 offset:50176
    s_waitcnt lgkmcnt(12)
    v_mfma_f32_16x16x32_bf16 v[136:139], v[20:23], v[48:51], 0
    ds_read_b64_tr_b16 v[16:17], v192 offset:57344
    v_mfma_f32_16x16x32_bf16 v[140:143], v[20:23], v[52:55], 0
    ds_read_b64_tr_b16 v[18:19], v192 offset:58368
    s_waitcnt lgkmcnt(12)
    v_mfma_f32_16x16x32_bf16 v[144:147], v[24:27], v[48:51], 0
    ds_read_b64_tr_b16 v[20:21], v193 offset:57344
    buffer_load_dwordx4 v[96:99], v8, s[16:19], s68 offen offset:0 sc1
    v_mfma_f32_16x16x32_bf16 v[148:151], v[24:27], v[52:55], 0
    ds_read_b64_tr_b16 v[22:23], v193 offset:58368
    s_waitcnt lgkmcnt(12)
    v_mfma_f32_16x16x32_bf16 v[152:155], v[28:31], v[48:51], 0
    ds_read_b64_tr_b16 v[24:25], v194 offset:57344
    v_mfma_f32_16x16x32_bf16 v[156:159], v[28:31], v[52:55], 0
    ds_read_b64_tr_b16 v[26:27], v194 offset:58368
    s_waitcnt lgkmcnt(12)
    v_mfma_f32_16x16x32_bf16 v[160:163], v[32:35], v[48:51], 0
    ds_read_b64_tr_b16 v[28:29], v195 offset:57344
    v_mfma_f32_16x16x32_bf16 v[164:167], v[32:35], v[52:55], 0
    ds_read_b64_tr_b16 v[30:31], v195 offset:58368
    s_waitcnt lgkmcnt(12)
    v_mfma_f32_16x16x32_bf16 v[168:171], v[36:39], v[48:51], 0
    ds_read_b64_tr_b16 v[32:33], v196 offset:57344
    v_mfma_f32_16x16x32_bf16 v[172:175], v[36:39], v[52:55], 0
    ds_read_b64_tr_b16 v[34:35], v196 offset:58368
    s_waitcnt vmcnt(9)
    v_max_u32 v200, v56, v60
    s_waitcnt lgkmcnt(12)
    v_mfma_f32_16x16x32_bf16 v[176:179], v[40:43], v[48:51], 0
    ds_read_b64_tr_b16 v[36:37], v197 offset:57344
    buffer_load_dwordx4 v[100:103], v8, s[16:19], s68 offen offset:256 sc1
    v_cmp_eq_u32 vcc, -1, v200
    v_mfma_f32_16x16x32_bf16 v[180:183], v[40:43], v[52:55], 0
    ds_read_b64_tr_b16 v[38:39], v197 offset:58368
    s_waitcnt lgkmcnt(12)
    v_mfma_f32_16x16x32_bf16 v[184:187], v[44:47], v[48:51], 0
    ds_read_b64_tr_b16 v[40:41], v198 offset:57344
    s_cbranch_vccnz LadaLN_cond__grouped_kv_mqa__dense_activation_relu__prompt_kernel_ffb79
LadaLN_cond__grouped_kv_mqa__dense_activation_relu__prompt_kernel_fbk80:
    v_mfma_f32_16x16x32_bf16 v[188:191], v[44:47], v[52:55], 0
    ds_read_b64_tr_b16 v[42:43], v198 offset:58368
    s_waitcnt lgkmcnt(12)
    v_mfma_f32_16x16x32_bf16 v[128:131], v[16:19], v[56:59], v[128:131]
    ds_read_b64_tr_b16 v[44:45], v199 offset:57344
    v_mfma_f32_16x16x32_bf16 v[132:135], v[16:19], v[60:63], v[132:135]
    ds_read_b64_tr_b16 v[46:47], v199 offset:58368
    s_waitcnt lgkmcnt(12)
    v_mfma_f32_16x16x32_bf16 v[136:139], v[20:23], v[56:59], v[136:139]
    v_add_u32 v192, 0x10000, v192
    v_add_u32 v193, 0x10000, v193
    v_add_u32 v194, 0x10000, v194
    v_add_u32 v195, 0x10000, v195
    v_add_u32 v196, 0x10000, v196
    v_add_u32 v197, 0x10000, v197
    v_add_u32 v198, 0x10000, v198
    v_add_u32 v199, 0x10000, v199
    ds_read_b64_tr_b16 v[16:17], v192 offset:0
    v_mfma_f32_16x16x32_bf16 v[140:143], v[20:23], v[60:63], v[140:143]
    ds_read_b64_tr_b16 v[18:19], v192 offset:1024
    s_waitcnt lgkmcnt(12)
    v_mfma_f32_16x16x32_bf16 v[144:147], v[24:27], v[56:59], v[144:147]
    ds_read_b64_tr_b16 v[20:21], v193 offset:0
    buffer_load_dwordx4 v[104:107], v8, s[16:19], s68 offen offset:2048 sc1
    v_mfma_f32_16x16x32_bf16 v[148:151], v[24:27], v[60:63], v[148:151]
    ds_read_b64_tr_b16 v[22:23], v193 offset:1024
    s_waitcnt lgkmcnt(12)
    v_mfma_f32_16x16x32_bf16 v[152:155], v[28:31], v[56:59], v[152:155]
    ds_read_b64_tr_b16 v[24:25], v194 offset:0
    v_mfma_f32_16x16x32_bf16 v[156:159], v[28:31], v[60:63], v[156:159]
    ds_read_b64_tr_b16 v[26:27], v194 offset:1024
    s_waitcnt lgkmcnt(12)
    v_mfma_f32_16x16x32_bf16 v[160:163], v[32:35], v[56:59], v[160:163]
    ds_read_b64_tr_b16 v[28:29], v195 offset:0
    v_mfma_f32_16x16x32_bf16 v[164:167], v[32:35], v[60:63], v[164:167]
    ds_read_b64_tr_b16 v[30:31], v195 offset:1024
    s_waitcnt lgkmcnt(12)
    v_mfma_f32_16x16x32_bf16 v[168:171], v[36:39], v[56:59], v[168:171]
    ds_read_b64_tr_b16 v[32:33], v196 offset:0
    v_mfma_f32_16x16x32_bf16 v[172:175], v[36:39], v[60:63], v[172:175]
    ds_read_b64_tr_b16 v[34:35], v196 offset:1024
    s_waitcnt vmcnt(9)
    v_max_u32 v200, v64, v68
    s_waitcnt lgkmcnt(12)
    v_mfma_f32_16x16x32_bf16 v[176:179], v[40:43], v[56:59], v[176:179]
    ds_read_b64_tr_b16 v[36:37], v197 offset:0
    buffer_load_dwordx4 v[108:111], v8, s[16:19], s68 offen offset:2304 sc1
    s_add_u32 s68, s68, 4096
    v_cmp_eq_u32 vcc, -1, v200
    v_mfma_f32_16x16x32_bf16 v[180:183], v[40:43], v[60:63], v[180:183]
    ds_read_b64_tr_b16 v[38:39], v197 offset:1024
    s_waitcnt lgkmcnt(12)
    v_mfma_f32_16x16x32_bf16 v[184:187], v[44:47], v[56:59], v[184:187]
    ds_read_b64_tr_b16 v[40:41], v198 offset:0
    s_cbranch_vccnz LadaLN_cond__grouped_kv_mqa__dense_activation_relu__prompt_kernel_ffb81
LadaLN_cond__grouped_kv_mqa__dense_activation_relu__prompt_kernel_fbk82:
    v_mfma_f32_16x16x32_bf16 v[188:191], v[44:47], v[60:63], v[188:191]
    ds_read_b64_tr_b16 v[42:43], v198 offset:1024
    s_waitcnt lgkmcnt(12)
    v_mfma_f32_16x16x32_bf16 v[128:131], v[16:19], v[64:67], v[128:131]
    ds_read_b64_tr_b16 v[44:45], v199 offset:0
    v_mfma_f32_16x16x32_bf16 v[132:135], v[16:19], v[68:71], v[132:135]
    ds_read_b64_tr_b16 v[46:47], v199 offset:1024
    s_waitcnt lgkmcnt(12)
    v_mfma_f32_16x16x32_bf16 v[136:139], v[20:23], v[64:67], v[136:139]
    ds_read_b64_tr_b16 v[16:17], v192 offset:8192
    v_mfma_f32_16x16x32_bf16 v[140:143], v[20:23], v[68:71], v[140:143]
    ds_read_b64_tr_b16 v[18:19], v192 offset:9216
    s_waitcnt lgkmcnt(12)
    v_mfma_f32_16x16x32_bf16 v[144:147], v[24:27], v[64:67], v[144:147]
    ds_read_b64_tr_b16 v[20:21], v193 offset:8192
    buffer_load_dwordx4 v[48:51], v8, s[16:19], s68 offen offset:0 sc1
    v_mfma_f32_16x16x32_bf16 v[148:151], v[24:27], v[68:71], v[148:151]
    ds_read_b64_tr_b16 v[22:23], v193 offset:9216
    s_waitcnt lgkmcnt(12)
    v_mfma_f32_16x16x32_bf16 v[152:155], v[28:31], v[64:67], v[152:155]
    ds_read_b64_tr_b16 v[24:25], v194 offset:8192
    v_mfma_f32_16x16x32_bf16 v[156:159], v[28:31], v[68:71], v[156:159]
    ds_read_b64_tr_b16 v[26:27], v194 offset:9216
    s_waitcnt lgkmcnt(12)
    v_mfma_f32_16x16x32_bf16 v[160:163], v[32:35], v[64:67], v[160:163]
    ds_read_b64_tr_b16 v[28:29], v195 offset:8192
    v_mfma_f32_16x16x32_bf16 v[164:167], v[32:35], v[68:71], v[164:167]
    ds_read_b64_tr_b16 v[30:31], v195 offset:9216
    s_waitcnt lgkmcnt(12)
    v_mfma_f32_16x16x32_bf16 v[168:171], v[36:39], v[64:67], v[168:171]
    ds_read_b64_tr_b16 v[32:33], v196 offset:8192
    v_mfma_f32_16x16x32_bf16 v[172:175], v[36:39], v[68:71], v[172:175]
    ds_read_b64_tr_b16 v[34:35], v196 offset:9216
    s_waitcnt vmcnt(9)
    v_max_u32 v200, v72, v76
    s_waitcnt lgkmcnt(12)
    v_mfma_f32_16x16x32_bf16 v[176:179], v[40:43], v[64:67], v[176:179]
    ds_read_b64_tr_b16 v[36:37], v197 offset:8192
    buffer_load_dwordx4 v[52:55], v8, s[16:19], s68 offen offset:256 sc1
    v_cmp_eq_u32 vcc, -1, v200
    v_mfma_f32_16x16x32_bf16 v[180:183], v[40:43], v[68:71], v[180:183]
    ds_read_b64_tr_b16 v[38:39], v197 offset:9216
    s_waitcnt lgkmcnt(12)
    v_mfma_f32_16x16x32_bf16 v[184:187], v[44:47], v[64:67], v[184:187]
    ds_read_b64_tr_b16 v[40:41], v198 offset:8192
    s_cbranch_vccnz LadaLN_cond__grouped_kv_mqa__dense_activation_relu__prompt_kernel_ffb83
LadaLN_cond__grouped_kv_mqa__dense_activation_relu__prompt_kernel_fbk84:
    v_mfma_f32_16x16x32_bf16 v[188:191], v[44:47], v[68:71], v[188:191]
    ds_read_b64_tr_b16 v[42:43], v198 offset:9216
    s_waitcnt lgkmcnt(12)
    v_mfma_f32_16x16x32_bf16 v[128:131], v[16:19], v[72:75], v[128:131]
    ds_read_b64_tr_b16 v[44:45], v199 offset:8192
    v_mfma_f32_16x16x32_bf16 v[132:135], v[16:19], v[76:79], v[132:135]
    ds_read_b64_tr_b16 v[46:47], v199 offset:9216
    s_waitcnt lgkmcnt(12)
    v_mfma_f32_16x16x32_bf16 v[136:139], v[20:23], v[72:75], v[136:139]
    v_add_u32 v192, 0xfffe0000, v192
    v_add_u32 v193, 0xfffe0000, v193
    v_add_u32 v194, 0xfffe0000, v194
    v_add_u32 v195, 0xfffe0000, v195
    v_add_u32 v196, 0xfffe0000, v196
    v_add_u32 v197, 0xfffe0000, v197
    v_add_u32 v198, 0xfffe0000, v198
    v_add_u32 v199, 0xfffe0000, v199
    ds_read_b64_tr_b16 v[16:17], v192 offset:0
    v_mfma_f32_16x16x32_bf16 v[140:143], v[20:23], v[76:79], v[140:143]
    ds_read_b64_tr_b16 v[18:19], v192 offset:1024
    s_waitcnt lgkmcnt(12)
    v_mfma_f32_16x16x32_bf16 v[144:147], v[24:27], v[72:75], v[144:147]
    ds_read_b64_tr_b16 v[20:21], v193 offset:0
    buffer_load_dwordx4 v[56:59], v8, s[16:19], s68 offen offset:2048 sc1
    v_mfma_f32_16x16x32_bf16 v[148:151], v[24:27], v[76:79], v[148:151]
    ds_read_b64_tr_b16 v[22:23], v193 offset:1024
    s_waitcnt lgkmcnt(12)
    v_mfma_f32_16x16x32_bf16 v[152:155], v[28:31], v[72:75], v[152:155]
    ds_read_b64_tr_b16 v[24:25], v194 offset:0
    v_mfma_f32_16x16x32_bf16 v[156:159], v[28:31], v[76:79], v[156:159]
    ds_read_b64_tr_b16 v[26:27], v194 offset:1024
    s_waitcnt lgkmcnt(12)
    v_mfma_f32_16x16x32_bf16 v[160:163], v[32:35], v[72:75], v[160:163]
    ds_read_b64_tr_b16 v[28:29], v195 offset:0
    v_mfma_f32_16x16x32_bf16 v[164:167], v[32:35], v[76:79], v[164:167]
    ds_read_b64_tr_b16 v[30:31], v195 offset:1024
    s_waitcnt lgkmcnt(12)
    v_mfma_f32_16x16x32_bf16 v[168:171], v[36:39], v[72:75], v[168:171]
    ds_read_b64_tr_b16 v[32:33], v196 offset:0
    v_mfma_f32_16x16x32_bf16 v[172:175], v[36:39], v[76:79], v[172:175]
    ds_read_b64_tr_b16 v[34:35], v196 offset:1024
    s_waitcnt vmcnt(9)
    v_max_u32 v200, v80, v84
    s_waitcnt lgkmcnt(12)
    v_mfma_f32_16x16x32_bf16 v[176:179], v[40:43], v[72:75], v[176:179]
    ds_read_b64_tr_b16 v[36:37], v197 offset:0
    buffer_load_dwordx4 v[60:63], v8, s[16:19], s68 offen offset:2304 sc1
    s_add_u32 s68, s68, 4096
    v_cmp_eq_u32 vcc, -1, v200
    v_mfma_f32_16x16x32_bf16 v[180:183], v[40:43], v[76:79], v[180:183]
    ds_read_b64_tr_b16 v[38:39], v197 offset:1024
    s_waitcnt lgkmcnt(12)
    v_mfma_f32_16x16x32_bf16 v[184:187], v[44:47], v[72:75], v[184:187]
    ds_read_b64_tr_b16 v[40:41], v198 offset:0
    s_cbranch_vccnz LadaLN_cond__grouped_kv_mqa__dense_activation_relu__prompt_kernel_ffb85
LadaLN_cond__grouped_kv_mqa__dense_activation_relu__prompt_kernel_fbk86:
    v_mfma_f32_16x16x32_bf16 v[188:191], v[44:47], v[76:79], v[188:191]
    ds_read_b64_tr_b16 v[42:43], v198 offset:1024
    s_waitcnt lgkmcnt(12)
    v_mfma_f32_16x16x32_bf16 v[128:131], v[16:19], v[80:83], v[128:131]
    ds_read_b64_tr_b16 v[44:45], v199 offset:0
    v_mfma_f32_16x16x32_bf16 v[132:135], v[16:19], v[84:87], v[132:135]
    ds_read_b64_tr_b16 v[46:47], v199 offset:1024
    s_waitcnt lgkmcnt(12)
    v_mfma_f32_16x16x32_bf16 v[136:139], v[20:23], v[80:83], v[136:139]
    s_barrier
LadaLN_cond__grouped_kv_mqa__dense_activation_relu__prompt_kernel_fb1:
    ds_read_b64_tr_b16 v[16:17], v192 offset:8192
    v_mfma_f32_16x16x32_bf16 v[140:143], v[20:23], v[84:87], v[140:143]
    ds_read_b64_tr_b16 v[18:19], v192 offset:9216
    s_waitcnt lgkmcnt(12)
    v_mfma_f32_16x16x32_bf16 v[144:147], v[24:27], v[80:83], v[144:147]
    ds_read_b64_tr_b16 v[20:21], v193 offset:8192
    buffer_load_dwordx4 v[64:67], v8, s[16:19], s68 offen offset:0 sc1
    v_mfma_f32_16x16x32_bf16 v[148:151], v[24:27], v[84:87], v[148:151]
    ds_read_b64_tr_b16 v[22:23], v193 offset:9216
    s_waitcnt lgkmcnt(12)
    v_mfma_f32_16x16x32_bf16 v[152:155], v[28:31], v[80:83], v[152:155]
    ds_read_b64_tr_b16 v[24:25], v194 offset:8192
    v_mfma_f32_16x16x32_bf16 v[156:159], v[28:31], v[84:87], v[156:159]
    ds_read_b64_tr_b16 v[26:27], v194 offset:9216
    s_waitcnt lgkmcnt(12)
    v_mfma_f32_16x16x32_bf16 v[160:163], v[32:35], v[80:83], v[160:163]
    ds_read_b64_tr_b16 v[28:29], v195 offset:8192
    v_mfma_f32_16x16x32_bf16 v[164:167], v[32:35], v[84:87], v[164:167]
    ds_read_b64_tr_b16 v[30:31], v195 offset:9216
    s_waitcnt lgkmcnt(12)
    v_mfma_f32_16x16x32_bf16 v[168:171], v[36:39], v[80:83], v[168:171]
    ds_read_b64_tr_b16 v[32:33], v196 offset:8192
    v_mfma_f32_16x16x32_bf16 v[172:175], v[36:39], v[84:87], v[172:175]
    ds_read_b64_tr_b16 v[34:35], v196 offset:9216
    s_waitcnt vmcnt(9)
    v_max_u32 v200, v88, v92
    s_waitcnt lgkmcnt(12)
    v_mfma_f32_16x16x32_bf16 v[176:179], v[40:43], v[80:83], v[176:179]
    ds_read_b64_tr_b16 v[36:37], v197 offset:8192
    buffer_load_dwordx4 v[68:71], v8, s[16:19], s68 offen offset:256 sc1
    v_cmp_eq_u32 vcc, -1, v200
    v_mfma_f32_16x16x32_bf16 v[180:183], v[40:43], v[84:87], v[180:183]
    ds_read_b64_tr_b16 v[38:39], v197 offset:9216
    s_waitcnt lgkmcnt(12)
    v_mfma_f32_16x16x32_bf16 v[184:187], v[44:47], v[80:83], v[184:187]
    ds_read_b64_tr_b16 v[40:41], v198 offset:8192
    s_cbranch_vccnz LadaLN_cond__grouped_kv_mqa__dense_activation_relu__prompt_kernel_ffb87
LadaLN_cond__grouped_kv_mqa__dense_activation_relu__prompt_kernel_fbk88:
    v_mfma_f32_16x16x32_bf16 v[188:191], v[44:47], v[84:87], v[188:191]
    ds_read_b64_tr_b16 v[42:43], v198 offset:9216
    s_waitcnt lgkmcnt(12)
    v_mfma_f32_16x16x32_bf16 v[128:131], v[16:19], v[88:91], v[128:131]
    ds_read_b64_tr_b16 v[44:45], v199 offset:8192
    v_mfma_f32_16x16x32_bf16 v[132:135], v[16:19], v[92:95], v[132:135]
    ds_read_b64_tr_b16 v[46:47], v199 offset:9216
    s_waitcnt lgkmcnt(12)
    v_mfma_f32_16x16x32_bf16 v[136:139], v[20:23], v[88:91], v[136:139]
    ds_read_b64_tr_b16 v[16:17], v192 offset:16384
    v_mfma_f32_16x16x32_bf16 v[140:143], v[20:23], v[92:95], v[140:143]
    ds_read_b64_tr_b16 v[18:19], v192 offset:17408
    s_waitcnt lgkmcnt(12)
    v_mfma_f32_16x16x32_bf16 v[144:147], v[24:27], v[88:91], v[144:147]
    ds_read_b64_tr_b16 v[20:21], v193 offset:16384
    buffer_load_dwordx4 v[72:75], v8, s[16:19], s68 offen offset:2048 sc1
    v_mfma_f32_16x16x32_bf16 v[148:151], v[24:27], v[92:95], v[148:151]
    ds_read_b64_tr_b16 v[22:23], v193 offset:17408
    s_waitcnt lgkmcnt(12)
    v_mfma_f32_16x16x32_bf16 v[152:155], v[28:31], v[88:91], v[152:155]
    ds_read_b64_tr_b16 v[24:25], v194 offset:16384
    v_mfma_f32_16x16x32_bf16 v[156:159], v[28:31], v[92:95], v[156:159]
    ds_read_b64_tr_b16 v[26:27], v194 offset:17408
    s_waitcnt lgkmcnt(12)
    v_mfma_f32_16x16x32_bf16 v[160:163], v[32:35], v[88:91], v[160:163]
    ds_read_b64_tr_b16 v[28:29], v195 offset:16384
    v_mfma_f32_16x16x32_bf16 v[164:167], v[32:35], v[92:95], v[164:167]
    ds_read_b64_tr_b16 v[30:31], v195 offset:17408
    s_waitcnt lgkmcnt(12)
    v_mfma_f32_16x16x32_bf16 v[168:171], v[36:39], v[88:91], v[168:171]
    ds_read_b64_tr_b16 v[32:33], v196 offset:16384
    v_mfma_f32_16x16x32_bf16 v[172:175], v[36:39], v[92:95], v[172:175]
    ds_read_b64_tr_b16 v[34:35], v196 offset:17408
    s_waitcnt vmcnt(9)
    v_max_u32 v200, v96, v100
    s_waitcnt lgkmcnt(12)
    v_mfma_f32_16x16x32_bf16 v[176:179], v[40:43], v[88:91], v[176:179]
    ds_read_b64_tr_b16 v[36:37], v197 offset:16384
    buffer_load_dwordx4 v[76:79], v8, s[16:19], s68 offen offset:2304 sc1
    s_add_u32 s68, s68, 4096
    v_cmp_eq_u32 vcc, -1, v200
    v_mfma_f32_16x16x32_bf16 v[180:183], v[40:43], v[92:95], v[180:183]
    ds_read_b64_tr_b16 v[38:39], v197 offset:17408
    s_waitcnt lgkmcnt(12)
    v_mfma_f32_16x16x32_bf16 v[184:187], v[44:47], v[88:91], v[184:187]
    ds_read_b64_tr_b16 v[40:41], v198 offset:16384
    s_cbranch_vccnz LadaLN_cond__grouped_kv_mqa__dense_activation_relu__prompt_kernel_ffb89
LadaLN_cond__grouped_kv_mqa__dense_activation_relu__prompt_kernel_fbk90:
    v_mfma_f32_16x16x32_bf16 v[188:191], v[44:47], v[92:95], v[188:191]
    ds_read_b64_tr_b16 v[42:43], v198 offset:17408
    s_waitcnt lgkmcnt(12)
    v_mfma_f32_16x16x32_bf16 v[128:131], v[16:19], v[96:99], v[128:131]
    ds_read_b64_tr_b16 v[44:45], v199 offset:16384
    v_mfma_f32_16x16x32_bf16 v[132:135], v[16:19], v[100:103], v[132:135]
    ds_read_b64_tr_b16 v[46:47], v199 offset:17408
    s_waitcnt lgkmcnt(12)
    v_mfma_f32_16x16x32_bf16 v[136:139], v[20:23], v[96:99], v[136:139]
    ds_read_b64_tr_b16 v[16:17], v192 offset:24576
    v_mfma_f32_16x16x32_bf16 v[140:143], v[20:23], v[100:103], v[140:143]
    ds_read_b64_tr_b16 v[18:19], v192 offset:25600
    s_waitcnt lgkmcnt(12)
    v_mfma_f32_16x16x32_bf16 v[144:147], v[24:27], v[96:99], v[144:147]
    ds_read_b64_tr_b16 v[20:21], v193 offset:24576
    buffer_load_dwordx4 v[80:83], v8, s[16:19], s68 offen offset:0 sc1
    v_mfma_f32_16x16x32_bf16 v[148:151], v[24:27], v[100:103], v[148:151]
    ds_read_b64_tr_b16 v[22:23], v193 offset:25600
    s_waitcnt lgkmcnt(12)
    v_mfma_f32_16x16x32_bf16 v[152:155], v[28:31], v[96:99], v[152:155]
    ds_read_b64_tr_b16 v[24:25], v194 offset:24576
    v_mfma_f32_16x16x32_bf16 v[156:159], v[28:31], v[100:103], v[156:159]
    ds_read_b64_tr_b16 v[26:27], v194 offset:25600
    s_branch LadaLN_cond__grouped_kv_mqa__dense_activation_relu__prompt_kernel_over12
LadaLN_cond__grouped_kv_mqa__dense_activation_relu__prompt_kernel_stub12:
    s_setpc_b64 s[96:97]
LadaLN_cond__grouped_kv_mqa__dense_activation_relu__prompt_kernel_over12:
    s_waitcnt lgkmcnt(12)
    v_mfma_f32_16x16x32_bf16 v[160:163], v[32:35], v[96:99], v[160:163]
    ds_read_b64_tr_b16 v[28:29], v195 offset:24576
    v_mfma_f32_16x16x32_bf16 v[164:167], v[32:35], v[100:103], v[164:167]
    ds_read_b64_tr_b16 v[30:31], v195 offset:25600
    s_waitcnt lgkmcnt(12)
    v_mfma_f32_16x16x32_bf16 v[168:171], v[36:39], v[96:99], v[168:171]
    ds_read_b64_tr_b16 v[32:33], v196 offset:24576
    v_mfma_f32_16x16x32_bf16 v[172:175], v[36:39], v[100:103], v[172:175]
    ds_read_b64_tr_b16 v[34:35], v196 offset:25600
    s_waitcnt vmcnt(9)
    v_max_u32 v200, v104, v108
    s_waitcnt lgkmcnt(12)
    v_mfma_f32_16x16x32_bf16 v[176:179], v[40:43], v[96:99], v[176:179]
    ds_read_b64_tr_b16 v[36:37], v197 offset:24576
    buffer_load_dwordx4 v[84:87], v8, s[16:19], s68 offen offset:256 sc1
    v_cmp_eq_u32 vcc, -1, v200
    v_mfma_f32_16x16x32_bf16 v[180:183], v[40:43], v[100:103], v[180:183]
    ds_read_b64_tr_b16 v[38:39], v197 offset:25600
    s_waitcnt lgkmcnt(12)
    v_mfma_f32_16x16x32_bf16 v[184:187], v[44:47], v[96:99], v[184:187]
    ds_read_b64_tr_b16 v[40:41], v198 offset:24576
    s_cbranch_vccnz LadaLN_cond__grouped_kv_mqa__dense_activation_relu__prompt_kernel_ffb91
LadaLN_cond__grouped_kv_mqa__dense_activation_relu__prompt_kernel_fbk92:
    v_mfma_f32_16x16x32_bf16 v[188:191], v[44:47], v[100:103], v[188:191]
    ds_read_b64_tr_b16 v[42:43], v198 offset:25600
    s_waitcnt lgkmcnt(12)
    v_mfma_f32_16x16x32_bf16 v[128:131], v[16:19], v[104:107], v[128:131]
    ds_read_b64_tr_b16 v[44:45], v199 offset:24576
    v_mfma_f32_16x16x32_bf16 v[132:135], v[16:19], v[108:111], v[132:135]
    ds_read_b64_tr_b16 v[46:47], v199 offset:25600
    s_waitcnt lgkmcnt(12)
    v_mfma_f32_16x16x32_bf16 v[136:139], v[20:23], v[104:107], v[136:139]
    ds_read_b64_tr_b16 v[16:17], v192 offset:32768
    v_mfma_f32_16x16x32_bf16 v[140:143], v[20:23], v[108:111], v[140:143]
    ds_read_b64_tr_b16 v[18:19], v192 offset:33792
    s_waitcnt lgkmcnt(12)
    v_mfma_f32_16x16x32_bf16 v[144:147], v[24:27], v[104:107], v[144:147]
    ds_read_b64_tr_b16 v[20:21], v193 offset:32768
    buffer_load_dwordx4 v[88:91], v8, s[16:19], s68 offen offset:2048 sc1
    v_mfma_f32_16x16x32_bf16 v[148:151], v[24:27], v[108:111], v[148:151]
    ds_read_b64_tr_b16 v[22:23], v193 offset:33792
    s_waitcnt lgkmcnt(12)
    v_mfma_f32_16x16x32_bf16 v[152:155], v[28:31], v[104:107], v[152:155]
    ds_read_b64_tr_b16 v[24:25], v194 offset:32768
    v_mfma_f32_16x16x32_bf16 v[156:159], v[28:31], v[108:111], v[156:159]
    ds_read_b64_tr_b16 v[26:27], v194 offset:33792
    s_waitcnt lgkmcnt(12)
    v_mfma_f32_16x16x32_bf16 v[160:163], v[32:35], v[104:107], v[160:163]
    ds_read_b64_tr_b16 v[28:29], v195 offset:32768
    v_mfma_f32_16x16x32_bf16 v[164:167], v[32:35], v[108:111], v[164:167]
    ds_read_b64_tr_b16 v[30:31], v195 offset:33792
    s_waitcnt lgkmcnt(12)
    v_mfma_f32_16x16x32_bf16 v[168:171], v[36:39], v[104:107], v[168:171]
    ds_read_b64_tr_b16 v[32:33], v196 offset:32768
    v_mfma_f32_16x16x32_bf16 v[172:175], v[36:39], v[108:111], v[172:175]
    ds_read_b64_tr_b16 v[34:35], v196 offset:33792
    s_waitcnt vmcnt(9)
    v_max_u32 v200, v48, v52
    s_waitcnt lgkmcnt(12)
    v_mfma_f32_16x16x32_bf16 v[176:179], v[40:43], v[104:107], v[176:179]
    ds_read_b64_tr_b16 v[36:37], v197 offset:32768
    buffer_load_dwordx4 v[92:95], v8, s[16:19], s68 offen offset:2304 sc1
    s_add_u32 s68, s68, 4096
    v_cmp_eq_u32 vcc, -1, v200
    v_mfma_f32_16x16x32_bf16 v[180:183], v[40:43], v[108:111], v[180:183]
    ds_read_b64_tr_b16 v[38:39], v197 offset:33792
    s_waitcnt lgkmcnt(12)
    v_mfma_f32_16x16x32_bf16 v[184:187], v[44:47], v[104:107], v[184:187]
    ds_read_b64_tr_b16 v[40:41], v198 offset:32768
    s_cbranch_vccnz LadaLN_cond__grouped_kv_mqa__dense_activation_relu__prompt_kernel_ffb93
LadaLN_cond__grouped_kv_mqa__dense_activation_relu__prompt_kernel_fbk94:
    v_mfma_f32_16x16x32_bf16 v[188:191], v[44:47], v[108:111], v[188:191]
    ds_read_b64_tr_b16 v[42:43], v198 offset:33792
    s_waitcnt lgkmcnt(12)
    v_mfma_f32_16x16x32_bf16 v[128:131], v[16:19], v[48:51], v[128:131]
    ds_read_b64_tr_b16 v[44:45], v199 offset:32768
    v_mfma_f32_16x16x32_bf16 v[132:135], v[16:19], v[52:55], v[132:135]
    ds_read_b64_tr_b16 v[46:47], v199 offset:33792
    s_waitcnt lgkmcnt(12)
    v_mfma_f32_16x16x32_bf16 v[136:139], v[20:23], v[48:51], v[136:139]
    s_barrier
LadaLN_cond__grouped_kv_mqa__dense_activation_relu__prompt_kernel_fb2:
    ds_read_b64_tr_b16 v[16:17], v192 offset:40960
    v_mfma_f32_16x16x32_bf16 v[140:143], v[20:23], v[52:55], v[140:143]
    ds_read_b64_tr_b16 v[18:19], v192 offset:41984
    s_waitcnt lgkmcnt(12)
    v_mfma_f32_16x16x32_bf16 v[144:147], v[24:27], v[48:51], v[144:147]
    ds_read_b64_tr_b16 v[20:21], v193 offset:40960
    buffer_load_dwordx4 v[96:99], v8, s[16:19], s68 offen offset:0 sc1
    v_mfma_f32_16x16x32_bf16 v[148:151], v[24:27], v[52:55], v[148:151]
    ds_read_b64_tr_b16 v[22:23], v193 offset:41984
    s_waitcnt lgkmcnt(12)
    v_mfma_f32_16x16x32_bf16 v[152:155], v[28:31], v[48:51], v[152:155]
    ds_read_b64_tr_b16 v[24:25], v194 offset:40960
    v_mfma_f32_16x16x32_bf16 v[156:159], v[28:31], v[52:55], v[156:159]
    ds_read_b64_tr_b16 v[26:27], v194 offset:41984
    s_waitcnt lgkmcnt(12)
    v_mfma_f32_16x16x32_bf16 v[160:163], v[32:35], v[48:51], v[160:163]
    ds_read_b64_tr_b16 v[28:29], v195 offset:40960
    v_mfma_f32_16x16x32_bf16 v[164:167], v[32:35], v[52:55], v[164:167]
    ds_read_b64_tr_b16 v[30:31], v195 offset:41984
    s_waitcnt lgkmcnt(12)
    v_mfma_f32_16x16x32_bf16 v[168:171], v[36:39], v[48:51], v[168:171]
    ds_read_b64_tr_b16 v[32:33], v196 offset:40960
    v_mfma_f32_16x16x32_bf16 v[172:175], v[36:39], v[52:55], v[172:175]
    ds_read_b64_tr_b16 v[34:35], v196 offset:41984
    s_waitcnt vmcnt(9)
    v_max_u32 v200, v56, v60
    s_waitcnt lgkmcnt(12)
    v_mfma_f32_16x16x32_bf16 v[176:179], v[40:43], v[48:51], v[176:179]
    ds_read_b64_tr_b16 v[36:37], v197 offset:40960
    buffer_load_dwordx4 v[100:103], v8, s[16:19], s68 offen offset:256 sc1
    v_cmp_eq_u32 vcc, -1, v200
    v_mfma_f32_16x16x32_bf16 v[180:183], v[40:43], v[52:55], v[180:183]
    ds_read_b64_tr_b16 v[38:39], v197 offset:41984
    s_waitcnt lgkmcnt(12)
    v_mfma_f32_16x16x32_bf16 v[184:187], v[44:47], v[48:51], v[184:187]
    ds_read_b64_tr_b16 v[40:41], v198 offset:40960
    s_cbranch_vccnz LadaLN_cond__grouped_kv_mqa__dense_activation_relu__prompt_kernel_ffb95
LadaLN_cond__grouped_kv_mqa__dense_activation_relu__prompt_kernel_fbk96:
    v_mfma_f32_16x16x32_bf16 v[188:191], v[44:47], v[52:55], v[188:191]
    ds_read_b64_tr_b16 v[42:43], v198 offset:41984
    s_waitcnt lgkmcnt(12)
    v_mfma_f32_16x16x32_bf16 v[128:131], v[16:19], v[56:59], v[128:131]
    ds_read_b64_tr_b16 v[44:45], v199 offset:40960
    v_mfma_f32_16x16x32_bf16 v[132:135], v[16:19], v[60:63], v[132:135]
    ds_read_b64_tr_b16 v[46:47], v199 offset:41984
    s_waitcnt lgkmcnt(12)
    v_mfma_f32_16x16x32_bf16 v[136:139], v[20:23], v[56:59], v[136:139]
    ds_read_b64_tr_b16 v[16:17], v192 offset:49152
    v_mfma_f32_16x16x32_bf16 v[140:143], v[20:23], v[60:63], v[140:143]
    ds_read_b64_tr_b16 v[18:19], v192 offset:50176
    s_waitcnt lgkmcnt(12)
    v_mfma_f32_16x16x32_bf16 v[144:147], v[24:27], v[56:59], v[144:147]
    ds_read_b64_tr_b16 v[20:21], v193 offset:49152
    buffer_load_dwordx4 v[104:107], v8, s[16:19], s68 offen offset:2048 sc1
    v_mfma_f32_16x16x32_bf16 v[148:151], v[24:27], v[60:63], v[148:151]
    ds_read_b64_tr_b16 v[22:23], v193 offset:50176
    s_waitcnt lgkmcnt(12)
    v_mfma_f32_16x16x32_bf16 v[152:155], v[28:31], v[56:59], v[152:155]
    ds_read_b64_tr_b16 v[24:25], v194 offset:49152
    v_mfma_f32_16x16x32_bf16 v[156:159], v[28:31], v[60:63], v[156:159]
    ds_read_b64_tr_b16 v[26:27], v194 offset:50176
    s_waitcnt lgkmcnt(12)
    v_mfma_f32_16x16x32_bf16 v[160:163], v[32:35], v[56:59], v[160:163]
    ds_read_b64_tr_b16 v[28:29], v195 offset:49152
    v_mfma_f32_16x16x32_bf16 v[164:167], v[32:35], v[60:63], v[164:167]
    ds_read_b64_tr_b16 v[30:31], v195 offset:50176
    s_waitcnt lgkmcnt(12)
    v_mfma_f32_16x16x32_bf16 v[168:171], v[36:39], v[56:59], v[168:171]
    ds_read_b64_tr_b16 v[32:33], v196 offset:49152
    v_mfma_f32_16x16x32_bf16 v[172:175], v[36:39], v[60:63], v[172:175]
    ds_read_b64_tr_b16 v[34:35], v196 offset:50176
    s_waitcnt vmcnt(9)
    v_max_u32 v200, v64, v68
    s_waitcnt lgkmcnt(12)
    v_mfma_f32_16x16x32_bf16 v[176:179], v[40:43], v[56:59], v[176:179]
    ds_read_b64_tr_b16 v[36:37], v197 offset:49152
    buffer_load_dwordx4 v[108:111], v8, s[16:19], s68 offen offset:2304 sc1
    s_add_u32 s68, s68, 4096
    v_cmp_eq_u32 vcc, -1, v200
    v_mfma_f32_16x16x32_bf16 v[180:183], v[40:43], v[60:63], v[180:183]
    ds_read_b64_tr_b16 v[38:39], v197 offset:50176
    s_waitcnt lgkmcnt(12)
    v_mfma_f32_16x16x32_bf16 v[184:187], v[44:47], v[56:59], v[184:187]
    ds_read_b64_tr_b16 v[40:41], v198 offset:49152
    s_cbranch_vccnz LadaLN_cond__grouped_kv_mqa__dense_activation_relu__prompt_kernel_ffb97
LadaLN_cond__grouped_kv_mqa__dense_activation_relu__prompt_kernel_fbk98:
    v_mfma_f32_16x16x32_bf16 v[188:191], v[44:47], v[60:63], v[188:191]
    ds_read_b64_tr_b16 v[42:43], v198 offset:50176
    s_waitcnt lgkmcnt(12)
    v_mfma_f32_16x16x32_bf16 v[128:131], v[16:19], v[64:67], v[128:131]
    ds_read_b64_tr_b16 v[44:45], v199 offset:49152
    v_mfma_f32_16x16x32_bf16 v[132:135], v[16:19], v[68:71], v[132:135]
    ds_read_b64_tr_b16 v[46:47], v199 offset:50176
    s_waitcnt lgkmcnt(12)
    v_mfma_f32_16x16x32_bf16 v[136:139], v[20:23], v[64:67], v[136:139]
    ds_read_b64_tr_b16 v[16:17], v192 offset:57344
    v_mfma_f32_16x16x32_bf16 v[140:143], v[20:23], v[68:71], v[140:143]
    ds_read_b64_tr_b16 v[18:19], v192 offset:58368
    s_waitcnt lgkmcnt(12)
    v_mfma_f32_16x16x32_bf16 v[144:147], v[24:27], v[64:67], v[144:147]
    ds_read_b64_tr_b16 v[20:21], v193 offset:57344
    buffer_load_dwordx4 v[48:51], v8, s[16:19], s68 offen offset:0 sc1
    v_mfma_f32_16x16x32_bf16 v[148:151], v[24:27], v[68:71], v[148:151]
    ds_read_b64_tr_b16 v[22:23], v193 offset:58368
    s_waitcnt lgkmcnt(12)
    v_mfma_f32_16x16x32_bf16 v[152:155], v[28:31], v[64:67], v[152:155]
    ds_read_b64_tr_b16 v[24:25], v194 offset:57344
    v_mfma_f32_16x16x32_bf16 v[156:159], v[28:31], v[68:71], v[156:159]
    ds_read_b64_tr_b16 v[26:27], v194 offset:58368
    s_waitcnt lgkmcnt(12)
    v_mfma_f32_16x16x32_bf16 v[160:163], v[32:35], v[64:67], v[160:163]
    ds_read_b64_tr_b16 v[28:29], v195 offset:57344
    v_mfma_f32_16x16x32_bf16 v[164:167], v[32:35], v[68:71], v[164:167]
    ds_read_b64_tr_b16 v[30:31], v195 offset:58368
    s_waitcnt lgkmcnt(12)
    v_mfma_f32_16x16x32_bf16 v[168:171], v[36:39], v[64:67], v[168:171]
    ds_read_b64_tr_b16 v[32:33], v196 offset:57344
    v_mfma_f32_16x16x32_bf16 v[172:175], v[36:39], v[68:71], v[172:175]
    ds_read_b64_tr_b16 v[34:35], v196 offset:58368
    s_waitcnt vmcnt(9)
    v_max_u32 v200, v72, v76
    s_waitcnt lgkmcnt(12)
    v_mfma_f32_16x16x32_bf16 v[176:179], v[40:43], v[64:67], v[176:179]
    ds_read_b64_tr_b16 v[36:37], v197 offset:57344
    buffer_load_dwordx4 v[52:55], v8, s[16:19], s68 offen offset:256 sc1
    v_cmp_eq_u32 vcc, -1, v200
    v_mfma_f32_16x16x32_bf16 v[180:183], v[40:43], v[68:71], v[180:183]
    ds_read_b64_tr_b16 v[38:39], v197 offset:58368
    s_waitcnt lgkmcnt(12)
    v_mfma_f32_16x16x32_bf16 v[184:187], v[44:47], v[64:67], v[184:187]
    ds_read_b64_tr_b16 v[40:41], v198 offset:57344
    s_cbranch_vccnz LadaLN_cond__grouped_kv_mqa__dense_activation_relu__prompt_kernel_ffb99
LadaLN_cond__grouped_kv_mqa__dense_activation_relu__prompt_kernel_fbk100:
    v_mfma_f32_16x16x32_bf16 v[188:191], v[44:47], v[68:71], v[188:191]
    ds_read_b64_tr_b16 v[42:43], v198 offset:58368
    s_waitcnt lgkmcnt(12)
    v_mfma_f32_16x16x32_bf16 v[128:131], v[16:19], v[72:75], v[128:131]
    ds_read_b64_tr_b16 v[44:45], v199 offset:57344
    v_mfma_f32_16x16x32_bf16 v[132:135], v[16:19], v[76:79], v[132:135]
    ds_read_b64_tr_b16 v[46:47], v199 offset:58368
    s_waitcnt lgkmcnt(12)
    v_mfma_f32_16x16x32_bf16 v[136:139], v[20:23], v[72:75], v[136:139]
    v_add_u32 v192, 0x10000, v192
    v_add_u32 v193, 0x10000, v193
    v_add_u32 v194, 0x10000, v194
    v_add_u32 v195, 0x10000, v195
    v_add_u32 v196, 0x10000, v196
    v_add_u32 v197, 0x10000, v197
    v_add_u32 v198, 0x10000, v198
    v_add_u32 v199, 0x10000, v199
    ds_read_b64_tr_b16 v[16:17], v192 offset:0
    v_mfma_f32_16x16x32_bf16 v[140:143], v[20:23], v[76:79], v[140:143]
    ds_read_b64_tr_b16 v[18:19], v192 offset:1024
    s_waitcnt lgkmcnt(12)
    v_mfma_f32_16x16x32_bf16 v[144:147], v[24:27], v[72:75], v[144:147]
    ds_read_b64_tr_b16 v[20:21], v193 offset:0
    buffer_load_dwordx4 v[56:59], v8, s[16:19], s68 offen offset:2048 sc1
    v_mfma_f32_16x16x32_bf16 v[148:151], v[24:27], v[76:79], v[148:151]
    ds_read_b64_tr_b16 v[22:23], v193 offset:1024
    s_waitcnt lgkmcnt(12)
    v_mfma_f32_16x16x32_bf16 v[152:155], v[28:31], v[72:75], v[152:155]
    ds_read_b64_tr_b16 v[24:25], v194 offset:0
    v_mfma_f32_16x16x32_bf16 v[156:159], v[28:31], v[76:79], v[156:159]
    ds_read_b64_tr_b16 v[26:27], v194 offset:1024
    s_waitcnt lgkmcnt(12)
    v_mfma_f32_16x16x32_bf16 v[160:163], v[32:35], v[72:75], v[160:163]
    ds_read_b64_tr_b16 v[28:29], v195 offset:0
    v_mfma_f32_16x16x32_bf16 v[164:167], v[32:35], v[76:79], v[164:167]
    ds_read_b64_tr_b16 v[30:31], v195 offset:1024
    s_waitcnt lgkmcnt(12)
    v_mfma_f32_16x16x32_bf16 v[168:171], v[36:39], v[72:75], v[168:171]
    ds_read_b64_tr_b16 v[32:33], v196 offset:0
    v_mfma_f32_16x16x32_bf16 v[172:175], v[36:39], v[76:79], v[172:175]
    ds_read_b64_tr_b16 v[34:35], v196 offset:1024
    s_waitcnt vmcnt(9)
    v_max_u32 v200, v80, v84
    s_waitcnt lgkmcnt(12)
    v_mfma_f32_16x16x32_bf16 v[176:179], v[40:43], v[72:75], v[176:179]
    ds_read_b64_tr_b16 v[36:37], v197 offset:0
    buffer_load_dwordx4 v[60:63], v8, s[16:19], s68 offen offset:2304 sc1
    s_add_u32 s68, s68, 4096
    v_cmp_eq_u32 vcc, -1, v200
    v_mfma_f32_16x16x32_bf16 v[180:183], v[40:43], v[76:79], v[180:183]
    ds_read_b64_tr_b16 v[38:39], v197 offset:1024
    s_waitcnt lgkmcnt(12)
    v_mfma_f32_16x16x32_bf16 v[184:187], v[44:47], v[72:75], v[184:187]
    ds_read_b64_tr_b16 v[40:41], v198 offset:0
    s_cbranch_vccnz LadaLN_cond__grouped_kv_mqa__dense_activation_relu__prompt_kernel_ffb101
LadaLN_cond__grouped_kv_mqa__dense_activation_relu__prompt_kernel_fbk102:
    v_mfma_f32_16x16x32_bf16 v[188:191], v[44:47], v[76:79], v[188:191]
    ds_read_b64_tr_b16 v[42:43], v198 offset:1024
    s_waitcnt lgkmcnt(12)
    v_mfma_f32_16x16x32_bf16 v[128:131], v[16:19], v[80:83], v[128:131]
    ds_read_b64_tr_b16 v[44:45], v199 offset:0
    v_mfma_f32_16x16x32_bf16 v[132:135], v[16:19], v[84:87], v[132:135]
    ds_read_b64_tr_b16 v[46:47], v199 offset:1024
    s_waitcnt lgkmcnt(12)
    v_mfma_f32_16x16x32_bf16 v[136:139], v[20:23], v[80:83], v[136:139]
    s_barrier
LadaLN_cond__grouped_kv_mqa__dense_activation_relu__prompt_kernel_fb3:
    ds_read_b64_tr_b16 v[16:17], v192 offset:8192
    v_mfma_f32_16x16x32_bf16 v[140:143], v[20:23], v[84:87], v[140:143]
    ds_read_b64_tr_b16 v[18:19], v192 offset:9216
    s_waitcnt lgkmcnt(12)
    v_mfma_f32_16x16x32_bf16 v[144:147], v[24:27], v[80:83], v[144:147]
    ds_read_b64_tr_b16 v[20:21], v193 offset:8192
    buffer_load_dwordx4 v[64:67], v8, s[16:19], s68 offen offset:0 sc1
    v_mfma_f32_16x16x32_bf16 v[148:151], v[24:27], v[84:87], v[148:151]
    ds_read_b64_tr_b16 v[22:23], v193 offset:9216
    s_waitcnt lgkmcnt(12)
    v_mfma_f32_16x16x32_bf16 v[152:155], v[28:31], v[80:83], v[152:155]
    ds_read_b64_tr_b16 v[24:25], v194 offset:8192
    v_mfma_f32_16x16x32_bf16 v[156:159], v[28:31], v[84:87], v[156:159]
    ds_read_b64_tr_b16 v[26:27], v194 offset:9216
    s_waitcnt lgkmcnt(12)
    v_mfma_f32_16x16x32_bf16 v[160:163], v[32:35], v[80:83], v[160:163]
    ds_read_b64_tr_b16 v[28:29], v195 offset:8192
    v_mfma_f32_16x16x32_bf16 v[164:167], v[32:35], v[84:87], v[164:167]
    ds_read_b64_tr_b16 v[30:31], v195 offset:9216
    s_waitcnt lgkmcnt(12)
    v_mfma_f32_16x16x32_bf16 v[168:171], v[36:39], v[80:83], v[168:171]
    ds_read_b64_tr_b16 v[32:33], v196 offset:8192
    v_mfma_f32_16x16x32_bf16 v[172:175], v[36:39], v[84:87], v[172:175]
    ds_read_b64_tr_b16 v[34:35], v196 offset:9216
    s_waitcnt vmcnt(9)
    v_max_u32 v200, v88, v92
    s_waitcnt lgkmcnt(12)
    v_mfma_f32_16x16x32_bf16 v[176:179], v[40:43], v[80:83], v[176:179]
    ds_read_b64_tr_b16 v[36:37], v197 offset:8192
    buffer_load_dwordx4 v[68:71], v8, s[16:19], s68 offen offset:256 sc1
    v_cmp_eq_u32 vcc, -1, v200
    v_mfma_f32_16x16x32_bf16 v[180:183], v[40:43], v[84:87], v[180:183]
    ds_read_b64_tr_b16 v[38:39], v197 offset:9216
    s_waitcnt lgkmcnt(12)
    v_mfma_f32_16x16x32_bf16 v[184:187], v[44:47], v[80:83], v[184:187]
    ds_read_b64_tr_b16 v[40:41], v198 offset:8192
    s_cbranch_vccnz LadaLN_cond__grouped_kv_mqa__dense_activation_relu__prompt_kernel_ffb103
LadaLN_cond__grouped_kv_mqa__dense_activation_relu__prompt_kernel_fbk104:
    v_mfma_f32_16x16x32_bf16 v[188:191], v[44:47], v[84:87], v[188:191]
    ds_read_b64_tr_b16 v[42:43], v198 offset:9216
    s_waitcnt lgkmcnt(12)
    v_mfma_f32_16x16x32_bf16 v[128:131], v[16:19], v[88:91], v[128:131]
    ds_read_b64_tr_b16 v[44:45], v199 offset:8192
    v_mfma_f32_16x16x32_bf16 v[132:135], v[16:19], v[92:95], v[132:135]
    ds_read_b64_tr_b16 v[46:47], v199 offset:9216
    s_waitcnt lgkmcnt(12)
    v_mfma_f32_16x16x32_bf16 v[136:139], v[20:23], v[88:91], v[136:139]
    ds_read_b64_tr_b16 v[16:17], v192 offset:16384
    v_mfma_f32_16x16x32_bf16 v[140:143], v[20:23], v[92:95], v[140:143]
    ds_read_b64_tr_b16 v[18:19], v192 offset:17408
    s_waitcnt lgkmcnt(12)
    v_mfma_f32_16x16x32_bf16 v[144:147], v[24:27], v[88:91], v[144:147]
    ds_read_b64_tr_b16 v[20:21], v193 offset:16384
    buffer_load_dwordx4 v[72:75], v8, s[16:19], s68 offen offset:2048 sc1
    v_mfma_f32_16x16x32_bf16 v[148:151], v[24:27], v[92:95], v[148:151]
    ds_read_b64_tr_b16 v[22:23], v193 offset:17408
    s_waitcnt lgkmcnt(12)
    v_mfma_f32_16x16x32_bf16 v[152:155], v[28:31], v[88:91], v[152:155]
    ds_read_b64_tr_b16 v[24:25], v194 offset:16384
    v_mfma_f32_16x16x32_bf16 v[156:159], v[28:31], v[92:95], v[156:159]
    ds_read_b64_tr_b16 v[26:27], v194 offset:17408
    s_waitcnt lgkmcnt(12)
    v_mfma_f32_16x16x32_bf16 v[160:163], v[32:35], v[88:91], v[160:163]
    ds_read_b64_tr_b16 v[28:29], v195 offset:16384
    v_mfma_f32_16x16x32_bf16 v[164:167], v[32:35], v[92:95], v[164:167]
    ds_read_b64_tr_b16 v[30:31], v195 offset:17408
    s_waitcnt lgkmcnt(12)
    v_mfma_f32_16x16x32_bf16 v[168:171], v[36:39], v[88:91], v[168:171]
    ds_read_b64_tr_b16 v[32:33], v196 offset:16384
    v_mfma_f32_16x16x32_bf16 v[172:175], v[36:39], v[92:95], v[172:175]
    ds_read_b64_tr_b16 v[34:35], v196 offset:17408
    s_waitcnt lgkmcnt(12)
    v_mfma_f32_16x16x32_bf16 v[176:179], v[40:43], v[88:91], v[176:179]
    ds_read_b64_tr_b16 v[36:37], v197 offset:16384
    buffer_load_dwordx4 v[76:79], v8, s[16:19], s68 offen offset:2304 sc1
    s_add_u32 s68, s68, 4096
    v_mfma_f32_16x16x32_bf16 v[180:183], v[40:43], v[92:95], v[180:183]
    ds_read_b64_tr_b16 v[38:39], v197 offset:17408
    s_waitcnt lgkmcnt(12)
    v_mfma_f32_16x16x32_bf16 v[184:187], v[44:47], v[88:91], v[184:187]
    ds_read_b64_tr_b16 v[40:41], v198 offset:16384
    v_mfma_f32_16x16x32_bf16 v[188:191], v[44:47], v[92:95], v[188:191]
    ds_read_b64_tr_b16 v[42:43], v198 offset:17408
    s_waitcnt vmcnt(10)
    s_waitcnt lgkmcnt(12)
    v_mfma_f32_16x16x32_bf16 v[128:131], v[16:19], v[96:99], v[128:131]
    ds_read_b64_tr_b16 v[44:45], v199 offset:16384
    v_mfma_f32_16x16x32_bf16 v[132:135], v[16:19], v[100:103], v[132:135]
    ds_read_b64_tr_b16 v[46:47], v199 offset:17408
    s_waitcnt lgkmcnt(12)
    v_mfma_f32_16x16x32_bf16 v[136:139], v[20:23], v[96:99], v[136:139]
    ds_read_b64_tr_b16 v[16:17], v192 offset:24576
    v_mfma_f32_16x16x32_bf16 v[140:143], v[20:23], v[100:103], v[140:143]
    ds_read_b64_tr_b16 v[18:19], v192 offset:25600
    s_waitcnt lgkmcnt(12)
    v_mfma_f32_16x16x32_bf16 v[144:147], v[24:27], v[96:99], v[144:147]
    ds_read_b64_tr_b16 v[20:21], v193 offset:24576
    buffer_load_dwordx4 v[80:83], v8, s[16:19], s68 offen offset:0 sc1
    v_mfma_f32_16x16x32_bf16 v[148:151], v[24:27], v[100:103], v[148:151]
    ds_read_b64_tr_b16 v[22:23], v193 offset:25600
    s_waitcnt lgkmcnt(12)
    v_mfma_f32_16x16x32_bf16 v[152:155], v[28:31], v[96:99], v[152:155]
    ds_read_b64_tr_b16 v[24:25], v194 offset:24576
    v_mfma_f32_16x16x32_bf16 v[156:159], v[28:31], v[100:103], v[156:159]
    ds_read_b64_tr_b16 v[26:27], v194 offset:25600
    s_waitcnt lgkmcnt(12)
    v_mfma_f32_16x16x32_bf16 v[160:163], v[32:35], v[96:99], v[160:163]
    ds_read_b64_tr_b16 v[28:29], v195 offset:24576
    v_mfma_f32_16x16x32_bf16 v[164:167], v[32:35], v[100:103], v[164:167]
    ds_read_b64_tr_b16 v[30:31], v195 offset:25600
    s_waitcnt lgkmcnt(12)
    v_mfma_f32_16x16x32_bf16 v[168:171], v[36:39], v[96:99], v[168:171]
    ds_read_b64_tr_b16 v[32:33], v196 offset:24576
    v_mfma_f32_16x16x32_bf16 v[172:175], v[36:39], v[100:103], v[172:175]
    ds_read_b64_tr_b16 v[34:35], v196 offset:25600
    s_waitcnt lgkmcnt(12)
    v_mfma_f32_16x16x32_bf16 v[176:179], v[40:43], v[96:99], v[176:179]
    ds_read_b64_tr_b16 v[36:37], v197 offset:24576
    buffer_load_dwordx4 v[84:87], v8, s[16:19], s68 offen offset:256 sc1
    v_mfma_f32_16x16x32_bf16 v[180:183], v[40:43], v[100:103], v[180:183]
    ds_read_b64_tr_b16 v[38:39], v197 offset:25600
    s_waitcnt lgkmcnt(12)
    v_mfma_f32_16x16x32_bf16 v[184:187], v[44:47], v[96:99], v[184:187]
    ds_read_b64_tr_b16 v[40:41], v198 offset:24576
    v_mfma_f32_16x16x32_bf16 v[188:191], v[44:47], v[100:103], v[188:191]
    ds_read_b64_tr_b16 v[42:43], v198 offset:25600
    s_waitcnt vmcnt(10)
    s_waitcnt lgkmcnt(12)
    v_mfma_f32_16x16x32_bf16 v[128:131], v[16:19], v[104:107], v[128:131]
    ds_read_b64_tr_b16 v[44:45], v199 offset:24576
    v_mfma_f32_16x16x32_bf16 v[132:135], v[16:19], v[108:111], v[132:135]
    ds_read_b64_tr_b16 v[46:47], v199 offset:25600
    s_waitcnt lgkmcnt(12)
    v_mfma_f32_16x16x32_bf16 v[136:139], v[20:23], v[104:107], v[136:139]
    ds_read_b64_tr_b16 v[16:17], v192 offset:32768
    v_mfma_f32_16x16x32_bf16 v[140:143], v[20:23], v[108:111], v[140:143]
    ds_read_b64_tr_b16 v[18:19], v192 offset:33792
    s_waitcnt lgkmcnt(12)
    v_mfma_f32_16x16x32_bf16 v[144:147], v[24:27], v[104:107], v[144:147]
    ds_read_b64_tr_b16 v[20:21], v193 offset:32768
    buffer_load_dwordx4 v[88:91], v8, s[16:19], s68 offen offset:2048 sc1
    v_mfma_f32_16x16x32_bf16 v[148:151], v[24:27], v[108:111], v[148:151]
    ds_read_b64_tr_b16 v[22:23], v193 offset:33792
    s_waitcnt lgkmcnt(12)
    v_mfma_f32_16x16x32_bf16 v[152:155], v[28:31], v[104:107], v[152:155]
    ds_read_b64_tr_b16 v[24:25], v194 offset:32768
    v_mfma_f32_16x16x32_bf16 v[156:159], v[28:31], v[108:111], v[156:159]
    ds_read_b64_tr_b16 v[26:27], v194 offset:33792
    s_waitcnt lgkmcnt(12)
    v_mfma_f32_16x16x32_bf16 v[160:163], v[32:35], v[104:107], v[160:163]
    ds_read_b64_tr_b16 v[28:29], v195 offset:32768
    v_mfma_f32_16x16x32_bf16 v[164:167], v[32:35], v[108:111], v[164:167]
    ds_read_b64_tr_b16 v[30:31], v195 offset:33792
    s_waitcnt lgkmcnt(12)
    v_mfma_f32_16x16x32_bf16 v[168:171], v[36:39], v[104:107], v[168:171]
    ds_read_b64_tr_b16 v[32:33], v196 offset:32768
    v_mfma_f32_16x16x32_bf16 v[172:175], v[36:39], v[108:111], v[172:175]
    ds_read_b64_tr_b16 v[34:35], v196 offset:33792
    s_waitcnt lgkmcnt(12)
    v_mfma_f32_16x16x32_bf16 v[176:179], v[40:43], v[104:107], v[176:179]
    ds_read_b64_tr_b16 v[36:37], v197 offset:32768
    buffer_load_dwordx4 v[92:95], v8, s[16:19], s68 offen offset:2304 sc1
    s_add_u32 s68, s68, 4096
    v_mfma_f32_16x16x32_bf16 v[180:183], v[40:43], v[108:111], v[180:183]
    ds_read_b64_tr_b16 v[38:39], v197 offset:33792
    s_waitcnt lgkmcnt(12)
    v_mfma_f32_16x16x32_bf16 v[184:187], v[44:47], v[104:107], v[184:187]
    ds_read_b64_tr_b16 v[40:41], v198 offset:32768
    v_mfma_f32_16x16x32_bf16 v[188:191], v[44:47], v[108:111], v[188:191]
    ds_read_b64_tr_b16 v[42:43], v198 offset:33792
    s_waitcnt vmcnt(10)
    s_waitcnt lgkmcnt(12)
    v_mfma_f32_16x16x32_bf16 v[128:131], v[16:19], v[48:51], v[128:131]
    ds_read_b64_tr_b16 v[44:45], v199 offset:32768
    v_mfma_f32_16x16x32_bf16 v[132:135], v[16:19], v[52:55], v[132:135]
    ds_read_b64_tr_b16 v[46:47], v199 offset:33792
    s_waitcnt lgkmcnt(12)
    v_mfma_f32_16x16x32_bf16 v[136:139], v[20:23], v[48:51], v[136:139]
    s_barrier
LadaLN_cond__grouped_kv_mqa__dense_activation_relu__prompt_kernel_fb4:
    ds_read_b64_tr_b16 v[16:17], v192 offset:40960
    v_mfma_f32_16x16x32_bf16 v[140:143], v[20:23], v[52:55], v[140:143]
    ds_read_b64_tr_b16 v[18:19], v192 offset:41984
    s_waitcnt lgkmcnt(12)
    v_mfma_f32_16x16x32_bf16 v[144:147], v[24:27], v[48:51], v[144:147]
    ds_read_b64_tr_b16 v[20:21], v193 offset:40960
    buffer_load_dwordx4 v[96:99], v8, s[16:19], s68 offen offset:0 sc1
    v_mfma_f32_16x16x32_bf16 v[148:151], v[24:27], v[52:55], v[148:151]
    ds_read_b64_tr_b16 v[22:23], v193 offset:41984
    s_waitcnt lgkmcnt(12)
    v_mfma_f32_16x16x32_bf16 v[152:155], v[28:31], v[48:51], v[152:155]
    ds_read_b64_tr_b16 v[24:25], v194 offset:40960
    v_mfma_f32_16x16x32_bf16 v[156:159], v[28:31], v[52:55], v[156:159]
    ds_read_b64_tr_b16 v[26:27], v194 offset:41984
    s_waitcnt lgkmcnt(12)
    v_mfma_f32_16x16x32_bf16 v[160:163], v[32:35], v[48:51], v[160:163]
    ds_read_b64_tr_b16 v[28:29], v195 offset:40960
    v_mfma_f32_16x16x32_bf16 v[164:167], v[32:35], v[52:55], v[164:167]
    ds_read_b64_tr_b16 v[30:31], v195 offset:41984
    s_waitcnt lgkmcnt(12)
    v_mfma_f32_16x16x32_bf16 v[168:171], v[36:39], v[48:51], v[168:171]
    ds_read_b64_tr_b16 v[32:33], v196 offset:40960
    v_mfma_f32_16x16x32_bf16 v[172:175], v[36:39], v[52:55], v[172:175]
    ds_read_b64_tr_b16 v[34:35], v196 offset:41984
    s_waitcnt lgkmcnt(12)
    v_mfma_f32_16x16x32_bf16 v[176:179], v[40:43], v[48:51], v[176:179]
    ds_read_b64_tr_b16 v[36:37], v197 offset:40960
    buffer_load_dwordx4 v[100:103], v8, s[16:19], s68 offen offset:256 sc1
    v_mfma_f32_16x16x32_bf16 v[180:183], v[40:43], v[52:55], v[180:183]
    ds_read_b64_tr_b16 v[38:39], v197 offset:41984
    s_waitcnt lgkmcnt(12)
    v_mfma_f32_16x16x32_bf16 v[184:187], v[44:47], v[48:51], v[184:187]
    ds_read_b64_tr_b16 v[40:41], v198 offset:40960
    v_mfma_f32_16x16x32_bf16 v[188:191], v[44:47], v[52:55], v[188:191]
    ds_read_b64_tr_b16 v[42:43], v198 offset:41984
    s_waitcnt vmcnt(10)
    s_waitcnt lgkmcnt(12)
    v_mfma_f32_16x16x32_bf16 v[128:131], v[16:19], v[56:59], v[128:131]
    ds_read_b64_tr_b16 v[44:45], v199 offset:40960
    v_mfma_f32_16x16x32_bf16 v[132:135], v[16:19], v[60:63], v[132:135]
    ds_read_b64_tr_b16 v[46:47], v199 offset:41984
    s_waitcnt lgkmcnt(12)
    v_mfma_f32_16x16x32_bf16 v[136:139], v[20:23], v[56:59], v[136:139]
    ds_read_b64_tr_b16 v[16:17], v192 offset:49152
    v_mfma_f32_16x16x32_bf16 v[140:143], v[20:23], v[60:63], v[140:143]
    ds_read_b64_tr_b16 v[18:19], v192 offset:50176
    s_waitcnt lgkmcnt(12)
    v_mfma_f32_16x16x32_bf16 v[144:147], v[24:27], v[56:59], v[144:147]
    ds_read_b64_tr_b16 v[20:21], v193 offset:49152
    buffer_load_dwordx4 v[104:107], v8, s[16:19], s68 offen offset:2048 sc1
    v_mfma_f32_16x16x32_bf16 v[148:151], v[24:27], v[60:63], v[148:151]
    ds_read_b64_tr_b16 v[22:23], v193 offset:50176
    s_waitcnt lgkmcnt(12)
    v_mfma_f32_16x16x32_bf16 v[152:155], v[28:31], v[56:59], v[152:155]
    ds_read_b64_tr_b16 v[24:25], v194 offset:49152
    v_mfma_f32_16x16x32_bf16 v[156:159], v[28:31], v[60:63], v[156:159]
    ds_read_b64_tr_b16 v[26:27], v194 offset:50176
    s_waitcnt lgkmcnt(12)
    v_mfma_f32_16x16x32_bf16 v[160:163], v[32:35], v[56:59], v[160:163]
    ds_read_b64_tr_b16 v[28:29], v195 offset:49152
    v_mfma_f32_16x16x32_bf16 v[164:167], v[32:35], v[60:63], v[164:167]
    ds_read_b64_tr_b16 v[30:31], v195 offset:50176
    s_waitcnt lgkmcnt(12)
    v_mfma_f32_16x16x32_bf16 v[168:171], v[36:39], v[56:59], v[168:171]
    ds_read_b64_tr_b16 v[32:33], v196 offset:49152
    v_mfma_f32_16x16x32_bf16 v[172:175], v[36:39], v[60:63], v[172:175]
    ds_read_b64_tr_b16 v[34:35], v196 offset:50176
    s_waitcnt lgkmcnt(12)
    v_mfma_f32_16x16x32_bf16 v[176:179], v[40:43], v[56:59], v[176:179]
    ds_read_b64_tr_b16 v[36:37], v197 offset:49152
    buffer_load_dwordx4 v[108:111], v8, s[16:19], s68 offen offset:2304 sc1
    s_add_u32 s68, s68, 4096
    v_mfma_f32_16x16x32_bf16 v[180:183], v[40:43], v[60:63], v[180:183]
    ds_read_b64_tr_b16 v[38:39], v197 offset:50176
    s_waitcnt lgkmcnt(12)
    v_mfma_f32_16x16x32_bf16 v[184:187], v[44:47], v[56:59], v[184:187]
    ds_read_b64_tr_b16 v[40:41], v198 offset:49152
    v_mfma_f32_16x16x32_bf16 v[188:191], v[44:47], v[60:63], v[188:191]
    ds_read_b64_tr_b16 v[42:43], v198 offset:50176
    s_waitcnt vmcnt(10)
    s_waitcnt lgkmcnt(12)
    v_mfma_f32_16x16x32_bf16 v[128:131], v[16:19], v[64:67], v[128:131]
    ds_read_b64_tr_b16 v[44:45], v199 offset:49152
    v_mfma_f32_16x16x32_bf16 v[132:135], v[16:19], v[68:71], v[132:135]
    ds_read_b64_tr_b16 v[46:47], v199 offset:50176
    s_waitcnt lgkmcnt(12)
    v_mfma_f32_16x16x32_bf16 v[136:139], v[20:23], v[64:67], v[136:139]
    ds_read_b64_tr_b16 v[16:17], v192 offset:57344
    v_mfma_f32_16x16x32_bf16 v[140:143], v[20:23], v[68:71], v[140:143]
    ds_read_b64_tr_b16 v[18:19], v192 offset:58368
    s_waitcnt lgkmcnt(12)
    v_mfma_f32_16x16x32_bf16 v[144:147], v[24:27], v[64:67], v[144:147]
    ds_read_b64_tr_b16 v[20:21], v193 offset:57344
    buffer_load_dwordx4 v[48:51], v8, s[16:19], s68 offen offset:0 sc1
    v_mfma_f32_16x16x32_bf16 v[148:151], v[24:27], v[68:71], v[148:151]
    ds_read_b64_tr_b16 v[22:23], v193 offset:58368
    s_waitcnt lgkmcnt(12)
    v_mfma_f32_16x16x32_bf16 v[152:155], v[28:31], v[64:67], v[152:155]
    ds_read_b64_tr_b16 v[24:25], v194 offset:57344
    v_mfma_f32_16x16x32_bf16 v[156:159], v[28:31], v[68:71], v[156:159]
    ds_read_b64_tr_b16 v[26:27], v194 offset:58368
    s_waitcnt lgkmcnt(12)
    v_mfma_f32_16x16x32_bf16 v[160:163], v[32:35], v[64:67], v[160:163]
    ds_read_b64_tr_b16 v[28:29], v195 offset:57344
    v_mfma_f32_16x16x32_bf16 v[164:167], v[32:35], v[68:71], v[164:167]
    ds_read_b64_tr_b16 v[30:31], v195 offset:58368
    s_waitcnt lgkmcnt(12)
    v_mfma_f32_16x16x32_bf16 v[168:171], v[36:39], v[64:67], v[168:171]
    ds_read_b64_tr_b16 v[32:33], v196 offset:57344
    v_mfma_f32_16x16x32_bf16 v[172:175], v[36:39], v[68:71], v[172:175]
    ds_read_b64_tr_b16 v[34:35], v196 offset:58368
    s_waitcnt lgkmcnt(12)
    v_mfma_f32_16x16x32_bf16 v[176:179], v[40:43], v[64:67], v[176:179]
    ds_read_b64_tr_b16 v[36:37], v197 offset:57344
    buffer_load_dwordx4 v[52:55], v8, s[16:19], s68 offen offset:256 sc1
    v_mfma_f32_16x16x32_bf16 v[180:183], v[40:43], v[68:71], v[180:183]
    ds_read_b64_tr_b16 v[38:39], v197 offset:58368
    s_waitcnt lgkmcnt(12)
    v_mfma_f32_16x16x32_bf16 v[184:187], v[44:47], v[64:67], v[184:187]
    ds_read_b64_tr_b16 v[40:41], v198 offset:57344
    v_mfma_f32_16x16x32_bf16 v[188:191], v[44:47], v[68:71], v[188:191]
    ds_read_b64_tr_b16 v[42:43], v198 offset:58368
    s_waitcnt vmcnt(10)
    s_waitcnt lgkmcnt(12)
    v_mfma_f32_16x16x32_bf16 v[128:131], v[16:19], v[72:75], v[128:131]
    ds_read_b64_tr_b16 v[44:45], v199 offset:57344
    v_mfma_f32_16x16x32_bf16 v[132:135], v[16:19], v[76:79], v[132:135]
    s_branch LadaLN_cond__grouped_kv_mqa__dense_activation_relu__prompt_kernel_over13
LadaLN_cond__grouped_kv_mqa__dense_activation_relu__prompt_kernel_stub13:
    s_setpc_b64 s[96:97]
LadaLN_cond__grouped_kv_mqa__dense_activation_relu__prompt_kernel_over13:
    ds_read_b64_tr_b16 v[46:47], v199 offset:58368
    s_waitcnt lgkmcnt(12)
    v_mfma_f32_16x16x32_bf16 v[136:139], v[20:23], v[72:75], v[136:139]
    v_add_u32 v192, 0x10000, v192
    v_add_u32 v193, 0x10000, v193
    v_add_u32 v194, 0x10000, v194
    v_add_u32 v195, 0x10000, v195
    v_add_u32 v196, 0x10000, v196
    v_add_u32 v197, 0x10000, v197
    v_add_u32 v198, 0x10000, v198
    v_add_u32 v199, 0x10000, v199
    ds_read_b64_tr_b16 v[16:17], v192 offset:0
    v_mfma_f32_16x16x32_bf16 v[140:143], v[20:23], v[76:79], v[140:143]
    ds_read_b64_tr_b16 v[18:19], v192 offset:1024
    s_waitcnt lgkmcnt(12)
    v_mfma_f32_16x16x32_bf16 v[144:147], v[24:27], v[72:75], v[144:147]
    ds_read_b64_tr_b16 v[20:21], v193 offset:0
    buffer_load_dwordx4 v[56:59], v8, s[16:19], s68 offen offset:2048 sc1
    v_mfma_f32_16x16x32_bf16 v[148:151], v[24:27], v[76:79], v[148:151]
    ds_read_b64_tr_b16 v[22:23], v193 offset:1024
    s_waitcnt lgkmcnt(12)
    v_mfma_f32_16x16x32_bf16 v[152:155], v[28:31], v[72:75], v[152:155]
    ds_read_b64_tr_b16 v[24:25], v194 offset:0
    v_mfma_f32_16x16x32_bf16 v[156:159], v[28:31], v[76:79], v[156:159]
    ds_read_b64_tr_b16 v[26:27], v194 offset:1024
    s_waitcnt lgkmcnt(12)
    v_mfma_f32_16x16x32_bf16 v[160:163], v[32:35], v[72:75], v[160:163]
    ds_read_b64_tr_b16 v[28:29], v195 offset:0
    v_mfma_f32_16x16x32_bf16 v[164:167], v[32:35], v[76:79], v[164:167]
    ds_read_b64_tr_b16 v[30:31], v195 offset:1024
    s_waitcnt lgkmcnt(12)
    v_mfma_f32_16x16x32_bf16 v[168:171], v[36:39], v[72:75], v[168:171]
    ds_read_b64_tr_b16 v[32:33], v196 offset:0
    v_mfma_f32_16x16x32_bf16 v[172:175], v[36:39], v[76:79], v[172:175]
    ds_read_b64_tr_b16 v[34:35], v196 offset:1024
    s_waitcnt lgkmcnt(12)
    v_mfma_f32_16x16x32_bf16 v[176:179], v[40:43], v[72:75], v[176:179]
    ds_read_b64_tr_b16 v[36:37], v197 offset:0
    buffer_load_dwordx4 v[60:63], v8, s[16:19], s68 offen offset:2304 sc1
    s_add_u32 s68, s68, 4096
    v_mfma_f32_16x16x32_bf16 v[180:183], v[40:43], v[76:79], v[180:183]
    ds_read_b64_tr_b16 v[38:39], v197 offset:1024
    s_waitcnt lgkmcnt(12)
    v_mfma_f32_16x16x32_bf16 v[184:187], v[44:47], v[72:75], v[184:187]
    ds_read_b64_tr_b16 v[40:41], v198 offset:0
    v_mfma_f32_16x16x32_bf16 v[188:191], v[44:47], v[76:79], v[188:191]
    ds_read_b64_tr_b16 v[42:43], v198 offset:1024
    s_waitcnt vmcnt(10)
    s_waitcnt lgkmcnt(12)
    v_mfma_f32_16x16x32_bf16 v[128:131], v[16:19], v[80:83], v[128:131]
    ds_read_b64_tr_b16 v[44:45], v199 offset:0
    v_mfma_f32_16x16x32_bf16 v[132:135], v[16:19], v[84:87], v[132:135]
    ds_read_b64_tr_b16 v[46:47], v199 offset:1024
    s_waitcnt lgkmcnt(12)
    v_mfma_f32_16x16x32_bf16 v[136:139], v[20:23], v[80:83], v[136:139]
    s_barrier
LadaLN_cond__grouped_kv_mqa__dense_activation_relu__prompt_kernel_fb5:
    ds_read_b64_tr_b16 v[16:17], v192 offset:8192
    v_mfma_f32_16x16x32_bf16 v[140:143], v[20:23], v[84:87], v[140:143]
    ds_read_b64_tr_b16 v[18:19], v192 offset:9216
    s_waitcnt lgkmcnt(12)
    v_mfma_f32_16x16x32_bf16 v[144:147], v[24:27], v[80:83], v[144:147]
    ds_read_b64_tr_b16 v[20:21], v193 offset:8192
    buffer_load_dwordx4 v[64:67], v8, s[16:19], s68 offen offset:0 sc1
    v_mfma_f32_16x16x32_bf16 v[148:151], v[24:27], v[84:87], v[148:151]
    ds_read_b64_tr_b16 v[22:23], v193 offset:9216
    s_waitcnt lgkmcnt(12)
    v_mfma_f32_16x16x32_bf16 v[152:155], v[28:31], v[80:83], v[152:155]
    ds_read_b64_tr_b16 v[24:25], v194 offset:8192
    v_mfma_f32_16x16x32_bf16 v[156:159], v[28:31], v[84:87], v[156:159]
    ds_read_b64_tr_b16 v[26:27], v194 offset:9216
    s_waitcnt lgkmcnt(12)
    v_mfma_f32_16x16x32_bf16 v[160:163], v[32:35], v[80:83], v[160:163]
    ds_read_b64_tr_b16 v[28:29], v195 offset:8192
    v_mfma_f32_16x16x32_bf16 v[164:167], v[32:35], v[84:87], v[164:167]
    ds_read_b64_tr_b16 v[30:31], v195 offset:9216
    s_waitcnt lgkmcnt(12)
    v_mfma_f32_16x16x32_bf16 v[168:171], v[36:39], v[80:83], v[168:171]
    ds_read_b64_tr_b16 v[32:33], v196 offset:8192
    v_mfma_f32_16x16x32_bf16 v[172:175], v[36:39], v[84:87], v[172:175]
    ds_read_b64_tr_b16 v[34:35], v196 offset:9216
    s_waitcnt lgkmcnt(12)
    v_mfma_f32_16x16x32_bf16 v[176:179], v[40:43], v[80:83], v[176:179]
    ds_read_b64_tr_b16 v[36:37], v197 offset:8192
    buffer_load_dwordx4 v[68:71], v8, s[16:19], s68 offen offset:256 sc1
    v_mfma_f32_16x16x32_bf16 v[180:183], v[40:43], v[84:87], v[180:183]
    ds_read_b64_tr_b16 v[38:39], v197 offset:9216
    s_waitcnt lgkmcnt(12)
    v_mfma_f32_16x16x32_bf16 v[184:187], v[44:47], v[80:83], v[184:187]
    ds_read_b64_tr_b16 v[40:41], v198 offset:8192
    v_mfma_f32_16x16x32_bf16 v[188:191], v[44:47], v[84:87], v[188:191]
    ds_read_b64_tr_b16 v[42:43], v198 offset:9216
    s_waitcnt vmcnt(10)
    s_waitcnt lgkmcnt(12)
    v_mfma_f32_16x16x32_bf16 v[128:131], v[16:19], v[88:91], v[128:131]
    ds_read_b64_tr_b16 v[44:45], v199 offset:8192
    v_mfma_f32_16x16x32_bf16 v[132:135], v[16:19], v[92:95], v[132:135]
    ds_read_b64_tr_b16 v[46:47], v199 offset:9216
    s_waitcnt lgkmcnt(12)
    v_mfma_f32_16x16x32_bf16 v[136:139], v[20:23], v[88:91], v[136:139]
    v_add_u32 v192, 0xfffe0000, v192
    v_add_u32 v193, 0xfffe0000, v193
    v_add_u32 v194, 0xfffe0000, v194
    v_add_u32 v195, 0xfffe0000, v195
    v_add_u32 v196, 0xfffe0000, v196
    v_add_u32 v197, 0xfffe0000, v197
    v_add_u32 v198, 0xfffe0000, v198
    v_add_u32 v199, 0xfffe0000, v199
    ds_read_b64_tr_b16 v[16:17], v192 offset:0
    v_mfma_f32_16x16x32_bf16 v[140:143], v[20:23], v[92:95], v[140:143]
    ds_read_b64_tr_b16 v[18:19], v192 offset:1024
    s_waitcnt lgkmcnt(12)
    v_mfma_f32_16x16x32_bf16 v[144:147], v[24:27], v[88:91], v[144:147]
    ds_read_b64_tr_b16 v[20:21], v193 offset:0
    buffer_load_dwordx4 v[72:75], v8, s[16:19], s68 offen offset:2048 sc1
    v_mfma_f32_16x16x32_bf16 v[148:151], v[24:27], v[92:95], v[148:151]
    ds_read_b64_tr_b16 v[22:23], v193 offset:1024
    s_waitcnt lgkmcnt(12)
    v_mfma_f32_16x16x32_bf16 v[152:155], v[28:31], v[88:91], v[152:155]
    ds_read_b64_tr_b16 v[24:25], v194 offset:0
    v_mfma_f32_16x16x32_bf16 v[156:159], v[28:31], v[92:95], v[156:159]
    ds_read_b64_tr_b16 v[26:27], v194 offset:1024
    s_waitcnt lgkmcnt(12)
    v_mfma_f32_16x16x32_bf16 v[160:163], v[32:35], v[88:91], v[160:163]
    ds_read_b64_tr_b16 v[28:29], v195 offset:0
    v_mfma_f32_16x16x32_bf16 v[164:167], v[32:35], v[92:95], v[164:167]
    ds_read_b64_tr_b16 v[30:31], v195 offset:1024
    s_waitcnt lgkmcnt(12)
    v_mfma_f32_16x16x32_bf16 v[168:171], v[36:39], v[88:91], v[168:171]
    ds_read_b64_tr_b16 v[32:33], v196 offset:0
    v_mfma_f32_16x16x32_bf16 v[172:175], v[36:39], v[92:95], v[172:175]
    ds_read_b64_tr_b16 v[34:35], v196 offset:1024
    s_waitcnt lgkmcnt(12)
    v_mfma_f32_16x16x32_bf16 v[176:179], v[40:43], v[88:91], v[176:179]
    ds_read_b64_tr_b16 v[36:37], v197 offset:0
    buffer_load_dwordx4 v[76:79], v8, s[16:19], s68 offen offset:2304 sc1
    s_add_u32 s68, s68, 4096
    v_mfma_f32_16x16x32_bf16 v[180:183], v[40:43], v[92:95], v[180:183]
    ds_read_b64_tr_b16 v[38:39], v197 offset:1024
    s_waitcnt lgkmcnt(12)
    v_mfma_f32_16x16x32_bf16 v[184:187], v[44:47], v[88:91], v[184:187]
    ds_read_b64_tr_b16 v[40:41], v198 offset:0
    v_mfma_f32_16x16x32_bf16 v[188:191], v[44:47], v[92:95], v[188:191]
    ds_read_b64_tr_b16 v[42:43], v198 offset:1024
    s_waitcnt vmcnt(10)
    s_waitcnt lgkmcnt(12)
    v_mfma_f32_16x16x32_bf16 v[128:131], v[16:19], v[96:99], v[128:131]
    ds_read_b64_tr_b16 v[44:45], v199 offset:0
    v_mfma_f32_16x16x32_bf16 v[132:135], v[16:19], v[100:103], v[132:135]
    ds_read_b64_tr_b16 v[46:47], v199 offset:1024
    s_waitcnt lgkmcnt(12)
    v_mfma_f32_16x16x32_bf16 v[136:139], v[20:23], v[96:99], v[136:139]
    ds_read_b64_tr_b16 v[16:17], v192 offset:8192
    v_mfma_f32_16x16x32_bf16 v[140:143], v[20:23], v[100:103], v[140:143]
    ds_read_b64_tr_b16 v[18:19], v192 offset:9216
    s_waitcnt lgkmcnt(12)
    v_mfma_f32_16x16x32_bf16 v[144:147], v[24:27], v[96:99], v[144:147]
    ds_read_b64_tr_b16 v[20:21], v193 offset:8192
    buffer_load_dwordx4 v[80:83], v8, s[16:19], s68 offen offset:0 sc1
    v_mfma_f32_16x16x32_bf16 v[148:151], v[24:27], v[100:103], v[148:151]
    ds_read_b64_tr_b16 v[22:23], v193 offset:9216
    s_waitcnt lgkmcnt(12)
    v_mfma_f32_16x16x32_bf16 v[152:155], v[28:31], v[96:99], v[152:155]
    ds_read_b64_tr_b16 v[24:25], v194 offset:8192
    v_mfma_f32_16x16x32_bf16 v[156:159], v[28:31], v[100:103], v[156:159]
    ds_read_b64_tr_b16 v[26:27], v194 offset:9216
    s_waitcnt lgkmcnt(12)
    v_mfma_f32_16x16x32_bf16 v[160:163], v[32:35], v[96:99], v[160:163]
    ds_read_b64_tr_b16 v[28:29], v195 offset:8192
    v_mfma_f32_16x16x32_bf16 v[164:167], v[32:35], v[100:103], v[164:167]
    ds_read_b64_tr_b16 v[30:31], v195 offset:9216
    s_waitcnt lgkmcnt(12)
    v_mfma_f32_16x16x32_bf16 v[168:171], v[36:39], v[96:99], v[168:171]
    ds_read_b64_tr_b16 v[32:33], v196 offset:8192
    v_mfma_f32_16x16x32_bf16 v[172:175], v[36:39], v[100:103], v[172:175]
    ds_read_b64_tr_b16 v[34:35], v196 offset:9216
    s_waitcnt lgkmcnt(12)
    v_mfma_f32_16x16x32_bf16 v[176:179], v[40:43], v[96:99], v[176:179]
    ds_read_b64_tr_b16 v[36:37], v197 offset:8192
    buffer_load_dwordx4 v[84:87], v8, s[16:19], s68 offen offset:256 sc1
    v_mfma_f32_16x16x32_bf16 v[180:183], v[40:43], v[100:103], v[180:183]
    ds_read_b64_tr_b16 v[38:39], v197 offset:9216
    s_waitcnt lgkmcnt(12)
    v_mfma_f32_16x16x32_bf16 v[184:187], v[44:47], v[96:99], v[184:187]
    ds_read_b64_tr_b16 v[40:41], v198 offset:8192
    v_mfma_f32_16x16x32_bf16 v[188:191], v[44:47], v[100:103], v[188:191]
    ds_read_b64_tr_b16 v[42:43], v198 offset:9216
    s_waitcnt vmcnt(10)
    s_waitcnt lgkmcnt(12)
    v_mfma_f32_16x16x32_bf16 v[128:131], v[16:19], v[104:107], v[128:131]
    ds_read_b64_tr_b16 v[44:45], v199 offset:8192
    v_mfma_f32_16x16x32_bf16 v[132:135], v[16:19], v[108:111], v[132:135]
    ds_read_b64_tr_b16 v[46:47], v199 offset:9216
    s_waitcnt lgkmcnt(12)
    v_mfma_f32_16x16x32_bf16 v[136:139], v[20:23], v[104:107], v[136:139]
    ds_read_b64_tr_b16 v[16:17], v192 offset:16384
    v_mfma_f32_16x16x32_bf16 v[140:143], v[20:23], v[108:111], v[140:143]
    ds_read_b64_tr_b16 v[18:19], v192 offset:17408
    s_waitcnt lgkmcnt(12)
    v_mfma_f32_16x16x32_bf16 v[144:147], v[24:27], v[104:107], v[144:147]
    ds_read_b64_tr_b16 v[20:21], v193 offset:16384
    buffer_load_dwordx4 v[88:91], v8, s[16:19], s68 offen offset:2048 sc1
    v_mfma_f32_16x16x32_bf16 v[148:151], v[24:27], v[108:111], v[148:151]
    ds_read_b64_tr_b16 v[22:23], v193 offset:17408
    s_waitcnt lgkmcnt(12)
    v_mfma_f32_16x16x32_bf16 v[152:155], v[28:31], v[104:107], v[152:155]
    ds_read_b64_tr_b16 v[24:25], v194 offset:16384
    v_mfma_f32_16x16x32_bf16 v[156:159], v[28:31], v[108:111], v[156:159]
    ds_read_b64_tr_b16 v[26:27], v194 offset:17408
    s_waitcnt lgkmcnt(12)
    v_mfma_f32_16x16x32_bf16 v[160:163], v[32:35], v[104:107], v[160:163]
    ds_read_b64_tr_b16 v[28:29], v195 offset:16384
    v_mfma_f32_16x16x32_bf16 v[164:167], v[32:35], v[108:111], v[164:167]
    ds_read_b64_tr_b16 v[30:31], v195 offset:17408
    s_waitcnt lgkmcnt(12)
    v_mfma_f32_16x16x32_bf16 v[168:171], v[36:39], v[104:107], v[168:171]
    ds_read_b64_tr_b16 v[32:33], v196 offset:16384
    v_mfma_f32_16x16x32_bf16 v[172:175], v[36:39], v[108:111], v[172:175]
    ds_read_b64_tr_b16 v[34:35], v196 offset:17408
    s_waitcnt lgkmcnt(12)
    v_mfma_f32_16x16x32_bf16 v[176:179], v[40:43], v[104:107], v[176:179]
    ds_read_b64_tr_b16 v[36:37], v197 offset:16384
    buffer_load_dwordx4 v[92:95], v8, s[16:19], s68 offen offset:2304 sc1
    s_add_u32 s68, s68, 4096
    v_mfma_f32_16x16x32_bf16 v[180:183], v[40:43], v[108:111], v[180:183]
    ds_read_b64_tr_b16 v[38:39], v197 offset:17408
    s_waitcnt lgkmcnt(12)
    v_mfma_f32_16x16x32_bf16 v[184:187], v[44:47], v[104:107], v[184:187]
    ds_read_b64_tr_b16 v[40:41], v198 offset:16384
    v_mfma_f32_16x16x32_bf16 v[188:191], v[44:47], v[108:111], v[188:191]
    ds_read_b64_tr_b16 v[42:43], v198 offset:17408
    s_waitcnt vmcnt(10)
    s_waitcnt lgkmcnt(12)
    v_mfma_f32_16x16x32_bf16 v[128:131], v[16:19], v[48:51], v[128:131]
    ds_read_b64_tr_b16 v[44:45], v199 offset:16384
    v_mfma_f32_16x16x32_bf16 v[132:135], v[16:19], v[52:55], v[132:135]
    ds_read_b64_tr_b16 v[46:47], v199 offset:17408
    s_waitcnt lgkmcnt(12)
    v_mfma_f32_16x16x32_bf16 v[136:139], v[20:23], v[48:51], v[136:139]
    s_barrier
LadaLN_cond__grouped_kv_mqa__dense_activation_relu__prompt_kernel_fb6:
    ds_read_b64_tr_b16 v[16:17], v192 offset:24576
    v_mfma_f32_16x16x32_bf16 v[140:143], v[20:23], v[52:55], v[140:143]
    ds_read_b64_tr_b16 v[18:19], v192 offset:25600
    s_waitcnt lgkmcnt(12)
    v_mfma_f32_16x16x32_bf16 v[144:147], v[24:27], v[48:51], v[144:147]
    ds_read_b64_tr_b16 v[20:21], v193 offset:24576
    buffer_load_dwordx4 v[96:99], v8, s[16:19], s68 offen offset:0 sc1
    v_mfma_f32_16x16x32_bf16 v[148:151], v[24:27], v[52:55], v[148:151]
    ds_read_b64_tr_b16 v[22:23], v193 offset:25600
    s_waitcnt lgkmcnt(12)
    v_mfma_f32_16x16x32_bf16 v[152:155], v[28:31], v[48:51], v[152:155]
    ds_read_b64_tr_b16 v[24:25], v194 offset:24576
    v_mfma_f32_16x16x32_bf16 v[156:159], v[28:31], v[52:55], v[156:159]
    ds_read_b64_tr_b16 v[26:27], v194 offset:25600
    s_waitcnt lgkmcnt(12)
    v_mfma_f32_16x16x32_bf16 v[160:163], v[32:35], v[48:51], v[160:163]
    ds_read_b64_tr_b16 v[28:29], v195 offset:24576
    v_mfma_f32_16x16x32_bf16 v[164:167], v[32:35], v[52:55], v[164:167]
    ds_read_b64_tr_b16 v[30:31], v195 offset:25600
    s_waitcnt lgkmcnt(12)
    v_mfma_f32_16x16x32_bf16 v[168:171], v[36:39], v[48:51], v[168:171]
    ds_read_b64_tr_b16 v[32:33], v196 offset:24576
    v_mfma_f32_16x16x32_bf16 v[172:175], v[36:39], v[52:55], v[172:175]
    ds_read_b64_tr_b16 v[34:35], v196 offset:25600
    s_waitcnt lgkmcnt(12)
    v_mfma_f32_16x16x32_bf16 v[176:179], v[40:43], v[48:51], v[176:179]
    ds_read_b64_tr_b16 v[36:37], v197 offset:24576
    buffer_load_dwordx4 v[100:103], v8, s[16:19], s68 offen offset:256 sc1
    v_mfma_f32_16x16x32_bf16 v[180:183], v[40:43], v[52:55], v[180:183]
    ds_read_b64_tr_b16 v[38:39], v197 offset:25600
    s_waitcnt lgkmcnt(12)
    v_mfma_f32_16x16x32_bf16 v[184:187], v[44:47], v[48:51], v[184:187]
    ds_read_b64_tr_b16 v[40:41], v198 offset:24576
    v_mfma_f32_16x16x32_bf16 v[188:191], v[44:47], v[52:55], v[188:191]
    ds_read_b64_tr_b16 v[42:43], v198 offset:25600
    s_waitcnt vmcnt(10)
    s_waitcnt lgkmcnt(12)
    v_mfma_f32_16x16x32_bf16 v[128:131], v[16:19], v[56:59], v[128:131]
    ds_read_b64_tr_b16 v[44:45], v199 offset:24576
    v_mfma_f32_16x16x32_bf16 v[132:135], v[16:19], v[60:63], v[132:135]
    ds_read_b64_tr_b16 v[46:47], v199 offset:25600
    s_waitcnt lgkmcnt(12)
    v_mfma_f32_16x16x32_bf16 v[136:139], v[20:23], v[56:59], v[136:139]
    ds_read_b64_tr_b16 v[16:17], v192 offset:32768
    v_mfma_f32_16x16x32_bf16 v[140:143], v[20:23], v[60:63], v[140:143]
    ds_read_b64_tr_b16 v[18:19], v192 offset:33792
    s_waitcnt lgkmcnt(12)
    v_mfma_f32_16x16x32_bf16 v[144:147], v[24:27], v[56:59], v[144:147]
    ds_read_b64_tr_b16 v[20:21], v193 offset:32768
    buffer_load_dwordx4 v[104:107], v8, s[16:19], s68 offen offset:2048 sc1
    v_mfma_f32_16x16x32_bf16 v[148:151], v[24:27], v[60:63], v[148:151]
    ds_read_b64_tr_b16 v[22:23], v193 offset:33792
    s_waitcnt lgkmcnt(12)
    v_mfma_f32_16x16x32_bf16 v[152:155], v[28:31], v[56:59], v[152:155]
    ds_read_b64_tr_b16 v[24:25], v194 offset:32768
    v_mfma_f32_16x16x32_bf16 v[156:159], v[28:31], v[60:63], v[156:159]
    ds_read_b64_tr_b16 v[26:27], v194 offset:33792
    s_waitcnt lgkmcnt(12)
    v_mfma_f32_16x16x32_bf16 v[160:163], v[32:35], v[56:59], v[160:163]
    ds_read_b64_tr_b16 v[28:29], v195 offset:32768
    v_mfma_f32_16x16x32_bf16 v[164:167], v[32:35], v[60:63], v[164:167]
    ds_read_b64_tr_b16 v[30:31], v195 offset:33792
    s_waitcnt lgkmcnt(12)
    v_mfma_f32_16x16x32_bf16 v[168:171], v[36:39], v[56:59], v[168:171]
    ds_read_b64_tr_b16 v[32:33], v196 offset:32768
    v_mfma_f32_16x16x32_bf16 v[172:175], v[36:39], v[60:63], v[172:175]
    ds_read_b64_tr_b16 v[34:35], v196 offset:33792
    s_waitcnt lgkmcnt(12)
    v_mfma_f32_16x16x32_bf16 v[176:179], v[40:43], v[56:59], v[176:179]
    ds_read_b64_tr_b16 v[36:37], v197 offset:32768
    buffer_load_dwordx4 v[108:111], v8, s[16:19], s68 offen offset:2304 sc1
    s_add_u32 s68, s68, 4096
    v_mfma_f32_16x16x32_bf16 v[180:183], v[40:43], v[60:63], v[180:183]
    ds_read_b64_tr_b16 v[38:39], v197 offset:33792
    s_waitcnt lgkmcnt(12)
    v_mfma_f32_16x16x32_bf16 v[184:187], v[44:47], v[56:59], v[184:187]
    ds_read_b64_tr_b16 v[40:41], v198 offset:32768
    v_mfma_f32_16x16x32_bf16 v[188:191], v[44:47], v[60:63], v[188:191]
    ds_read_b64_tr_b16 v[42:43], v198 offset:33792
    s_waitcnt vmcnt(10)
    s_waitcnt lgkmcnt(12)
    v_mfma_f32_16x16x32_bf16 v[128:131], v[16:19], v[64:67], v[128:131]
    ds_read_b64_tr_b16 v[44:45], v199 offset:32768
    v_mfma_f32_16x16x32_bf16 v[132:135], v[16:19], v[68:71], v[132:135]
    ds_read_b64_tr_b16 v[46:47], v199 offset:33792
    s_waitcnt lgkmcnt(12)
    v_mfma_f32_16x16x32_bf16 v[136:139], v[20:23], v[64:67], v[136:139]
    ds_read_b64_tr_b16 v[16:17], v192 offset:40960
    v_mfma_f32_16x16x32_bf16 v[140:143], v[20:23], v[68:71], v[140:143]
    ds_read_b64_tr_b16 v[18:19], v192 offset:41984
    s_waitcnt lgkmcnt(12)
    v_mfma_f32_16x16x32_bf16 v[144:147], v[24:27], v[64:67], v[144:147]
    ds_read_b64_tr_b16 v[20:21], v193 offset:40960
    buffer_load_dwordx4 v[48:51], v8, s[16:19], s68 offen offset:0 sc1
    v_mfma_f32_16x16x32_bf16 v[148:151], v[24:27], v[68:71], v[148:151]
    ds_read_b64_tr_b16 v[22:23], v193 offset:41984
    s_waitcnt lgkmcnt(12)
    v_mfma_f32_16x16x32_bf16 v[152:155], v[28:31], v[64:67], v[152:155]
    ds_read_b64_tr_b16 v[24:25], v194 offset:40960
    v_mfma_f32_16x16x32_bf16 v[156:159], v[28:31], v[68:71], v[156:159]
    ds_read_b64_tr_b16 v[26:27], v194 offset:41984
    s_waitcnt lgkmcnt(12)
    v_mfma_f32_16x16x32_bf16 v[160:163], v[32:35], v[64:67], v[160:163]
    ds_read_b64_tr_b16 v[28:29], v195 offset:40960
    v_mfma_f32_16x16x32_bf16 v[164:167], v[32:35], v[68:71], v[164:167]
    ds_read_b64_tr_b16 v[30:31], v195 offset:41984
    s_waitcnt lgkmcnt(12)
    v_mfma_f32_16x16x32_bf16 v[168:171], v[36:39], v[64:67], v[168:171]
    ds_read_b64_tr_b16 v[32:33], v196 offset:40960
    v_mfma_f32_16x16x32_bf16 v[172:175], v[36:39], v[68:71], v[172:175]
    ds_read_b64_tr_b16 v[34:35], v196 offset:41984
    s_waitcnt lgkmcnt(12)
    v_mfma_f32_16x16x32_bf16 v[176:179], v[40:43], v[64:67], v[176:179]
    ds_read_b64_tr_b16 v[36:37], v197 offset:40960
    buffer_load_dwordx4 v[52:55], v8, s[16:19], s68 offen offset:256 sc1
    v_mfma_f32_16x16x32_bf16 v[180:183], v[40:43], v[68:71], v[180:183]
    ds_read_b64_tr_b16 v[38:39], v197 offset:41984
    s_waitcnt lgkmcnt(12)
    v_mfma_f32_16x16x32_bf16 v[184:187], v[44:47], v[64:67], v[184:187]
    ds_read_b64_tr_b16 v[40:41], v198 offset:40960
    v_mfma_f32_16x16x32_bf16 v[188:191], v[44:47], v[68:71], v[188:191]
    ds_read_b64_tr_b16 v[42:43], v198 offset:41984
    s_waitcnt vmcnt(10)
    s_waitcnt lgkmcnt(12)
    v_mfma_f32_16x16x32_bf16 v[128:131], v[16:19], v[72:75], v[128:131]
    ds_read_b64_tr_b16 v[44:45], v199 offset:40960
    v_mfma_f32_16x16x32_bf16 v[132:135], v[16:19], v[76:79], v[132:135]
    ds_read_b64_tr_b16 v[46:47], v199 offset:41984
    s_waitcnt lgkmcnt(12)
    v_mfma_f32_16x16x32_bf16 v[136:139], v[20:23], v[72:75], v[136:139]
    ds_read_b64_tr_b16 v[16:17], v192 offset:49152
    v_mfma_f32_16x16x32_bf16 v[140:143], v[20:23], v[76:79], v[140:143]
    ds_read_b64_tr_b16 v[18:19], v192 offset:50176
    s_waitcnt lgkmcnt(12)
    v_mfma_f32_16x16x32_bf16 v[144:147], v[24:27], v[72:75], v[144:147]
    ds_read_b64_tr_b16 v[20:21], v193 offset:49152
    buffer_load_dwordx4 v[56:59], v8, s[16:19], s68 offen offset:2048 sc1
    v_mfma_f32_16x16x32_bf16 v[148:151], v[24:27], v[76:79], v[148:151]
    ds_read_b64_tr_b16 v[22:23], v193 offset:50176
    s_waitcnt lgkmcnt(12)
    v_mfma_f32_16x16x32_bf16 v[152:155], v[28:31], v[72:75], v[152:155]
    ds_read_b64_tr_b16 v[24:25], v194 offset:49152
    v_mfma_f32_16x16x32_bf16 v[156:159], v[28:31], v[76:79], v[156:159]
    ds_read_b64_tr_b16 v[26:27], v194 offset:50176
    s_waitcnt lgkmcnt(12)
    v_mfma_f32_16x16x32_bf16 v[160:163], v[32:35], v[72:75], v[160:163]
    ds_read_b64_tr_b16 v[28:29], v195 offset:49152
    v_mfma_f32_16x16x32_bf16 v[164:167], v[32:35], v[76:79], v[164:167]
    ds_read_b64_tr_b16 v[30:31], v195 offset:50176
    s_waitcnt lgkmcnt(12)
    v_mfma_f32_16x16x32_bf16 v[168:171], v[36:39], v[72:75], v[168:171]
    ds_read_b64_tr_b16 v[32:33], v196 offset:49152
    v_mfma_f32_16x16x32_bf16 v[172:175], v[36:39], v[76:79], v[172:175]
    ds_read_b64_tr_b16 v[34:35], v196 offset:50176
    s_waitcnt lgkmcnt(12)
    v_mfma_f32_16x16x32_bf16 v[176:179], v[40:43], v[72:75], v[176:179]
    ds_read_b64_tr_b16 v[36:37], v197 offset:49152
    buffer_load_dwordx4 v[60:63], v8, s[16:19], s68 offen offset:2304 sc1
    s_add_u32 s68, s68, 4096
    v_mfma_f32_16x16x32_bf16 v[180:183], v[40:43], v[76:79], v[180:183]
    ds_read_b64_tr_b16 v[38:39], v197 offset:50176
    s_waitcnt lgkmcnt(12)
    v_mfma_f32_16x16x32_bf16 v[184:187], v[44:47], v[72:75], v[184:187]
    ds_read_b64_tr_b16 v[40:41], v198 offset:49152
    v_mfma_f32_16x16x32_bf16 v[188:191], v[44:47], v[76:79], v[188:191]
    ds_read_b64_tr_b16 v[42:43], v198 offset:50176
    s_waitcnt vmcnt(10)
    s_waitcnt lgkmcnt(12)
    v_mfma_f32_16x16x32_bf16 v[128:131], v[16:19], v[80:83], v[128:131]
    ds_read_b64_tr_b16 v[44:45], v199 offset:49152
    v_mfma_f32_16x16x32_bf16 v[132:135], v[16:19], v[84:87], v[132:135]
    ds_read_b64_tr_b16 v[46:47], v199 offset:50176
    s_waitcnt lgkmcnt(12)
    v_mfma_f32_16x16x32_bf16 v[136:139], v[20:23], v[80:83], v[136:139]
    s_barrier
LadaLN_cond__grouped_kv_mqa__dense_activation_relu__prompt_kernel_fb7:
    ds_read_b64_tr_b16 v[16:17], v192 offset:57344
    v_mfma_f32_16x16x32_bf16 v[140:143], v[20:23], v[84:87], v[140:143]
    ds_read_b64_tr_b16 v[18:19], v192 offset:58368
    s_waitcnt lgkmcnt(12)
    v_mfma_f32_16x16x32_bf16 v[144:147], v[24:27], v[80:83], v[144:147]
    ds_read_b64_tr_b16 v[20:21], v193 offset:57344
    buffer_load_dwordx4 v[64:67], v8, s[16:19], s68 offen offset:0 sc1
    v_mfma_f32_16x16x32_bf16 v[148:151], v[24:27], v[84:87], v[148:151]
    ds_read_b64_tr_b16 v[22:23], v193 offset:58368
    s_waitcnt lgkmcnt(12)
    v_mfma_f32_16x16x32_bf16 v[152:155], v[28:31], v[80:83], v[152:155]
    ds_read_b64_tr_b16 v[24:25], v194 offset:57344
    v_mfma_f32_16x16x32_bf16 v[156:159], v[28:31], v[84:87], v[156:159]
    ds_read_b64_tr_b16 v[26:27], v194 offset:58368
    s_waitcnt lgkmcnt(12)
    v_mfma_f32_16x16x32_bf16 v[160:163], v[32:35], v[80:83], v[160:163]
    ds_read_b64_tr_b16 v[28:29], v195 offset:57344
    v_mfma_f32_16x16x32_bf16 v[164:167], v[32:35], v[84:87], v[164:167]
    ds_read_b64_tr_b16 v[30:31], v195 offset:58368
    s_waitcnt lgkmcnt(12)
    v_mfma_f32_16x16x32_bf16 v[168:171], v[36:39], v[80:83], v[168:171]
    ds_read_b64_tr_b16 v[32:33], v196 offset:57344
    v_mfma_f32_16x16x32_bf16 v[172:175], v[36:39], v[84:87], v[172:175]
    ds_read_b64_tr_b16 v[34:35], v196 offset:58368
    s_waitcnt lgkmcnt(12)
    v_mfma_f32_16x16x32_bf16 v[176:179], v[40:43], v[80:83], v[176:179]
    ds_read_b64_tr_b16 v[36:37], v197 offset:57344
    buffer_load_dwordx4 v[68:71], v8, s[16:19], s68 offen offset:256 sc1
    v_mfma_f32_16x16x32_bf16 v[180:183], v[40:43], v[84:87], v[180:183]
    ds_read_b64_tr_b16 v[38:39], v197 offset:58368
    s_waitcnt lgkmcnt(12)
    v_mfma_f32_16x16x32_bf16 v[184:187], v[44:47], v[80:83], v[184:187]
    ds_read_b64_tr_b16 v[40:41], v198 offset:57344
    v_mfma_f32_16x16x32_bf16 v[188:191], v[44:47], v[84:87], v[188:191]
    ds_read_b64_tr_b16 v[42:43], v198 offset:58368
    s_waitcnt vmcnt(10)
    s_waitcnt lgkmcnt(12)
    v_mfma_f32_16x16x32_bf16 v[128:131], v[16:19], v[88:91], v[128:131]
    ds_read_b64_tr_b16 v[44:45], v199 offset:57344
    v_mfma_f32_16x16x32_bf16 v[132:135], v[16:19], v[92:95], v[132:135]
    ds_read_b64_tr_b16 v[46:47], v199 offset:58368
    s_waitcnt lgkmcnt(12)
    v_mfma_f32_16x16x32_bf16 v[136:139], v[20:23], v[88:91], v[136:139]
    v_add_u32 v192, 0x10000, v192
    v_add_u32 v193, 0x10000, v193
    v_add_u32 v194, 0x10000, v194
    v_add_u32 v195, 0x10000, v195
    v_add_u32 v196, 0x10000, v196
    v_add_u32 v197, 0x10000, v197
    v_add_u32 v198, 0x10000, v198
    v_add_u32 v199, 0x10000, v199
    ds_read_b64_tr_b16 v[16:17], v192 offset:0
    v_mfma_f32_16x16x32_bf16 v[140:143], v[20:23], v[92:95], v[140:143]
    ds_read_b64_tr_b16 v[18:19], v192 offset:1024
    s_waitcnt lgkmcnt(12)
    v_mfma_f32_16x16x32_bf16 v[144:147], v[24:27], v[88:91], v[144:147]
    ds_read_b64_tr_b16 v[20:21], v193 offset:0
    buffer_load_dwordx4 v[72:75], v8, s[16:19], s68 offen offset:2048 sc1
    v_mfma_f32_16x16x32_bf16 v[148:151], v[24:27], v[92:95], v[148:151]
    ds_read_b64_tr_b16 v[22:23], v193 offset:1024
    s_waitcnt lgkmcnt(12)
    v_mfma_f32_16x16x32_bf16 v[152:155], v[28:31], v[88:91], v[152:155]
    ds_read_b64_tr_b16 v[24:25], v194 offset:0
    v_mfma_f32_16x16x32_bf16 v[156:159], v[28:31], v[92:95], v[156:159]
    ds_read_b64_tr_b16 v[26:27], v194 offset:1024
    s_waitcnt lgkmcnt(12)
    v_mfma_f32_16x16x32_bf16 v[160:163], v[32:35], v[88:91], v[160:163]
    ds_read_b64_tr_b16 v[28:29], v195 offset:0
    v_mfma_f32_16x16x32_bf16 v[164:167], v[32:35], v[92:95], v[164:167]
    ds_read_b64_tr_b16 v[30:31], v195 offset:1024
    s_waitcnt lgkmcnt(12)
    v_mfma_f32_16x16x32_bf16 v[168:171], v[36:39], v[88:91], v[168:171]
    ds_read_b64_tr_b16 v[32:33], v196 offset:0
    v_mfma_f32_16x16x32_bf16 v[172:175], v[36:39], v[92:95], v[172:175]
    ds_read_b64_tr_b16 v[34:35], v196 offset:1024
    s_waitcnt lgkmcnt(12)
    v_mfma_f32_16x16x32_bf16 v[176:179], v[40:43], v[88:91], v[176:179]
    ds_read_b64_tr_b16 v[36:37], v197 offset:0
    buffer_load_dwordx4 v[76:79], v8, s[16:19], s68 offen offset:2304 sc1
    s_add_u32 s68, s68, 4096
    v_mfma_f32_16x16x32_bf16 v[180:183], v[40:43], v[92:95], v[180:183]
    ds_read_b64_tr_b16 v[38:39], v197 offset:1024
    s_waitcnt lgkmcnt(12)
    v_mfma_f32_16x16x32_bf16 v[184:187], v[44:47], v[88:91], v[184:187]
    ds_read_b64_tr_b16 v[40:41], v198 offset:0
    v_mfma_f32_16x16x32_bf16 v[188:191], v[44:47], v[92:95], v[188:191]
    ds_read_b64_tr_b16 v[42:43], v198 offset:1024
    s_waitcnt vmcnt(10)
    s_waitcnt lgkmcnt(12)
    v_mfma_f32_16x16x32_bf16 v[128:131], v[16:19], v[96:99], v[128:131]
    ds_read_b64_tr_b16 v[44:45], v199 offset:0
    v_mfma_f32_16x16x32_bf16 v[132:135], v[16:19], v[100:103], v[132:135]
    ds_read_b64_tr_b16 v[46:47], v199 offset:1024
    s_waitcnt lgkmcnt(12)
    v_mfma_f32_16x16x32_bf16 v[136:139], v[20:23], v[96:99], v[136:139]
    ds_read_b64_tr_b16 v[16:17], v192 offset:8192
    v_mfma_f32_16x16x32_bf16 v[140:143], v[20:23], v[100:103], v[140:143]
    ds_read_b64_tr_b16 v[18:19], v192 offset:9216
    s_waitcnt lgkmcnt(12)
    v_mfma_f32_16x16x32_bf16 v[144:147], v[24:27], v[96:99], v[144:147]
    ds_read_b64_tr_b16 v[20:21], v193 offset:8192
    buffer_load_dwordx4 v[80:83], v8, s[16:19], s68 offen offset:0 sc1
    v_mfma_f32_16x16x32_bf16 v[148:151], v[24:27], v[100:103], v[148:151]
    ds_read_b64_tr_b16 v[22:23], v193 offset:9216
    s_waitcnt lgkmcnt(12)
    v_mfma_f32_16x16x32_bf16 v[152:155], v[28:31], v[96:99], v[152:155]
    ds_read_b64_tr_b16 v[24:25], v194 offset:8192
    v_mfma_f32_16x16x32_bf16 v[156:159], v[28:31], v[100:103], v[156:159]
    ds_read_b64_tr_b16 v[26:27], v194 offset:9216
    s_waitcnt lgkmcnt(12)
    v_mfma_f32_16x16x32_bf16 v[160:163], v[32:35], v[96:99], v[160:163]
    ds_read_b64_tr_b16 v[28:29], v195 offset:8192
    v_mfma_f32_16x16x32_bf16 v[164:167], v[32:35], v[100:103], v[164:167]
    ds_read_b64_tr_b16 v[30:31], v195 offset:9216
    s_waitcnt lgkmcnt(12)
    v_mfma_f32_16x16x32_bf16 v[168:171], v[36:39], v[96:99], v[168:171]
    ds_read_b64_tr_b16 v[32:33], v196 offset:8192
    v_mfma_f32_16x16x32_bf16 v[172:175], v[36:39], v[100:103], v[172:175]
    ds_read_b64_tr_b16 v[34:35], v196 offset:9216
    s_waitcnt lgkmcnt(12)
    v_mfma_f32_16x16x32_bf16 v[176:179], v[40:43], v[96:99], v[176:179]
    ds_read_b64_tr_b16 v[36:37], v197 offset:8192
    buffer_load_dwordx4 v[84:87], v8, s[16:19], s68 offen offset:256 sc1
    v_mfma_f32_16x16x32_bf16 v[180:183], v[40:43], v[100:103], v[180:183]
    ds_read_b64_tr_b16 v[38:39], v197 offset:9216
    s_waitcnt lgkmcnt(12)
    v_mfma_f32_16x16x32_bf16 v[184:187], v[44:47], v[96:99], v[184:187]
    ds_read_b64_tr_b16 v[40:41], v198 offset:8192
    v_mfma_f32_16x16x32_bf16 v[188:191], v[44:47], v[100:103], v[188:191]
    ds_read_b64_tr_b16 v[42:43], v198 offset:9216
    s_waitcnt vmcnt(10)
    s_waitcnt lgkmcnt(12)
    v_mfma_f32_16x16x32_bf16 v[128:131], v[16:19], v[104:107], v[128:131]
    ds_read_b64_tr_b16 v[44:45], v199 offset:8192
    v_mfma_f32_16x16x32_bf16 v[132:135], v[16:19], v[108:111], v[132:135]
    ds_read_b64_tr_b16 v[46:47], v199 offset:9216
    s_waitcnt lgkmcnt(12)
    v_mfma_f32_16x16x32_bf16 v[136:139], v[20:23], v[104:107], v[136:139]
    ds_read_b64_tr_b16 v[16:17], v192 offset:16384
    v_mfma_f32_16x16x32_bf16 v[140:143], v[20:23], v[108:111], v[140:143]
    ds_read_b64_tr_b16 v[18:19], v192 offset:17408
    s_waitcnt lgkmcnt(12)
    v_mfma_f32_16x16x32_bf16 v[144:147], v[24:27], v[104:107], v[144:147]
    ds_read_b64_tr_b16 v[20:21], v193 offset:16384
    buffer_load_dwordx4 v[88:91], v8, s[16:19], s68 offen offset:2048 sc1
    v_mfma_f32_16x16x32_bf16 v[148:151], v[24:27], v[108:111], v[148:151]
    ds_read_b64_tr_b16 v[22:23], v193 offset:17408
    s_waitcnt lgkmcnt(12)
    v_mfma_f32_16x16x32_bf16 v[152:155], v[28:31], v[104:107], v[152:155]
    ds_read_b64_tr_b16 v[24:25], v194 offset:16384
    v_mfma_f32_16x16x32_bf16 v[156:159], v[28:31], v[108:111], v[156:159]
    ds_read_b64_tr_b16 v[26:27], v194 offset:17408
    s_waitcnt lgkmcnt(12)
    v_mfma_f32_16x16x32_bf16 v[160:163], v[32:35], v[104:107], v[160:163]
    s_branch LadaLN_cond__grouped_kv_mqa__dense_activation_relu__prompt_kernel_over14
LadaLN_cond__grouped_kv_mqa__dense_activation_relu__prompt_kernel_stub14:
    s_setpc_b64 s[96:97]
LadaLN_cond__grouped_kv_mqa__dense_activation_relu__prompt_kernel_over14:
    ds_read_b64_tr_b16 v[28:29], v195 offset:16384
    v_mfma_f32_16x16x32_bf16 v[164:167], v[32:35], v[108:111], v[164:167]
    ds_read_b64_tr_b16 v[30:31], v195 offset:17408
    s_waitcnt lgkmcnt(12)
    v_mfma_f32_16x16x32_bf16 v[168:171], v[36:39], v[104:107], v[168:171]
    ds_read_b64_tr_b16 v[32:33], v196 offset:16384
    v_mfma_f32_16x16x32_bf16 v[172:175], v[36:39], v[108:111], v[172:175]
    ds_read_b64_tr_b16 v[34:35], v196 offset:17408
    s_waitcnt lgkmcnt(12)
    v_mfma_f32_16x16x32_bf16 v[176:179], v[40:43], v[104:107], v[176:179]
    ds_read_b64_tr_b16 v[36:37], v197 offset:16384
    buffer_load_dwordx4 v[92:95], v8, s[16:19], s68 offen offset:2304 sc1
    s_add_u32 s68, s68, 4096
    v_mfma_f32_16x16x32_bf16 v[180:183], v[40:43], v[108:111], v[180:183]
    ds_read_b64_tr_b16 v[38:39], v197 offset:17408
    s_waitcnt lgkmcnt(12)
    v_mfma_f32_16x16x32_bf16 v[184:187], v[44:47], v[104:107], v[184:187]
    ds_read_b64_tr_b16 v[40:41], v198 offset:16384
    v_mfma_f32_16x16x32_bf16 v[188:191], v[44:47], v[108:111], v[188:191]
    ds_read_b64_tr_b16 v[42:43], v198 offset:17408
    s_waitcnt vmcnt(10)
    s_waitcnt lgkmcnt(12)
    v_mfma_f32_16x16x32_bf16 v[128:131], v[16:19], v[48:51], v[128:131]
    ds_read_b64_tr_b16 v[44:45], v199 offset:16384
    v_mfma_f32_16x16x32_bf16 v[132:135], v[16:19], v[52:55], v[132:135]
    ds_read_b64_tr_b16 v[46:47], v199 offset:17408
    s_waitcnt lgkmcnt(12)
    v_mfma_f32_16x16x32_bf16 v[136:139], v[20:23], v[48:51], v[136:139]
    s_barrier
LadaLN_cond__grouped_kv_mqa__dense_activation_relu__prompt_kernel_fb8:
    ds_read_b64_tr_b16 v[16:17], v192 offset:24576
    v_mfma_f32_16x16x32_bf16 v[140:143], v[20:23], v[52:55], v[140:143]
    ds_read_b64_tr_b16 v[18:19], v192 offset:25600
    s_waitcnt lgkmcnt(12)
    v_mfma_f32_16x16x32_bf16 v[144:147], v[24:27], v[48:51], v[144:147]
    ds_read_b64_tr_b16 v[20:21], v193 offset:24576
    buffer_load_dwordx4 v[96:99], v8, s[16:19], s68 offen offset:0 sc1
    v_mfma_f32_16x16x32_bf16 v[148:151], v[24:27], v[52:55], v[148:151]
    ds_read_b64_tr_b16 v[22:23], v193 offset:25600
    s_waitcnt lgkmcnt(12)
    v_mfma_f32_16x16x32_bf16 v[152:155], v[28:31], v[48:51], v[152:155]
    ds_read_b64_tr_b16 v[24:25], v194 offset:24576
    v_mfma_f32_16x16x32_bf16 v[156:159], v[28:31], v[52:55], v[156:159]
    ds_read_b64_tr_b16 v[26:27], v194 offset:25600
    s_waitcnt lgkmcnt(12)
    v_mfma_f32_16x16x32_bf16 v[160:163], v[32:35], v[48:51], v[160:163]
    ds_read_b64_tr_b16 v[28:29], v195 offset:24576
    v_mfma_f32_16x16x32_bf16 v[164:167], v[32:35], v[52:55], v[164:167]
    ds_read_b64_tr_b16 v[30:31], v195 offset:25600
    s_waitcnt lgkmcnt(12)
    v_mfma_f32_16x16x32_bf16 v[168:171], v[36:39], v[48:51], v[168:171]
    ds_read_b64_tr_b16 v[32:33], v196 offset:24576
    v_mfma_f32_16x16x32_bf16 v[172:175], v[36:39], v[52:55], v[172:175]
    ds_read_b64_tr_b16 v[34:35], v196 offset:25600
    s_waitcnt lgkmcnt(12)
    v_mfma_f32_16x16x32_bf16 v[176:179], v[40:43], v[48:51], v[176:179]
    ds_read_b64_tr_b16 v[36:37], v197 offset:24576
    buffer_load_dwordx4 v[100:103], v8, s[16:19], s68 offen offset:256 sc1
    v_mfma_f32_16x16x32_bf16 v[180:183], v[40:43], v[52:55], v[180:183]
    ds_read_b64_tr_b16 v[38:39], v197 offset:25600
    s_waitcnt lgkmcnt(12)
    v_mfma_f32_16x16x32_bf16 v[184:187], v[44:47], v[48:51], v[184:187]
    ds_read_b64_tr_b16 v[40:41], v198 offset:24576
    v_mfma_f32_16x16x32_bf16 v[188:191], v[44:47], v[52:55], v[188:191]
    ds_read_b64_tr_b16 v[42:43], v198 offset:25600
    s_waitcnt vmcnt(10)
    s_waitcnt lgkmcnt(12)
    v_mfma_f32_16x16x32_bf16 v[128:131], v[16:19], v[56:59], v[128:131]
    ds_read_b64_tr_b16 v[44:45], v199 offset:24576
    v_mfma_f32_16x16x32_bf16 v[132:135], v[16:19], v[60:63], v[132:135]
    ds_read_b64_tr_b16 v[46:47], v199 offset:25600
    s_waitcnt lgkmcnt(12)
    v_mfma_f32_16x16x32_bf16 v[136:139], v[20:23], v[56:59], v[136:139]
    ds_read_b64_tr_b16 v[16:17], v192 offset:32768
    v_mfma_f32_16x16x32_bf16 v[140:143], v[20:23], v[60:63], v[140:143]
    ds_read_b64_tr_b16 v[18:19], v192 offset:33792
    s_waitcnt lgkmcnt(12)
    v_mfma_f32_16x16x32_bf16 v[144:147], v[24:27], v[56:59], v[144:147]
    ds_read_b64_tr_b16 v[20:21], v193 offset:32768
    buffer_load_dwordx4 v[104:107], v8, s[16:19], s68 offen offset:2048 sc1
    v_mfma_f32_16x16x32_bf16 v[148:151], v[24:27], v[60:63], v[148:151]
    ds_read_b64_tr_b16 v[22:23], v193 offset:33792
    s_waitcnt lgkmcnt(12)
    v_mfma_f32_16x16x32_bf16 v[152:155], v[28:31], v[56:59], v[152:155]
    ds_read_b64_tr_b16 v[24:25], v194 offset:32768
    v_mfma_f32_16x16x32_bf16 v[156:159], v[28:31], v[60:63], v[156:159]
    ds_read_b64_tr_b16 v[26:27], v194 offset:33792
    s_waitcnt lgkmcnt(12)
    v_mfma_f32_16x16x32_bf16 v[160:163], v[32:35], v[56:59], v[160:163]
    ds_read_b64_tr_b16 v[28:29], v195 offset:32768
    v_mfma_f32_16x16x32_bf16 v[164:167], v[32:35], v[60:63], v[164:167]
    ds_read_b64_tr_b16 v[30:31], v195 offset:33792
    s_waitcnt lgkmcnt(12)
    v_mfma_f32_16x16x32_bf16 v[168:171], v[36:39], v[56:59], v[168:171]
    ds_read_b64_tr_b16 v[32:33], v196 offset:32768
    v_mfma_f32_16x16x32_bf16 v[172:175], v[36:39], v[60:63], v[172:175]
    ds_read_b64_tr_b16 v[34:35], v196 offset:33792
    s_waitcnt lgkmcnt(12)
    v_mfma_f32_16x16x32_bf16 v[176:179], v[40:43], v[56:59], v[176:179]
    ds_read_b64_tr_b16 v[36:37], v197 offset:32768
    buffer_load_dwordx4 v[108:111], v8, s[16:19], s68 offen offset:2304 sc1
    s_add_u32 s68, s68, 4096
    v_mfma_f32_16x16x32_bf16 v[180:183], v[40:43], v[60:63], v[180:183]
    ds_read_b64_tr_b16 v[38:39], v197 offset:33792
    s_waitcnt lgkmcnt(12)
    v_mfma_f32_16x16x32_bf16 v[184:187], v[44:47], v[56:59], v[184:187]
    ds_read_b64_tr_b16 v[40:41], v198 offset:32768
    v_mfma_f32_16x16x32_bf16 v[188:191], v[44:47], v[60:63], v[188:191]
    ds_read_b64_tr_b16 v[42:43], v198 offset:33792
    s_waitcnt vmcnt(10)
    s_waitcnt lgkmcnt(12)
    v_mfma_f32_16x16x32_bf16 v[128:131], v[16:19], v[64:67], v[128:131]
    ds_read_b64_tr_b16 v[44:45], v199 offset:32768
    v_mfma_f32_16x16x32_bf16 v[132:135], v[16:19], v[68:71], v[132:135]
    ds_read_b64_tr_b16 v[46:47], v199 offset:33792
    s_waitcnt lgkmcnt(12)
    v_mfma_f32_16x16x32_bf16 v[136:139], v[20:23], v[64:67], v[136:139]
    ds_read_b64_tr_b16 v[16:17], v192 offset:40960
    v_mfma_f32_16x16x32_bf16 v[140:143], v[20:23], v[68:71], v[140:143]
    ds_read_b64_tr_b16 v[18:19], v192 offset:41984
    s_waitcnt lgkmcnt(12)
    v_mfma_f32_16x16x32_bf16 v[144:147], v[24:27], v[64:67], v[144:147]
    ds_read_b64_tr_b16 v[20:21], v193 offset:40960
    buffer_load_dwordx4 v[48:51], v8, s[16:19], s68 offen offset:0 sc1
    v_mfma_f32_16x16x32_bf16 v[148:151], v[24:27], v[68:71], v[148:151]
    ds_read_b64_tr_b16 v[22:23], v193 offset:41984
    s_waitcnt lgkmcnt(12)
    v_mfma_f32_16x16x32_bf16 v[152:155], v[28:31], v[64:67], v[152:155]
    ds_read_b64_tr_b16 v[24:25], v194 offset:40960
    v_mfma_f32_16x16x32_bf16 v[156:159], v[28:31], v[68:71], v[156:159]
    ds_read_b64_tr_b16 v[26:27], v194 offset:41984
    s_waitcnt lgkmcnt(12)
    v_mfma_f32_16x16x32_bf16 v[160:163], v[32:35], v[64:67], v[160:163]
    ds_read_b64_tr_b16 v[28:29], v195 offset:40960
    v_mfma_f32_16x16x32_bf16 v[164:167], v[32:35], v[68:71], v[164:167]
    ds_read_b64_tr_b16 v[30:31], v195 offset:41984
    s_waitcnt lgkmcnt(12)
    v_mfma_f32_16x16x32_bf16 v[168:171], v[36:39], v[64:67], v[168:171]
    ds_read_b64_tr_b16 v[32:33], v196 offset:40960
    v_mfma_f32_16x16x32_bf16 v[172:175], v[36:39], v[68:71], v[172:175]
    ds_read_b64_tr_b16 v[34:35], v196 offset:41984
    s_waitcnt lgkmcnt(12)
    v_mfma_f32_16x16x32_bf16 v[176:179], v[40:43], v[64:67], v[176:179]
    ds_read_b64_tr_b16 v[36:37], v197 offset:40960
    buffer_load_dwordx4 v[52:55], v8, s[16:19], s68 offen offset:256 sc1
    v_mfma_f32_16x16x32_bf16 v[180:183], v[40:43], v[68:71], v[180:183]
    ds_read_b64_tr_b16 v[38:39], v197 offset:41984
    s_waitcnt lgkmcnt(12)
    v_mfma_f32_16x16x32_bf16 v[184:187], v[44:47], v[64:67], v[184:187]
    ds_read_b64_tr_b16 v[40:41], v198 offset:40960
    v_mfma_f32_16x16x32_bf16 v[188:191], v[44:47], v[68:71], v[188:191]
    ds_read_b64_tr_b16 v[42:43], v198 offset:41984
    s_waitcnt vmcnt(10)
    s_waitcnt lgkmcnt(12)
    v_mfma_f32_16x16x32_bf16 v[128:131], v[16:19], v[72:75], v[128:131]
    ds_read_b64_tr_b16 v[44:45], v199 offset:40960
    v_mfma_f32_16x16x32_bf16 v[132:135], v[16:19], v[76:79], v[132:135]
    ds_read_b64_tr_b16 v[46:47], v199 offset:41984
    s_waitcnt lgkmcnt(12)
    v_mfma_f32_16x16x32_bf16 v[136:139], v[20:23], v[72:75], v[136:139]
    ds_read_b64_tr_b16 v[16:17], v192 offset:49152
    v_mfma_f32_16x16x32_bf16 v[140:143], v[20:23], v[76:79], v[140:143]
    ds_read_b64_tr_b16 v[18:19], v192 offset:50176
    s_waitcnt lgkmcnt(12)
    v_mfma_f32_16x16x32_bf16 v[144:147], v[24:27], v[72:75], v[144:147]
    ds_read_b64_tr_b16 v[20:21], v193 offset:49152
    buffer_load_dwordx4 v[56:59], v8, s[16:19], s68 offen offset:2048 sc1
    v_mfma_f32_16x16x32_bf16 v[148:151], v[24:27], v[76:79], v[148:151]
    ds_read_b64_tr_b16 v[22:23], v193 offset:50176
    s_waitcnt lgkmcnt(12)
    v_mfma_f32_16x16x32_bf16 v[152:155], v[28:31], v[72:75], v[152:155]
    ds_read_b64_tr_b16 v[24:25], v194 offset:49152
    v_mfma_f32_16x16x32_bf16 v[156:159], v[28:31], v[76:79], v[156:159]
    ds_read_b64_tr_b16 v[26:27], v194 offset:50176
    s_waitcnt lgkmcnt(12)
    v_mfma_f32_16x16x32_bf16 v[160:163], v[32:35], v[72:75], v[160:163]
    ds_read_b64_tr_b16 v[28:29], v195 offset:49152
    v_mfma_f32_16x16x32_bf16 v[164:167], v[32:35], v[76:79], v[164:167]
    ds_read_b64_tr_b16 v[30:31], v195 offset:50176
    s_waitcnt lgkmcnt(12)
    v_mfma_f32_16x16x32_bf16 v[168:171], v[36:39], v[72:75], v[168:171]
    ds_read_b64_tr_b16 v[32:33], v196 offset:49152
    v_mfma_f32_16x16x32_bf16 v[172:175], v[36:39], v[76:79], v[172:175]
    ds_read_b64_tr_b16 v[34:35], v196 offset:50176
    s_waitcnt lgkmcnt(12)
    v_mfma_f32_16x16x32_bf16 v[176:179], v[40:43], v[72:75], v[176:179]
    ds_read_b64_tr_b16 v[36:37], v197 offset:49152
    buffer_load_dwordx4 v[60:63], v8, s[16:19], s68 offen offset:2304 sc1
    s_add_u32 s68, s68, 4096
    v_mfma_f32_16x16x32_bf16 v[180:183], v[40:43], v[76:79], v[180:183]
    ds_read_b64_tr_b16 v[38:39], v197 offset:50176
    s_waitcnt lgkmcnt(12)
    v_mfma_f32_16x16x32_bf16 v[184:187], v[44:47], v[72:75], v[184:187]
    ds_read_b64_tr_b16 v[40:41], v198 offset:49152
    v_mfma_f32_16x16x32_bf16 v[188:191], v[44:47], v[76:79], v[188:191]
    ds_read_b64_tr_b16 v[42:43], v198 offset:50176
    s_waitcnt vmcnt(10)
    s_waitcnt lgkmcnt(12)
    v_mfma_f32_16x16x32_bf16 v[128:131], v[16:19], v[80:83], v[128:131]
    ds_read_b64_tr_b16 v[44:45], v199 offset:49152
    v_mfma_f32_16x16x32_bf16 v[132:135], v[16:19], v[84:87], v[132:135]
    ds_read_b64_tr_b16 v[46:47], v199 offset:50176
    s_waitcnt lgkmcnt(12)
    v_mfma_f32_16x16x32_bf16 v[136:139], v[20:23], v[80:83], v[136:139]
    s_barrier
LadaLN_cond__grouped_kv_mqa__dense_activation_relu__prompt_kernel_fb9:
    ds_read_b64_tr_b16 v[16:17], v192 offset:57344
    v_mfma_f32_16x16x32_bf16 v[140:143], v[20:23], v[84:87], v[140:143]
    ds_read_b64_tr_b16 v[18:19], v192 offset:58368
    s_waitcnt lgkmcnt(12)
    v_mfma_f32_16x16x32_bf16 v[144:147], v[24:27], v[80:83], v[144:147]
    ds_read_b64_tr_b16 v[20:21], v193 offset:57344
    buffer_load_dwordx4 v[64:67], v8, s[16:19], s68 offen offset:0 sc1
    v_mfma_f32_16x16x32_bf16 v[148:151], v[24:27], v[84:87], v[148:151]
    ds_read_b64_tr_b16 v[22:23], v193 offset:58368
    s_waitcnt lgkmcnt(12)
    v_mfma_f32_16x16x32_bf16 v[152:155], v[28:31], v[80:83], v[152:155]
    ds_read_b64_tr_b16 v[24:25], v194 offset:57344
    v_mfma_f32_16x16x32_bf16 v[156:159], v[28:31], v[84:87], v[156:159]
    ds_read_b64_tr_b16 v[26:27], v194 offset:58368
    s_waitcnt lgkmcnt(12)
    v_mfma_f32_16x16x32_bf16 v[160:163], v[32:35], v[80:83], v[160:163]
    ds_read_b64_tr_b16 v[28:29], v195 offset:57344
    v_mfma_f32_16x16x32_bf16 v[164:167], v[32:35], v[84:87], v[164:167]
    ds_read_b64_tr_b16 v[30:31], v195 offset:58368
    s_waitcnt lgkmcnt(12)
    v_mfma_f32_16x16x32_bf16 v[168:171], v[36:39], v[80:83], v[168:171]
    ds_read_b64_tr_b16 v[32:33], v196 offset:57344
    v_mfma_f32_16x16x32_bf16 v[172:175], v[36:39], v[84:87], v[172:175]
    ds_read_b64_tr_b16 v[34:35], v196 offset:58368
    s_waitcnt lgkmcnt(12)
    v_mfma_f32_16x16x32_bf16 v[176:179], v[40:43], v[80:83], v[176:179]
    ds_read_b64_tr_b16 v[36:37], v197 offset:57344
    buffer_load_dwordx4 v[68:71], v8, s[16:19], s68 offen offset:256 sc1
    v_mfma_f32_16x16x32_bf16 v[180:183], v[40:43], v[84:87], v[180:183]
    ds_read_b64_tr_b16 v[38:39], v197 offset:58368
    s_waitcnt lgkmcnt(12)
    v_mfma_f32_16x16x32_bf16 v[184:187], v[44:47], v[80:83], v[184:187]
    ds_read_b64_tr_b16 v[40:41], v198 offset:57344
    v_mfma_f32_16x16x32_bf16 v[188:191], v[44:47], v[84:87], v[188:191]
    ds_read_b64_tr_b16 v[42:43], v198 offset:58368
    s_waitcnt vmcnt(10)
    s_waitcnt lgkmcnt(12)
    v_mfma_f32_16x16x32_bf16 v[128:131], v[16:19], v[88:91], v[128:131]
    ds_read_b64_tr_b16 v[44:45], v199 offset:57344
    v_mfma_f32_16x16x32_bf16 v[132:135], v[16:19], v[92:95], v[132:135]
    ds_read_b64_tr_b16 v[46:47], v199 offset:58368
    s_waitcnt lgkmcnt(12)
    v_mfma_f32_16x16x32_bf16 v[136:139], v[20:23], v[88:91], v[136:139]
    v_add_u32 v192, 0x10000, v192
    v_add_u32 v193, 0x10000, v193
    v_add_u32 v194, 0x10000, v194
    v_add_u32 v195, 0x10000, v195
    v_add_u32 v196, 0x10000, v196
    v_add_u32 v197, 0x10000, v197
    v_add_u32 v198, 0x10000, v198
    v_add_u32 v199, 0x10000, v199
    ds_read_b64_tr_b16 v[16:17], v192 offset:0
    v_mfma_f32_16x16x32_bf16 v[140:143], v[20:23], v[92:95], v[140:143]
    ds_read_b64_tr_b16 v[18:19], v192 offset:1024
    s_waitcnt lgkmcnt(12)
    v_mfma_f32_16x16x32_bf16 v[144:147], v[24:27], v[88:91], v[144:147]
    ds_read_b64_tr_b16 v[20:21], v193 offset:0
    buffer_load_dwordx4 v[72:75], v8, s[16:19], s68 offen offset:2048 sc1
    v_mfma_f32_16x16x32_bf16 v[148:151], v[24:27], v[92:95], v[148:151]
    ds_read_b64_tr_b16 v[22:23], v193 offset:1024
    s_waitcnt lgkmcnt(12)
    v_mfma_f32_16x16x32_bf16 v[152:155], v[28:31], v[88:91], v[152:155]
    ds_read_b64_tr_b16 v[24:25], v194 offset:0
    v_mfma_f32_16x16x32_bf16 v[156:159], v[28:31], v[92:95], v[156:159]
    ds_read_b64_tr_b16 v[26:27], v194 offset:1024
    s_waitcnt lgkmcnt(12)
    v_mfma_f32_16x16x32_bf16 v[160:163], v[32:35], v[88:91], v[160:163]
    ds_read_b64_tr_b16 v[28:29], v195 offset:0
    v_mfma_f32_16x16x32_bf16 v[164:167], v[32:35], v[92:95], v[164:167]
    ds_read_b64_tr_b16 v[30:31], v195 offset:1024
    s_waitcnt lgkmcnt(12)
    v_mfma_f32_16x16x32_bf16 v[168:171], v[36:39], v[88:91], v[168:171]
    ds_read_b64_tr_b16 v[32:33], v196 offset:0
    v_mfma_f32_16x16x32_bf16 v[172:175], v[36:39], v[92:95], v[172:175]
    ds_read_b64_tr_b16 v[34:35], v196 offset:1024
    s_waitcnt lgkmcnt(12)
    v_mfma_f32_16x16x32_bf16 v[176:179], v[40:43], v[88:91], v[176:179]
    ds_read_b64_tr_b16 v[36:37], v197 offset:0
    buffer_load_dwordx4 v[76:79], v8, s[16:19], s68 offen offset:2304 sc1
    s_add_u32 s68, s68, 4096
    v_mfma_f32_16x16x32_bf16 v[180:183], v[40:43], v[92:95], v[180:183]
    ds_read_b64_tr_b16 v[38:39], v197 offset:1024
    s_waitcnt lgkmcnt(12)
    v_mfma_f32_16x16x32_bf16 v[184:187], v[44:47], v[88:91], v[184:187]
    ds_read_b64_tr_b16 v[40:41], v198 offset:0
    v_mfma_f32_16x16x32_bf16 v[188:191], v[44:47], v[92:95], v[188:191]
    ds_read_b64_tr_b16 v[42:43], v198 offset:1024
    s_waitcnt vmcnt(10)
    s_waitcnt lgkmcnt(12)
    v_mfma_f32_16x16x32_bf16 v[128:131], v[16:19], v[96:99], v[128:131]
    ds_read_b64_tr_b16 v[44:45], v199 offset:0
    v_mfma_f32_16x16x32_bf16 v[132:135], v[16:19], v[100:103], v[132:135]
    ds_read_b64_tr_b16 v[46:47], v199 offset:1024
    s_waitcnt lgkmcnt(12)
    v_mfma_f32_16x16x32_bf16 v[136:139], v[20:23], v[96:99], v[136:139]
    ds_read_b64_tr_b16 v[16:17], v192 offset:8192
    v_mfma_f32_16x16x32_bf16 v[140:143], v[20:23], v[100:103], v[140:143]
    ds_read_b64_tr_b16 v[18:19], v192 offset:9216
    s_waitcnt lgkmcnt(12)
    v_mfma_f32_16x16x32_bf16 v[144:147], v[24:27], v[96:99], v[144:147]
    ds_read_b64_tr_b16 v[20:21], v193 offset:8192
    buffer_load_dwordx4 v[80:83], v8, s[16:19], s68 offen offset:0 sc1
    v_mfma_f32_16x16x32_bf16 v[148:151], v[24:27], v[100:103], v[148:151]
    ds_read_b64_tr_b16 v[22:23], v193 offset:9216
    s_waitcnt lgkmcnt(12)
    v_mfma_f32_16x16x32_bf16 v[152:155], v[28:31], v[96:99], v[152:155]
    ds_read_b64_tr_b16 v[24:25], v194 offset:8192
    v_mfma_f32_16x16x32_bf16 v[156:159], v[28:31], v[100:103], v[156:159]
    ds_read_b64_tr_b16 v[26:27], v194 offset:9216
    s_waitcnt lgkmcnt(12)
    v_mfma_f32_16x16x32_bf16 v[160:163], v[32:35], v[96:99], v[160:163]
    ds_read_b64_tr_b16 v[28:29], v195 offset:8192
    v_mfma_f32_16x16x32_bf16 v[164:167], v[32:35], v[100:103], v[164:167]
    ds_read_b64_tr_b16 v[30:31], v195 offset:9216
    s_waitcnt lgkmcnt(12)
    v_mfma_f32_16x16x32_bf16 v[168:171], v[36:39], v[96:99], v[168:171]
    ds_read_b64_tr_b16 v[32:33], v196 offset:8192
    v_mfma_f32_16x16x32_bf16 v[172:175], v[36:39], v[100:103], v[172:175]
    ds_read_b64_tr_b16 v[34:35], v196 offset:9216
    s_waitcnt lgkmcnt(12)
    v_mfma_f32_16x16x32_bf16 v[176:179], v[40:43], v[96:99], v[176:179]
    ds_read_b64_tr_b16 v[36:37], v197 offset:8192
    buffer_load_dwordx4 v[84:87], v8, s[16:19], s68 offen offset:256 sc1
    v_mfma_f32_16x16x32_bf16 v[180:183], v[40:43], v[100:103], v[180:183]
    ds_read_b64_tr_b16 v[38:39], v197 offset:9216
    s_waitcnt lgkmcnt(12)
    v_mfma_f32_16x16x32_bf16 v[184:187], v[44:47], v[96:99], v[184:187]
    ds_read_b64_tr_b16 v[40:41], v198 offset:8192
    v_mfma_f32_16x16x32_bf16 v[188:191], v[44:47], v[100:103], v[188:191]
    ds_read_b64_tr_b16 v[42:43], v198 offset:9216
    s_waitcnt vmcnt(10)
    s_waitcnt lgkmcnt(12)
    v_mfma_f32_16x16x32_bf16 v[128:131], v[16:19], v[104:107], v[128:131]
    ds_read_b64_tr_b16 v[44:45], v199 offset:8192
    v_mfma_f32_16x16x32_bf16 v[132:135], v[16:19], v[108:111], v[132:135]
    ds_read_b64_tr_b16 v[46:47], v199 offset:9216
    s_waitcnt lgkmcnt(12)
    v_mfma_f32_16x16x32_bf16 v[136:139], v[20:23], v[104:107], v[136:139]
    v_add_u32 v192, 0xfffe0000, v192
    v_add_u32 v193, 0xfffe0000, v193
    v_add_u32 v194, 0xfffe0000, v194
    v_add_u32 v195, 0xfffe0000, v195
    v_add_u32 v196, 0xfffe0000, v196
    v_add_u32 v197, 0xfffe0000, v197
    v_add_u32 v198, 0xfffe0000, v198
    v_add_u32 v199, 0xfffe0000, v199
    ds_read_b64_tr_b16 v[16:17], v192 offset:0
    v_mfma_f32_16x16x32_bf16 v[140:143], v[20:23], v[108:111], v[140:143]
    ds_read_b64_tr_b16 v[18:19], v192 offset:1024
    s_waitcnt lgkmcnt(12)
    v_mfma_f32_16x16x32_bf16 v[144:147], v[24:27], v[104:107], v[144:147]
    ds_read_b64_tr_b16 v[20:21], v193 offset:0
    buffer_load_dwordx4 v[88:91], v8, s[16:19], s68 offen offset:2048 sc1
    v_mfma_f32_16x16x32_bf16 v[148:151], v[24:27], v[108:111], v[148:151]
    ds_read_b64_tr_b16 v[22:23], v193 offset:1024
    s_waitcnt lgkmcnt(12)
    v_mfma_f32_16x16x32_bf16 v[152:155], v[28:31], v[104:107], v[152:155]
    ds_read_b64_tr_b16 v[24:25], v194 offset:0
    v_mfma_f32_16x16x32_bf16 v[156:159], v[28:31], v[108:111], v[156:159]
    ds_read_b64_tr_b16 v[26:27], v194 offset:1024
    s_waitcnt lgkmcnt(12)
    v_mfma_f32_16x16x32_bf16 v[160:163], v[32:35], v[104:107], v[160:163]
    ds_read_b64_tr_b16 v[28:29], v195 offset:0
    v_mfma_f32_16x16x32_bf16 v[164:167], v[32:35], v[108:111], v[164:167]
    ds_read_b64_tr_b16 v[30:31], v195 offset:1024
    s_waitcnt lgkmcnt(12)
    v_mfma_f32_16x16x32_bf16 v[168:171], v[36:39], v[104:107], v[168:171]
    ds_read_b64_tr_b16 v[32:33], v196 offset:0
    v_mfma_f32_16x16x32_bf16 v[172:175], v[36:39], v[108:111], v[172:175]
    ds_read_b64_tr_b16 v[34:35], v196 offset:1024
    s_waitcnt lgkmcnt(12)
    v_mfma_f32_16x16x32_bf16 v[176:179], v[40:43], v[104:107], v[176:179]
    ds_read_b64_tr_b16 v[36:37], v197 offset:0
    buffer_load_dwordx4 v[92:95], v8, s[16:19], s68 offen offset:2304 sc1
    s_add_u32 s68, s68, 4096
    v_mfma_f32_16x16x32_bf16 v[180:183], v[40:43], v[108:111], v[180:183]
    ds_read_b64_tr_b16 v[38:39], v197 offset:1024
    s_waitcnt lgkmcnt(12)
    v_mfma_f32_16x16x32_bf16 v[184:187], v[44:47], v[104:107], v[184:187]
    ds_read_b64_tr_b16 v[40:41], v198 offset:0
    v_mfma_f32_16x16x32_bf16 v[188:191], v[44:47], v[108:111], v[188:191]
    ds_read_b64_tr_b16 v[42:43], v198 offset:1024
    s_waitcnt vmcnt(10)
    s_waitcnt lgkmcnt(12)
    v_mfma_f32_16x16x32_bf16 v[128:131], v[16:19], v[48:51], v[128:131]
    ds_read_b64_tr_b16 v[44:45], v199 offset:0
    v_mfma_f32_16x16x32_bf16 v[132:135], v[16:19], v[52:55], v[132:135]
    ds_read_b64_tr_b16 v[46:47], v199 offset:1024
    s_waitcnt lgkmcnt(12)
    v_mfma_f32_16x16x32_bf16 v[136:139], v[20:23], v[48:51], v[136:139]
    s_barrier
LadaLN_cond__grouped_kv_mqa__dense_activation_relu__prompt_kernel_fb10:
    ds_read_b64_tr_b16 v[16:17], v192 offset:8192
    v_mfma_f32_16x16x32_bf16 v[140:143], v[20:23], v[52:55], v[140:143]
    ds_read_b64_tr_b16 v[18:19], v192 offset:9216
    s_waitcnt lgkmcnt(12)
    v_mfma_f32_16x16x32_bf16 v[144:147], v[24:27], v[48:51], v[144:147]
    ds_read_b64_tr_b16 v[20:21], v193 offset:8192
    buffer_load_dwordx4 v[96:99], v8, s[16:19], s68 offen offset:0 sc1
    v_mfma_f32_16x16x32_bf16 v[148:151], v[24:27], v[52:55], v[148:151]
    ds_read_b64_tr_b16 v[22:23], v193 offset:9216
    s_waitcnt lgkmcnt(12)
    v_mfma_f32_16x16x32_bf16 v[152:155], v[28:31], v[48:51], v[152:155]
    ds_read_b64_tr_b16 v[24:25], v194 offset:8192
    v_mfma_f32_16x16x32_bf16 v[156:159], v[28:31], v[52:55], v[156:159]
    ds_read_b64_tr_b16 v[26:27], v194 offset:9216
    s_waitcnt lgkmcnt(12)
    v_mfma_f32_16x16x32_bf16 v[160:163], v[32:35], v[48:51], v[160:163]
    ds_read_b64_tr_b16 v[28:29], v195 offset:8192
    v_mfma_f32_16x16x32_bf16 v[164:167], v[32:35], v[52:55], v[164:167]
    ds_read_b64_tr_b16 v[30:31], v195 offset:9216
    s_waitcnt lgkmcnt(12)
    v_mfma_f32_16x16x32_bf16 v[168:171], v[36:39], v[48:51], v[168:171]
    ds_read_b64_tr_b16 v[32:33], v196 offset:8192
    v_mfma_f32_16x16x32_bf16 v[172:175], v[36:39], v[52:55], v[172:175]
    ds_read_b64_tr_b16 v[34:35], v196 offset:9216
    s_waitcnt lgkmcnt(12)
    v_mfma_f32_16x16x32_bf16 v[176:179], v[40:43], v[48:51], v[176:179]
    ds_read_b64_tr_b16 v[36:37], v197 offset:8192
    buffer_load_dwordx4 v[100:103], v8, s[16:19], s68 offen offset:256 sc1
    v_mfma_f32_16x16x32_bf16 v[180:183], v[40:43], v[52:55], v[180:183]
    ds_read_b64_tr_b16 v[38:39], v197 offset:9216
    s_waitcnt lgkmcnt(12)
    v_mfma_f32_16x16x32_bf16 v[184:187], v[44:47], v[48:51], v[184:187]
    ds_read_b64_tr_b16 v[40:41], v198 offset:8192
    v_mfma_f32_16x16x32_bf16 v[188:191], v[44:47], v[52:55], v[188:191]
    ds_read_b64_tr_b16 v[42:43], v198 offset:9216
    s_waitcnt vmcnt(10)
    s_waitcnt lgkmcnt(12)
    v_mfma_f32_16x16x32_bf16 v[128:131], v[16:19], v[56:59], v[128:131]
    ds_read_b64_tr_b16 v[44:45], v199 offset:8192
    v_mfma_f32_16x16x32_bf16 v[132:135], v[16:19], v[60:63], v[132:135]
    ds_read_b64_tr_b16 v[46:47], v199 offset:9216
    s_waitcnt lgkmcnt(12)
    v_mfma_f32_16x16x32_bf16 v[136:139], v[20:23], v[56:59], v[136:139]
    ds_read_b64_tr_b16 v[16:17], v192 offset:16384
    v_mfma_f32_16x16x32_bf16 v[140:143], v[20:23], v[60:63], v[140:143]
    ds_read_b64_tr_b16 v[18:19], v192 offset:17408
    s_waitcnt lgkmcnt(12)
    v_mfma_f32_16x16x32_bf16 v[144:147], v[24:27], v[56:59], v[144:147]
    ds_read_b64_tr_b16 v[20:21], v193 offset:16384
    buffer_load_dwordx4 v[104:107], v8, s[16:19], s68 offen offset:2048 sc1
    v_mfma_f32_16x16x32_bf16 v[148:151], v[24:27], v[60:63], v[148:151]
    ds_read_b64_tr_b16 v[22:23], v193 offset:17408
    s_waitcnt lgkmcnt(12)
    v_mfma_f32_16x16x32_bf16 v[152:155], v[28:31], v[56:59], v[152:155]
    ds_read_b64_tr_b16 v[24:25], v194 offset:16384
    v_mfma_f32_16x16x32_bf16 v[156:159], v[28:31], v[60:63], v[156:159]
    ds_read_b64_tr_b16 v[26:27], v194 offset:17408
    s_waitcnt lgkmcnt(12)
    v_mfma_f32_16x16x32_bf16 v[160:163], v[32:35], v[56:59], v[160:163]
    ds_read_b64_tr_b16 v[28:29], v195 offset:16384
    v_mfma_f32_16x16x32_bf16 v[164:167], v[32:35], v[60:63], v[164:167]
    ds_read_b64_tr_b16 v[30:31], v195 offset:17408
    s_waitcnt lgkmcnt(12)
    v_mfma_f32_16x16x32_bf16 v[168:171], v[36:39], v[56:59], v[168:171]
    ds_read_b64_tr_b16 v[32:33], v196 offset:16384
    v_mfma_f32_16x16x32_bf16 v[172:175], v[36:39], v[60:63], v[172:175]
    ds_read_b64_tr_b16 v[34:35], v196 offset:17408
    s_waitcnt lgkmcnt(12)
    v_mfma_f32_16x16x32_bf16 v[176:179], v[40:43], v[56:59], v[176:179]
    ds_read_b64_tr_b16 v[36:37], v197 offset:16384
    buffer_load_dwordx4 v[108:111], v8, s[16:19], s68 offen offset:2304 sc1
    s_add_u32 s68, s68, 4096
    v_mfma_f32_16x16x32_bf16 v[180:183], v[40:43], v[60:63], v[180:183]
    ds_read_b64_tr_b16 v[38:39], v197 offset:17408
    s_waitcnt lgkmcnt(12)
    v_mfma_f32_16x16x32_bf16 v[184:187], v[44:47], v[56:59], v[184:187]
    ds_read_b64_tr_b16 v[40:41], v198 offset:16384
    v_mfma_f32_16x16x32_bf16 v[188:191], v[44:47], v[60:63], v[188:191]
    ds_read_b64_tr_b16 v[42:43], v198 offset:17408
    s_waitcnt vmcnt(10)
    s_waitcnt lgkmcnt(12)
    v_mfma_f32_16x16x32_bf16 v[128:131], v[16:19], v[64:67], v[128:131]
    ds_read_b64_tr_b16 v[44:45], v199 offset:16384
    v_mfma_f32_16x16x32_bf16 v[132:135], v[16:19], v[68:71], v[132:135]
    ds_read_b64_tr_b16 v[46:47], v199 offset:17408
    s_waitcnt lgkmcnt(12)
    v_mfma_f32_16x16x32_bf16 v[136:139], v[20:23], v[64:67], v[136:139]
    ds_read_b64_tr_b16 v[16:17], v192 offset:24576
    v_mfma_f32_16x16x32_bf16 v[140:143], v[20:23], v[68:71], v[140:143]
    ds_read_b64_tr_b16 v[18:19], v192 offset:25600
    s_waitcnt lgkmcnt(12)
    v_mfma_f32_16x16x32_bf16 v[144:147], v[24:27], v[64:67], v[144:147]
    ds_read_b64_tr_b16 v[20:21], v193 offset:24576
    buffer_load_dwordx4 v[48:51], v8, s[16:19], s68 offen offset:0 sc1
    v_mfma_f32_16x16x32_bf16 v[148:151], v[24:27], v[68:71], v[148:151]
    ds_read_b64_tr_b16 v[22:23], v193 offset:25600
    s_waitcnt lgkmcnt(12)
    v_mfma_f32_16x16x32_bf16 v[152:155], v[28:31], v[64:67], v[152:155]
    ds_read_b64_tr_b16 v[24:25], v194 offset:24576
    v_mfma_f32_16x16x32_bf16 v[156:159], v[28:31], v[68:71], v[156:159]
    ds_read_b64_tr_b16 v[26:27], v194 offset:25600
    s_waitcnt lgkmcnt(12)
    v_mfma_f32_16x16x32_bf16 v[160:163], v[32:35], v[64:67], v[160:163]
    ds_read_b64_tr_b16 v[28:29], v195 offset:24576
    v_mfma_f32_16x16x32_bf16 v[164:167], v[32:35], v[68:71], v[164:167]
    ds_read_b64_tr_b16 v[30:31], v195 offset:25600
    s_waitcnt lgkmcnt(12)
    v_mfma_f32_16x16x32_bf16 v[168:171], v[36:39], v[64:67], v[168:171]
    ds_read_b64_tr_b16 v[32:33], v196 offset:24576
    v_mfma_f32_16x16x32_bf16 v[172:175], v[36:39], v[68:71], v[172:175]
    ds_read_b64_tr_b16 v[34:35], v196 offset:25600
    s_waitcnt lgkmcnt(12)
    v_mfma_f32_16x16x32_bf16 v[176:179], v[40:43], v[64:67], v[176:179]
    ds_read_b64_tr_b16 v[36:37], v197 offset:24576
    buffer_load_dwordx4 v[52:55], v8, s[16:19], s68 offen offset:256 sc1
    v_mfma_f32_16x16x32_bf16 v[180:183], v[40:43], v[68:71], v[180:183]
    ds_read_b64_tr_b16 v[38:39], v197 offset:25600
    s_waitcnt lgkmcnt(12)
    v_mfma_f32_16x16x32_bf16 v[184:187], v[44:47], v[64:67], v[184:187]
    ds_read_b64_tr_b16 v[40:41], v198 offset:24576
    v_mfma_f32_16x16x32_bf16 v[188:191], v[44:47], v[68:71], v[188:191]
    ds_read_b64_tr_b16 v[42:43], v198 offset:25600
    s_waitcnt vmcnt(10)
    s_waitcnt lgkmcnt(12)
    v_mfma_f32_16x16x32_bf16 v[128:131], v[16:19], v[72:75], v[128:131]
    ds_read_b64_tr_b16 v[44:45], v199 offset:24576
    v_mfma_f32_16x16x32_bf16 v[132:135], v[16:19], v[76:79], v[132:135]
    ds_read_b64_tr_b16 v[46:47], v199 offset:25600
    s_waitcnt lgkmcnt(12)
    v_mfma_f32_16x16x32_bf16 v[136:139], v[20:23], v[72:75], v[136:139]
    ds_read_b64_tr_b16 v[16:17], v192 offset:32768
    v_mfma_f32_16x16x32_bf16 v[140:143], v[20:23], v[76:79], v[140:143]
    ds_read_b64_tr_b16 v[18:19], v192 offset:33792
    s_waitcnt lgkmcnt(12)
    v_mfma_f32_16x16x32_bf16 v[144:147], v[24:27], v[72:75], v[144:147]
    ds_read_b64_tr_b16 v[20:21], v193 offset:32768
    buffer_load_dwordx4 v[56:59], v8, s[16:19], s68 offen offset:2048 sc1
    v_mfma_f32_16x16x32_bf16 v[148:151], v[24:27], v[76:79], v[148:151]
    ds_read_b64_tr_b16 v[22:23], v193 offset:33792
    s_waitcnt lgkmcnt(12)
    v_mfma_f32_16x16x32_bf16 v[152:155], v[28:31], v[72:75], v[152:155]
    ds_read_b64_tr_b16 v[24:25], v194 offset:32768
    v_mfma_f32_16x16x32_bf16 v[156:159], v[28:31], v[76:79], v[156:159]
    ds_read_b64_tr_b16 v[26:27], v194 offset:33792
    s_waitcnt lgkmcnt(12)
    v_mfma_f32_16x16x32_bf16 v[160:163], v[32:35], v[72:75], v[160:163]
    ds_read_b64_tr_b16 v[28:29], v195 offset:32768
    v_mfma_f32_16x16x32_bf16 v[164:167], v[32:35], v[76:79], v[164:167]
    ds_read_b64_tr_b16 v[30:31], v195 offset:33792
    s_waitcnt lgkmcnt(12)
    v_mfma_f32_16x16x32_bf16 v[168:171], v[36:39], v[72:75], v[168:171]
    ds_read_b64_tr_b16 v[32:33], v196 offset:32768
    v_mfma_f32_16x16x32_bf16 v[172:175], v[36:39], v[76:79], v[172:175]
    ds_read_b64_tr_b16 v[34:35], v196 offset:33792
    s_waitcnt lgkmcnt(12)
    v_mfma_f32_16x16x32_bf16 v[176:179], v[40:43], v[72:75], v[176:179]
    ds_read_b64_tr_b16 v[36:37], v197 offset:32768
    buffer_load_dwordx4 v[60:63], v8, s[16:19], s68 offen offset:2304 sc1
    s_add_u32 s68, s68, 4096
    v_mfma_f32_16x16x32_bf16 v[180:183], v[40:43], v[76:79], v[180:183]
    ds_read_b64_tr_b16 v[38:39], v197 offset:33792
    s_waitcnt lgkmcnt(12)
    v_mfma_f32_16x16x32_bf16 v[184:187], v[44:47], v[72:75], v[184:187]
    ds_read_b64_tr_b16 v[40:41], v198 offset:32768
    v_mfma_f32_16x16x32_bf16 v[188:191], v[44:47], v[76:79], v[188:191]
    ds_read_b64_tr_b16 v[42:43], v198 offset:33792
    s_waitcnt vmcnt(10)
    s_waitcnt lgkmcnt(12)
    v_mfma_f32_16x16x32_bf16 v[128:131], v[16:19], v[80:83], v[128:131]
    ds_read_b64_tr_b16 v[44:45], v199 offset:32768
    v_mfma_f32_16x16x32_bf16 v[132:135], v[16:19], v[84:87], v[132:135]
    ds_read_b64_tr_b16 v[46:47], v199 offset:33792
    s_waitcnt lgkmcnt(12)
    v_mfma_f32_16x16x32_bf16 v[136:139], v[20:23], v[80:83], v[136:139]
    s_barrier
LadaLN_cond__grouped_kv_mqa__dense_activation_relu__prompt_kernel_fb11:
    s_branch LadaLN_cond__grouped_kv_mqa__dense_activation_relu__prompt_kernel_over15
LadaLN_cond__grouped_kv_mqa__dense_activation_relu__prompt_kernel_stub15:
    s_setpc_b64 s[96:97]
LadaLN_cond__grouped_kv_mqa__dense_activation_relu__prompt_kernel_over15:
    ds_read_b64_tr_b16 v[16:17], v192 offset:40960
    v_mfma_f32_16x16x32_bf16 v[140:143], v[20:23], v[84:87], v[140:143]
    ds_read_b64_tr_b16 v[18:19], v192 offset:41984
    s_waitcnt lgkmcnt(12)
    v_mfma_f32_16x16x32_bf16 v[144:147], v[24:27], v[80:83], v[144:147]
    ds_read_b64_tr_b16 v[20:21], v193 offset:40960
    buffer_load_dwordx4 v[64:67], v8, s[16:19], s68 offen offset:0 sc1
    v_mfma_f32_16x16x32_bf16 v[148:151], v[24:27], v[84:87], v[148:151]
    ds_read_b64_tr_b16 v[22:23], v193 offset:41984
    s_waitcnt lgkmcnt(12)
    v_mfma_f32_16x16x32_bf16 v[152:155], v[28:31], v[80:83], v[152:155]
    ds_read_b64_tr_b16 v[24:25], v194 offset:40960
    v_mfma_f32_16x16x32_bf16 v[156:159], v[28:31], v[84:87], v[156:159]
    ds_read_b64_tr_b16 v[26:27], v194 offset:41984
    s_waitcnt lgkmcnt(12)
    v_mfma_f32_16x16x32_bf16 v[160:163], v[32:35], v[80:83], v[160:163]
    ds_read_b64_tr_b16 v[28:29], v195 offset:40960
    v_mfma_f32_16x16x32_bf16 v[164:167], v[32:35], v[84:87], v[164:167]
    ds_read_b64_tr_b16 v[30:31], v195 offset:41984
    s_waitcnt lgkmcnt(12)
    v_mfma_f32_16x16x32_bf16 v[168:171], v[36:39], v[80:83], v[168:171]
    ds_read_b64_tr_b16 v[32:33], v196 offset:40960
    v_mfma_f32_16x16x32_bf16 v[172:175], v[36:39], v[84:87], v[172:175]
    ds_read_b64_tr_b16 v[34:35], v196 offset:41984
    s_waitcnt lgkmcnt(12)
    v_mfma_f32_16x16x32_bf16 v[176:179], v[40:43], v[80:83], v[176:179]
    ds_read_b64_tr_b16 v[36:37], v197 offset:40960
    buffer_load_dwordx4 v[68:71], v8, s[16:19], s68 offen offset:256 sc1
    v_mfma_f32_16x16x32_bf16 v[180:183], v[40:43], v[84:87], v[180:183]
    ds_read_b64_tr_b16 v[38:39], v197 offset:41984
    s_waitcnt lgkmcnt(12)
    v_mfma_f32_16x16x32_bf16 v[184:187], v[44:47], v[80:83], v[184:187]
    ds_read_b64_tr_b16 v[40:41], v198 offset:40960
    v_mfma_f32_16x16x32_bf16 v[188:191], v[44:47], v[84:87], v[188:191]
    ds_read_b64_tr_b16 v[42:43], v198 offset:41984
    s_waitcnt vmcnt(10)
    s_waitcnt lgkmcnt(12)
    v_mfma_f32_16x16x32_bf16 v[128:131], v[16:19], v[88:91], v[128:131]
    ds_read_b64_tr_b16 v[44:45], v199 offset:40960
    v_mfma_f32_16x16x32_bf16 v[132:135], v[16:19], v[92:95], v[132:135]
    ds_read_b64_tr_b16 v[46:47], v199 offset:41984
    s_waitcnt lgkmcnt(12)
    v_mfma_f32_16x16x32_bf16 v[136:139], v[20:23], v[88:91], v[136:139]
    ds_read_b64_tr_b16 v[16:17], v192 offset:49152
    v_mfma_f32_16x16x32_bf16 v[140:143], v[20:23], v[92:95], v[140:143]
    ds_read_b64_tr_b16 v[18:19], v192 offset:50176
    s_waitcnt lgkmcnt(12)
    v_mfma_f32_16x16x32_bf16 v[144:147], v[24:27], v[88:91], v[144:147]
    ds_read_b64_tr_b16 v[20:21], v193 offset:49152
    buffer_load_dwordx4 v[72:75], v8, s[16:19], s68 offen offset:2048 sc1
    v_mfma_f32_16x16x32_bf16 v[148:151], v[24:27], v[92:95], v[148:151]
    ds_read_b64_tr_b16 v[22:23], v193 offset:50176
    s_waitcnt lgkmcnt(12)
    v_mfma_f32_16x16x32_bf16 v[152:155], v[28:31], v[88:91], v[152:155]
    ds_read_b64_tr_b16 v[24:25], v194 offset:49152
    v_mfma_f32_16x16x32_bf16 v[156:159], v[28:31], v[92:95], v[156:159]
    ds_read_b64_tr_b16 v[26:27], v194 offset:50176
    s_waitcnt lgkmcnt(12)
    v_mfma_f32_16x16x32_bf16 v[160:163], v[32:35], v[88:91], v[160:163]
    ds_read_b64_tr_b16 v[28:29], v195 offset:49152
    v_mfma_f32_16x16x32_bf16 v[164:167], v[32:35], v[92:95], v[164:167]
    ds_read_b64_tr_b16 v[30:31], v195 offset:50176
    s_waitcnt lgkmcnt(12)
    v_mfma_f32_16x16x32_bf16 v[168:171], v[36:39], v[88:91], v[168:171]
    ds_read_b64_tr_b16 v[32:33], v196 offset:49152
    v_mfma_f32_16x16x32_bf16 v[172:175], v[36:39], v[92:95], v[172:175]
    ds_read_b64_tr_b16 v[34:35], v196 offset:50176
    s_waitcnt lgkmcnt(12)
    v_mfma_f32_16x16x32_bf16 v[176:179], v[40:43], v[88:91], v[176:179]
    ds_read_b64_tr_b16 v[36:37], v197 offset:49152
    buffer_load_dwordx4 v[76:79], v8, s[16:19], s68 offen offset:2304 sc1
    s_add_u32 s68, s68, 4096
    v_mfma_f32_16x16x32_bf16 v[180:183], v[40:43], v[92:95], v[180:183]
    ds_read_b64_tr_b16 v[38:39], v197 offset:50176
    s_waitcnt lgkmcnt(12)
    v_mfma_f32_16x16x32_bf16 v[184:187], v[44:47], v[88:91], v[184:187]
    ds_read_b64_tr_b16 v[40:41], v198 offset:49152
    v_mfma_f32_16x16x32_bf16 v[188:191], v[44:47], v[92:95], v[188:191]
    ds_read_b64_tr_b16 v[42:43], v198 offset:50176
    s_waitcnt vmcnt(10)
    s_waitcnt lgkmcnt(12)
    v_mfma_f32_16x16x32_bf16 v[128:131], v[16:19], v[96:99], v[128:131]
    ds_read_b64_tr_b16 v[44:45], v199 offset:49152
    v_mfma_f32_16x16x32_bf16 v[132:135], v[16:19], v[100:103], v[132:135]
    ds_read_b64_tr_b16 v[46:47], v199 offset:50176
    s_waitcnt lgkmcnt(12)
    v_mfma_f32_16x16x32_bf16 v[136:139], v[20:23], v[96:99], v[136:139]
    ds_read_b64_tr_b16 v[16:17], v192 offset:57344
    v_mfma_f32_16x16x32_bf16 v[140:143], v[20:23], v[100:103], v[140:143]
    ds_read_b64_tr_b16 v[18:19], v192 offset:58368
    s_waitcnt lgkmcnt(12)
    v_mfma_f32_16x16x32_bf16 v[144:147], v[24:27], v[96:99], v[144:147]
    ds_read_b64_tr_b16 v[20:21], v193 offset:57344
    buffer_load_dwordx4 v[80:83], v8, s[16:19], s68 offen offset:0 sc1
    v_mfma_f32_16x16x32_bf16 v[148:151], v[24:27], v[100:103], v[148:151]
    ds_read_b64_tr_b16 v[22:23], v193 offset:58368
    s_waitcnt lgkmcnt(12)
    v_mfma_f32_16x16x32_bf16 v[152:155], v[28:31], v[96:99], v[152:155]
    ds_read_b64_tr_b16 v[24:25], v194 offset:57344
    v_mfma_f32_16x16x32_bf16 v[156:159], v[28:31], v[100:103], v[156:159]
    ds_read_b64_tr_b16 v[26:27], v194 offset:58368
    s_waitcnt lgkmcnt(12)
    v_mfma_f32_16x16x32_bf16 v[160:163], v[32:35], v[96:99], v[160:163]
    ds_read_b64_tr_b16 v[28:29], v195 offset:57344
    v_mfma_f32_16x16x32_bf16 v[164:167], v[32:35], v[100:103], v[164:167]
    ds_read_b64_tr_b16 v[30:31], v195 offset:58368
    s_waitcnt lgkmcnt(12)
    v_mfma_f32_16x16x32_bf16 v[168:171], v[36:39], v[96:99], v[168:171]
    ds_read_b64_tr_b16 v[32:33], v196 offset:57344
    v_mfma_f32_16x16x32_bf16 v[172:175], v[36:39], v[100:103], v[172:175]
    ds_read_b64_tr_b16 v[34:35], v196 offset:58368
    s_waitcnt lgkmcnt(12)
    v_mfma_f32_16x16x32_bf16 v[176:179], v[40:43], v[96:99], v[176:179]
    ds_read_b64_tr_b16 v[36:37], v197 offset:57344
    buffer_load_dwordx4 v[84:87], v8, s[16:19], s68 offen offset:256 sc1
    v_mfma_f32_16x16x32_bf16 v[180:183], v[40:43], v[100:103], v[180:183]
    ds_read_b64_tr_b16 v[38:39], v197 offset:58368
    s_waitcnt lgkmcnt(12)
    v_mfma_f32_16x16x32_bf16 v[184:187], v[44:47], v[96:99], v[184:187]
    ds_read_b64_tr_b16 v[40:41], v198 offset:57344
    v_mfma_f32_16x16x32_bf16 v[188:191], v[44:47], v[100:103], v[188:191]
    ds_read_b64_tr_b16 v[42:43], v198 offset:58368
    s_waitcnt vmcnt(10)
    s_waitcnt lgkmcnt(12)
    v_mfma_f32_16x16x32_bf16 v[128:131], v[16:19], v[104:107], v[128:131]
    ds_read_b64_tr_b16 v[44:45], v199 offset:57344
    v_mfma_f32_16x16x32_bf16 v[132:135], v[16:19], v[108:111], v[132:135]
    ds_read_b64_tr_b16 v[46:47], v199 offset:58368
    s_waitcnt lgkmcnt(12)
    v_mfma_f32_16x16x32_bf16 v[136:139], v[20:23], v[104:107], v[136:139]
    v_add_u32 v192, 0x10000, v192
    v_add_u32 v193, 0x10000, v193
    v_add_u32 v194, 0x10000, v194
    v_add_u32 v195, 0x10000, v195
    v_add_u32 v196, 0x10000, v196
    v_add_u32 v197, 0x10000, v197
    v_add_u32 v198, 0x10000, v198
    v_add_u32 v199, 0x10000, v199
    ds_read_b64_tr_b16 v[16:17], v192 offset:0
    v_mfma_f32_16x16x32_bf16 v[140:143], v[20:23], v[108:111], v[140:143]
    ds_read_b64_tr_b16 v[18:19], v192 offset:1024
    s_waitcnt lgkmcnt(12)
    v_mfma_f32_16x16x32_bf16 v[144:147], v[24:27], v[104:107], v[144:147]
    ds_read_b64_tr_b16 v[20:21], v193 offset:0
    buffer_load_dwordx4 v[88:91], v8, s[16:19], s68 offen offset:2048 sc1
    v_mfma_f32_16x16x32_bf16 v[148:151], v[24:27], v[108:111], v[148:151]
    ds_read_b64_tr_b16 v[22:23], v193 offset:1024
    s_waitcnt lgkmcnt(12)
    v_mfma_f32_16x16x32_bf16 v[152:155], v[28:31], v[104:107], v[152:155]
    ds_read_b64_tr_b16 v[24:25], v194 offset:0
    v_mfma_f32_16x16x32_bf16 v[156:159], v[28:31], v[108:111], v[156:159]
    ds_read_b64_tr_b16 v[26:27], v194 offset:1024
    s_waitcnt lgkmcnt(12)
    v_mfma_f32_16x16x32_bf16 v[160:163], v[32:35], v[104:107], v[160:163]
    ds_read_b64_tr_b16 v[28:29], v195 offset:0
    v_mfma_f32_16x16x32_bf16 v[164:167], v[32:35], v[108:111], v[164:167]
    ds_read_b64_tr_b16 v[30:31], v195 offset:1024
    s_waitcnt lgkmcnt(12)
    v_mfma_f32_16x16x32_bf16 v[168:171], v[36:39], v[104:107], v[168:171]
    ds_read_b64_tr_b16 v[32:33], v196 offset:0
    v_mfma_f32_16x16x32_bf16 v[172:175], v[36:39], v[108:111], v[172:175]
    ds_read_b64_tr_b16 v[34:35], v196 offset:1024
    s_waitcnt lgkmcnt(12)
    v_mfma_f32_16x16x32_bf16 v[176:179], v[40:43], v[104:107], v[176:179]
    ds_read_b64_tr_b16 v[36:37], v197 offset:0
    buffer_load_dwordx4 v[92:95], v8, s[16:19], s68 offen offset:2304 sc1
    s_add_u32 s68, s68, 4096
    v_mfma_f32_16x16x32_bf16 v[180:183], v[40:43], v[108:111], v[180:183]
    ds_read_b64_tr_b16 v[38:39], v197 offset:1024
    s_waitcnt lgkmcnt(12)
    v_mfma_f32_16x16x32_bf16 v[184:187], v[44:47], v[104:107], v[184:187]
    ds_read_b64_tr_b16 v[40:41], v198 offset:0
    v_mfma_f32_16x16x32_bf16 v[188:191], v[44:47], v[108:111], v[188:191]
    ds_read_b64_tr_b16 v[42:43], v198 offset:1024
    s_waitcnt vmcnt(10)
    s_waitcnt lgkmcnt(12)
    v_mfma_f32_16x16x32_bf16 v[128:131], v[16:19], v[48:51], v[128:131]
    ds_read_b64_tr_b16 v[44:45], v199 offset:0
    v_mfma_f32_16x16x32_bf16 v[132:135], v[16:19], v[52:55], v[132:135]
    ds_read_b64_tr_b16 v[46:47], v199 offset:1024
    s_waitcnt lgkmcnt(12)
    v_mfma_f32_16x16x32_bf16 v[136:139], v[20:23], v[48:51], v[136:139]
    s_barrier
LadaLN_cond__grouped_kv_mqa__dense_activation_relu__prompt_kernel_fb12:
    ds_read_b64_tr_b16 v[16:17], v192 offset:8192
    v_mfma_f32_16x16x32_bf16 v[140:143], v[20:23], v[52:55], v[140:143]
    ds_read_b64_tr_b16 v[18:19], v192 offset:9216
    s_waitcnt lgkmcnt(12)
    v_mfma_f32_16x16x32_bf16 v[144:147], v[24:27], v[48:51], v[144:147]
    ds_read_b64_tr_b16 v[20:21], v193 offset:8192
    buffer_load_dwordx4 v[96:99], v8, s[16:19], s68 offen offset:0 sc1
    v_mfma_f32_16x16x32_bf16 v[148:151], v[24:27], v[52:55], v[148:151]
    ds_read_b64_tr_b16 v[22:23], v193 offset:9216
    s_waitcnt lgkmcnt(12)
    v_mfma_f32_16x16x32_bf16 v[152:155], v[28:31], v[48:51], v[152:155]
    ds_read_b64_tr_b16 v[24:25], v194 offset:8192
    v_mfma_f32_16x16x32_bf16 v[156:159], v[28:31], v[52:55], v[156:159]
    ds_read_b64_tr_b16 v[26:27], v194 offset:9216
    s_waitcnt lgkmcnt(12)
    v_mfma_f32_16x16x32_bf16 v[160:163], v[32:35], v[48:51], v[160:163]
    ds_read_b64_tr_b16 v[28:29], v195 offset:8192
    v_mfma_f32_16x16x32_bf16 v[164:167], v[32:35], v[52:55], v[164:167]
    ds_read_b64_tr_b16 v[30:31], v195 offset:9216
    s_waitcnt lgkmcnt(12)
    v_mfma_f32_16x16x32_bf16 v[168:171], v[36:39], v[48:51], v[168:171]
    ds_read_b64_tr_b16 v[32:33], v196 offset:8192
    v_mfma_f32_16x16x32_bf16 v[172:175], v[36:39], v[52:55], v[172:175]
    ds_read_b64_tr_b16 v[34:35], v196 offset:9216
    s_waitcnt lgkmcnt(12)
    v_mfma_f32_16x16x32_bf16 v[176:179], v[40:43], v[48:51], v[176:179]
    ds_read_b64_tr_b16 v[36:37], v197 offset:8192
    buffer_load_dwordx4 v[100:103], v8, s[16:19], s68 offen offset:256 sc1
    v_mfma_f32_16x16x32_bf16 v[180:183], v[40:43], v[52:55], v[180:183]
    ds_read_b64_tr_b16 v[38:39], v197 offset:9216
    s_waitcnt lgkmcnt(12)
    v_mfma_f32_16x16x32_bf16 v[184:187], v[44:47], v[48:51], v[184:187]
    ds_read_b64_tr_b16 v[40:41], v198 offset:8192
    v_mfma_f32_16x16x32_bf16 v[188:191], v[44:47], v[52:55], v[188:191]
    ds_read_b64_tr_b16 v[42:43], v198 offset:9216
    s_waitcnt vmcnt(10)
    s_waitcnt lgkmcnt(12)
    v_mfma_f32_16x16x32_bf16 v[128:131], v[16:19], v[56:59], v[128:131]
    ds_read_b64_tr_b16 v[44:45], v199 offset:8192
    v_mfma_f32_16x16x32_bf16 v[132:135], v[16:19], v[60:63], v[132:135]
    ds_read_b64_tr_b16 v[46:47], v199 offset:9216
    s_waitcnt lgkmcnt(12)
    v_mfma_f32_16x16x32_bf16 v[136:139], v[20:23], v[56:59], v[136:139]
    ds_read_b64_tr_b16 v[16:17], v196 offset:16384
    v_mfma_f32_16x16x32_bf16 v[140:143], v[20:23], v[60:63], v[140:143]
    ds_read_b64_tr_b16 v[18:19], v196 offset:17408
    s_waitcnt lgkmcnt(12)
    v_mfma_f32_16x16x32_bf16 v[144:147], v[24:27], v[56:59], v[144:147]
    ds_read_b64_tr_b16 v[20:21], v197 offset:16384
    buffer_load_dwordx4 v[104:107], v8, s[16:19], s68 offen offset:2048 sc1
    v_mfma_f32_16x16x32_bf16 v[148:151], v[24:27], v[60:63], v[148:151]
    ds_read_b64_tr_b16 v[22:23], v197 offset:17408
    s_waitcnt lgkmcnt(12)
    v_mfma_f32_16x16x32_bf16 v[152:155], v[28:31], v[56:59], v[152:155]
    ds_read_b64_tr_b16 v[24:25], v198 offset:16384
    v_mfma_f32_16x16x32_bf16 v[156:159], v[28:31], v[60:63], v[156:159]
    ds_read_b64_tr_b16 v[26:27], v198 offset:17408
    s_waitcnt lgkmcnt(12)
    v_mfma_f32_16x16x32_bf16 v[160:163], v[32:35], v[56:59], v[160:163]
    ds_read_b64_tr_b16 v[28:29], v199 offset:16384
    v_mfma_f32_16x16x32_bf16 v[164:167], v[32:35], v[60:63], v[164:167]
    ds_read_b64_tr_b16 v[30:31], v199 offset:17408
    s_waitcnt lgkmcnt(12)
    v_mfma_f32_16x16x32_bf16 v[168:171], v[36:39], v[56:59], v[168:171]
    ds_read_b64_tr_b16 v[32:33], v196 offset:24576
    v_mfma_f32_16x16x32_bf16 v[172:175], v[36:39], v[60:63], v[172:175]
    ds_read_b64_tr_b16 v[34:35], v196 offset:25600
    s_waitcnt lgkmcnt(12)
    v_mfma_f32_16x16x32_bf16 v[176:179], v[40:43], v[56:59], v[176:179]
    ds_read_b64_tr_b16 v[36:37], v197 offset:24576
    buffer_load_dwordx4 v[108:111], v8, s[16:19], s68 offen offset:2304 sc1
    s_add_u32 s68, s68, 4096
    v_mfma_f32_16x16x32_bf16 v[180:183], v[40:43], v[60:63], v[180:183]
    ds_read_b64_tr_b16 v[38:39], v197 offset:25600
    s_waitcnt lgkmcnt(12)
    v_mfma_f32_16x16x32_bf16 v[184:187], v[44:47], v[56:59], v[184:187]
    ds_read_b64_tr_b16 v[40:41], v198 offset:24576
    v_mfma_f32_16x16x32_bf16 v[188:191], v[44:47], v[60:63], v[188:191]
    ds_read_b64_tr_b16 v[42:43], v198 offset:25600
    s_waitcnt vmcnt(10)
    s_waitcnt lgkmcnt(12)
    v_mfma_f32_16x16x32_bf16 v[160:163], v[16:19], v[64:67], v[160:163]
    ds_read_b64_tr_b16 v[44:45], v199 offset:24576
    v_mfma_f32_16x16x32_bf16 v[164:167], v[16:19], v[68:71], v[164:167]
    ds_read_b64_tr_b16 v[46:47], v199 offset:25600
    s_waitcnt lgkmcnt(12)
    v_mfma_f32_16x16x32_bf16 v[168:171], v[20:23], v[64:67], v[168:171]
    ds_read_b64_tr_b16 v[16:17], v196 offset:32768
    v_mfma_f32_16x16x32_bf16 v[172:175], v[20:23], v[68:71], v[172:175]
    ds_read_b64_tr_b16 v[18:19], v196 offset:33792
    s_waitcnt lgkmcnt(12)
    v_mfma_f32_16x16x32_bf16 v[176:179], v[24:27], v[64:67], v[176:179]
    ds_read_b64_tr_b16 v[20:21], v197 offset:32768
    v_mfma_f32_16x16x32_bf16 v[180:183], v[24:27], v[68:71], v[180:183]
    ds_read_b64_tr_b16 v[22:23], v197 offset:33792
    s_waitcnt lgkmcnt(12)
    v_mfma_f32_16x16x32_bf16 v[184:187], v[28:31], v[64:67], v[184:187]
    ds_read_b64_tr_b16 v[24:25], v198 offset:32768
    v_mfma_f32_16x16x32_bf16 v[188:191], v[28:31], v[68:71], v[188:191]
    ds_read_b64_tr_b16 v[26:27], v198 offset:33792
    s_waitcnt vmcnt(8)
    s_waitcnt lgkmcnt(12)
    v_mfma_f32_16x16x32_bf16 v[160:163], v[32:35], v[72:75], v[160:163]
    ds_read_b64_tr_b16 v[28:29], v199 offset:32768
    v_mfma_f32_16x16x32_bf16 v[164:167], v[32:35], v[76:79], v[164:167]
    ds_read_b64_tr_b16 v[30:31], v199 offset:33792
    s_waitcnt lgkmcnt(12)
    v_mfma_f32_16x16x32_bf16 v[168:171], v[36:39], v[72:75], v[168:171]
    s_barrier
LadaLN_cond__grouped_kv_mqa__dense_activation_relu__prompt_kernel_fb13:
    ds_read_b64_tr_b16 v[32:33], v196 offset:40960
    v_mfma_f32_16x16x32_bf16 v[172:175], v[36:39], v[76:79], v[172:175]
    ds_read_b64_tr_b16 v[34:35], v196 offset:41984
    s_waitcnt lgkmcnt(12)
    v_mfma_f32_16x16x32_bf16 v[176:179], v[40:43], v[72:75], v[176:179]
    ds_read_b64_tr_b16 v[36:37], v197 offset:40960
    v_mfma_f32_16x16x32_bf16 v[180:183], v[40:43], v[76:79], v[180:183]
    ds_read_b64_tr_b16 v[38:39], v197 offset:41984
    s_waitcnt lgkmcnt(12)
    v_mfma_f32_16x16x32_bf16 v[184:187], v[44:47], v[72:75], v[184:187]
    ds_read_b64_tr_b16 v[40:41], v198 offset:40960
    v_mfma_f32_16x16x32_bf16 v[188:191], v[44:47], v[76:79], v[188:191]
    ds_read_b64_tr_b16 v[42:43], v198 offset:41984
    s_waitcnt vmcnt(6)
    s_waitcnt lgkmcnt(12)
    v_mfma_f32_16x16x32_bf16 v[160:163], v[16:19], v[80:83], v[160:163]
    ds_read_b64_tr_b16 v[44:45], v199 offset:40960
    v_mfma_f32_16x16x32_bf16 v[164:167], v[16:19], v[84:87], v[164:167]
    ds_read_b64_tr_b16 v[46:47], v199 offset:41984
    s_waitcnt lgkmcnt(12)
    v_mfma_f32_16x16x32_bf16 v[168:171], v[20:23], v[80:83], v[168:171]
    ds_read_b64_tr_b16 v[16:17], v196 offset:49152
    v_mfma_f32_16x16x32_bf16 v[172:175], v[20:23], v[84:87], v[172:175]
    ds_read_b64_tr_b16 v[18:19], v196 offset:50176
    s_waitcnt lgkmcnt(12)
    v_mfma_f32_16x16x32_bf16 v[176:179], v[24:27], v[80:83], v[176:179]
    ds_read_b64_tr_b16 v[20:21], v197 offset:49152
    v_mfma_f32_16x16x32_bf16 v[180:183], v[24:27], v[84:87], v[180:183]
    ds_read_b64_tr_b16 v[22:23], v197 offset:50176
    s_waitcnt lgkmcnt(12)
    v_mfma_f32_16x16x32_bf16 v[184:187], v[28:31], v[80:83], v[184:187]
    ds_read_b64_tr_b16 v[24:25], v198 offset:49152
    v_mfma_f32_16x16x32_bf16 v[188:191], v[28:31], v[84:87], v[188:191]
    ds_read_b64_tr_b16 v[26:27], v198 offset:50176
    s_waitcnt vmcnt(4)
    s_waitcnt lgkmcnt(12)
    v_mfma_f32_16x16x32_bf16 v[160:163], v[32:35], v[88:91], v[160:163]
    ds_read_b64_tr_b16 v[28:29], v199 offset:49152
    v_mfma_f32_16x16x32_bf16 v[164:167], v[32:35], v[92:95], v[164:167]
    ds_read_b64_tr_b16 v[30:31], v199 offset:50176
    s_waitcnt lgkmcnt(12)
    v_mfma_f32_16x16x32_bf16 v[168:171], v[36:39], v[88:91], v[168:171]
    ds_read_b64_tr_b16 v[32:33], v196 offset:57344
    v_mfma_f32_16x16x32_bf16 v[172:175], v[36:39], v[92:95], v[172:175]
    ds_read_b64_tr_b16 v[34:35], v196 offset:58368
    s_waitcnt lgkmcnt(12)
    v_mfma_f32_16x16x32_bf16 v[176:179], v[40:43], v[88:91], v[176:179]
    ds_read_b64_tr_b16 v[36:37], v197 offset:57344
    v_mfma_f32_16x16x32_bf16 v[180:183], v[40:43], v[92:95], v[180:183]
    ds_read_b64_tr_b16 v[38:39], v197 offset:58368
    s_waitcnt lgkmcnt(12)
    v_mfma_f32_16x16x32_bf16 v[184:187], v[44:47], v[88:91], v[184:187]
    ds_read_b64_tr_b16 v[40:41], v198 offset:57344
    v_mfma_f32_16x16x32_bf16 v[188:191], v[44:47], v[92:95], v[188:191]
    ds_read_b64_tr_b16 v[42:43], v198 offset:58368
    s_waitcnt vmcnt(2)
    s_waitcnt lgkmcnt(12)
    v_mfma_f32_16x16x32_bf16 v[160:163], v[16:19], v[96:99], v[160:163]
    ds_read_b64_tr_b16 v[44:45], v199 offset:57344
    v_mfma_f32_16x16x32_bf16 v[164:167], v[16:19], v[100:103], v[164:167]
    ds_read_b64_tr_b16 v[46:47], v199 offset:58368
    s_waitcnt lgkmcnt(12)
    v_mfma_f32_16x16x32_bf16 v[168:171], v[20:23], v[96:99], v[168:171]
    ds_read_b64_tr_b16 v[16:17], v192 offset:16384
    v_mfma_f32_16x16x32_bf16 v[172:175], v[20:23], v[100:103], v[172:175]
    ds_read_b64_tr_b16 v[18:19], v192 offset:17408
    s_waitcnt lgkmcnt(12)
    v_mfma_f32_16x16x32_bf16 v[176:179], v[24:27], v[96:99], v[176:179]
    ds_read_b64_tr_b16 v[20:21], v193 offset:16384
    v_mfma_f32_16x16x32_bf16 v[180:183], v[24:27], v[100:103], v[180:183]
    ds_read_b64_tr_b16 v[22:23], v193 offset:17408
    s_waitcnt lgkmcnt(12)
    v_mfma_f32_16x16x32_bf16 v[184:187], v[28:31], v[96:99], v[184:187]
    ds_read_b64_tr_b16 v[24:25], v194 offset:16384
    v_mfma_f32_16x16x32_bf16 v[188:191], v[28:31], v[100:103], v[188:191]
    ds_read_b64_tr_b16 v[26:27], v194 offset:17408
    s_waitcnt vmcnt(0)
    s_waitcnt lgkmcnt(12)
    v_mfma_f32_16x16x32_bf16 v[160:163], v[32:35], v[104:107], v[160:163]
    ds_read_b64_tr_b16 v[28:29], v195 offset:16384
    v_mfma_f32_16x16x32_bf16 v[164:167], v[32:35], v[108:111], v[164:167]
    ds_read_b64_tr_b16 v[30:31], v195 offset:17408
    s_waitcnt lgkmcnt(12)
    v_mfma_f32_16x16x32_bf16 v[168:171], v[36:39], v[104:107], v[168:171]
    ds_read_b64_tr_b16 v[32:33], v192 offset:24576
    v_mfma_f32_16x16x32_bf16 v[172:175], v[36:39], v[108:111], v[172:175]
    ds_read_b64_tr_b16 v[34:35], v192 offset:25600
    s_waitcnt lgkmcnt(12)
    v_mfma_f32_16x16x32_bf16 v[176:179], v[40:43], v[104:107], v[176:179]
    ds_read_b64_tr_b16 v[36:37], v193 offset:24576
    v_mfma_f32_16x16x32_bf16 v[180:183], v[40:43], v[108:111], v[180:183]
    ds_read_b64_tr_b16 v[38:39], v193 offset:25600
    s_waitcnt lgkmcnt(12)
    v_mfma_f32_16x16x32_bf16 v[184:187], v[44:47], v[104:107], v[184:187]
    ds_read_b64_tr_b16 v[40:41], v194 offset:24576
    v_mfma_f32_16x16x32_bf16 v[188:191], v[44:47], v[108:111], v[188:191]
    ds_read_b64_tr_b16 v[42:43], v194 offset:25600
    s_waitcnt lgkmcnt(12)
    v_mfma_f32_16x16x32_bf16 v[128:131], v[16:19], v[64:67], v[128:131]
    ds_read_b64_tr_b16 v[44:45], v195 offset:24576
    v_mfma_f32_16x16x32_bf16 v[132:135], v[16:19], v[68:71], v[132:135]
    ds_read_b64_tr_b16 v[46:47], v195 offset:25600
    s_waitcnt lgkmcnt(12)
    v_mfma_f32_16x16x32_bf16 v[136:139], v[20:23], v[64:67], v[136:139]
    ds_read_b64_tr_b16 v[16:17], v192 offset:32768
    v_mfma_f32_16x16x32_bf16 v[140:143], v[20:23], v[68:71], v[140:143]
    ds_read_b64_tr_b16 v[18:19], v192 offset:33792
    s_waitcnt lgkmcnt(12)
    v_mfma_f32_16x16x32_bf16 v[144:147], v[24:27], v[64:67], v[144:147]
    ds_read_b64_tr_b16 v[20:21], v193 offset:32768
    v_cvt_pk_bf16_f32 v160, v160, v161
    v_cvt_pk_bf16_f32 v161, v162, v163
    v_cvt_pk_bf16_f32 v162, v164, v165
    v_cvt_pk_bf16_f32 v163, v166, v167
    v_min_u32 v160, -2, v160
    v_min_u32 v161, -2, v161
    v_mfma_f32_16x16x32_bf16 v[148:151], v[24:27], v[68:71], v[148:151]
    ds_read_b64_tr_b16 v[22:23], v193 offset:33792
    s_waitcnt lgkmcnt(12)
    v_min_u32 v162, -2, v162
    v_min_u32 v163, -2, v163
    buffer_store_dwordx4 v[160:163], v1, s[16:19], s72 offen offset:0 sc1
    v_cvt_pk_bf16_f32 v168, v168, v169
    v_cvt_pk_bf16_f32 v169, v170, v171
    v_cvt_pk_bf16_f32 v170, v172, v173
    v_mfma_f32_16x16x32_bf16 v[152:155], v[28:31], v[64:67], v[152:155]
    ds_read_b64_tr_b16 v[24:25], v194 offset:32768
    v_cvt_pk_bf16_f32 v171, v174, v175
    v_min_u32 v168, -2, v168
    v_min_u32 v169, -2, v169
    v_min_u32 v170, -2, v170
    v_min_u32 v171, -2, v171
    buffer_store_dwordx4 v[168:171], v1, s[16:19], s72 offen offset:1024 sc1
    v_mfma_f32_16x16x32_bf16 v[156:159], v[28:31], v[68:71], v[156:159]
    ds_read_b64_tr_b16 v[26:27], v194 offset:33792
    s_waitcnt lgkmcnt(12)
    v_cvt_pk_bf16_f32 v176, v176, v177
    v_cvt_pk_bf16_f32 v177, v178, v179
    v_cvt_pk_bf16_f32 v178, v180, v181
    v_cvt_pk_bf16_f32 v179, v182, v183
    v_min_u32 v176, -2, v176
    v_min_u32 v177, -2, v177
    v_mfma_f32_16x16x32_bf16 v[128:131], v[32:35], v[72:75], v[128:131]
    ds_read_b64_tr_b16 v[28:29], v195 offset:32768
    v_min_u32 v178, -2, v178
    v_min_u32 v179, -2, v179
    buffer_store_dwordx4 v[176:179], v1, s[16:19], s72 offen offset:2048 sc1
    v_cvt_pk_bf16_f32 v184, v184, v185
    v_cvt_pk_bf16_f32 v185, v186, v187
    v_cvt_pk_bf16_f32 v186, v188, v189
    v_mfma_f32_16x16x32_bf16 v[132:135], v[32:35], v[76:79], v[132:135]
    ds_read_b64_tr_b16 v[30:31], v195 offset:33792
    s_waitcnt lgkmcnt(12)
    v_cvt_pk_bf16_f32 v187, v190, v191
    v_min_u32 v184, -2, v184
    v_min_u32 v185, -2, v185
    v_min_u32 v186, -2, v186
    v_min_u32 v187, -2, v187
    buffer_store_dwordx4 v[184:187], v1, s[16:19], s72 offen offset:3072 sc1
    v_mfma_f32_16x16x32_bf16 v[136:139], v[36:39], v[72:75], v[136:139]
    ds_read_b64_tr_b16 v[32:33], v192 offset:40960
    v_mfma_f32_16x16x32_bf16 v[140:143], v[36:39], v[76:79], v[140:143]
    ds_read_b64_tr_b16 v[34:35], v192 offset:41984
    s_waitcnt lgkmcnt(12)
    v_mfma_f32_16x16x32_bf16 v[144:147], v[40:43], v[72:75], v[144:147]
    ds_read_b64_tr_b16 v[36:37], v193 offset:40960
    v_mfma_f32_16x16x32_bf16 v[148:151], v[40:43], v[76:79], v[148:151]
    ds_read_b64_tr_b16 v[38:39], v193 offset:41984
    s_waitcnt lgkmcnt(12)
    v_mfma_f32_16x16x32_bf16 v[152:155], v[44:47], v[72:75], v[152:155]
    ds_read_b64_tr_b16 v[40:41], v194 offset:40960
    v_mfma_f32_16x16x32_bf16 v[156:159], v[44:47], v[76:79], v[156:159]
    ds_read_b64_tr_b16 v[42:43], v194 offset:41984
    s_waitcnt lgkmcnt(12)
    v_mfma_f32_16x16x32_bf16 v[128:131], v[16:19], v[80:83], v[128:131]
    ds_read_b64_tr_b16 v[44:45], v195 offset:40960
    v_mfma_f32_16x16x32_bf16 v[132:135], v[16:19], v[84:87], v[132:135]
    ds_read_b64_tr_b16 v[46:47], v195 offset:41984
    s_waitcnt lgkmcnt(12)
    v_mfma_f32_16x16x32_bf16 v[136:139], v[20:23], v[80:83], v[136:139]
    ds_read_b64_tr_b16 v[16:17], v192 offset:49152
    v_mfma_f32_16x16x32_bf16 v[140:143], v[20:23], v[84:87], v[140:143]
    ds_read_b64_tr_b16 v[18:19], v192 offset:50176
    s_waitcnt lgkmcnt(12)
    v_mfma_f32_16x16x32_bf16 v[144:147], v[24:27], v[80:83], v[144:147]
    ds_read_b64_tr_b16 v[20:21], v193 offset:49152
    v_mfma_f32_16x16x32_bf16 v[148:151], v[24:27], v[84:87], v[148:151]
    ds_read_b64_tr_b16 v[22:23], v193 offset:50176
    s_waitcnt lgkmcnt(12)
    v_mfma_f32_16x16x32_bf16 v[152:155], v[28:31], v[80:83], v[152:155]
    ds_read_b64_tr_b16 v[24:25], v194 offset:49152
    v_mfma_f32_16x16x32_bf16 v[156:159], v[28:31], v[84:87], v[156:159]
    ds_read_b64_tr_b16 v[26:27], v194 offset:50176
    s_waitcnt lgkmcnt(12)
    v_mfma_f32_16x16x32_bf16 v[128:131], v[32:35], v[88:91], v[128:131]
    ds_read_b64_tr_b16 v[28:29], v195 offset:49152
    v_mfma_f32_16x16x32_bf16 v[132:135], v[32:35], v[92:95], v[132:135]
    ds_read_b64_tr_b16 v[30:31], v195 offset:50176
    s_waitcnt lgkmcnt(12)
    v_mfma_f32_16x16x32_bf16 v[136:139], v[36:39], v[88:91], v[136:139]
    ds_read_b64_tr_b16 v[32:33], v192 offset:57344
    v_mfma_f32_16x16x32_bf16 v[140:143], v[36:39], v[92:95], v[140:143]
    ds_read_b64_tr_b16 v[34:35], v192 offset:58368
    s_waitcnt lgkmcnt(12)
    v_mfma_f32_16x16x32_bf16 v[144:147], v[40:43], v[88:91], v[144:147]
    ds_read_b64_tr_b16 v[36:37], v193 offset:57344
    v_mfma_f32_16x16x32_bf16 v[148:151], v[40:43], v[92:95], v[148:151]
    ds_read_b64_tr_b16 v[38:39], v193 offset:58368
    s_waitcnt lgkmcnt(12)
    v_mfma_f32_16x16x32_bf16 v[152:155], v[44:47], v[88:91], v[152:155]
    ds_read_b64_tr_b16 v[40:41], v194 offset:57344
    v_mfma_f32_16x16x32_bf16 v[156:159], v[44:47], v[92:95], v[156:159]
    ds_read_b64_tr_b16 v[42:43], v194 offset:58368
    s_waitcnt lgkmcnt(12)
    v_mfma_f32_16x16x32_bf16 v[128:131], v[16:19], v[96:99], v[128:131]
    ds_read_b64_tr_b16 v[44:45], v195 offset:57344
    s_barrier
    s_xor_b32 s79, s2, 1
    v_mfma_f32_16x16x32_bf16 v[132:135], v[16:19], v[100:103], v[132:135]
    ds_read_b64_tr_b16 v[46:47], v195 offset:58368
    s_waitcnt lgkmcnt(12)
    s_lshl_b32 s79, s79, 2
    v_mfma_f32_16x16x32_bf16 v[136:139], v[20:23], v[96:99], v[136:139]
    s_add_u32 s79, s79, s24
    v_mfma_f32_16x16x32_bf16 v[140:143], v[20:23], v[100:103], v[140:143]
    s_waitcnt lgkmcnt(10)
    s_lshl_b32 s79, s79, 12
    v_mfma_f32_16x16x32_bf16 v[144:147], v[24:27], v[96:99], v[144:147]
    s_add_u32 s79, s79, 28311552
    v_mfma_f32_16x16x32_bf16 v[148:151], v[24:27], v[100:103], v[148:151]
    s_waitcnt lgkmcnt(8)
    buffer_load_dwordx4 v[208:211], v1, s[16:19], s79 offen offset:0 sc1
    v_mfma_f32_16x16x32_bf16 v[152:155], v[28:31], v[96:99], v[152:155]
    buffer_load_dwordx4 v[212:215], v1, s[16:19], s79 offen offset:1024 sc1
    v_mfma_f32_16x16x32_bf16 v[156:159], v[28:31], v[100:103], v[156:159]
    s_waitcnt lgkmcnt(6)
    v_mfma_f32_16x16x32_bf16 v[128:131], v[32:35], v[104:107], v[128:131]
    v_mfma_f32_16x16x32_bf16 v[132:135], v[32:35], v[108:111], v[132:135]
    s_waitcnt lgkmcnt(4)
    v_mfma_f32_16x16x32_bf16 v[136:139], v[36:39], v[104:107], v[136:139]
    v_mfma_f32_16x16x32_bf16 v[140:143], v[36:39], v[108:111], v[140:143]
    s_waitcnt lgkmcnt(2)
    v_mfma_f32_16x16x32_bf16 v[144:147], v[40:43], v[104:107], v[144:147]
    v_mfma_f32_16x16x32_bf16 v[148:151], v[40:43], v[108:111], v[148:151]
    s_waitcnt lgkmcnt(0)
    v_mfma_f32_16x16x32_bf16 v[152:155], v[44:47], v[104:107], v[152:155]
    v_mfma_f32_16x16x32_bf16 v[156:159], v[44:47], v[108:111], v[156:159]
    s_nop 7
    ds_write_b128 v13, v[144:147] offset:0
    ds_write_b128 v13, v[148:151] offset:1024
    ds_write_b128 v13, v[152:155] offset:2048
    ds_write_b128 v13, v[156:159] offset:3072
    s_waitcnt lgkmcnt(0)
    s_barrier
    s_setprio 0
    v_lshlrev_b32 v13, 4, v10
    s_lshl_b32 s72, s25, 7
    s_add_u32 s72, s72, 147968
    v_add_u32 v13, s72, v13
    ds_read_b128 v[64:67], v13 offset:0
    ds_read_b128 v[68:71], v13 offset:64
    s_and_b32 s72, s66, 7
    s_lshl_b32 s72, s72, 7
    s_add_u32 s72, s72, 151552
    v_lshlrev_b32 v13, 2, v9
    v_add_u32 v13, s72, v13
    ds_read_b32 v14, v13
    ds_read_b32 v15, v13 offset:64
    v_and_b32 v11, 31, v2
    v_lshrrev_b32 v12, 5, v2
    v_lshlrev_b32 v12, 4, v12
    v_lshl_add_u32 v11, v11, 11, v12
    v_lshrrev_b32 v72, 2, v2
    v_and_b32 v73, 3, v2
    v_lshlrev_b32 v73, 4, v73
    v_lshl_add_u32 v11, v72, 11, v73
    v_mul_u32_u24 v72, 80, v72
    s_lshl_b32 s72, s20, 12
    s_add_u32 s72, s72, 32768
    v_add3_u32 v73, v72, v73, s72
    v_mul_u32_u24 v72, 80, v9
    v_lshl_add_u32 v72, v10, 3, v72
    v_add_u32 v72, s72, v72
    s_mov_b32 s12, s56
    s_mov_b32 s13, s57
    s_mov_b32 s14, 0x400000
    s_mov_b32 s15, 0x20000
    s_lshl_b32 s74, s66, 16
    s_lshl_b32 s75, s22, 7
    s_add_u32 s74, s74, s75
    s_lshl_b32 s75, s25, 6
    s_add_u32 s74, s74, s75
    s_xor_b32 s72, s2, 1
    s_lshl_b32 s72, s72, 14
    s_lshl_b32 s73, s24, 12
    s_add_u32 s72, s72, s73
    s_add_u32 s72, s72, 28311552
    s_waitcnt vmcnt(0)
    v_max_u32 v12, v208, v212
    s_branch LadaLN_cond__grouped_kv_mqa__dense_activation_relu__prompt_kernel_over16
LadaLN_cond__grouped_kv_mqa__dense_activation_relu__prompt_kernel_stub16:
    s_setpc_b64 s[96:97]
LadaLN_cond__grouped_kv_mqa__dense_activation_relu__prompt_kernel_over16:
    v_cmp_eq_u32 vcc, -1, v12
    s_nop 1
    s_cbranch_vccz LadaLN_cond__grouped_kv_mqa__dense_activation_relu__prompt_kernel_pok105
    s_mov_b32 s67, 400000
LadaLN_cond__grouped_kv_mqa__dense_activation_relu__prompt_kernel_poll106:
    buffer_load_dwordx4 v[208:211], v1, s[16:19], s72 offen offset:0 sc1
    buffer_load_dwordx4 v[212:215], v1, s[16:19], s72 offen offset:1024 sc1
    s_waitcnt vmcnt(0)
    v_max_u32 v12, v208, v212
    v_cmp_eq_u32 vcc, -1, v12
    s_nop 1
    s_cbranch_vccz LadaLN_cond__grouped_kv_mqa__dense_activation_relu__prompt_kernel_pok107
    s_sleep 1
    s_sub_u32 s67, s67, 1
    s_cbranch_scc0 LadaLN_cond__grouped_kv_mqa__dense_activation_relu__prompt_kernel_poll106
    s_branch LadaLN_cond__grouped_kv_mqa__dense_activation_relu__prompt_kernel_exit
LadaLN_cond__grouped_kv_mqa__dense_activation_relu__prompt_kernel_pok107:
LadaLN_cond__grouped_kv_mqa__dense_activation_relu__prompt_kernel_pok105:
    s_waitcnt lgkmcnt(0)
    v_lshlrev_b32 v216, 16, v208
    v_and_b32 v217, 0xffff0000, v208
    v_lshlrev_b32 v12, 16, v116
    v_and_b32 v13, 0xffff0000, v116
    v_add_f32 v128, v128, v216
    v_add_f32 v129, v129, v217
    v_mul_f32 v128, v128, v14
    v_mul_f32 v129, v129, v14
    v_fmac_f32 v12, v128, v64
    v_fmac_f32 v13, v129, v65
    v_cvt_pk_bf16_f32 v116, v12, v13
    v_lshlrev_b32 v216, 16, v209
    v_and_b32 v217, 0xffff0000, v209
    v_lshlrev_b32 v12, 16, v117
    v_and_b32 v13, 0xffff0000, v117
    v_add_f32 v130, v130, v216
    v_add_f32 v131, v131, v217
    v_mul_f32 v130, v130, v14
    v_mul_f32 v131, v131, v14
    v_fmac_f32 v12, v130, v66
    v_fmac_f32 v13, v131, v67
    v_cvt_pk_bf16_f32 v117, v12, v13
    ds_write_b64 v72, v[116:117] offset:0
    v_lshlrev_b32 v216, 16, v210
    v_and_b32 v217, 0xffff0000, v210
    v_lshlrev_b32 v12, 16, v118
    v_and_b32 v13, 0xffff0000, v118
    v_add_f32 v132, v132, v216
    v_add_f32 v133, v133, v217
    v_mul_f32 v132, v132, v15
    v_mul_f32 v133, v133, v15
    v_fmac_f32 v12, v132, v64
    v_fmac_f32 v13, v133, v65
    v_cvt_pk_bf16_f32 v118, v12, v13
    v_lshlrev_b32 v216, 16, v211
    v_and_b32 v217, 0xffff0000, v211
    v_lshlrev_b32 v12, 16, v119
    v_and_b32 v13, 0xffff0000, v119
    v_add_f32 v134, v134, v216
    v_add_f32 v135, v135, v217
    v_mul_f32 v134, v134, v15
    v_mul_f32 v135, v135, v15
    v_fmac_f32 v12, v134, v66
    v_fmac_f32 v13, v135, v67
    v_cvt_pk_bf16_f32 v119, v12, v13
    ds_write_b64 v72, v[118:119] offset:1280
    v_lshlrev_b32 v216, 16, v212
    v_and_b32 v217, 0xffff0000, v212
    v_lshlrev_b32 v12, 16, v120
    v_and_b32 v13, 0xffff0000, v120
    v_add_f32 v136, v136, v216
    v_add_f32 v137, v137, v217
    v_mul_f32 v136, v136, v14
    v_mul_f32 v137, v137, v14
    v_fmac_f32 v12, v136, v68
    v_fmac_f32 v13, v137, v69
    v_cvt_pk_bf16_f32 v120, v12, v13
    v_lshlrev_b32 v216, 16, v213
    v_and_b32 v217, 0xffff0000, v213
    v_lshlrev_b32 v12, 16, v121
    v_and_b32 v13, 0xffff0000, v121
    v_add_f32 v138, v138, v216
    v_add_f32 v139, v139, v217
    v_mul_f32 v138, v138, v14
    v_mul_f32 v139, v139, v14
    v_fmac_f32 v12, v138, v70
    v_fmac_f32 v13, v139, v71
    v_cvt_pk_bf16_f32 v121, v12, v13
    ds_write_b64 v72, v[120:121] offset:32
    v_lshlrev_b32 v216, 16, v214
    v_and_b32 v217, 0xffff0000, v214
    v_lshlrev_b32 v12, 16, v122
    v_and_b32 v13, 0xffff0000, v122
    v_add_f32 v140, v140, v216
    v_add_f32 v141, v141, v217
    v_mul_f32 v140, v140, v15
    v_mul_f32 v141, v141, v15
    v_fmac_f32 v12, v140, v68
    v_fmac_f32 v13, v141, v69
    v_cvt_pk_bf16_f32 v122, v12, v13
    v_lshlrev_b32 v216, 16, v215
    v_and_b32 v217, 0xffff0000, v215
    v_lshlrev_b32 v12, 16, v123
    v_and_b32 v13, 0xffff0000, v123
    v_add_f32 v142, v142, v216
    v_add_f32 v143, v143, v217
    v_mul_f32 v142, v142, v15
    v_mul_f32 v143, v143, v15
    v_fmac_f32 v12, v142, v70
    v_fmac_f32 v13, v143, v71
    v_cvt_pk_bf16_f32 v123, v12, v13
    ds_write_b64 v72, v[122:123] offset:1312
    ds_read_b128 v[64:67], v73 offset:0
    ds_read_b128 v[68:71], v73 offset:1280
    s_add_u32 s75, s74, 32768
    s_waitcnt lgkmcnt(1)
    buffer_store_dwordx4 v[64:67], v11, s[12:15], s74 offen nt
    s_waitcnt lgkmcnt(0)
    buffer_store_dwordx4 v[68:71], v11, s[12:15], s75 offen nt
LadaLN_cond__grouped_kv_mqa__dense_activation_relu__prompt_kernel_fend:
    s_branch LadaLN_cond__grouped_kv_mqa__dense_activation_relu__prompt_kernel_end108
LadaLN_cond__grouped_kv_mqa__dense_activation_relu__prompt_kernel_hcode:
LadaLN_cond__grouped_kv_mqa__dense_activation_relu__prompt_kernel_helper52:
    ds_write_b128 v6, v[48:51]
    ds_write_b128 v6, v[52:55] offset:1024
    v_mov_b32 v98, v96
    s_nop 1
    v_permlane32_swap_b32 v96, v98
    s_nop 0
    v_add_f32 v96, v96, v98
    v_mov_b32 v99, v97
    s_nop 1
    v_permlane32_swap_b32 v97, v99
    s_nop 0
    v_add_f32 v97, v97, v99
    ds_write_b64 v6, v[96:97] offset:2048
    s_waitcnt lgkmcnt(0)
    s_barrier
    v_xor_b32 v124, s62, v124
    v_xor_b32 v125, s63, v125
    v_xor_b32 v126, s64, v126
    v_xor_b32 v127, s65, v127
    v_xor_b32 v128, s62, v128
    v_xor_b32 v129, s63, v129
    v_xor_b32 v130, s64, v130
    v_xor_b32 v131, s65, v131
    v_xor_b32 v132, s62, v132
    v_xor_b32 v133, s63, v133
    v_xor_b32 v134, s64, v134
    v_xor_b32 v135, s65, v135
    v_xor_b32 v136, s62, v136
    v_xor_b32 v137, s63, v137
    v_xor_b32 v138, s64, v138
    v_xor_b32 v139, s65, v139
    v_xor_b32 v140, s62, v140
    v_xor_b32 v141, s63, v141
    v_xor_b32 v142, s64, v142
    v_xor_b32 v143, s65, v143
    v_xor_b32 v144, s62, v144
    v_xor_b32 v145, s63, v145
    v_xor_b32 v146, s64, v146
    v_xor_b32 v147, s65, v147
    v_xor_b32 v148, s62, v148
    v_xor_b32 v149, s63, v149
    v_xor_b32 v150, s64, v150
    v_xor_b32 v151, s65, v151
    v_xor_b32 v152, s62, v152
    v_xor_b32 v153, s63, v153
    v_xor_b32 v154, s64, v154
    v_xor_b32 v155, s65, v155
    v_or3_b32 v12, v124, v125, v126
    v_or3_b32 v12, v12, v127, v128
    v_or3_b32 v12, v12, v129, v130
    v_or3_b32 v12, v12, v131, v132
    v_or3_b32 v12, v12, v133, v134
    v_or3_b32 v12, v12, v135, v136
    v_or3_b32 v12, v12, v137, v138
    v_or3_b32 v12, v12, v139, v140
    v_or3_b32 v12, v12, v141, v142
    v_or3_b32 v12, v12, v143, v144
    v_or3_b32 v12, v12, v145, v146
    v_or3_b32 v12, v12, v147, v148
    v_or3_b32 v12, v12, v149, v150
    v_or3_b32 v12, v12, v151, v152
    v_or3_b32 v12, v12, v153, v154
    v_or_b32 v12, v12, v155
    v_and_b32 v12, 0xff, v12
    v_cmp_ne_u32 vcc, 0, v12
    s_nop 1
    s_cbranch_vccz LadaLN_cond__grouped_kv_mqa__dense_activation_relu__prompt_kernel_ok109
    s_mov_b32 s67, 400000
LadaLN_cond__grouped_kv_mqa__dense_activation_relu__prompt_kernel_poll110:
    buffer_load_dwordx4 v[124:127], v1, s[16:19], s28 offen offset:0 sc1
    buffer_load_dwordx4 v[128:131], v1, s[16:19], s29 offen offset:0 sc1
    buffer_load_dwordx4 v[132:135], v1, s[16:19], s30 offen offset:0 sc1
    buffer_load_dwordx4 v[136:139], v1, s[16:19], s31 offen offset:0 sc1
    buffer_load_dwordx4 v[140:143], v1, s[16:19], s28 offen offset:1024 sc1
    buffer_load_dwordx4 v[144:147], v1, s[16:19], s29 offen offset:1024 sc1
    buffer_load_dwordx4 v[148:151], v1, s[16:19], s30 offen offset:1024 sc1
    buffer_load_dwordx4 v[152:155], v1, s[16:19], s31 offen offset:1024 sc1
    s_waitcnt vmcnt(0)
    v_xor_b32 v124, s62, v124
    v_xor_b32 v125, s63, v125
    v_xor_b32 v126, s64, v126
    v_xor_b32 v127, s65, v127
    v_xor_b32 v128, s62, v128
    v_xor_b32 v129, s63, v129
    v_xor_b32 v130, s64, v130
    v_xor_b32 v131, s65, v131
    v_xor_b32 v132, s62, v132
    v_xor_b32 v133, s63, v133
    v_xor_b32 v134, s64, v134
    v_xor_b32 v135, s65, v135
    v_xor_b32 v136, s62, v136
    v_xor_b32 v137, s63, v137
    v_xor_b32 v138, s64, v138
    v_xor_b32 v139, s65, v139
    v_xor_b32 v140, s62, v140
    v_xor_b32 v141, s63, v141
    v_xor_b32 v142, s64, v142
    v_xor_b32 v143, s65, v143
    v_xor_b32 v144, s62, v144
    v_xor_b32 v145, s63, v145
    v_xor_b32 v146, s64, v146
    v_xor_b32 v147, s65, v147
    v_xor_b32 v148, s62, v148
    v_xor_b32 v149, s63, v149
    v_xor_b32 v150, s64, v150
    v_xor_b32 v151, s65, v151
    v_xor_b32 v152, s62, v152
    v_xor_b32 v153, s63, v153
    v_xor_b32 v154, s64, v154
    v_xor_b32 v155, s65, v155
    v_or3_b32 v12, v124, v125, v126
    v_or3_b32 v12, v12, v127, v128
    v_or3_b32 v12, v12, v129, v130
    v_or3_b32 v12, v12, v131, v132
    v_or3_b32 v12, v12, v133, v134
    v_or3_b32 v12, v12, v135, v136
    v_or3_b32 v12, v12, v137, v138
    v_or3_b32 v12, v12, v139, v140
    v_or3_b32 v12, v12, v141, v142
    v_or3_b32 v12, v12, v143, v144
    v_or3_b32 v12, v12, v145, v146
    v_or3_b32 v12, v12, v147, v148
    v_or3_b32 v12, v12, v149, v150
    v_or3_b32 v12, v12, v151, v152
    v_or3_b32 v12, v12, v153, v154
    v_or_b32 v12, v12, v155
    v_and_b32 v12, 0xff, v12
    v_cmp_ne_u32 vcc, 0, v12
    s_nop 1
    s_cbranch_vccz LadaLN_cond__grouped_kv_mqa__dense_activation_relu__prompt_kernel_pok111
    s_sleep 1
    s_sub_u32 s67, s67, 1
    s_cbranch_scc0 LadaLN_cond__grouped_kv_mqa__dense_activation_relu__prompt_kernel_poll110
    s_branch LadaLN_cond__grouped_kv_mqa__dense_activation_relu__prompt_kernel_exit
LadaLN_cond__grouped_kv_mqa__dense_activation_relu__prompt_kernel_pok111:
LadaLN_cond__grouped_kv_mqa__dense_activation_relu__prompt_kernel_ok109:
    s_lshr_b32 s74, s24, 1
    s_cmp_eq_u32 s74, 0
    s_cselect_b32 s29, 1.0, 0
    v_lshrrev_b32 v12, 2, v9
    v_lshlrev_b32 v12, 4, v12
    v_lshl_add_u32 v12, v10, 8, v12
    v_and_b32 v13, 1, v2
    v_lshl_add_u32 v12, v13, 3, v12
    v_bfe_u32 v13, v2, 1, 1
    v_lshl_add_u32 v12, v13, 2, v12
    s_and_b32 s76, s24, 1
    s_lshl_b32 s76, s76, 11
    s_lshl_b32 s74, s74, 7
    s_add_u32 s76, s76, s74
    s_add_u32 s76, s76, 155648
    v_add_u32 v12, s76, v12
    v_add_f32 v124, v124, v128
    v_add_f32 v132, v132, v136
    v_add_f32 v125, v125, v129
    v_add_f32 v133, v133, v137
    v_add_f32 v126, v126, v130
    v_add_f32 v134, v134, v138
    v_add_f32 v127, v127, v131
    v_add_f32 v135, v135, v139
    v_add_f32 v124, v124, v132
    v_add_f32 v125, v125, v133
    v_add_f32 v126, v126, v134
    v_add_f32 v127, v127, v135
    v_cvt_pk_bf16_f32 v125, v124, v125
    v_lshlrev_b32 v124, 16, v125
    v_and_b32 v125, 0xffff0000, v125
    v_cvt_pk_bf16_f32 v127, v126, v127
    v_lshlrev_b32 v126, 16, v127
    v_and_b32 v127, 0xffff0000, v127
    v_add_f32 v124, s29, v124
    v_add_f32 v125, s29, v125
    v_add_f32 v126, s29, v126
    v_add_f32 v127, s29, v127
    v_cvt_pk_bf16_f32 v124, v124, v125
    v_cvt_pk_bf16_f32 v125, v126, v127
    ds_write_b32 v12, v124 offset:0
    ds_write_b32 v12, v125 offset:64
    v_add_f32 v140, v140, v144
    v_add_f32 v148, v148, v152
    v_add_f32 v141, v141, v145
    v_add_f32 v149, v149, v153
    v_add_f32 v142, v142, v146
    v_add_f32 v150, v150, v154
    v_add_f32 v143, v143, v147
    v_add_f32 v151, v151, v155
    v_add_f32 v140, v140, v148
    v_add_f32 v141, v141, v149
    v_add_f32 v142, v142, v150
    v_add_f32 v143, v143, v151
    v_cvt_pk_bf16_f32 v141, v140, v141
    v_lshlrev_b32 v140, 16, v141
    v_and_b32 v141, 0xffff0000, v141
    v_cvt_pk_bf16_f32 v143, v142, v143
    v_lshlrev_b32 v142, 16, v143
    v_and_b32 v143, 0xffff0000, v143
    v_add_f32 v140, s29, v140
    v_add_f32 v141, s29, v141
    v_add_f32 v142, s29, v142
    v_add_f32 v143, s29, v143
    v_cvt_pk_bf16_f32 v140, v140, v141
    v_cvt_pk_bf16_f32 v141, v142, v143
    ds_write_b32 v12, v140 offset:1024
    ds_write_b32 v12, v141 offset:1088
    s_add_u32 m0, s83, 40960
    s_nop 0
    buffer_load_dwordx4 v252, s[8:11], s82 offen lds
    buffer_load_dwordx4 v253, s[8:11], s82 offen offset:1024 lds
    s_add_u32 s82, s82, 229376
    s_add_u32 m0, s83, 49152
    s_nop 0
    buffer_load_dwordx4 v252, s[8:11], s82 offen lds
    buffer_load_dwordx4 v253, s[8:11], s82 offen offset:1024 lds
    s_add_u32 s82, s82, 229376
    s_mov_b32 s12, s50
    s_mov_b32 s13, s51
    s_mov_b32 s14, 0x700000
    s_mov_b32 s15, 0x20000
    v_lshlrev_b32 v12, 2, v10
    v_xor_b32 v12, v12, v9
    s_and_b32 s79, s24, 1
    s_lshl_b32 s79, s79, 1
    v_xor_b32 v12, s79, v12
    v_permlane32_swap_b32 v116, v118
    v_permlane32_swap_b32 v117, v119
    v_permlane32_swap_b32 v120, v122
    v_permlane32_swap_b32 v121, v123
    s_nop 0
    v_permlane16_swap_b32 v116, v118
    v_permlane16_swap_b32 v117, v119
    v_permlane16_swap_b32 v120, v122
    v_permlane16_swap_b32 v121, v123
    s_nop 0
    v_lshlrev_b32 v6, 11, v10
    v_lshl_add_u32 v6, v12, 4, v6
    s_mul_i32 s79, s90, 3670016
    s_lshl_b32 s78, s24, 14
    s_add_u32 s79, s79, s78
    s_lshl_b32 s78, s91, 8
    s_add_u32 s79, s79, s78
    v_add_u32 v6, s79, v6
    v_add_u32 v7, 7168, v6
    s_mov_b32 s78, 0
    v_lshrrev_b32 v3, 5, v2
    v_lshlrev_b32 v3, 4, v3
    v_and_b32 v12, 1, v10
    v_lshl_add_u32 v3, v12, 2, v3
    v_lshrrev_b32 v12, 2, v9
    v_add_u32 v3, v3, v12
    v_mul_u32_u24 v3, 224, v3
    v_and_b32 v12, 3, v9
    v_lshl_add_u32 v3, v12, 3, v3
    s_lshl_b32 s76, s24, 6
    v_add_u32 v3, s76, v3
    v_and_b32 v8, 1, v2
    v_mul_u32_u24 v8, 0xaaaa, v8
    v_add_u32 v111, 0x4444, v8
    v_mov_b32 v80, 0
    v_mov_b32 v81, 0
    v_mov_b32 v82, 0
    v_mov_b32 v83, 0
    v_mov_b32 v84, 0
    v_mov_b32 v85, 0
    v_mov_b32 v86, 0
    v_mov_b32 v87, 0
    v_and_b32 v8, 3, v2
    v_lshlrev_b32 v8, 6, v8
    v_lshl_add_u32 v8, v10, 4, v8
    v_add_u32 v8, 155648, v8
    s_lshl_b32 s75, s88, 2
    s_add_u32 s75, s75, s24
    s_lshl_b32 s75, s75, 13
    s_add_u32 s75, s75, 196608
    s_add_u32 s76, s75, 4096
    v_mov_b32 v48, 0
    v_mov_b32 v49, 0
    v_mov_b32 v50, 0
    v_mov_b32 v51, 0
    v_add_u32 v12, 152576, v1
    ds_write_b128 v12, v[48:51]
    s_waitcnt vmcnt(4)
    s_waitcnt lgkmcnt(0)
    s_lshr_b32 s75, s89, 2
    s_lshl_b32 s76, s88, 3
    s_add_u32 s75, s75, s76
    s_lshl_b32 s75, s75, 12
    s_and_b32 s76, s89, 3
    s_lshl_b32 s76, s76, 2
    s_add_u32 s76, s76, s24
    s_lshl_b32 s76, s76, 4
    s_add_u32 s75, s75, s76
    s_add_u32 s75, s75, 196608
    s_lshl_b32 s76, s88, 5
    s_add_u32 s76, s76, s89
    s_lshl_b32 s76, s76, 2
    s_add_u32 s76, s76, s24
    s_lshl_b32 s76, s76, 5
    s_add_u32 s76, s76, 37289984
    s_lshl_b32 s70, s88, 2
    s_add_u32 s70, s70, s24
    s_lshl_b32 s70, s70, 10
    s_add_u32 s70, s70, 37289984
    v_and_b32 v56, 1, v10
    v_lshlrev_b32 v57, 4, v56
    v_lshlrev_b32 v56, 3, v56
    v_lshl_add_u32 v56, v9, 8, v56
    v_mov_b32 v58, 0xff
    s_lshl_b32 s74, s24, 8
    v_lshl_add_u32 v59, v2, 2, s74
    v_lshlrev_b32 v60, 1, v59
    v_add_u32 v59, 151552, v59
    v_add_u32 v60, 149504, v60
    v_and_b32 v113, 31, v2
    v_lshlrev_b32 v113, 7, v113
    s_lshl_b32 s77, s88, 2
    s_add_u32 s77, s77, s24
    s_lshl_b32 s77, s77, 12
    s_add_u32 s77, s77, 36962304
    s_barrier
    s_add_u32 m0, s83, 57344
    s_nop 0
    buffer_load_dwordx4 v252, s[8:11], s82 offen lds
    buffer_load_dwordx4 v253, s[8:11], s82 offen offset:1024 lds
    s_add_u32 s82, s82, 229376
    s_add_u32 m0, s83, 65536
    s_nop 0
    buffer_load_dwordx4 v252, s[8:11], s82 offen lds
    buffer_load_dwordx4 v253, s[8:11], s82 offen offset:1024 lds
    s_add_u32 s82, s82, 229376
    s_add_u32 m0, s83, 73728
    s_nop 0
    buffer_load_dwordx4 v252, s[8:11], s82 offen lds
    buffer_load_dwordx4 v253, s[8:11], s82 offen offset:1024 lds
    s_add_u32 s82, s82, 229376
    s_add_u32 m0, s83, 81920
    s_nop 0
    buffer_load_dwordx4 v252, s[8:11], s82 offen lds
    buffer_load_dwordx4 v253, s[8:11], s82 offen offset:1024 lds
    s_add_u32 s82, s82, 229376
    ds_read_b128 v[104:107], v8 offset:0
    ds_read_b64_tr_b16 v[88:89], v3 offset:0
    ds_read_b64_tr_b16 v[90:91], v3 offset:1792
    ds_read_b64_tr_b16 v[92:93], v3 offset:8192
    ds_read_b64_tr_b16 v[94:95], v3 offset:9984
    ds_read_b64_tr_b16 v[96:97], v3 offset:32
    ds_read_b64_tr_b16 v[98:99], v3 offset:1824
    ds_read_b64_tr_b16 v[100:101], v3 offset:8224
    ds_read_b64_tr_b16 v[102:103], v3 offset:10016
    s_waitcnt lgkmcnt(4)
    v_smfmac_f32_16x16x64_bf16 v[80:83], v[104:107], v[88:95], v111
    s_waitcnt lgkmcnt(0)
    v_smfmac_f32_16x16x64_bf16 v[84:87], v[104:107], v[96:103], v111
    s_waitcnt vmcnt(4)
    s_add_u32 m0, s83, 90112
    s_nop 0
    buffer_load_dwordx4 v252, s[8:11], s82 offen lds
    buffer_load_dwordx4 v253, s[8:11], s82 offen offset:1024 lds
    s_add_u32 s82, s82, 229376
    s_add_u32 m0, s83, 98304
    s_nop 0
    buffer_load_dwordx4 v252, s[8:11], s82 offen lds
    buffer_load_dwordx4 v253, s[8:11], s82 offen offset:1024 lds
    s_add_u32 s82, s82, 229376
    ds_read_b128 v[104:107], v8 offset:256
    ds_read_b64_tr_b16 v[88:89], v3 offset:16384
    ds_read_b64_tr_b16 v[90:91], v3 offset:18176
    ds_read_b64_tr_b16 v[92:93], v3 offset:24576
    ds_read_b64_tr_b16 v[94:95], v3 offset:26368
    ds_read_b64_tr_b16 v[96:97], v3 offset:16416
    ds_read_b64_tr_b16 v[98:99], v3 offset:18208
    ds_read_b64_tr_b16 v[100:101], v3 offset:24608
    ds_read_b64_tr_b16 v[102:103], v3 offset:26400
    s_waitcnt lgkmcnt(4)
    v_smfmac_f32_16x16x64_bf16 v[80:83], v[104:107], v[88:95], v111
    s_waitcnt lgkmcnt(0)
    v_smfmac_f32_16x16x64_bf16 v[84:87], v[104:107], v[96:103], v111
    s_waitcnt vmcnt(6)
    s_barrier
    buffer_load_dword v114, v113, s[16:19], s77 offen sc1
    s_add_u32 m0, s83, 106496
    s_nop 0
    buffer_load_dwordx4 v252, s[8:11], s82 offen lds
    buffer_load_dwordx4 v253, s[8:11], s82 offen offset:1024 lds
    s_add_u32 s82, s82, 229376
    s_add_u32 m0, s83, 114688
    s_nop 0
    buffer_load_dwordx4 v252, s[8:11], s82 offen lds
    buffer_load_dwordx4 v253, s[8:11], s82 offen offset:1024 lds
    s_add_u32 s82, s82, 229376
    ds_read_b128 v[104:107], v8 offset:512
    ds_read_b64_tr_b16 v[88:89], v3 offset:32768
    ds_read_b64_tr_b16 v[90:91], v3 offset:34560
    ds_read_b64_tr_b16 v[92:93], v3 offset:40960
    ds_read_b64_tr_b16 v[94:95], v3 offset:42752
    ds_read_b64_tr_b16 v[96:97], v3 offset:32800
    ds_read_b64_tr_b16 v[98:99], v3 offset:34592
    ds_read_b64_tr_b16 v[100:101], v3 offset:40992
    ds_read_b64_tr_b16 v[102:103], v3 offset:42784
    s_waitcnt lgkmcnt(4)
    v_smfmac_f32_16x16x64_bf16 v[80:83], v[104:107], v[88:95], v111
    s_waitcnt lgkmcnt(0)
    v_smfmac_f32_16x16x64_bf16 v[84:87], v[104:107], v[96:103], v111
    s_waitcnt vmcnt(5)
    s_add_u32 m0, s83, 122880
    s_nop 0
    buffer_load_dwordx4 v252, s[8:11], s82 offen lds
    buffer_load_dwordx4 v253, s[8:11], s82 offen offset:1024 lds
    s_add_u32 s82, s82, 229376
    s_add_u32 m0, s83, 131072
    s_nop 0
    buffer_load_dwordx4 v252, s[8:11], s82 offen lds
    buffer_load_dwordx4 v253, s[8:11], s82 offen offset:1024 lds
    s_add_u32 s82, s82, 229376
    ds_read_b128 v[104:107], v8 offset:768
    ds_read_b64_tr_b16 v[88:89], v3 offset:49152
    ds_read_b64_tr_b16 v[90:91], v3 offset:50944
    ds_read_b64_tr_b16 v[92:93], v3 offset:57344
    ds_read_b64_tr_b16 v[94:95], v3 offset:59136
    ds_read_b64_tr_b16 v[96:97], v3 offset:49184
    ds_read_b64_tr_b16 v[98:99], v3 offset:50976
    ds_read_b64_tr_b16 v[100:101], v3 offset:57376
    ds_read_b64_tr_b16 v[102:103], v3 offset:59168
    s_waitcnt lgkmcnt(4)
    v_smfmac_f32_16x16x64_bf16 v[80:83], v[104:107], v[88:95], v111
    s_waitcnt lgkmcnt(0)
    v_smfmac_f32_16x16x64_bf16 v[84:87], v[104:107], v[96:103], v111
    ds_read_b128 v[104:107], v8 offset:1024
    v_add_u32 v3, 0x10000, v3
    ds_read_b64_tr_b16 v[88:89], v3 offset:0
    ds_read_b64_tr_b16 v[90:91], v3 offset:1792
    ds_read_b64_tr_b16 v[92:93], v3 offset:8192
    ds_read_b64_tr_b16 v[94:95], v3 offset:9984
    ds_read_b64_tr_b16 v[96:97], v3 offset:32
    ds_read_b64_tr_b16 v[98:99], v3 offset:1824
    ds_read_b64_tr_b16 v[100:101], v3 offset:8224
    ds_read_b64_tr_b16 v[102:103], v3 offset:10016
    s_waitcnt lgkmcnt(4)
    v_smfmac_f32_16x16x64_bf16 v[80:83], v[104:107], v[88:95], v111
    s_waitcnt lgkmcnt(0)
    v_smfmac_f32_16x16x64_bf16 v[84:87], v[104:107], v[96:103], v111
    s_waitcnt vmcnt(8)
    v_cmp_ne_u32 vcc, s23, v114
    s_nop 1
    s_cbranch_vccz LadaLN_cond__grouped_kv_mqa__dense_activation_relu__prompt_kernel_fxok112
    s_mov_b32 s67, 400000
LadaLN_cond__grouped_kv_mqa__dense_activation_relu__prompt_kernel_poll113:
    buffer_load_dword v114, v113, s[16:19], s77 offen sc1
    s_waitcnt vmcnt(0)
    v_cmp_ne_u32 vcc, s23, v114
    s_nop 1
    s_cbranch_vccz LadaLN_cond__grouped_kv_mqa__dense_activation_relu__prompt_kernel_pok114
    s_sleep 1
    s_sub_u32 s67, s67, 1
    s_cbranch_scc0 LadaLN_cond__grouped_kv_mqa__dense_activation_relu__prompt_kernel_poll113
    s_branch LadaLN_cond__grouped_kv_mqa__dense_activation_relu__prompt_kernel_exit
LadaLN_cond__grouped_kv_mqa__dense_activation_relu__prompt_kernel_pok114:
LadaLN_cond__grouped_kv_mqa__dense_activation_relu__prompt_kernel_fxok112:
    s_waitcnt vmcnt(6)
    s_barrier
    buffer_load_dwordx2 v[48:49], v56, s[16:19], s75 offen sc1
    s_add_u32 m0, s83, 139264
    s_nop 0
    buffer_load_dwordx4 v252, s[8:11], s82 offen lds
    buffer_load_dwordx4 v253, s[8:11], s82 offen offset:1024 lds
    s_add_u32 s82, s82, 229376
    s_add_u32 m0, s83, 0
    s_nop 0
    buffer_load_dwordx4 v252, s[8:11], s82 offen lds
    buffer_load_dwordx4 v253, s[8:11], s82 offen offset:1024 lds
    s_add_u32 s82, s82, 229376
    ds_read_b128 v[104:107], v8 offset:1280
    ds_read_b64_tr_b16 v[88:89], v3 offset:16384
    ds_read_b64_tr_b16 v[90:91], v3 offset:18176
    ds_read_b64_tr_b16 v[92:93], v3 offset:24576
    ds_read_b64_tr_b16 v[94:95], v3 offset:26368
    ds_read_b64_tr_b16 v[96:97], v3 offset:16416
    ds_read_b64_tr_b16 v[98:99], v3 offset:18208
    ds_read_b64_tr_b16 v[100:101], v3 offset:24608
    ds_read_b64_tr_b16 v[102:103], v3 offset:26400
    s_waitcnt lgkmcnt(4)
    v_smfmac_f32_16x16x64_bf16 v[80:83], v[104:107], v[88:95], v111
    s_waitcnt lgkmcnt(0)
    v_smfmac_f32_16x16x64_bf16 v[84:87], v[104:107], v[96:103], v111
    s_waitcnt vmcnt(5)
    s_add_u32 m0, s83, 8192
    s_nop 0
    buffer_load_dwordx4 v252, s[8:11], s82 offen lds
    buffer_load_dwordx4 v253, s[8:11], s82 offen offset:1024 lds
    s_add_u32 s82, s82, 229376
    s_add_u32 m0, s83, 16384
    s_nop 0
    buffer_load_dwordx4 v252, s[8:11], s82 offen lds
    buffer_load_dwordx4 v253, s[8:11], s82 offen offset:1024 lds
    s_add_u32 s82, s82, 229376
    ds_read_b128 v[104:107], v8 offset:1536
    ds_read_b64_tr_b16 v[88:89], v3 offset:32768
    ds_read_b64_tr_b16 v[90:91], v3 offset:34560
    ds_read_b64_tr_b16 v[92:93], v3 offset:40960
    ds_read_b64_tr_b16 v[94:95], v3 offset:42752
    ds_read_b64_tr_b16 v[96:97], v3 offset:32800
    ds_read_b64_tr_b16 v[98:99], v3 offset:34592
    ds_read_b64_tr_b16 v[100:101], v3 offset:40992
    ds_read_b64_tr_b16 v[102:103], v3 offset:42784
    s_waitcnt lgkmcnt(4)
    v_smfmac_f32_16x16x64_bf16 v[80:83], v[104:107], v[88:95], v111
    s_waitcnt lgkmcnt(0)
    v_smfmac_f32_16x16x64_bf16 v[84:87], v[104:107], v[96:103], v111
    s_waitcnt vmcnt(8)
    v_add_f32_dpp v48, v48, v48 row_ror:8 row_mask:0xf bank_mask:0xf
    v_add_f32_dpp v49, v49, v49 row_ror:8 row_mask:0xf bank_mask:0xf
    s_nop 0
    v_add_f32_dpp v48, v48, v48 row_ror:4 row_mask:0xf bank_mask:0xf
    v_add_f32_dpp v49, v49, v49 row_ror:4 row_mask:0xf bank_mask:0xf
    s_nop 0
    v_add_f32_dpp v48, v48, v48 row_ror:2 row_mask:0xf bank_mask:0xf
    v_add_f32_dpp v49, v49, v49 row_ror:2 row_mask:0xf bank_mask:0xf
    s_nop 0
    v_add_f32_dpp v48, v48, v48 row_ror:1 row_mask:0xf bank_mask:0xf
    v_add_f32_dpp v49, v49, v49 row_ror:1 row_mask:0xf bank_mask:0xf
    v_mul_f32 v48, 0x3a800000, v48
    v_mul_f32 v52, v48, v48
    v_mov_b32 v53, 0x3a800000
    v_fma_f32 v49, v49, v53, -v52
    v_max_f32 v49, 0, v49
    v_cvt_pk_bf16_f32 v49, v48, v49
    v_lshlrev_b32 v48, 16, v49
    v_and_b32 v49, 0xffff0000, v49
    v_add_f32 v49, 0x3727c5ac, v49
    v_cvt_pk_bf16_f32 v49, v49, v49
    v_and_b32 v49, 0xffff0000, v49
    v_sqrt_f32 v49, v49
    s_nop 0
    v_cvt_pk_bf16_f32 v49, v49, v49
    v_and_b32 v49, 0xffff0000, v49
    v_rcp_f32 v50, v49
    v_sub_f32 v48, 0, v48
    v_mov_b32 v51, s65
    v_bfi_b32 v48, v58, s62, v48
    v_bfi_b32 v49, v58, s63, v49
    v_bfi_b32 v50, v58, s64, v50
    s_mov_b64 exec, 0x10001
    buffer_store_dwordx4 v[48:51], v57, s[16:19], s76 offen sc1
    s_mov_b64 exec, -1
    s_waitcnt vmcnt(5)
    s_barrier
    s_add_u32 m0, s83, 24576
    s_nop 0
    buffer_load_dwordx4 v252, s[8:11], s82 offen lds
    buffer_load_dwordx4 v253, s[8:11], s82 offen offset:1024 lds
    s_add_u32 s82, s82, 229376
    s_add_u32 m0, s83, 32768
    s_nop 0
    buffer_load_dwordx4 v252, s[8:11], s82 offen lds
    buffer_load_dwordx4 v253, s[8:11], s82 offen offset:1024 lds
    s_add_u32 s82, s82, 229376
    ds_read_b128 v[104:107], v8 offset:1792
    ds_read_b64_tr_b16 v[88:89], v3 offset:49152
    ds_read_b64_tr_b16 v[90:91], v3 offset:50944
    ds_read_b64_tr_b16 v[92:93], v3 offset:57344
    ds_read_b64_tr_b16 v[94:95], v3 offset:59136
    ds_read_b64_tr_b16 v[96:97], v3 offset:49184
    ds_read_b64_tr_b16 v[98:99], v3 offset:50976
    ds_read_b64_tr_b16 v[100:101], v3 offset:57376
    ds_read_b64_tr_b16 v[102:103], v3 offset:59168
    s_waitcnt lgkmcnt(4)
    v_smfmac_f32_16x16x64_bf16 v[80:83], v[104:107], v[88:95], v111
    s_waitcnt lgkmcnt(0)
    v_smfmac_f32_16x16x64_bf16 v[84:87], v[104:107], v[96:103], v111
    s_waitcnt vmcnt(5)
    s_add_u32 m0, s83, 40960
    s_nop 0
    buffer_load_dwordx4 v252, s[8:11], s82 offen lds
    buffer_load_dwordx4 v253, s[8:11], s82 offen offset:1024 lds
    s_add_u32 s82, s82, 229376
    s_add_u32 m0, s83, 49152
    s_nop 0
    buffer_load_dwordx4 v252, s[8:11], s82 offen lds
    buffer_load_dwordx4 v253, s[8:11], s82 offen offset:1024 lds
    s_add_u32 s82, s82, 229376
    ds_read_b128 v[104:107], v8 offset:2048
    v_add_u32 v3, 0x10000, v3
    ds_read_b64_tr_b16 v[88:89], v3 offset:0
    ds_read_b64_tr_b16 v[90:91], v3 offset:1792
    ds_read_b64_tr_b16 v[92:93], v3 offset:8192
    ds_read_b64_tr_b16 v[94:95], v3 offset:9984
    s_branch LadaLN_cond__grouped_kv_mqa__dense_activation_relu__prompt_kernel_over17
LadaLN_cond__grouped_kv_mqa__dense_activation_relu__prompt_kernel_stub17:
    s_setpc_b64 s[96:97]
LadaLN_cond__grouped_kv_mqa__dense_activation_relu__prompt_kernel_over17:
    ds_read_b64_tr_b16 v[96:97], v3 offset:32
    ds_read_b64_tr_b16 v[98:99], v3 offset:1824
    ds_read_b64_tr_b16 v[100:101], v3 offset:8224
    ds_read_b64_tr_b16 v[102:103], v3 offset:10016
    s_waitcnt lgkmcnt(4)
    v_smfmac_f32_16x16x64_bf16 v[80:83], v[104:107], v[88:95], v111
    s_waitcnt lgkmcnt(0)
    v_smfmac_f32_16x16x64_bf16 v[84:87], v[104:107], v[96:103], v111
    s_waitcnt vmcnt(4)
    s_barrier
    buffer_load_dwordx4 v[52:55], v1, s[16:19], s70 offen sc1
    s_add_u32 m0, s83, 57344
    s_nop 0
    buffer_load_dwordx4 v252, s[8:11], s82 offen lds
    buffer_load_dwordx4 v253, s[8:11], s82 offen offset:1024 lds
    s_add_u32 s82, s82, 229376
    s_add_u32 m0, s83, 65536
    s_nop 0
    buffer_load_dwordx4 v252, s[8:11], s82 offen lds
    buffer_load_dwordx4 v253, s[8:11], s82 offen offset:1024 lds
    s_add_u32 s82, s82, 229376
    s_add_u32 m0, s83, 73728
    s_nop 0
    buffer_load_dwordx4 v252, s[8:11], s82 offen lds
    buffer_load_dwordx4 v253, s[8:11], s82 offen offset:1024 lds
    s_add_u32 s82, s82, 229376
    ds_read_b128 v[104:107], v8 offset:2304
    v_add_u32 v3, 0xfffe0000, v3
    ds_read_b64_tr_b16 v[88:89], v3 offset:0
    ds_read_b64_tr_b16 v[90:91], v3 offset:1792
    ds_read_b64_tr_b16 v[92:93], v3 offset:8192
    ds_read_b64_tr_b16 v[94:95], v3 offset:9984
    ds_read_b64_tr_b16 v[96:97], v3 offset:32
    ds_read_b64_tr_b16 v[98:99], v3 offset:1824
    ds_read_b64_tr_b16 v[100:101], v3 offset:8224
    ds_read_b64_tr_b16 v[102:103], v3 offset:10016
    s_waitcnt lgkmcnt(4)
    v_smfmac_f32_16x16x64_bf16 v[80:83], v[104:107], v[88:95], v111
    s_waitcnt lgkmcnt(0)
    v_smfmac_f32_16x16x64_bf16 v[84:87], v[104:107], v[96:103], v111
    s_waitcnt vmcnt(7)
    s_add_u32 m0, s83, 81920
    s_nop 0
    buffer_load_dwordx4 v252, s[8:11], s82 offen lds
    buffer_load_dwordx4 v253, s[8:11], s82 offen offset:1024 lds
    s_add_u32 s82, s82, 229376
    s_add_u32 m0, s83, 90112
    s_nop 0
    buffer_load_dwordx4 v252, s[8:11], s82 offen lds
    buffer_load_dwordx4 v253, s[8:11], s82 offen offset:1024 lds
    s_add_u32 s82, s82, 229376
    ds_read_b128 v[104:107], v8 offset:2560
    ds_read_b64_tr_b16 v[88:89], v3 offset:16384
    ds_read_b64_tr_b16 v[90:91], v3 offset:18176
    ds_read_b64_tr_b16 v[92:93], v3 offset:24576
    ds_read_b64_tr_b16 v[94:95], v3 offset:26368
    ds_read_b64_tr_b16 v[96:97], v3 offset:16416
    ds_read_b64_tr_b16 v[98:99], v3 offset:18208
    ds_read_b64_tr_b16 v[100:101], v3 offset:24608
    ds_read_b64_tr_b16 v[102:103], v3 offset:26400
    s_waitcnt lgkmcnt(4)
    v_smfmac_f32_16x16x64_bf16 v[80:83], v[104:107], v[88:95], v111
    s_waitcnt lgkmcnt(0)
    v_smfmac_f32_16x16x64_bf16 v[84:87], v[104:107], v[96:103], v111
    s_waitcnt vmcnt(10)
    v_xor_b32 v52, s62, v52
    v_xor_b32 v53, s63, v53
    v_xor_b32 v54, s64, v54
    v_xor_b32 v55, s65, v55
    v_or3_b32 v12, v52, v53, v54
    v_or_b32 v12, v12, v55
    v_and_b32 v12, 0xff, v12
    v_cmp_ne_u32 vcc, 0, v12
    s_nop 1
    s_cbranch_vccz LadaLN_cond__grouped_kv_mqa__dense_activation_relu__prompt_kernel_ok115
    s_mov_b32 s67, 400000
LadaLN_cond__grouped_kv_mqa__dense_activation_relu__prompt_kernel_poll116:
    buffer_load_dwordx4 v[52:55], v1, s[16:19], s70 offen sc1
    s_waitcnt vmcnt(0)
    v_xor_b32 v52, s62, v52
    v_xor_b32 v53, s63, v53
    v_xor_b32 v54, s64, v54
    v_xor_b32 v55, s65, v55
    v_or3_b32 v12, v52, v53, v54
    v_or_b32 v12, v12, v55
    v_and_b32 v12, 0xff, v12
    v_cmp_ne_u32 vcc, 0, v12
    s_nop 1
    s_cbranch_vccz LadaLN_cond__grouped_kv_mqa__dense_activation_relu__prompt_kernel_pok117
    s_sleep 1
    s_sub_u32 s67, s67, 1
    s_cbranch_scc0 LadaLN_cond__grouped_kv_mqa__dense_activation_relu__prompt_kernel_poll116
    s_branch LadaLN_cond__grouped_kv_mqa__dense_activation_relu__prompt_kernel_exit
LadaLN_cond__grouped_kv_mqa__dense_activation_relu__prompt_kernel_pok117:
LadaLN_cond__grouped_kv_mqa__dense_activation_relu__prompt_kernel_ok115:
    v_cvt_pk_bf16_f32 v52, v52, v52
    v_cvt_pk_bf16_f32 v53, v53, v53
    ds_write_b32 v59, v54
    ds_write_b64 v60, v[52:53]
    s_waitcnt lgkmcnt(0)
    s_waitcnt vmcnt(4)
    s_barrier
    s_add_u32 m0, s83, 98304
    s_nop 0
    buffer_load_dwordx4 v252, s[8:11], s82 offen lds
    buffer_load_dwordx4 v253, s[8:11], s82 offen offset:1024 lds
    s_add_u32 s82, s82, 229376
    s_add_u32 m0, s83, 106496
    s_nop 0
    buffer_load_dwordx4 v252, s[8:11], s82 offen lds
    buffer_load_dwordx4 v253, s[8:11], s82 offen offset:1024 lds
    s_add_u32 s82, s82, 229376
    ds_read_b128 v[104:107], v8 offset:2816
    ds_read_b64_tr_b16 v[88:89], v3 offset:32768
    ds_read_b64_tr_b16 v[90:91], v3 offset:34560
    ds_read_b64_tr_b16 v[92:93], v3 offset:40960
    ds_read_b64_tr_b16 v[94:95], v3 offset:42752
    ds_read_b64_tr_b16 v[96:97], v3 offset:32800
    ds_read_b64_tr_b16 v[98:99], v3 offset:34592
    ds_read_b64_tr_b16 v[100:101], v3 offset:40992
    ds_read_b64_tr_b16 v[102:103], v3 offset:42784
    s_waitcnt lgkmcnt(4)
    v_smfmac_f32_16x16x64_bf16 v[80:83], v[104:107], v[88:95], v111
    s_waitcnt lgkmcnt(0)
    v_smfmac_f32_16x16x64_bf16 v[84:87], v[104:107], v[96:103], v111
    s_waitcnt vmcnt(4)
    s_add_u32 m0, s83, 114688
    s_nop 0
    buffer_load_dwordx4 v6, s[12:15], s78 offen lds
    buffer_load_dwordx4 v7, s[12:15], s78 offen offset:1024 lds
    s_add_u32 s78, s78, 65536
    s_add_u32 m0, s83, 122880
    s_nop 0
    buffer_load_dwordx4 v6, s[12:15], s78 offen lds
    buffer_load_dwordx4 v7, s[12:15], s78 offen offset:1024 lds
    s_add_u32 s78, s78, 65536
    ds_read_b128 v[104:107], v8 offset:3072
    ds_read_b64_tr_b16 v[88:89], v3 offset:49152
    ds_read_b64_tr_b16 v[90:91], v3 offset:50944
    ds_read_b64_tr_b16 v[92:93], v3 offset:57344
    ds_read_b64_tr_b16 v[94:95], v3 offset:59136
    ds_read_b64_tr_b16 v[96:97], v3 offset:49184
    ds_read_b64_tr_b16 v[98:99], v3 offset:50976
    ds_read_b64_tr_b16 v[100:101], v3 offset:57376
    ds_read_b64_tr_b16 v[102:103], v3 offset:59168
    s_waitcnt lgkmcnt(4)
    v_smfmac_f32_16x16x64_bf16 v[80:83], v[104:107], v[88:95], v111
    s_waitcnt lgkmcnt(0)
    v_smfmac_f32_16x16x64_bf16 v[84:87], v[104:107], v[96:103], v111
    ds_read_b128 v[104:107], v8 offset:3328
    v_add_u32 v3, 0x10000, v3
    ds_read_b64_tr_b16 v[88:89], v3 offset:0
    ds_read_b64_tr_b16 v[90:91], v3 offset:1792
    ds_read_b64_tr_b16 v[92:93], v3 offset:8192
    ds_read_b64_tr_b16 v[94:95], v3 offset:9984
    ds_read_b64_tr_b16 v[96:97], v3 offset:32
    ds_read_b64_tr_b16 v[98:99], v3 offset:1824
    ds_read_b64_tr_b16 v[100:101], v3 offset:8224
    ds_read_b64_tr_b16 v[102:103], v3 offset:10016
    s_waitcnt lgkmcnt(4)
    v_smfmac_f32_16x16x64_bf16 v[80:83], v[104:107], v[88:95], v111
    s_waitcnt lgkmcnt(0)
    v_smfmac_f32_16x16x64_bf16 v[84:87], v[104:107], v[96:103], v111
    s_waitcnt vmcnt(4)
    s_barrier
    s_add_u32 m0, s83, 131072
    s_nop 0
    buffer_load_dwordx4 v6, s[12:15], s78 offen lds
    buffer_load_dwordx4 v7, s[12:15], s78 offen offset:1024 lds
    s_add_u32 s78, s78, 65536
    s_add_u32 m0, s83, 139264
    s_nop 0
    buffer_load_dwordx4 v6, s[12:15], s78 offen lds
    buffer_load_dwordx4 v7, s[12:15], s78 offen offset:1024 lds
    s_add_u32 s78, s78, 65536
    ds_read_b128 v[104:107], v8 offset:3584
    ds_read_b64_tr_b16 v[88:89], v3 offset:16384
    ds_read_b64_tr_b16 v[90:91], v3 offset:18176
    ds_read_b64_tr_b16 v[92:93], v3 offset:24576
    ds_read_b64_tr_b16 v[94:95], v3 offset:26368
    ds_read_b64_tr_b16 v[96:97], v3 offset:16416
    ds_read_b64_tr_b16 v[98:99], v3 offset:18208
    ds_read_b64_tr_b16 v[100:101], v3 offset:24608
    ds_read_b64_tr_b16 v[102:103], v3 offset:26400
    s_waitcnt lgkmcnt(4)
    v_smfmac_f32_16x16x64_bf16 v[80:83], v[104:107], v[88:95], v111
    s_waitcnt lgkmcnt(0)
    v_smfmac_f32_16x16x64_bf16 v[84:87], v[104:107], v[96:103], v111
    s_waitcnt vmcnt(4)
    s_add_u32 m0, s83, 0
    s_nop 0
    buffer_load_dwordx4 v6, s[12:15], s78 offen lds
    buffer_load_dwordx4 v7, s[12:15], s78 offen offset:1024 lds
    s_add_u32 s78, s78, 65536
    s_add_u32 m0, s83, 8192
    s_nop 0
    buffer_load_dwordx4 v6, s[12:15], s78 offen lds
    buffer_load_dwordx4 v7, s[12:15], s78 offen offset:1024 lds
    s_add_u32 s78, s78, 65536
    ds_read_b128 v[104:107], v8 offset:3840
    ds_read_b64_tr_b16 v[88:89], v3 offset:32768
    ds_read_b64_tr_b16 v[90:91], v3 offset:34560
    ds_read_b64_tr_b16 v[92:93], v3 offset:40960
    ds_read_b64_tr_b16 v[94:95], v3 offset:42752
    ds_read_b64_tr_b16 v[96:97], v3 offset:32800
    ds_read_b64_tr_b16 v[98:99], v3 offset:34592
    ds_read_b64_tr_b16 v[100:101], v3 offset:40992
    ds_read_b64_tr_b16 v[102:103], v3 offset:42784
    s_waitcnt lgkmcnt(4)
    v_smfmac_f32_16x16x64_bf16 v[80:83], v[104:107], v[88:95], v111
    s_waitcnt lgkmcnt(0)
    v_smfmac_f32_16x16x64_bf16 v[84:87], v[104:107], v[96:103], v111
    s_lshl_b32 s74, s24, 8
    s_add_u32 s74, s74, 148480
    v_lshl_add_u32 v11, v2, 3, s74
    v_cmp_gt_u32 vcc, 16, v2
    s_nop 8
    v_add_f32 v80, v80, v81
    v_add_f32 v82, v82, v83
    v_add_f32 v84, v84, v85
    v_add_f32 v86, v86, v87
    v_cndmask_b32 v80, v84, v80, vcc
    v_cndmask_b32 v81, v86, v82, vcc
    v_cvt_pk_bf16_f32 v12, v80, v80
    v_cvt_pk_bf16_f32 v13, v81, v81
    v_and_b32 v12, 0xffff0000, v12
    v_and_b32 v13, 0xffff0000, v13
    v_sub_f32 v80, v80, v12
    v_sub_f32 v81, v81, v13
    v_cvt_pk_bf16_f32 v80, v12, v80
    v_cvt_pk_bf16_f32 v81, v13, v81
    s_mov_b32 exec_hi, 0
    ds_write_b64 v11, v[80:81]
    s_mov_b32 exec_hi, -1
    s_waitcnt lgkmcnt(0)
    s_barrier
    s_add_u32 m0, s83, 16384
    s_nop 0
    buffer_load_dwordx4 v6, s[12:15], s78 offen lds
    buffer_load_dwordx4 v7, s[12:15], s78 offen offset:1024 lds
    s_add_u32 s78, s78, 65536
    s_add_u32 m0, s83, 24576
    s_nop 0
    buffer_load_dwordx4 v6, s[12:15], s78 offen lds
    buffer_load_dwordx4 v7, s[12:15], s78 offen offset:1024 lds
    s_add_u32 s78, s78, 65536
    s_waitcnt vmcnt(4)
    s_add_u32 m0, s83, 32768
    s_nop 0
    buffer_load_dwordx4 v6, s[12:15], s78 offen lds
    buffer_load_dwordx4 v7, s[12:15], s78 offen offset:1024 lds
    s_add_u32 s78, s78, 65536
    s_add_u32 m0, s83, 40960
    s_nop 0
    buffer_load_dwordx4 v6, s[12:15], s78 offen lds
    buffer_load_dwordx4 v7, s[12:15], s78 offen offset:1024 lds
    s_add_u32 s78, s78, 65536
    s_call_b64 s[96:97], LadaLN_cond__grouped_kv_mqa__dense_activation_relu__prompt_kernel_stub12
    s_call_b64 s[96:97], LadaLN_cond__grouped_kv_mqa__dense_activation_relu__prompt_kernel_stub13
    s_call_b64 s[96:97], LadaLN_cond__grouped_kv_mqa__dense_activation_relu__prompt_kernel_stub14
    s_call_b64 s[96:97], LadaLN_cond__grouped_kv_mqa__dense_activation_relu__prompt_kernel_stub15
    s_call_b64 s[96:97], LadaLN_cond__grouped_kv_mqa__dense_activation_relu__prompt_kernel_stub16
    s_barrier
    s_barrier
    v_lshlrev_b32 v11, 7, v9
    s_lshr_b32 s72, s66, 1
    s_lshl_b32 s72, s72, 5
    s_lshl_b32 s73, s90, 4
    s_add_u32 s72, s72, s73
    s_lshl_b32 s72, s72, 7
    s_add_u32 s72, s72, 37093376
    s_add_u32 m0, s83, 49152
    s_nop 0
    buffer_load_dwordx4 v6, s[12:15], s78 offen lds
    buffer_load_dwordx4 v7, s[12:15], s78 offen offset:1024 lds
    s_add_u32 s78, s78, 65536
    s_add_u32 m0, s83, 57344
    s_nop 0
    buffer_load_dwordx4 v6, s[12:15], s78 offen lds
    buffer_load_dwordx4 v7, s[12:15], s78 offen offset:1024 lds
    s_add_u32 s78, s78, 65536
    s_add_u32 m0, s83, 65536
    s_nop 0
    buffer_load_dwordx4 v6, s[12:15], s78 offen lds
    buffer_load_dwordx4 v7, s[12:15], s78 offen offset:1024 lds
    s_add_u32 s78, s78, 65536
    s_add_u32 m0, s83, 73728
    s_nop 0
    buffer_load_dwordx4 v6, s[12:15], s78 offen lds
    buffer_load_dwordx4 v7, s[12:15], s78 offen offset:1024 lds
    s_add_u32 s78, s78, 65536
    s_add_u32 m0, s83, 81920
    s_nop 0
    s_waitcnt vmcnt(3)
    buffer_load_dwordx4 v6, s[12:15], s78 offen lds
    s_waitcnt vmcnt(3)
    buffer_load_dwordx4 v7, s[12:15], s78 offen offset:1024 lds
    s_add_u32 s78, s78, 65536
    s_add_u32 m0, s83, 90112
    s_nop 0
    s_waitcnt vmcnt(3)
    buffer_load_dwordx4 v6, s[12:15], s78 offen lds
    s_waitcnt vmcnt(3)
    buffer_load_dwordx4 v7, s[12:15], s78 offen offset:1024 lds
    s_add_u32 s78, s78, 65536
    s_add_u32 m0, s83, 98304
    s_nop 0
    s_waitcnt vmcnt(3)
    buffer_load_dwordx4 v6, s[12:15], s78 offen lds
    s_waitcnt vmcnt(3)
    buffer_load_dwordx4 v7, s[12:15], s78 offen offset:1024 lds
    s_add_u32 s78, s78, 65536
    s_add_u32 m0, s83, 106496
    s_nop 0
    s_waitcnt vmcnt(3)
    buffer_load_dwordx4 v6, s[12:15], s78 offen lds
    s_waitcnt vmcnt(3)
    buffer_load_dwordx4 v7, s[12:15], s78 offen offset:1024 lds
    s_add_u32 s78, s78, 65536
    s_barrier
    buffer_load_dword v12, v11, s[16:19], s72 offen sc1
    s_add_u32 m0, s83, 114688
    s_nop 0
    s_waitcnt vmcnt(3)
    buffer_load_dwordx4 v6, s[12:15], s78 offen lds
    s_waitcnt vmcnt(3)
    buffer_load_dwordx4 v7, s[12:15], s78 offen offset:1024 lds
    s_add_u32 s78, s78, 65536
    s_add_u32 m0, s83, 122880
    s_nop 0
    s_waitcnt vmcnt(3)
    buffer_load_dwordx4 v6, s[12:15], s78 offen lds
    s_waitcnt vmcnt(3)
    buffer_load_dwordx4 v7, s[12:15], s78 offen offset:1024 lds
    s_add_u32 s78, s78, 65536
    s_add_u32 m0, s83, 131072
    s_nop 0
    s_waitcnt vmcnt(3)
    buffer_load_dwordx4 v6, s[12:15], s78 offen lds
    s_waitcnt vmcnt(3)
    buffer_load_dwordx4 v7, s[12:15], s78 offen offset:1024 lds
    s_add_u32 s78, s78, 65536
    v_cmp_ne_u32 vcc, s23, v12
    s_nop 1
    s_cbranch_vccz LadaLN_cond__grouped_kv_mqa__dense_activation_relu__prompt_kernel_ffok118
    s_mov_b32 s67, 400000
LadaLN_cond__grouped_kv_mqa__dense_activation_relu__prompt_kernel_poll119:
    buffer_load_dword v12, v11, s[16:19], s72 offen sc1
    s_waitcnt vmcnt(0)
    v_cmp_ne_u32 vcc, s23, v12
    s_nop 1
    s_cbranch_vccz LadaLN_cond__grouped_kv_mqa__dense_activation_relu__prompt_kernel_pok120
    s_sleep 1
    s_sub_u32 s67, s67, 1
    s_cbranch_scc0 LadaLN_cond__grouped_kv_mqa__dense_activation_relu__prompt_kernel_poll119
    s_branch LadaLN_cond__grouped_kv_mqa__dense_activation_relu__prompt_kernel_exit
LadaLN_cond__grouped_kv_mqa__dense_activation_relu__prompt_kernel_pok120:
LadaLN_cond__grouped_kv_mqa__dense_activation_relu__prompt_kernel_ffok118:
    s_barrier
    s_add_u32 m0, s83, 139264
    s_nop 0
    s_waitcnt vmcnt(3)
    buffer_load_dwordx4 v6, s[12:15], s78 offen lds
    s_waitcnt vmcnt(3)
    buffer_load_dwordx4 v7, s[12:15], s78 offen offset:1024 lds
    s_add_u32 s78, s78, 65536
    s_add_u32 m0, s83, 0
    s_nop 0
    s_waitcnt vmcnt(3)
    buffer_load_dwordx4 v6, s[12:15], s78 offen lds
    s_waitcnt vmcnt(3)
    buffer_load_dwordx4 v7, s[12:15], s78 offen offset:1024 lds
    s_add_u32 s78, s78, 65536
    s_add_u32 m0, s83, 8192
    s_nop 0
    s_waitcnt vmcnt(3)
    buffer_load_dwordx4 v6, s[12:15], s78 offen lds
    s_waitcnt vmcnt(3)
    buffer_load_dwordx4 v7, s[12:15], s78 offen offset:1024 lds
    s_add_u32 s78, s78, 65536
    s_add_u32 m0, s83, 16384
    s_nop 0
    s_waitcnt vmcnt(3)
    buffer_load_dwordx4 v6, s[12:15], s78 offen lds
    s_waitcnt vmcnt(3)
    buffer_load_dwordx4 v7, s[12:15], s78 offen offset:1024 lds
    s_add_u32 s78, s78, 65536
    s_barrier
    s_add_u32 m0, s83, 24576
    s_nop 0
    s_waitcnt vmcnt(3)
    buffer_load_dwordx4 v6, s[12:15], s78 offen lds
    s_waitcnt vmcnt(3)
    buffer_load_dwordx4 v7, s[12:15], s78 offen offset:1024 lds
    s_add_u32 s78, s78, 65536
    s_add_u32 m0, s83, 32768
    s_nop 0
    s_waitcnt vmcnt(3)
    buffer_load_dwordx4 v6, s[12:15], s78 offen lds
    s_waitcnt vmcnt(3)
    buffer_load_dwordx4 v7, s[12:15], s78 offen offset:1024 lds
    s_add_u32 s78, s78, 65536
    s_add_u32 m0, s83, 40960
    s_nop 0
    s_waitcnt vmcnt(3)
    buffer_load_dwordx4 v6, s[12:15], s78 offen lds
    s_waitcnt vmcnt(3)
    buffer_load_dwordx4 v7, s[12:15], s78 offen offset:1024 lds
    s_add_u32 s78, s78, 65536
    s_barrier
    s_add_u32 m0, s83, 49152
    s_nop 0
    s_waitcnt vmcnt(3)
    buffer_load_dwordx4 v6, s[12:15], s78 offen lds
    s_waitcnt vmcnt(3)
    buffer_load_dwordx4 v7, s[12:15], s78 offen offset:1024 lds
    s_add_u32 s78, s78, 65536
    s_add_u32 m0, s83, 57344
    s_nop 0
    s_waitcnt vmcnt(3)
    buffer_load_dwordx4 v6, s[12:15], s78 offen lds
    s_waitcnt vmcnt(3)
    buffer_load_dwordx4 v7, s[12:15], s78 offen offset:1024 lds
    s_add_u32 s78, s78, 65536
    s_add_u32 m0, s83, 65536
    s_nop 0
    s_waitcnt vmcnt(3)
    buffer_load_dwordx4 v6, s[12:15], s78 offen lds
    s_waitcnt vmcnt(3)
    buffer_load_dwordx4 v7, s[12:15], s78 offen offset:1024 lds
    s_add_u32 s78, s78, 65536
    s_add_u32 m0, s83, 73728
    s_nop 0
    s_waitcnt vmcnt(3)
    buffer_load_dwordx4 v6, s[12:15], s78 offen lds
    s_waitcnt vmcnt(3)
    buffer_load_dwordx4 v7, s[12:15], s78 offen offset:1024 lds
    s_add_u32 s78, s78, 65536
    s_barrier
    s_add_u32 m0, s83, 81920
    s_nop 0
    s_waitcnt vmcnt(3)
    buffer_load_dwordx4 v6, s[12:15], s78 offen lds
    s_waitcnt vmcnt(3)
    buffer_load_dwordx4 v7, s[12:15], s78 offen offset:1024 lds
    s_add_u32 s78, s78, 65536
    s_add_u32 m0, s83, 90112
    s_nop 0
    s_waitcnt vmcnt(3)
    buffer_load_dwordx4 v6, s[12:15], s78 offen lds
    s_waitcnt vmcnt(3)
    buffer_load_dwordx4 v7, s[12:15], s78 offen offset:1024 lds
    s_add_u32 s78, s78, 65536
    s_add_u32 m0, s83, 98304
    s_nop 0
    s_waitcnt vmcnt(3)
    buffer_load_dwordx4 v6, s[12:15], s78 offen lds
    s_waitcnt vmcnt(3)
    buffer_load_dwordx4 v7, s[12:15], s78 offen offset:1024 lds
    s_add_u32 s78, s78, 65536
    s_barrier
    s_add_u32 m0, s83, 106496
    s_nop 0
    s_waitcnt vmcnt(3)
    buffer_load_dwordx4 v6, s[12:15], s78 offen lds
    s_waitcnt vmcnt(3)
    buffer_load_dwordx4 v7, s[12:15], s78 offen offset:1024 lds
    s_add_u32 s78, s78, 65536
    s_add_u32 m0, s83, 114688
    s_nop 0
    s_waitcnt vmcnt(3)
    buffer_load_dwordx4 v6, s[12:15], s78 offen lds
    s_waitcnt vmcnt(3)
    buffer_load_dwordx4 v7, s[12:15], s78 offen offset:1024 lds
    s_add_u32 s78, s78, 65536
    s_add_u32 m0, s83, 122880
    s_nop 0
    s_waitcnt vmcnt(3)
    buffer_load_dwordx4 v6, s[12:15], s78 offen lds
    s_waitcnt vmcnt(3)
    buffer_load_dwordx4 v7, s[12:15], s78 offen offset:1024 lds
    s_add_u32 s78, s78, 65536
    s_add_u32 m0, s83, 131072
    s_nop 0
    s_waitcnt vmcnt(3)
    buffer_load_dwordx4 v6, s[12:15], s78 offen lds
    s_waitcnt vmcnt(3)
    buffer_load_dwordx4 v7, s[12:15], s78 offen offset:1024 lds
    s_add_u32 s78, s78, 65536
    s_barrier
    s_add_u32 m0, s83, 139264
    s_nop 0
    s_waitcnt vmcnt(3)
    buffer_load_dwordx4 v6, s[12:15], s78 offen lds
    s_waitcnt vmcnt(3)
    buffer_load_dwordx4 v7, s[12:15], s78 offen offset:1024 lds
    s_add_u32 s78, s78, 65536
    s_add_u32 m0, s83, 0
    s_nop 0
    s_waitcnt vmcnt(3)
    buffer_load_dwordx4 v6, s[12:15], s78 offen lds
    s_waitcnt vmcnt(3)
    buffer_load_dwordx4 v7, s[12:15], s78 offen offset:1024 lds
    s_add_u32 s78, s78, 65536
    s_add_u32 m0, s83, 8192
    s_nop 0
    s_waitcnt vmcnt(3)
    buffer_load_dwordx4 v6, s[12:15], s78 offen lds
    s_waitcnt vmcnt(3)
    buffer_load_dwordx4 v7, s[12:15], s78 offen offset:1024 lds
    s_add_u32 s78, s78, 65536
    s_barrier
    s_add_u32 m0, s83, 16384
    s_nop 0
    s_waitcnt vmcnt(3)
    buffer_load_dwordx4 v6, s[12:15], s78 offen lds
    s_waitcnt vmcnt(3)
    buffer_load_dwordx4 v7, s[12:15], s78 offen offset:1024 lds
    s_add_u32 s78, s78, 65536
    s_add_u32 m0, s83, 24576
    s_nop 0
    s_waitcnt vmcnt(3)
    buffer_load_dwordx4 v6, s[12:15], s78 offen lds
    s_waitcnt vmcnt(3)
    buffer_load_dwordx4 v7, s[12:15], s78 offen offset:1024 lds
    s_add_u32 s78, s78, 65536
    s_add_u32 m0, s83, 32768
    s_nop 0
    s_waitcnt vmcnt(3)
    buffer_load_dwordx4 v6, s[12:15], s78 offen lds
    s_waitcnt vmcnt(3)
    buffer_load_dwordx4 v7, s[12:15], s78 offen offset:1024 lds
    s_add_u32 s78, s78, 65536
    s_add_u32 m0, s83, 40960
    s_nop 0
    s_waitcnt vmcnt(3)
    buffer_load_dwordx4 v6, s[12:15], s78 offen lds
    s_waitcnt vmcnt(3)
    buffer_load_dwordx4 v7, s[12:15], s78 offen offset:1024 lds
    s_add_u32 s78, s78, 65536
    s_barrier
    s_add_u32 m0, s83, 49152
    s_nop 0
    s_waitcnt vmcnt(3)
    buffer_load_dwordx4 v6, s[12:15], s78 offen lds
    s_waitcnt vmcnt(3)
    buffer_load_dwordx4 v7, s[12:15], s78 offen offset:1024 lds
    s_add_u32 s78, s78, 65536
    s_add_u32 m0, s83, 57344
    s_nop 0
    s_waitcnt vmcnt(3)
    buffer_load_dwordx4 v6, s[12:15], s78 offen lds
    s_waitcnt vmcnt(3)
    buffer_load_dwordx4 v7, s[12:15], s78 offen offset:1024 lds
    s_add_u32 s78, s78, 65536
    s_add_u32 m0, s83, 65536
    s_nop 0
    s_waitcnt vmcnt(3)
    buffer_load_dwordx4 v6, s[12:15], s78 offen lds
    s_waitcnt vmcnt(3)
    buffer_load_dwordx4 v7, s[12:15], s78 offen offset:1024 lds
    s_add_u32 s78, s78, 65536
    s_barrier
    s_add_u32 m0, s83, 73728
    s_nop 0
    s_waitcnt vmcnt(3)
    buffer_load_dwordx4 v6, s[12:15], s78 offen lds
    s_waitcnt vmcnt(3)
    buffer_load_dwordx4 v7, s[12:15], s78 offen offset:1024 lds
    s_add_u32 s78, s78, 65536
    s_add_u32 m0, s83, 81920
    s_nop 0
    s_waitcnt vmcnt(3)
    buffer_load_dwordx4 v6, s[12:15], s78 offen lds
    s_waitcnt vmcnt(3)
    buffer_load_dwordx4 v7, s[12:15], s78 offen offset:1024 lds
    s_add_u32 s78, s78, 65536
    s_add_u32 m0, s83, 90112
    s_nop 0
    s_waitcnt vmcnt(3)
    buffer_load_dwordx4 v6, s[12:15], s78 offen lds
    s_waitcnt vmcnt(3)
    buffer_load_dwordx4 v7, s[12:15], s78 offen offset:1024 lds
    s_add_u32 s78, s78, 65536
    s_add_u32 m0, s83, 98304
    s_nop 0
    s_waitcnt vmcnt(3)
    buffer_load_dwordx4 v6, s[12:15], s78 offen lds
    s_waitcnt vmcnt(3)
    buffer_load_dwordx4 v7, s[12:15], s78 offen offset:1024 lds
    s_add_u32 s78, s78, 65536
    s_barrier
    s_add_u32 m0, s83, 106496
    s_nop 0
    s_waitcnt vmcnt(3)
    buffer_load_dwordx4 v6, s[12:15], s78 offen lds
    s_waitcnt vmcnt(3)
    buffer_load_dwordx4 v7, s[12:15], s78 offen offset:1024 lds
    s_add_u32 s78, s78, 65536
    s_add_u32 m0, s83, 114688
    s_nop 0
    s_waitcnt vmcnt(3)
    buffer_load_dwordx4 v6, s[12:15], s78 offen lds
    s_waitcnt vmcnt(3)
    buffer_load_dwordx4 v7, s[12:15], s78 offen offset:1024 lds
    s_add_u32 s78, s78, 65536
    s_add_u32 m0, s83, 122880
    s_nop 0
    s_waitcnt vmcnt(3)
    buffer_load_dwordx4 v6, s[12:15], s78 offen lds
    s_waitcnt vmcnt(3)
    buffer_load_dwordx4 v7, s[12:15], s78 offen offset:1024 lds
    s_add_u32 s78, s78, 65536
    s_barrier
    s_waitcnt vmcnt(0)
    s_barrier
    s_lshl_b32 s74, s24, 12
    v_add_u32 v13, s74, v1
    s_barrier
    s_xor_b32 s79, s2, 1
    s_lshl_b32 s79, s79, 2
    s_add_u32 s79, s79, s24
    s_lshl_b32 s79, s79, 12
    s_add_u32 s79, s79, 28313600
    buffer_load_dwordx4 v[16:19], v1, s[16:19], s79 offen offset:0 sc1
    buffer_load_dwordx4 v[20:23], v1, s[16:19], s79 offen offset:1024 sc1
    s_barrier
    ds_read_b128 v[32:35], v13 offset:0
    ds_read_b128 v[36:39], v13 offset:1024
    ds_read_b128 v[40:43], v13 offset:2048
    ds_read_b128 v[44:47], v13 offset:3072
    v_lshlrev_b32 v13, 4, v10
    s_lshl_b32 s72, s25, 7
    s_add_u32 s72, s72, 147968
    v_add_u32 v13, s72, v13
    ds_read_b128 v[64:67], v13 offset:0
    ds_read_b128 v[68:71], v13 offset:64
    s_and_b32 s72, s66, 7
    s_lshl_b32 s72, s72, 7
    s_add_u32 s72, s72, 151552
    v_lshlrev_b32 v13, 2, v9
    v_add_u32 v13, s72, v13
    ds_read_b32 v14, v13
    ds_read_b32 v15, v13 offset:64
    v_and_b32 v11, 31, v2
    v_lshrrev_b32 v12, 5, v2
    v_lshlrev_b32 v12, 4, v12
    v_lshl_add_u32 v11, v11, 11, v12
    v_lshrrev_b32 v72, 2, v2
    v_and_b32 v73, 3, v2
    v_lshlrev_b32 v73, 4, v73
    v_lshl_add_u32 v11, v72, 11, v73
    v_mul_u32_u24 v72, 80, v72
    s_lshl_b32 s72, s20, 12
    s_branch LadaLN_cond__grouped_kv_mqa__dense_activation_relu__prompt_kernel_over18
LadaLN_cond__grouped_kv_mqa__dense_activation_relu__prompt_kernel_stub18:
    s_setpc_b64 s[96:97]
LadaLN_cond__grouped_kv_mqa__dense_activation_relu__prompt_kernel_over18:
    s_add_u32 s72, s72, 32768
    v_add3_u32 v73, v72, v73, s72
    v_mul_u32_u24 v72, 80, v9
    v_lshl_add_u32 v72, v10, 3, v72
    v_add_u32 v72, s72, v72
    s_mov_b32 s12, s56
    s_mov_b32 s13, s57
    s_mov_b32 s14, 0x400000
    s_mov_b32 s15, 0x20000
    s_lshl_b32 s74, s66, 16
    s_lshl_b32 s75, s22, 7
    s_add_u32 s74, s74, s75
    s_lshl_b32 s75, s25, 6
    s_add_u32 s74, s74, s75
    s_xor_b32 s72, s2, 1
    s_lshl_b32 s72, s72, 14
    s_lshl_b32 s73, s24, 12
    s_add_u32 s72, s72, s73
    s_add_u32 s72, s72, 28313600
    s_waitcnt vmcnt(0)
    v_max_u32 v12, v16, v20
    v_cmp_eq_u32 vcc, -1, v12
    s_nop 1
    s_cbranch_vccz LadaLN_cond__grouped_kv_mqa__dense_activation_relu__prompt_kernel_pok121
    s_mov_b32 s67, 400000
LadaLN_cond__grouped_kv_mqa__dense_activation_relu__prompt_kernel_poll122:
    buffer_load_dwordx4 v[16:19], v1, s[16:19], s72 offen offset:0 sc1
    buffer_load_dwordx4 v[20:23], v1, s[16:19], s72 offen offset:1024 sc1
    s_waitcnt vmcnt(0)
    v_max_u32 v12, v16, v20
    v_cmp_eq_u32 vcc, -1, v12
    s_nop 1
    s_cbranch_vccz LadaLN_cond__grouped_kv_mqa__dense_activation_relu__prompt_kernel_pok123
    s_sleep 1
    s_sub_u32 s67, s67, 1
    s_cbranch_scc0 LadaLN_cond__grouped_kv_mqa__dense_activation_relu__prompt_kernel_poll122
    s_branch LadaLN_cond__grouped_kv_mqa__dense_activation_relu__prompt_kernel_exit
LadaLN_cond__grouped_kv_mqa__dense_activation_relu__prompt_kernel_pok123:
LadaLN_cond__grouped_kv_mqa__dense_activation_relu__prompt_kernel_pok121:
    s_waitcnt lgkmcnt(0)
    v_lshlrev_b32 v24, 16, v16
    v_and_b32 v25, 0xffff0000, v16
    v_lshlrev_b32 v12, 16, v116
    v_and_b32 v13, 0xffff0000, v116
    v_add_f32 v32, v32, v24
    v_add_f32 v33, v33, v25
    v_mul_f32 v32, v32, v14
    v_mul_f32 v33, v33, v14
    v_fmac_f32 v12, v32, v64
    v_fmac_f32 v13, v33, v65
    v_cvt_pk_bf16_f32 v116, v12, v13
    v_lshlrev_b32 v24, 16, v17
    v_and_b32 v25, 0xffff0000, v17
    v_lshlrev_b32 v12, 16, v117
    v_and_b32 v13, 0xffff0000, v117
    v_add_f32 v34, v34, v24
    v_add_f32 v35, v35, v25
    v_mul_f32 v34, v34, v14
    v_mul_f32 v35, v35, v14
    v_fmac_f32 v12, v34, v66
    v_fmac_f32 v13, v35, v67
    v_cvt_pk_bf16_f32 v117, v12, v13
    ds_write_b64 v72, v[116:117] offset:0
    v_lshlrev_b32 v24, 16, v18
    v_and_b32 v25, 0xffff0000, v18
    v_lshlrev_b32 v12, 16, v118
    v_and_b32 v13, 0xffff0000, v118
    v_add_f32 v36, v36, v24
    v_add_f32 v37, v37, v25
    v_mul_f32 v36, v36, v15
    v_mul_f32 v37, v37, v15
    v_fmac_f32 v12, v36, v64
    v_fmac_f32 v13, v37, v65
    v_cvt_pk_bf16_f32 v118, v12, v13
    v_lshlrev_b32 v24, 16, v19
    v_and_b32 v25, 0xffff0000, v19
    v_lshlrev_b32 v12, 16, v119
    v_and_b32 v13, 0xffff0000, v119
    v_add_f32 v38, v38, v24
    v_add_f32 v39, v39, v25
    v_mul_f32 v38, v38, v15
    v_mul_f32 v39, v39, v15
    v_fmac_f32 v12, v38, v66
    v_fmac_f32 v13, v39, v67
    v_cvt_pk_bf16_f32 v119, v12, v13
    ds_write_b64 v72, v[118:119] offset:1280
    v_lshlrev_b32 v24, 16, v20
    v_and_b32 v25, 0xffff0000, v20
    v_lshlrev_b32 v12, 16, v120
    v_and_b32 v13, 0xffff0000, v120
    v_add_f32 v40, v40, v24
    v_add_f32 v41, v41, v25
    v_mul_f32 v40, v40, v14
    v_mul_f32 v41, v41, v14
    v_fmac_f32 v12, v40, v68
    v_fmac_f32 v13, v41, v69
    v_cvt_pk_bf16_f32 v120, v12, v13
    v_lshlrev_b32 v24, 16, v21
    v_and_b32 v25, 0xffff0000, v21
    v_lshlrev_b32 v12, 16, v121
    v_and_b32 v13, 0xffff0000, v121
    v_add_f32 v42, v42, v24
    v_add_f32 v43, v43, v25
    v_mul_f32 v42, v42, v14
    v_mul_f32 v43, v43, v14
    v_fmac_f32 v12, v42, v70
    v_fmac_f32 v13, v43, v71
    v_cvt_pk_bf16_f32 v121, v12, v13
    ds_write_b64 v72, v[120:121] offset:32
    v_lshlrev_b32 v24, 16, v22
    v_and_b32 v25, 0xffff0000, v22
    v_lshlrev_b32 v12, 16, v122
    v_and_b32 v13, 0xffff0000, v122
    v_add_f32 v44, v44, v24
    v_add_f32 v45, v45, v25
    v_mul_f32 v44, v44, v15
    v_mul_f32 v45, v45, v15
    v_fmac_f32 v12, v44, v68
    v_fmac_f32 v13, v45, v69
    v_cvt_pk_bf16_f32 v122, v12, v13
    v_lshlrev_b32 v24, 16, v23
    v_and_b32 v25, 0xffff0000, v23
    v_lshlrev_b32 v12, 16, v123
    v_and_b32 v13, 0xffff0000, v123
    v_add_f32 v46, v46, v24
    v_add_f32 v47, v47, v25
    v_mul_f32 v46, v46, v15
    v_mul_f32 v47, v47, v15
    v_fmac_f32 v12, v46, v70
    v_fmac_f32 v13, v47, v71
    v_cvt_pk_bf16_f32 v123, v12, v13
    ds_write_b64 v72, v[122:123] offset:1312
    ds_read_b128 v[64:67], v73 offset:0
    ds_read_b128 v[68:71], v73 offset:1280
    s_add_u32 s75, s74, 32768
    s_waitcnt lgkmcnt(1)
    buffer_store_dwordx4 v[64:67], v11, s[12:15], s74 offen nt
    s_waitcnt lgkmcnt(0)
    buffer_store_dwordx4 v[68:71], v11, s[12:15], s75 offen nt
LadaLN_cond__grouped_kv_mqa__dense_activation_relu__prompt_kernel_end108:
LadaLN_cond__grouped_kv_mqa__dense_activation_relu__prompt_kernel_hend:
    s_waitcnt vmcnt(0)
LadaLN_cond__grouped_kv_mqa__dense_activation_relu__prompt_kernel_exit:
    s_endpgm
LadaLN_cond__grouped_kv_mqa__dense_activation_relu__prompt_kernel_slow32:
    s_waitcnt vmcnt(0)
    v_mov_b32 v8, 0xff7fffff
    s_mov_b32 s76, 524288
LadaLN_cond__grouped_kv_mqa__dense_activation_relu__prompt_kernel_slow1124:
    buffer_load_dwordx4 v[144:147], v1, s[16:19], s76 offen sc1
    buffer_load_dwordx4 v[148:151], v1, s[16:19], s76 offen offset:1024 sc1
    s_waitcnt vmcnt(0)
    v_mfma_f32_32x32x16_bf16 v[16:31], v[144:147], v[160:163], 0
    v_mfma_f32_32x32x16_bf16 v[16:31], v[148:151], v[164:167], v[16:31]
    s_nop 11
    v_max3_f32 v11, v16, v17, v18
    v_max3_f32 v11, v11, v19, v20
    v_max3_f32 v11, v11, v21, v22
    v_max3_f32 v11, v11, v23, v24
    v_max3_f32 v11, v11, v25, v26
    v_max3_f32 v11, v11, v27, v28
    v_max3_f32 v11, v11, v29, v30
    v_max_f32 v11, v11, v31
    v_max_f32 v8, v8, v11
    s_add_u32 s76, s76, 4096
    s_cmp_lt_u32 s76, 786432
    s_cbranch_scc1 LadaLN_cond__grouped_kv_mqa__dense_activation_relu__prompt_kernel_slow1124
    s_nop 7
    v_mov_b32 v7, v8
    s_nop 1
    v_permlane32_swap_b32 v8, v7
    s_nop 0
    v_max_f32 v8, v8, v7
    v_sub_f32 v168, 0, v8
    v_mov_b32 v169, v168
    v_mov_b32 v170, v168
    v_mov_b32 v171, v168
    v_mov_b32 v172, v168
    v_mov_b32 v173, v168
    v_mov_b32 v174, v168
    v_mov_b32 v175, v168
    v_mov_b32 v176, v168
    v_mov_b32 v177, v168
    v_mov_b32 v178, v168
    v_mov_b32 v179, v168
    v_mov_b32 v180, v168
    v_mov_b32 v181, v168
    v_mov_b32 v182, v168
    v_mov_b32 v183, v168
    s_nop 1
    v_mov_b32 v128, 0
    v_mov_b32 v129, 0
    v_mov_b32 v130, 0
    v_mov_b32 v131, 0
    v_mov_b32 v132, 0
    v_mov_b32 v133, 0
    v_mov_b32 v134, 0
    v_mov_b32 v135, 0
    v_mov_b32 v136, 0
    v_mov_b32 v137, 0
    v_mov_b32 v138, 0
    v_mov_b32 v139, 0
    v_mov_b32 v140, 0
    v_mov_b32 v141, 0
    v_mov_b32 v142, 0
    v_mov_b32 v143, 0
    v_mov_b32 v56, 0
    v_mov_b32 v57, 0
    v_mov_b32 v58, 0
    v_mov_b32 v59, 0
    s_mov_b32 s76, 524288
LadaLN_cond__grouped_kv_mqa__dense_activation_relu__prompt_kernel_slow2125:
    buffer_load_dwordx4 v[144:147], v1, s[16:19], s76 offen offset:0 sc1
    buffer_load_dwordx4 v[148:151], v1, s[16:19], s76 offen offset:1024 sc1
    buffer_load_dwordx4 v[152:155], v1, s[16:19], s76 offen offset:2048 sc1
    buffer_load_dwordx4 v[156:159], v1, s[16:19], s76 offen offset:3072 sc1
    s_waitcnt vmcnt(0)
    v_mfma_f32_32x32x16_bf16 v[16:31], v[144:147], v[160:163], v[168:183]
    v_mfma_f32_32x32x16_bf16 v[16:31], v[148:151], v[164:167], v[16:31]
    s_nop 11
    v_exp_f32 v16, v16
    v_exp_f32 v17, v17
    v_exp_f32 v18, v18
    v_exp_f32 v19, v19
    v_exp_f32 v20, v20
    v_exp_f32 v21, v21
    v_exp_f32 v22, v22
    v_exp_f32 v23, v23
    v_exp_f32 v24, v24
    v_exp_f32 v25, v25
    v_exp_f32 v26, v26
    v_exp_f32 v27, v27
    v_exp_f32 v28, v28
    v_exp_f32 v29, v29
    v_exp_f32 v30, v30
    v_exp_f32 v31, v31
    s_nop 0
    v_cvt_pk_bf16_f32 v48, v16, v17
    v_cvt_pk_bf16_f32 v49, v18, v19
    v_cvt_pk_bf16_f32 v50, v20, v21
    v_cvt_pk_bf16_f32 v51, v22, v23
    v_cvt_pk_bf16_f32 v52, v24, v25
    v_cvt_pk_bf16_f32 v53, v26, v27
    v_cvt_pk_bf16_f32 v54, v28, v29
    v_cvt_pk_bf16_f32 v55, v30, v31
    s_nop 1
    v_mfma_f32_32x32x16_bf16 v[128:143], v[152:155], v[48:51], v[128:143]
    v_mfma_f32_32x32x16_bf16 v[128:143], v[156:159], v[52:55], v[128:143]
    v_smfmac_f32_16x16x64_bf16 v[56:59], v[60:63], v[48:55], v192
    s_add_u32 s76, s76, 4096
    s_cmp_lt_u32 s76, 786432
    s_cbranch_scc1 LadaLN_cond__grouped_kv_mqa__dense_activation_relu__prompt_kernel_slow2125
    s_nop 11
    v_add_f32 v56, v56, v58
    v_add_f32 v57, v57, v59
    v_cndmask_b32 v7, v57, v56, s[74:75]
    v_rcp_f32 v7, v7
    s_lshl_b32 s76, s66, 16
    s_lshl_b32 s77, s22, 12
    s_add_u32 s76, s76, s77
    s_lshl_b32 s77, s25, 11
    s_add_u32 s76, s76, s77
    s_add_u32 s76, s76, 5242880
    v_mul_f32 v128, v128, v7
    v_mul_f32 v129, v129, v7
    v_mul_f32 v130, v130, v7
    v_mul_f32 v131, v131, v7
    v_mul_f32 v132, v132, v7
    v_mul_f32 v133, v133, v7
    v_mul_f32 v134, v134, v7
    v_mul_f32 v135, v135, v7
    v_cvt_pk_bf16_f32 v48, v128, v129
    v_cvt_pk_bf16_f32 v49, v130, v131
    v_cvt_pk_bf16_f32 v50, v132, v133
    v_cvt_pk_bf16_f32 v51, v134, v135
    buffer_store_dwordx4 v[48:51], v1, s[16:19], s76 offen offset:0 sc1
    v_mul_f32 v136, v136, v7
    v_mul_f32 v137, v137, v7
    v_mul_f32 v138, v138, v7
    v_mul_f32 v139, v139, v7
    v_mul_f32 v140, v140, v7
    v_mul_f32 v141, v141, v7
    v_mul_f32 v142, v142, v7
    v_mul_f32 v143, v143, v7
    v_cvt_pk_bf16_f32 v52, v136, v137
    v_cvt_pk_bf16_f32 v53, v138, v139
    v_cvt_pk_bf16_f32 v54, v140, v141
    v_cvt_pk_bf16_f32 v55, v142, v143
    buffer_store_dwordx4 v[52:55], v1, s[16:19], s76 offen offset:1024 sc1
    s_branch LadaLN_cond__grouped_kv_mqa__dense_activation_relu__prompt_kernel_epi31
LadaLN_cond__grouped_kv_mqa__dense_activation_relu__prompt_kernel_efb53:
    s_mov_b32 s67, 400000
LadaLN_cond__grouped_kv_mqa__dense_activation_relu__prompt_kernel_poll126:
    s_add_u32 s78, s68, 0xffffe000
    buffer_load_dwordx4 v[44:47], v8, s[16:19], s78 offen offset:0 sc1
    buffer_load_dwordx4 v[48:51], v8, s[16:19], s78 offen offset:256 sc1
    s_add_u32 s79, s69, 0xffffe000
    buffer_load_dwordx4 v[52:55], v8, s[16:19], s79 offen offset:0 sc1
    buffer_load_dwordx4 v[56:59], v8, s[16:19], s79 offen offset:256 sc1
    s_waitcnt vmcnt(0)
    v_max3_u32 v5, v44, v48, v52
    v_max_u32 v5, v5, v56
    v_cmp_eq_u32 vcc, -1, v5
    s_nop 1
    s_cbranch_vccz LadaLN_cond__grouped_kv_mqa__dense_activation_relu__prompt_kernel_pok127
    s_sleep 1
    s_sub_u32 s67, s67, 1
    s_cbranch_scc0 LadaLN_cond__grouped_kv_mqa__dense_activation_relu__prompt_kernel_poll126
    s_branch LadaLN_cond__grouped_kv_mqa__dense_activation_relu__prompt_kernel_exit
LadaLN_cond__grouped_kv_mqa__dense_activation_relu__prompt_kernel_pok127:
    s_add_u32 s78, s68, 0xffffe000
    buffer_load_dwordx4 v[60:63], v8, s[16:19], s78 offen offset:2048 sc1
    buffer_load_dwordx4 v[64:67], v8, s[16:19], s78 offen offset:2304 sc1
    s_add_u32 s79, s69, 0xffffe000
    buffer_load_dwordx4 v[68:71], v8, s[16:19], s79 offen offset:2048 sc1
    buffer_load_dwordx4 v[72:75], v8, s[16:19], s79 offen offset:2304 sc1
    s_add_u32 s78, s68, 0xfffff000
    buffer_load_dwordx4 v[76:79], v8, s[16:19], s78 offen offset:0 sc1
    buffer_load_dwordx4 v[80:83], v8, s[16:19], s78 offen offset:256 sc1
    s_add_u32 s79, s69, 0xfffff000
    buffer_load_dwordx4 v[84:87], v8, s[16:19], s79 offen offset:0 sc1
    buffer_load_dwordx4 v[88:91], v8, s[16:19], s79 offen offset:256 sc1
    buffer_load_dwordx4 v[92:95], v8, s[16:19], s78 offen offset:2048 sc1
    buffer_load_dwordx4 v[96:99], v8, s[16:19], s78 offen offset:2304 sc1
    buffer_load_dwordx4 v[100:103], v8, s[16:19], s79 offen offset:2048 sc1
    buffer_load_dwordx4 v[104:107], v8, s[16:19], s79 offen offset:2304 sc1
    s_branch LadaLN_cond__grouped_kv_mqa__dense_activation_relu__prompt_kernel_ebk54
LadaLN_cond__grouped_kv_mqa__dense_activation_relu__prompt_kernel_efb55:
    s_mov_b32 s67, 400000
LadaLN_cond__grouped_kv_mqa__dense_activation_relu__prompt_kernel_poll128:
    s_add_u32 s78, s68, 0xffffe000
    buffer_load_dwordx4 v[60:63], v8, s[16:19], s78 offen offset:2048 sc1
    buffer_load_dwordx4 v[64:67], v8, s[16:19], s78 offen offset:2304 sc1
    s_add_u32 s79, s69, 0xffffe000
    buffer_load_dwordx4 v[68:71], v8, s[16:19], s79 offen offset:2048 sc1
    buffer_load_dwordx4 v[72:75], v8, s[16:19], s79 offen offset:2304 sc1
    s_waitcnt vmcnt(0)
    v_max3_u32 v5, v60, v64, v68
    v_max_u32 v5, v5, v72
    v_cmp_eq_u32 vcc, -1, v5
    s_nop 1
    s_cbranch_vccz LadaLN_cond__grouped_kv_mqa__dense_activation_relu__prompt_kernel_pok129
    s_sleep 1
    s_sub_u32 s67, s67, 1
    s_cbranch_scc0 LadaLN_cond__grouped_kv_mqa__dense_activation_relu__prompt_kernel_poll128
    s_branch LadaLN_cond__grouped_kv_mqa__dense_activation_relu__prompt_kernel_exit
LadaLN_cond__grouped_kv_mqa__dense_activation_relu__prompt_kernel_pok129:
    s_add_u32 s78, s68, 0xfffff000
    buffer_load_dwordx4 v[76:79], v8, s[16:19], s78 offen offset:0 sc1
    buffer_load_dwordx4 v[80:83], v8, s[16:19], s78 offen offset:256 sc1
    s_add_u32 s79, s69, 0xfffff000
    buffer_load_dwordx4 v[84:87], v8, s[16:19], s79 offen offset:0 sc1
    buffer_load_dwordx4 v[88:91], v8, s[16:19], s79 offen offset:256 sc1
    buffer_load_dwordx4 v[92:95], v8, s[16:19], s78 offen offset:2048 sc1
    buffer_load_dwordx4 v[96:99], v8, s[16:19], s78 offen offset:2304 sc1
    buffer_load_dwordx4 v[100:103], v8, s[16:19], s79 offen offset:2048 sc1
    buffer_load_dwordx4 v[104:107], v8, s[16:19], s79 offen offset:2304 sc1
    s_add_u32 s78, s68, 0x0
    buffer_load_dwordx4 v[108:111], v8, s[16:19], s78 offen offset:0 sc1
    buffer_load_dwordx4 v[112:115], v8, s[16:19], s78 offen offset:256 sc1
    s_add_u32 s79, s69, 0x0
    buffer_load_dwordx4 v[124:127], v8, s[16:19], s79 offen offset:0 sc1
    buffer_load_dwordx4 v[240:243], v8, s[16:19], s79 offen offset:256 sc1
    s_branch LadaLN_cond__grouped_kv_mqa__dense_activation_relu__prompt_kernel_ebk56
LadaLN_cond__grouped_kv_mqa__dense_activation_relu__prompt_kernel_efb57:
    s_mov_b32 s67, 400000
LadaLN_cond__grouped_kv_mqa__dense_activation_relu__prompt_kernel_poll130:
    s_add_u32 s78, s68, 0xffffe000
    buffer_load_dwordx4 v[76:79], v8, s[16:19], s78 offen offset:0 sc1
    buffer_load_dwordx4 v[80:83], v8, s[16:19], s78 offen offset:256 sc1
    s_add_u32 s79, s69, 0xffffe000
    buffer_load_dwordx4 v[84:87], v8, s[16:19], s79 offen offset:0 sc1
    buffer_load_dwordx4 v[88:91], v8, s[16:19], s79 offen offset:256 sc1
    s_waitcnt vmcnt(0)
    v_max3_u32 v5, v76, v80, v84
    v_max_u32 v5, v5, v88
    v_cmp_eq_u32 vcc, -1, v5
    s_nop 1
    s_cbranch_vccz LadaLN_cond__grouped_kv_mqa__dense_activation_relu__prompt_kernel_pok131
    s_sleep 1
    s_sub_u32 s67, s67, 1
    s_cbranch_scc0 LadaLN_cond__grouped_kv_mqa__dense_activation_relu__prompt_kernel_poll130
    s_branch LadaLN_cond__grouped_kv_mqa__dense_activation_relu__prompt_kernel_exit
LadaLN_cond__grouped_kv_mqa__dense_activation_relu__prompt_kernel_pok131:
    s_add_u32 s78, s68, 0xffffe000
    buffer_load_dwordx4 v[92:95], v8, s[16:19], s78 offen offset:2048 sc1
    buffer_load_dwordx4 v[96:99], v8, s[16:19], s78 offen offset:2304 sc1
    s_add_u32 s79, s69, 0xffffe000
    buffer_load_dwordx4 v[100:103], v8, s[16:19], s79 offen offset:2048 sc1
    buffer_load_dwordx4 v[104:107], v8, s[16:19], s79 offen offset:2304 sc1
    s_add_u32 s78, s68, 0xfffff000
    buffer_load_dwordx4 v[108:111], v8, s[16:19], s78 offen offset:0 sc1
    buffer_load_dwordx4 v[112:115], v8, s[16:19], s78 offen offset:256 sc1
    s_add_u32 s79, s69, 0xfffff000
    buffer_load_dwordx4 v[124:127], v8, s[16:19], s79 offen offset:0 sc1
    buffer_load_dwordx4 v[240:243], v8, s[16:19], s79 offen offset:256 sc1
    buffer_load_dwordx4 v[44:47], v8, s[16:19], s78 offen offset:2048 sc1
    buffer_load_dwordx4 v[48:51], v8, s[16:19], s78 offen offset:2304 sc1
    buffer_load_dwordx4 v[52:55], v8, s[16:19], s79 offen offset:2048 sc1
    buffer_load_dwordx4 v[56:59], v8, s[16:19], s79 offen offset:2304 sc1
    s_branch LadaLN_cond__grouped_kv_mqa__dense_activation_relu__prompt_kernel_ebk58
LadaLN_cond__grouped_kv_mqa__dense_activation_relu__prompt_kernel_efb59:
    s_mov_b32 s67, 400000
LadaLN_cond__grouped_kv_mqa__dense_activation_relu__prompt_kernel_poll132:
    s_add_u32 s78, s68, 0xffffe000
    buffer_load_dwordx4 v[92:95], v8, s[16:19], s78 offen offset:2048 sc1
    buffer_load_dwordx4 v[96:99], v8, s[16:19], s78 offen offset:2304 sc1
    s_add_u32 s79, s69, 0xffffe000
    buffer_load_dwordx4 v[100:103], v8, s[16:19], s79 offen offset:2048 sc1
    buffer_load_dwordx4 v[104:107], v8, s[16:19], s79 offen offset:2304 sc1
    s_waitcnt vmcnt(0)
    v_max3_u32 v5, v92, v96, v100
    v_max_u32 v5, v5, v104
    v_cmp_eq_u32 vcc, -1, v5
    s_nop 1
    s_cbranch_vccz LadaLN_cond__grouped_kv_mqa__dense_activation_relu__prompt_kernel_pok133
    s_sleep 1
    s_sub_u32 s67, s67, 1
    s_cbranch_scc0 LadaLN_cond__grouped_kv_mqa__dense_activation_relu__prompt_kernel_poll132
    s_branch LadaLN_cond__grouped_kv_mqa__dense_activation_relu__prompt_kernel_exit
LadaLN_cond__grouped_kv_mqa__dense_activation_relu__prompt_kernel_pok133:
    s_add_u32 s78, s68, 0xfffff000
    buffer_load_dwordx4 v[108:111], v8, s[16:19], s78 offen offset:0 sc1
    buffer_load_dwordx4 v[112:115], v8, s[16:19], s78 offen offset:256 sc1
    s_add_u32 s79, s69, 0xfffff000
    buffer_load_dwordx4 v[124:127], v8, s[16:19], s79 offen offset:0 sc1
    buffer_load_dwordx4 v[240:243], v8, s[16:19], s79 offen offset:256 sc1
    buffer_load_dwordx4 v[44:47], v8, s[16:19], s78 offen offset:2048 sc1
    buffer_load_dwordx4 v[48:51], v8, s[16:19], s78 offen offset:2304 sc1
    buffer_load_dwordx4 v[52:55], v8, s[16:19], s79 offen offset:2048 sc1
    buffer_load_dwordx4 v[56:59], v8, s[16:19], s79 offen offset:2304 sc1
    s_add_u32 s78, s68, 0x0
    buffer_load_dwordx4 v[60:63], v8, s[16:19], s78 offen offset:0 sc1
    buffer_load_dwordx4 v[64:67], v8, s[16:19], s78 offen offset:256 sc1
    s_add_u32 s79, s69, 0x0
    buffer_load_dwordx4 v[68:71], v8, s[16:19], s79 offen offset:0 sc1
    buffer_load_dwordx4 v[72:75], v8, s[16:19], s79 offen offset:256 sc1
    s_branch LadaLN_cond__grouped_kv_mqa__dense_activation_relu__prompt_kernel_ebk60
LadaLN_cond__grouped_kv_mqa__dense_activation_relu__prompt_kernel_efb61:
    s_mov_b32 s67, 400000
LadaLN_cond__grouped_kv_mqa__dense_activation_relu__prompt_kernel_poll134:
    s_add_u32 s78, s68, 0xffffe000
    buffer_load_dwordx4 v[108:111], v8, s[16:19], s78 offen offset:0 sc1
    buffer_load_dwordx4 v[112:115], v8, s[16:19], s78 offen offset:256 sc1
    s_add_u32 s79, s69, 0xffffe000
    buffer_load_dwordx4 v[124:127], v8, s[16:19], s79 offen offset:0 sc1
    buffer_load_dwordx4 v[240:243], v8, s[16:19], s79 offen offset:256 sc1
    s_waitcnt vmcnt(0)
    v_max3_u32 v5, v108, v112, v124
    v_max_u32 v5, v5, v240
    v_cmp_eq_u32 vcc, -1, v5
    s_nop 1
    s_cbranch_vccz LadaLN_cond__grouped_kv_mqa__dense_activation_relu__prompt_kernel_pok135
    s_sleep 1
    s_sub_u32 s67, s67, 1
    s_cbranch_scc0 LadaLN_cond__grouped_kv_mqa__dense_activation_relu__prompt_kernel_poll134
    s_branch LadaLN_cond__grouped_kv_mqa__dense_activation_relu__prompt_kernel_exit
LadaLN_cond__grouped_kv_mqa__dense_activation_relu__prompt_kernel_pok135:
    s_add_u32 s78, s68, 0xffffe000
    buffer_load_dwordx4 v[44:47], v8, s[16:19], s78 offen offset:2048 sc1
    buffer_load_dwordx4 v[48:51], v8, s[16:19], s78 offen offset:2304 sc1
    s_add_u32 s79, s69, 0xffffe000
    buffer_load_dwordx4 v[52:55], v8, s[16:19], s79 offen offset:2048 sc1
    buffer_load_dwordx4 v[56:59], v8, s[16:19], s79 offen offset:2304 sc1
    s_add_u32 s78, s68, 0xfffff000
    buffer_load_dwordx4 v[60:63], v8, s[16:19], s78 offen offset:0 sc1
    buffer_load_dwordx4 v[64:67], v8, s[16:19], s78 offen offset:256 sc1
    s_add_u32 s79, s69, 0xfffff000
    buffer_load_dwordx4 v[68:71], v8, s[16:19], s79 offen offset:0 sc1
    buffer_load_dwordx4 v[72:75], v8, s[16:19], s79 offen offset:256 sc1
    buffer_load_dwordx4 v[76:79], v8, s[16:19], s78 offen offset:2048 sc1
    buffer_load_dwordx4 v[80:83], v8, s[16:19], s78 offen offset:2304 sc1
    buffer_load_dwordx4 v[84:87], v8, s[16:19], s79 offen offset:2048 sc1
    buffer_load_dwordx4 v[88:91], v8, s[16:19], s79 offen offset:2304 sc1
    s_branch LadaLN_cond__grouped_kv_mqa__dense_activation_relu__prompt_kernel_ebk62
LadaLN_cond__grouped_kv_mqa__dense_activation_relu__prompt_kernel_efb63:
    s_mov_b32 s67, 400000
LadaLN_cond__grouped_kv_mqa__dense_activation_relu__prompt_kernel_poll136:
    s_add_u32 s78, s68, 0xffffe000
    buffer_load_dwordx4 v[44:47], v8, s[16:19], s78 offen offset:2048 sc1
    buffer_load_dwordx4 v[48:51], v8, s[16:19], s78 offen offset:2304 sc1
    s_add_u32 s79, s69, 0xffffe000
    buffer_load_dwordx4 v[52:55], v8, s[16:19], s79 offen offset:2048 sc1
    buffer_load_dwordx4 v[56:59], v8, s[16:19], s79 offen offset:2304 sc1
    s_waitcnt vmcnt(0)
    v_max3_u32 v5, v44, v48, v52
    v_max_u32 v5, v5, v56
    v_cmp_eq_u32 vcc, -1, v5
    s_nop 1
    s_cbranch_vccz LadaLN_cond__grouped_kv_mqa__dense_activation_relu__prompt_kernel_pok137
    s_sleep 1
    s_sub_u32 s67, s67, 1
    s_cbranch_scc0 LadaLN_cond__grouped_kv_mqa__dense_activation_relu__prompt_kernel_poll136
    s_branch LadaLN_cond__grouped_kv_mqa__dense_activation_relu__prompt_kernel_exit
LadaLN_cond__grouped_kv_mqa__dense_activation_relu__prompt_kernel_pok137:
    s_add_u32 s78, s68, 0xfffff000
    buffer_load_dwordx4 v[60:63], v8, s[16:19], s78 offen offset:0 sc1
    buffer_load_dwordx4 v[64:67], v8, s[16:19], s78 offen offset:256 sc1
    s_add_u32 s79, s69, 0xfffff000
    buffer_load_dwordx4 v[68:71], v8, s[16:19], s79 offen offset:0 sc1
    buffer_load_dwordx4 v[72:75], v8, s[16:19], s79 offen offset:256 sc1
    buffer_load_dwordx4 v[76:79], v8, s[16:19], s78 offen offset:2048 sc1
    buffer_load_dwordx4 v[80:83], v8, s[16:19], s78 offen offset:2304 sc1
    buffer_load_dwordx4 v[84:87], v8, s[16:19], s79 offen offset:2048 sc1
    buffer_load_dwordx4 v[88:91], v8, s[16:19], s79 offen offset:2304 sc1
    s_add_u32 s78, s68, 0x0
    buffer_load_dwordx4 v[92:95], v8, s[16:19], s78 offen offset:0 sc1
    buffer_load_dwordx4 v[96:99], v8, s[16:19], s78 offen offset:256 sc1
    s_add_u32 s79, s69, 0x0
    buffer_load_dwordx4 v[100:103], v8, s[16:19], s79 offen offset:0 sc1
    buffer_load_dwordx4 v[104:107], v8, s[16:19], s79 offen offset:256 sc1
    s_branch LadaLN_cond__grouped_kv_mqa__dense_activation_relu__prompt_kernel_ebk64
LadaLN_cond__grouped_kv_mqa__dense_activation_relu__prompt_kernel_efb65:
    s_mov_b32 s67, 400000
LadaLN_cond__grouped_kv_mqa__dense_activation_relu__prompt_kernel_poll138:
    s_add_u32 s78, s68, 0xffffe000
    buffer_load_dwordx4 v[60:63], v8, s[16:19], s78 offen offset:0 sc1
    buffer_load_dwordx4 v[64:67], v8, s[16:19], s78 offen offset:256 sc1
    s_add_u32 s79, s69, 0xffffe000
    buffer_load_dwordx4 v[68:71], v8, s[16:19], s79 offen offset:0 sc1
    buffer_load_dwordx4 v[72:75], v8, s[16:19], s79 offen offset:256 sc1
    s_waitcnt vmcnt(0)
    v_max3_u32 v5, v60, v64, v68
    v_max_u32 v5, v5, v72
    v_cmp_eq_u32 vcc, -1, v5
    s_nop 1
    s_cbranch_vccz LadaLN_cond__grouped_kv_mqa__dense_activation_relu__prompt_kernel_pok139
    s_sleep 1
    s_sub_u32 s67, s67, 1
    s_cbranch_scc0 LadaLN_cond__grouped_kv_mqa__dense_activation_relu__prompt_kernel_poll138
    s_branch LadaLN_cond__grouped_kv_mqa__dense_activation_relu__prompt_kernel_exit
LadaLN_cond__grouped_kv_mqa__dense_activation_relu__prompt_kernel_pok139:
    s_add_u32 s78, s68, 0xffffe000
    buffer_load_dwordx4 v[76:79], v8, s[16:19], s78 offen offset:2048 sc1
    buffer_load_dwordx4 v[80:83], v8, s[16:19], s78 offen offset:2304 sc1
    s_add_u32 s79, s69, 0xffffe000
    buffer_load_dwordx4 v[84:87], v8, s[16:19], s79 offen offset:2048 sc1
    buffer_load_dwordx4 v[88:91], v8, s[16:19], s79 offen offset:2304 sc1
    s_add_u32 s78, s68, 0xfffff000
    buffer_load_dwordx4 v[92:95], v8, s[16:19], s78 offen offset:0 sc1
    buffer_load_dwordx4 v[96:99], v8, s[16:19], s78 offen offset:256 sc1
    s_add_u32 s79, s69, 0xfffff000
    buffer_load_dwordx4 v[100:103], v8, s[16:19], s79 offen offset:0 sc1
    buffer_load_dwordx4 v[104:107], v8, s[16:19], s79 offen offset:256 sc1
    buffer_load_dwordx4 v[108:111], v8, s[16:19], s78 offen offset:2048 sc1
    buffer_load_dwordx4 v[112:115], v8, s[16:19], s78 offen offset:2304 sc1
    buffer_load_dwordx4 v[124:127], v8, s[16:19], s79 offen offset:2048 sc1
    buffer_load_dwordx4 v[240:243], v8, s[16:19], s79 offen offset:2304 sc1
    s_branch LadaLN_cond__grouped_kv_mqa__dense_activation_relu__prompt_kernel_ebk66
LadaLN_cond__grouped_kv_mqa__dense_activation_relu__prompt_kernel_efb67:
    s_mov_b32 s67, 400000
LadaLN_cond__grouped_kv_mqa__dense_activation_relu__prompt_kernel_poll140:
    s_add_u32 s78, s68, 0xffffe000
    buffer_load_dwordx4 v[76:79], v8, s[16:19], s78 offen offset:2048 sc1
    buffer_load_dwordx4 v[80:83], v8, s[16:19], s78 offen offset:2304 sc1
    s_add_u32 s79, s69, 0xffffe000
    buffer_load_dwordx4 v[84:87], v8, s[16:19], s79 offen offset:2048 sc1
    buffer_load_dwordx4 v[88:91], v8, s[16:19], s79 offen offset:2304 sc1
    s_waitcnt vmcnt(0)
    v_max3_u32 v5, v76, v80, v84
    v_max_u32 v5, v5, v88
    v_cmp_eq_u32 vcc, -1, v5
    s_nop 1
    s_cbranch_vccz LadaLN_cond__grouped_kv_mqa__dense_activation_relu__prompt_kernel_pok141
    s_sleep 1
    s_sub_u32 s67, s67, 1
    s_cbranch_scc0 LadaLN_cond__grouped_kv_mqa__dense_activation_relu__prompt_kernel_poll140
    s_branch LadaLN_cond__grouped_kv_mqa__dense_activation_relu__prompt_kernel_exit
LadaLN_cond__grouped_kv_mqa__dense_activation_relu__prompt_kernel_pok141:
    s_add_u32 s78, s68, 0xfffff000
    buffer_load_dwordx4 v[92:95], v8, s[16:19], s78 offen offset:0 sc1
    buffer_load_dwordx4 v[96:99], v8, s[16:19], s78 offen offset:256 sc1
    s_add_u32 s79, s69, 0xfffff000
    buffer_load_dwordx4 v[100:103], v8, s[16:19], s79 offen offset:0 sc1
    buffer_load_dwordx4 v[104:107], v8, s[16:19], s79 offen offset:256 sc1
    buffer_load_dwordx4 v[108:111], v8, s[16:19], s78 offen offset:2048 sc1
    buffer_load_dwordx4 v[112:115], v8, s[16:19], s78 offen offset:2304 sc1
    buffer_load_dwordx4 v[124:127], v8, s[16:19], s79 offen offset:2048 sc1
    buffer_load_dwordx4 v[240:243], v8, s[16:19], s79 offen offset:2304 sc1
    s_add_u32 s78, s68, 0x0
    buffer_load_dwordx4 v[44:47], v8, s[16:19], s78 offen offset:0 sc1
    buffer_load_dwordx4 v[48:51], v8, s[16:19], s78 offen offset:256 sc1
    s_add_u32 s79, s69, 0x0
    buffer_load_dwordx4 v[52:55], v8, s[16:19], s79 offen offset:0 sc1
    buffer_load_dwordx4 v[56:59], v8, s[16:19], s79 offen offset:256 sc1
    s_branch LadaLN_cond__grouped_kv_mqa__dense_activation_relu__prompt_kernel_ebk68
LadaLN_cond__grouped_kv_mqa__dense_activation_relu__prompt_kernel_efb69:
    s_mov_b32 s67, 400000
LadaLN_cond__grouped_kv_mqa__dense_activation_relu__prompt_kernel_poll142:
    s_add_u32 s78, s68, 0xffffe000
    buffer_load_dwordx4 v[92:95], v8, s[16:19], s78 offen offset:0 sc1
    buffer_load_dwordx4 v[96:99], v8, s[16:19], s78 offen offset:256 sc1
    s_add_u32 s79, s69, 0xffffe000
    buffer_load_dwordx4 v[100:103], v8, s[16:19], s79 offen offset:0 sc1
    buffer_load_dwordx4 v[104:107], v8, s[16:19], s79 offen offset:256 sc1
    s_waitcnt vmcnt(0)
    v_max3_u32 v5, v92, v96, v100
    v_max_u32 v5, v5, v104
    v_cmp_eq_u32 vcc, -1, v5
    s_nop 1
    s_cbranch_vccz LadaLN_cond__grouped_kv_mqa__dense_activation_relu__prompt_kernel_pok143
    s_sleep 1
    s_sub_u32 s67, s67, 1
    s_cbranch_scc0 LadaLN_cond__grouped_kv_mqa__dense_activation_relu__prompt_kernel_poll142
    s_branch LadaLN_cond__grouped_kv_mqa__dense_activation_relu__prompt_kernel_exit
LadaLN_cond__grouped_kv_mqa__dense_activation_relu__prompt_kernel_pok143:
    s_add_u32 s78, s68, 0xffffe000
    buffer_load_dwordx4 v[108:111], v8, s[16:19], s78 offen offset:2048 sc1
    buffer_load_dwordx4 v[112:115], v8, s[16:19], s78 offen offset:2304 sc1
    s_add_u32 s79, s69, 0xffffe000
    buffer_load_dwordx4 v[124:127], v8, s[16:19], s79 offen offset:2048 sc1
    buffer_load_dwordx4 v[240:243], v8, s[16:19], s79 offen offset:2304 sc1
    s_add_u32 s78, s68, 0xfffff000
    buffer_load_dwordx4 v[44:47], v8, s[16:19], s78 offen offset:0 sc1
    buffer_load_dwordx4 v[48:51], v8, s[16:19], s78 offen offset:256 sc1
    s_add_u32 s79, s69, 0xfffff000
    buffer_load_dwordx4 v[52:55], v8, s[16:19], s79 offen offset:0 sc1
    buffer_load_dwordx4 v[56:59], v8, s[16:19], s79 offen offset:256 sc1
    buffer_load_dwordx4 v[60:63], v8, s[16:19], s78 offen offset:2048 sc1
    buffer_load_dwordx4 v[64:67], v8, s[16:19], s78 offen offset:2304 sc1
    buffer_load_dwordx4 v[68:71], v8, s[16:19], s79 offen offset:2048 sc1
    buffer_load_dwordx4 v[72:75], v8, s[16:19], s79 offen offset:2304 sc1
    s_branch LadaLN_cond__grouped_kv_mqa__dense_activation_relu__prompt_kernel_ebk70
LadaLN_cond__grouped_kv_mqa__dense_activation_relu__prompt_kernel_efb71:
    s_mov_b32 s67, 400000
LadaLN_cond__grouped_kv_mqa__dense_activation_relu__prompt_kernel_poll144:
    s_add_u32 s78, s68, 0xffffe000
    buffer_load_dwordx4 v[108:111], v8, s[16:19], s78 offen offset:2048 sc1
    buffer_load_dwordx4 v[112:115], v8, s[16:19], s78 offen offset:2304 sc1
    s_add_u32 s79, s69, 0xffffe000
    buffer_load_dwordx4 v[124:127], v8, s[16:19], s79 offen offset:2048 sc1
    buffer_load_dwordx4 v[240:243], v8, s[16:19], s79 offen offset:2304 sc1
    s_waitcnt vmcnt(0)
    v_max3_u32 v5, v108, v112, v124
    v_max_u32 v5, v5, v240
    v_cmp_eq_u32 vcc, -1, v5
    s_nop 1
    s_cbranch_vccz LadaLN_cond__grouped_kv_mqa__dense_activation_relu__prompt_kernel_pok145
    s_sleep 1
    s_sub_u32 s67, s67, 1
    s_cbranch_scc0 LadaLN_cond__grouped_kv_mqa__dense_activation_relu__prompt_kernel_poll144
    s_branch LadaLN_cond__grouped_kv_mqa__dense_activation_relu__prompt_kernel_exit
LadaLN_cond__grouped_kv_mqa__dense_activation_relu__prompt_kernel_pok145:
    s_add_u32 s78, s68, 0xfffff000
    buffer_load_dwordx4 v[44:47], v8, s[16:19], s78 offen offset:0 sc1
    buffer_load_dwordx4 v[48:51], v8, s[16:19], s78 offen offset:256 sc1
    s_add_u32 s79, s69, 0xfffff000
    buffer_load_dwordx4 v[52:55], v8, s[16:19], s79 offen offset:0 sc1
    buffer_load_dwordx4 v[56:59], v8, s[16:19], s79 offen offset:256 sc1
    buffer_load_dwordx4 v[60:63], v8, s[16:19], s78 offen offset:2048 sc1
    buffer_load_dwordx4 v[64:67], v8, s[16:19], s78 offen offset:2304 sc1
    buffer_load_dwordx4 v[68:71], v8, s[16:19], s79 offen offset:2048 sc1
    buffer_load_dwordx4 v[72:75], v8, s[16:19], s79 offen offset:2304 sc1
    s_add_u32 s78, s68, 0x0
    buffer_load_dwordx4 v[76:79], v8, s[16:19], s78 offen offset:0 sc1
    buffer_load_dwordx4 v[80:83], v8, s[16:19], s78 offen offset:256 sc1
    s_add_u32 s79, s69, 0x0
    buffer_load_dwordx4 v[84:87], v8, s[16:19], s79 offen offset:0 sc1
    buffer_load_dwordx4 v[88:91], v8, s[16:19], s79 offen offset:256 sc1
    s_branch LadaLN_cond__grouped_kv_mqa__dense_activation_relu__prompt_kernel_ebk72
LadaLN_cond__grouped_kv_mqa__dense_activation_relu__prompt_kernel_efb73:
    s_mov_b32 s67, 400000
LadaLN_cond__grouped_kv_mqa__dense_activation_relu__prompt_kernel_poll146:
    s_add_u32 s78, s68, 0xffffe000
    buffer_load_dwordx4 v[44:47], v8, s[16:19], s78 offen offset:0 sc1
    buffer_load_dwordx4 v[48:51], v8, s[16:19], s78 offen offset:256 sc1
    s_add_u32 s79, s69, 0xffffe000
    buffer_load_dwordx4 v[52:55], v8, s[16:19], s79 offen offset:0 sc1
    buffer_load_dwordx4 v[56:59], v8, s[16:19], s79 offen offset:256 sc1
    s_waitcnt vmcnt(0)
    v_max3_u32 v5, v44, v48, v52
    v_max_u32 v5, v5, v56
    v_cmp_eq_u32 vcc, -1, v5
    s_nop 1
    s_cbranch_vccz LadaLN_cond__grouped_kv_mqa__dense_activation_relu__prompt_kernel_pok147
    s_sleep 1
    s_sub_u32 s67, s67, 1
    s_cbranch_scc0 LadaLN_cond__grouped_kv_mqa__dense_activation_relu__prompt_kernel_poll146
    s_branch LadaLN_cond__grouped_kv_mqa__dense_activation_relu__prompt_kernel_exit
LadaLN_cond__grouped_kv_mqa__dense_activation_relu__prompt_kernel_pok147:
    s_add_u32 s78, s68, 0xffffe000
    buffer_load_dwordx4 v[60:63], v8, s[16:19], s78 offen offset:2048 sc1
    buffer_load_dwordx4 v[64:67], v8, s[16:19], s78 offen offset:2304 sc1
    s_add_u32 s79, s69, 0xffffe000
    buffer_load_dwordx4 v[68:71], v8, s[16:19], s79 offen offset:2048 sc1
    buffer_load_dwordx4 v[72:75], v8, s[16:19], s79 offen offset:2304 sc1
    s_add_u32 s78, s68, 0xfffff000
    buffer_load_dwordx4 v[76:79], v8, s[16:19], s78 offen offset:0 sc1
    buffer_load_dwordx4 v[80:83], v8, s[16:19], s78 offen offset:256 sc1
    s_add_u32 s79, s69, 0xfffff000
    buffer_load_dwordx4 v[84:87], v8, s[16:19], s79 offen offset:0 sc1
    buffer_load_dwordx4 v[88:91], v8, s[16:19], s79 offen offset:256 sc1
    buffer_load_dwordx4 v[92:95], v8, s[16:19], s78 offen offset:2048 sc1
    buffer_load_dwordx4 v[96:99], v8, s[16:19], s78 offen offset:2304 sc1
    buffer_load_dwordx4 v[100:103], v8, s[16:19], s79 offen offset:2048 sc1
    buffer_load_dwordx4 v[104:107], v8, s[16:19], s79 offen offset:2304 sc1
    s_branch LadaLN_cond__grouped_kv_mqa__dense_activation_relu__prompt_kernel_ebk74
LadaLN_cond__grouped_kv_mqa__dense_activation_relu__prompt_kernel_efb75:
    s_mov_b32 s67, 400000
LadaLN_cond__grouped_kv_mqa__dense_activation_relu__prompt_kernel_poll148:
    s_add_u32 s78, s68, 0xffffe000
    buffer_load_dwordx4 v[60:63], v8, s[16:19], s78 offen offset:2048 sc1
    buffer_load_dwordx4 v[64:67], v8, s[16:19], s78 offen offset:2304 sc1
    s_add_u32 s79, s69, 0xffffe000
    buffer_load_dwordx4 v[68:71], v8, s[16:19], s79 offen offset:2048 sc1
    buffer_load_dwordx4 v[72:75], v8, s[16:19], s79 offen offset:2304 sc1
    s_waitcnt vmcnt(0)
    v_max3_u32 v5, v60, v64, v68
    v_max_u32 v5, v5, v72
    v_cmp_eq_u32 vcc, -1, v5
    s_nop 1
    s_cbranch_vccz LadaLN_cond__grouped_kv_mqa__dense_activation_relu__prompt_kernel_pok149
    s_sleep 1
    s_sub_u32 s67, s67, 1
    s_branch LadaLN_cond__grouped_kv_mqa__dense_activation_relu__prompt_kernel_over19
LadaLN_cond__grouped_kv_mqa__dense_activation_relu__prompt_kernel_stub19:
    s_setpc_b64 s[96:97]
LadaLN_cond__grouped_kv_mqa__dense_activation_relu__prompt_kernel_over19:
    s_cbranch_scc0 LadaLN_cond__grouped_kv_mqa__dense_activation_relu__prompt_kernel_poll148
    s_branch LadaLN_cond__grouped_kv_mqa__dense_activation_relu__prompt_kernel_exit
LadaLN_cond__grouped_kv_mqa__dense_activation_relu__prompt_kernel_pok149:
    s_add_u32 s78, s68, 0xfffff000
    buffer_load_dwordx4 v[76:79], v8, s[16:19], s78 offen offset:0 sc1
    buffer_load_dwordx4 v[80:83], v8, s[16:19], s78 offen offset:256 sc1
    s_add_u32 s79, s69, 0xfffff000
    buffer_load_dwordx4 v[84:87], v8, s[16:19], s79 offen offset:0 sc1
    buffer_load_dwordx4 v[88:91], v8, s[16:19], s79 offen offset:256 sc1
    buffer_load_dwordx4 v[92:95], v8, s[16:19], s78 offen offset:2048 sc1
    buffer_load_dwordx4 v[96:99], v8, s[16:19], s78 offen offset:2304 sc1
    buffer_load_dwordx4 v[100:103], v8, s[16:19], s79 offen offset:2048 sc1
    buffer_load_dwordx4 v[104:107], v8, s[16:19], s79 offen offset:2304 sc1
    s_add_u32 s78, s68, 0x0
    buffer_load_dwordx4 v[108:111], v8, s[16:19], s78 offen offset:0 sc1
    buffer_load_dwordx4 v[112:115], v8, s[16:19], s78 offen offset:256 sc1
    s_add_u32 s79, s69, 0x0
    buffer_load_dwordx4 v[124:127], v8, s[16:19], s79 offen offset:0 sc1
    buffer_load_dwordx4 v[240:243], v8, s[16:19], s79 offen offset:256 sc1
    s_branch LadaLN_cond__grouped_kv_mqa__dense_activation_relu__prompt_kernel_ebk76
LadaLN_cond__grouped_kv_mqa__dense_activation_relu__prompt_kernel_ffb77:
    s_mov_b32 s67, 400000
LadaLN_cond__grouped_kv_mqa__dense_activation_relu__prompt_kernel_poll150:
    s_add_u32 s69, s68, 0xffffd000
    buffer_load_dwordx4 v[48:51], v8, s[16:19], s69 offen offset:0 sc1
    buffer_load_dwordx4 v[52:55], v8, s[16:19], s69 offen offset:256 sc1
    s_waitcnt vmcnt(0)
    v_max_u32 v200, v48, v52
    v_cmp_eq_u32 vcc, -1, v200
    s_nop 1
    s_cbranch_vccz LadaLN_cond__grouped_kv_mqa__dense_activation_relu__prompt_kernel_pok151
    s_sleep 1
    s_sub_u32 s67, s67, 1
    s_cbranch_scc0 LadaLN_cond__grouped_kv_mqa__dense_activation_relu__prompt_kernel_poll150
    s_branch LadaLN_cond__grouped_kv_mqa__dense_activation_relu__prompt_kernel_exit
LadaLN_cond__grouped_kv_mqa__dense_activation_relu__prompt_kernel_pok151:
    s_add_u32 s69, s68, 0xffffd000
    buffer_load_dwordx4 v[56:59], v8, s[16:19], s69 offen offset:2048 sc1
    buffer_load_dwordx4 v[60:63], v8, s[16:19], s69 offen offset:2304 sc1
    s_add_u32 s69, s68, 0xffffe000
    buffer_load_dwordx4 v[64:67], v8, s[16:19], s69 offen offset:0 sc1
    buffer_load_dwordx4 v[68:71], v8, s[16:19], s69 offen offset:256 sc1
    buffer_load_dwordx4 v[72:75], v8, s[16:19], s69 offen offset:2048 sc1
    buffer_load_dwordx4 v[76:79], v8, s[16:19], s69 offen offset:2304 sc1
    s_add_u32 s69, s68, 0xfffff000
    buffer_load_dwordx4 v[80:83], v8, s[16:19], s69 offen offset:0 sc1
    buffer_load_dwordx4 v[84:87], v8, s[16:19], s69 offen offset:256 sc1
    buffer_load_dwordx4 v[88:91], v8, s[16:19], s69 offen offset:2048 sc1
    buffer_load_dwordx4 v[92:95], v8, s[16:19], s69 offen offset:2304 sc1
    s_branch LadaLN_cond__grouped_kv_mqa__dense_activation_relu__prompt_kernel_fbk78
LadaLN_cond__grouped_kv_mqa__dense_activation_relu__prompt_kernel_ffb79:
    s_mov_b32 s67, 400000
LadaLN_cond__grouped_kv_mqa__dense_activation_relu__prompt_kernel_poll152:
    s_add_u32 s69, s68, 0xffffd000
    buffer_load_dwordx4 v[56:59], v8, s[16:19], s69 offen offset:2048 sc1
    buffer_load_dwordx4 v[60:63], v8, s[16:19], s69 offen offset:2304 sc1
    s_waitcnt vmcnt(0)
    v_max_u32 v200, v56, v60
    v_cmp_eq_u32 vcc, -1, v200
    s_nop 1
    s_cbranch_vccz LadaLN_cond__grouped_kv_mqa__dense_activation_relu__prompt_kernel_pok153
    s_sleep 1
    s_sub_u32 s67, s67, 1
    s_cbranch_scc0 LadaLN_cond__grouped_kv_mqa__dense_activation_relu__prompt_kernel_poll152
    s_branch LadaLN_cond__grouped_kv_mqa__dense_activation_relu__prompt_kernel_exit
LadaLN_cond__grouped_kv_mqa__dense_activation_relu__prompt_kernel_pok153:
    s_add_u32 s69, s68, 0xffffe000
    buffer_load_dwordx4 v[64:67], v8, s[16:19], s69 offen offset:0 sc1
    buffer_load_dwordx4 v[68:71], v8, s[16:19], s69 offen offset:256 sc1
    buffer_load_dwordx4 v[72:75], v8, s[16:19], s69 offen offset:2048 sc1
    buffer_load_dwordx4 v[76:79], v8, s[16:19], s69 offen offset:2304 sc1
    s_add_u32 s69, s68, 0xfffff000
    buffer_load_dwordx4 v[80:83], v8, s[16:19], s69 offen offset:0 sc1
    buffer_load_dwordx4 v[84:87], v8, s[16:19], s69 offen offset:256 sc1
    buffer_load_dwordx4 v[88:91], v8, s[16:19], s69 offen offset:2048 sc1
    buffer_load_dwordx4 v[92:95], v8, s[16:19], s69 offen offset:2304 sc1
    s_add_u32 s69, s68, 0x0
    buffer_load_dwordx4 v[96:99], v8, s[16:19], s69 offen offset:0 sc1
    buffer_load_dwordx4 v[100:103], v8, s[16:19], s69 offen offset:256 sc1
    s_branch LadaLN_cond__grouped_kv_mqa__dense_activation_relu__prompt_kernel_fbk80
LadaLN_cond__grouped_kv_mqa__dense_activation_relu__prompt_kernel_ffb81:
    s_mov_b32 s67, 400000
LadaLN_cond__grouped_kv_mqa__dense_activation_relu__prompt_kernel_poll154:
    s_add_u32 s69, s68, 0xffffd000
    buffer_load_dwordx4 v[64:67], v8, s[16:19], s69 offen offset:0 sc1
    buffer_load_dwordx4 v[68:71], v8, s[16:19], s69 offen offset:256 sc1
    s_waitcnt vmcnt(0)
    v_max_u32 v200, v64, v68
    v_cmp_eq_u32 vcc, -1, v200
    s_nop 1
    s_cbranch_vccz LadaLN_cond__grouped_kv_mqa__dense_activation_relu__prompt_kernel_pok155
    s_sleep 1
    s_sub_u32 s67, s67, 1
    s_cbranch_scc0 LadaLN_cond__grouped_kv_mqa__dense_activation_relu__prompt_kernel_poll154
    s_branch LadaLN_cond__grouped_kv_mqa__dense_activation_relu__prompt_kernel_exit
LadaLN_cond__grouped_kv_mqa__dense_activation_relu__prompt_kernel_pok155:
    s_add_u32 s69, s68, 0xffffd000
    buffer_load_dwordx4 v[72:75], v8, s[16:19], s69 offen offset:2048 sc1
    buffer_load_dwordx4 v[76:79], v8, s[16:19], s69 offen offset:2304 sc1
    s_add_u32 s69, s68, 0xffffe000
    buffer_load_dwordx4 v[80:83], v8, s[16:19], s69 offen offset:0 sc1
    buffer_load_dwordx4 v[84:87], v8, s[16:19], s69 offen offset:256 sc1
    buffer_load_dwordx4 v[88:91], v8, s[16:19], s69 offen offset:2048 sc1
    buffer_load_dwordx4 v[92:95], v8, s[16:19], s69 offen offset:2304 sc1
    s_add_u32 s69, s68, 0xfffff000
    buffer_load_dwordx4 v[96:99], v8, s[16:19], s69 offen offset:0 sc1
    buffer_load_dwordx4 v[100:103], v8, s[16:19], s69 offen offset:256 sc1
    buffer_load_dwordx4 v[104:107], v8, s[16:19], s69 offen offset:2048 sc1
    buffer_load_dwordx4 v[108:111], v8, s[16:19], s69 offen offset:2304 sc1
    s_branch LadaLN_cond__grouped_kv_mqa__dense_activation_relu__prompt_kernel_fbk82
LadaLN_cond__grouped_kv_mqa__dense_activation_relu__prompt_kernel_ffb83:
    s_mov_b32 s67, 400000
LadaLN_cond__grouped_kv_mqa__dense_activation_relu__prompt_kernel_poll156:
    s_add_u32 s69, s68, 0xffffd000
    buffer_load_dwordx4 v[72:75], v8, s[16:19], s69 offen offset:2048 sc1
    buffer_load_dwordx4 v[76:79], v8, s[16:19], s69 offen offset:2304 sc1
    s_waitcnt vmcnt(0)
    v_max_u32 v200, v72, v76
    v_cmp_eq_u32 vcc, -1, v200
    s_nop 1
    s_cbranch_vccz LadaLN_cond__grouped_kv_mqa__dense_activation_relu__prompt_kernel_pok157
    s_sleep 1
    s_sub_u32 s67, s67, 1
    s_cbranch_scc0 LadaLN_cond__grouped_kv_mqa__dense_activation_relu__prompt_kernel_poll156
    s_branch LadaLN_cond__grouped_kv_mqa__dense_activation_relu__prompt_kernel_exit
LadaLN_cond__grouped_kv_mqa__dense_activation_relu__prompt_kernel_pok157:
    s_add_u32 s69, s68, 0xffffe000
    buffer_load_dwordx4 v[80:83], v8, s[16:19], s69 offen offset:0 sc1
    buffer_load_dwordx4 v[84:87], v8, s[16:19], s69 offen offset:256 sc1
    buffer_load_dwordx4 v[88:91], v8, s[16:19], s69 offen offset:2048 sc1
    buffer_load_dwordx4 v[92:95], v8, s[16:19], s69 offen offset:2304 sc1
    s_add_u32 s69, s68, 0xfffff000
    buffer_load_dwordx4 v[96:99], v8, s[16:19], s69 offen offset:0 sc1
    buffer_load_dwordx4 v[100:103], v8, s[16:19], s69 offen offset:256 sc1
    buffer_load_dwordx4 v[104:107], v8, s[16:19], s69 offen offset:2048 sc1
    buffer_load_dwordx4 v[108:111], v8, s[16:19], s69 offen offset:2304 sc1
    s_add_u32 s69, s68, 0x0
    buffer_load_dwordx4 v[48:51], v8, s[16:19], s69 offen offset:0 sc1
    buffer_load_dwordx4 v[52:55], v8, s[16:19], s69 offen offset:256 sc1
    s_branch LadaLN_cond__grouped_kv_mqa__dense_activation_relu__prompt_kernel_fbk84
LadaLN_cond__grouped_kv_mqa__dense_activation_relu__prompt_kernel_ffb85:
    s_mov_b32 s67, 400000
LadaLN_cond__grouped_kv_mqa__dense_activation_relu__prompt_kernel_poll158:
    s_add_u32 s69, s68, 0xffffd000
    buffer_load_dwordx4 v[80:83], v8, s[16:19], s69 offen offset:0 sc1
    buffer_load_dwordx4 v[84:87], v8, s[16:19], s69 offen offset:256 sc1
    s_waitcnt vmcnt(0)
    v_max_u32 v200, v80, v84
    v_cmp_eq_u32 vcc, -1, v200
    s_nop 1
    s_cbranch_vccz LadaLN_cond__grouped_kv_mqa__dense_activation_relu__prompt_kernel_pok159
    s_sleep 1
    s_sub_u32 s67, s67, 1
    s_cbranch_scc0 LadaLN_cond__grouped_kv_mqa__dense_activation_relu__prompt_kernel_poll158
    s_branch LadaLN_cond__grouped_kv_mqa__dense_activation_relu__prompt_kernel_exit
LadaLN_cond__grouped_kv_mqa__dense_activation_relu__prompt_kernel_pok159:
    s_add_u32 s69, s68, 0xffffd000
    buffer_load_dwordx4 v[88:91], v8, s[16:19], s69 offen offset:2048 sc1
    buffer_load_dwordx4 v[92:95], v8, s[16:19], s69 offen offset:2304 sc1
    s_add_u32 s69, s68, 0xffffe000
    buffer_load_dwordx4 v[96:99], v8, s[16:19], s69 offen offset:0 sc1
    buffer_load_dwordx4 v[100:103], v8, s[16:19], s69 offen offset:256 sc1
    buffer_load_dwordx4 v[104:107], v8, s[16:19], s69 offen offset:2048 sc1
    buffer_load_dwordx4 v[108:111], v8, s[16:19], s69 offen offset:2304 sc1
    s_add_u32 s69, s68, 0xfffff000
    buffer_load_dwordx4 v[48:51], v8, s[16:19], s69 offen offset:0 sc1
    buffer_load_dwordx4 v[52:55], v8, s[16:19], s69 offen offset:256 sc1
    buffer_load_dwordx4 v[56:59], v8, s[16:19], s69 offen offset:2048 sc1
    buffer_load_dwordx4 v[60:63], v8, s[16:19], s69 offen offset:2304 sc1
    s_branch LadaLN_cond__grouped_kv_mqa__dense_activation_relu__prompt_kernel_fbk86
LadaLN_cond__grouped_kv_mqa__dense_activation_relu__prompt_kernel_ffb87:
    s_mov_b32 s67, 400000
LadaLN_cond__grouped_kv_mqa__dense_activation_relu__prompt_kernel_poll160:
    s_add_u32 s69, s68, 0xffffd000
    buffer_load_dwordx4 v[88:91], v8, s[16:19], s69 offen offset:2048 sc1
    buffer_load_dwordx4 v[92:95], v8, s[16:19], s69 offen offset:2304 sc1
    s_waitcnt vmcnt(0)
    v_max_u32 v200, v88, v92
    v_cmp_eq_u32 vcc, -1, v200
    s_nop 1
    s_cbranch_vccz LadaLN_cond__grouped_kv_mqa__dense_activation_relu__prompt_kernel_pok161
    s_sleep 1
    s_sub_u32 s67, s67, 1
    s_cbranch_scc0 LadaLN_cond__grouped_kv_mqa__dense_activation_relu__prompt_kernel_poll160
    s_branch LadaLN_cond__grouped_kv_mqa__dense_activation_relu__prompt_kernel_exit
LadaLN_cond__grouped_kv_mqa__dense_activation_relu__prompt_kernel_pok161:
    s_add_u32 s69, s68, 0xffffe000
    buffer_load_dwordx4 v[96:99], v8, s[16:19], s69 offen offset:0 sc1
    buffer_load_dwordx4 v[100:103], v8, s[16:19], s69 offen offset:256 sc1
    buffer_load_dwordx4 v[104:107], v8, s[16:19], s69 offen offset:2048 sc1
    buffer_load_dwordx4 v[108:111], v8, s[16:19], s69 offen offset:2304 sc1
    s_add_u32 s69, s68, 0xfffff000
    buffer_load_dwordx4 v[48:51], v8, s[16:19], s69 offen offset:0 sc1
    buffer_load_dwordx4 v[52:55], v8, s[16:19], s69 offen offset:256 sc1
    buffer_load_dwordx4 v[56:59], v8, s[16:19], s69 offen offset:2048 sc1
    buffer_load_dwordx4 v[60:63], v8, s[16:19], s69 offen offset:2304 sc1
    s_add_u32 s69, s68, 0x0
    buffer_load_dwordx4 v[64:67], v8, s[16:19], s69 offen offset:0 sc1
    buffer_load_dwordx4 v[68:71], v8, s[16:19], s69 offen offset:256 sc1
    s_branch LadaLN_cond__grouped_kv_mqa__dense_activation_relu__prompt_kernel_fbk88
LadaLN_cond__grouped_kv_mqa__dense_activation_relu__prompt_kernel_ffb89:
    s_mov_b32 s67, 400000
LadaLN_cond__grouped_kv_mqa__dense_activation_relu__prompt_kernel_poll162:
    s_add_u32 s69, s68, 0xffffd000
    buffer_load_dwordx4 v[96:99], v8, s[16:19], s69 offen offset:0 sc1
    buffer_load_dwordx4 v[100:103], v8, s[16:19], s69 offen offset:256 sc1
    s_waitcnt vmcnt(0)
    v_max_u32 v200, v96, v100
    v_cmp_eq_u32 vcc, -1, v200
    s_nop 1
    s_cbranch_vccz LadaLN_cond__grouped_kv_mqa__dense_activation_relu__prompt_kernel_pok163
    s_sleep 1
    s_sub_u32 s67, s67, 1
    s_cbranch_scc0 LadaLN_cond__grouped_kv_mqa__dense_activation_relu__prompt_kernel_poll162
    s_branch LadaLN_cond__grouped_kv_mqa__dense_activation_relu__prompt_kernel_exit
LadaLN_cond__grouped_kv_mqa__dense_activation_relu__prompt_kernel_pok163:
    s_add_u32 s69, s68, 0xffffd000
    buffer_load_dwordx4 v[104:107], v8, s[16:19], s69 offen offset:2048 sc1
    buffer_load_dwordx4 v[108:111], v8, s[16:19], s69 offen offset:2304 sc1
    s_add_u32 s69, s68, 0xffffe000
    buffer_load_dwordx4 v[48:51], v8, s[16:19], s69 offen offset:0 sc1
    buffer_load_dwordx4 v[52:55], v8, s[16:19], s69 offen offset:256 sc1
    buffer_load_dwordx4 v[56:59], v8, s[16:19], s69 offen offset:2048 sc1
    buffer_load_dwordx4 v[60:63], v8, s[16:19], s69 offen offset:2304 sc1
    s_add_u32 s69, s68, 0xfffff000
    buffer_load_dwordx4 v[64:67], v8, s[16:19], s69 offen offset:0 sc1
    buffer_load_dwordx4 v[68:71], v8, s[16:19], s69 offen offset:256 sc1
    buffer_load_dwordx4 v[72:75], v8, s[16:19], s69 offen offset:2048 sc1
    buffer_load_dwordx4 v[76:79], v8, s[16:19], s69 offen offset:2304 sc1
    s_branch LadaLN_cond__grouped_kv_mqa__dense_activation_relu__prompt_kernel_fbk90
LadaLN_cond__grouped_kv_mqa__dense_activation_relu__prompt_kernel_ffb91:
    s_mov_b32 s67, 400000
LadaLN_cond__grouped_kv_mqa__dense_activation_relu__prompt_kernel_poll164:
    s_add_u32 s69, s68, 0xffffd000
    buffer_load_dwordx4 v[104:107], v8, s[16:19], s69 offen offset:2048 sc1
    buffer_load_dwordx4 v[108:111], v8, s[16:19], s69 offen offset:2304 sc1
    s_waitcnt vmcnt(0)
    v_max_u32 v200, v104, v108
    v_cmp_eq_u32 vcc, -1, v200
    s_nop 1
    s_cbranch_vccz LadaLN_cond__grouped_kv_mqa__dense_activation_relu__prompt_kernel_pok165
    s_sleep 1
    s_sub_u32 s67, s67, 1
    s_cbranch_scc0 LadaLN_cond__grouped_kv_mqa__dense_activation_relu__prompt_kernel_poll164
    s_branch LadaLN_cond__grouped_kv_mqa__dense_activation_relu__prompt_kernel_exit
LadaLN_cond__grouped_kv_mqa__dense_activation_relu__prompt_kernel_pok165:
    s_add_u32 s69, s68, 0xffffe000
    buffer_load_dwordx4 v[48:51], v8, s[16:19], s69 offen offset:0 sc1
    buffer_load_dwordx4 v[52:55], v8, s[16:19], s69 offen offset:256 sc1
    buffer_load_dwordx4 v[56:59], v8, s[16:19], s69 offen offset:2048 sc1
    buffer_load_dwordx4 v[60:63], v8, s[16:19], s69 offen offset:2304 sc1
    s_add_u32 s69, s68, 0xfffff000
    buffer_load_dwordx4 v[64:67], v8, s[16:19], s69 offen offset:0 sc1
    buffer_load_dwordx4 v[68:71], v8, s[16:19], s69 offen offset:256 sc1
    buffer_load_dwordx4 v[72:75], v8, s[16:19], s69 offen offset:2048 sc1
    buffer_load_dwordx4 v[76:79], v8, s[16:19], s69 offen offset:2304 sc1
    s_add_u32 s69, s68, 0x0
    buffer_load_dwordx4 v[80:83], v8, s[16:19], s69 offen offset:0 sc1
    buffer_load_dwordx4 v[84:87], v8, s[16:19], s69 offen offset:256 sc1
    s_branch LadaLN_cond__grouped_kv_mqa__dense_activation_relu__prompt_kernel_fbk92
LadaLN_cond__grouped_kv_mqa__dense_activation_relu__prompt_kernel_ffb93:
    s_mov_b32 s67, 400000
LadaLN_cond__grouped_kv_mqa__dense_activation_relu__prompt_kernel_poll166:
    s_add_u32 s69, s68, 0xffffd000
    buffer_load_dwordx4 v[48:51], v8, s[16:19], s69 offen offset:0 sc1
    buffer_load_dwordx4 v[52:55], v8, s[16:19], s69 offen offset:256 sc1
    s_waitcnt vmcnt(0)
    v_max_u32 v200, v48, v52
    v_cmp_eq_u32 vcc, -1, v200
    s_nop 1
    s_cbranch_vccz LadaLN_cond__grouped_kv_mqa__dense_activation_relu__prompt_kernel_pok167
    s_sleep 1
    s_sub_u32 s67, s67, 1
    s_cbranch_scc0 LadaLN_cond__grouped_kv_mqa__dense_activation_relu__prompt_kernel_poll166
    s_branch LadaLN_cond__grouped_kv_mqa__dense_activation_relu__prompt_kernel_exit
LadaLN_cond__grouped_kv_mqa__dense_activation_relu__prompt_kernel_pok167:
    s_add_u32 s69, s68, 0xffffd000
    buffer_load_dwordx4 v[56:59], v8, s[16:19], s69 offen offset:2048 sc1
    buffer_load_dwordx4 v[60:63], v8, s[16:19], s69 offen offset:2304 sc1
    s_add_u32 s69, s68, 0xffffe000
    buffer_load_dwordx4 v[64:67], v8, s[16:19], s69 offen offset:0 sc1
    buffer_load_dwordx4 v[68:71], v8, s[16:19], s69 offen offset:256 sc1
    buffer_load_dwordx4 v[72:75], v8, s[16:19], s69 offen offset:2048 sc1
    buffer_load_dwordx4 v[76:79], v8, s[16:19], s69 offen offset:2304 sc1
    s_add_u32 s69, s68, 0xfffff000
    buffer_load_dwordx4 v[80:83], v8, s[16:19], s69 offen offset:0 sc1
    buffer_load_dwordx4 v[84:87], v8, s[16:19], s69 offen offset:256 sc1
    buffer_load_dwordx4 v[88:91], v8, s[16:19], s69 offen offset:2048 sc1
    buffer_load_dwordx4 v[92:95], v8, s[16:19], s69 offen offset:2304 sc1
    s_branch LadaLN_cond__grouped_kv_mqa__dense_activation_relu__prompt_kernel_fbk94
LadaLN_cond__grouped_kv_mqa__dense_activation_relu__prompt_kernel_ffb95:
    s_mov_b32 s67, 400000
LadaLN_cond__grouped_kv_mqa__dense_activation_relu__prompt_kernel_poll168:
    s_add_u32 s69, s68, 0xffffd000
    buffer_load_dwordx4 v[56:59], v8, s[16:19], s69 offen offset:2048 sc1
    buffer_load_dwordx4 v[60:63], v8, s[16:19], s69 offen offset:2304 sc1
    s_waitcnt vmcnt(0)
    v_max_u32 v200, v56, v60
    v_cmp_eq_u32 vcc, -1, v200
    s_nop 1
    s_cbranch_vccz LadaLN_cond__grouped_kv_mqa__dense_activation_relu__prompt_kernel_pok169
    s_sleep 1
    s_sub_u32 s67, s67, 1
    s_cbranch_scc0 LadaLN_cond__grouped_kv_mqa__dense_activation_relu__prompt_kernel_poll168
    s_branch LadaLN_cond__grouped_kv_mqa__dense_activation_relu__prompt_kernel_exit
LadaLN_cond__grouped_kv_mqa__dense_activation_relu__prompt_kernel_pok169:
    s_add_u32 s69, s68, 0xffffe000
    buffer_load_dwordx4 v[64:67], v8, s[16:19], s69 offen offset:0 sc1
    buffer_load_dwordx4 v[68:71], v8, s[16:19], s69 offen offset:256 sc1
    buffer_load_dwordx4 v[72:75], v8, s[16:19], s69 offen offset:2048 sc1
    buffer_load_dwordx4 v[76:79], v8, s[16:19], s69 offen offset:2304 sc1
    s_add_u32 s69, s68, 0xfffff000
    buffer_load_dwordx4 v[80:83], v8, s[16:19], s69 offen offset:0 sc1
    buffer_load_dwordx4 v[84:87], v8, s[16:19], s69 offen offset:256 sc1
    buffer_load_dwordx4 v[88:91], v8, s[16:19], s69 offen offset:2048 sc1
    buffer_load_dwordx4 v[92:95], v8, s[16:19], s69 offen offset:2304 sc1
    s_add_u32 s69, s68, 0x0
    buffer_load_dwordx4 v[96:99], v8, s[16:19], s69 offen offset:0 sc1
    buffer_load_dwordx4 v[100:103], v8, s[16:19], s69 offen offset:256 sc1
    s_branch LadaLN_cond__grouped_kv_mqa__dense_activation_relu__prompt_kernel_fbk96
LadaLN_cond__grouped_kv_mqa__dense_activation_relu__prompt_kernel_ffb97:
    s_mov_b32 s67, 400000
LadaLN_cond__grouped_kv_mqa__dense_activation_relu__prompt_kernel_poll170:
    s_add_u32 s69, s68, 0xffffd000
    buffer_load_dwordx4 v[64:67], v8, s[16:19], s69 offen offset:0 sc1
    buffer_load_dwordx4 v[68:71], v8, s[16:19], s69 offen offset:256 sc1
    s_waitcnt vmcnt(0)
    v_max_u32 v200, v64, v68
    v_cmp_eq_u32 vcc, -1, v200
    s_nop 1
    s_cbranch_vccz LadaLN_cond__grouped_kv_mqa__dense_activation_relu__prompt_kernel_pok171
    s_sleep 1
    s_sub_u32 s67, s67, 1
    s_cbranch_scc0 LadaLN_cond__grouped_kv_mqa__dense_activation_relu__prompt_kernel_poll170
    s_branch LadaLN_cond__grouped_kv_mqa__dense_activation_relu__prompt_kernel_exit
LadaLN_cond__grouped_kv_mqa__dense_activation_relu__prompt_kernel_pok171:
    s_add_u32 s69, s68, 0xffffd000
    buffer_load_dwordx4 v[72:75], v8, s[16:19], s69 offen offset:2048 sc1
    buffer_load_dwordx4 v[76:79], v8, s[16:19], s69 offen offset:2304 sc1
    s_add_u32 s69, s68, 0xffffe000
    buffer_load_dwordx4 v[80:83], v8, s[16:19], s69 offen offset:0 sc1
    buffer_load_dwordx4 v[84:87], v8, s[16:19], s69 offen offset:256 sc1
    buffer_load_dwordx4 v[88:91], v8, s[16:19], s69 offen offset:2048 sc1
    buffer_load_dwordx4 v[92:95], v8, s[16:19], s69 offen offset:2304 sc1
    s_add_u32 s69, s68, 0xfffff000
    buffer_load_dwordx4 v[96:99], v8, s[16:19], s69 offen offset:0 sc1
    buffer_load_dwordx4 v[100:103], v8, s[16:19], s69 offen offset:256 sc1
    buffer_load_dwordx4 v[104:107], v8, s[16:19], s69 offen offset:2048 sc1
    buffer_load_dwordx4 v[108:111], v8, s[16:19], s69 offen offset:2304 sc1
    s_branch LadaLN_cond__grouped_kv_mqa__dense_activation_relu__prompt_kernel_fbk98
LadaLN_cond__grouped_kv_mqa__dense_activation_relu__prompt_kernel_ffb99:
    s_mov_b32 s67, 400000
LadaLN_cond__grouped_kv_mqa__dense_activation_relu__prompt_kernel_poll172:
    s_add_u32 s69, s68, 0xffffd000
    buffer_load_dwordx4 v[72:75], v8, s[16:19], s69 offen offset:2048 sc1
    buffer_load_dwordx4 v[76:79], v8, s[16:19], s69 offen offset:2304 sc1
    s_waitcnt vmcnt(0)
    v_max_u32 v200, v72, v76
    v_cmp_eq_u32 vcc, -1, v200
    s_nop 1
    s_cbranch_vccz LadaLN_cond__grouped_kv_mqa__dense_activation_relu__prompt_kernel_pok173
    s_sleep 1
    s_sub_u32 s67, s67, 1
    s_cbranch_scc0 LadaLN_cond__grouped_kv_mqa__dense_activation_relu__prompt_kernel_poll172
    s_branch LadaLN_cond__grouped_kv_mqa__dense_activation_relu__prompt_kernel_exit
LadaLN_cond__grouped_kv_mqa__dense_activation_relu__prompt_kernel_pok173:
    s_add_u32 s69, s68, 0xffffe000
    buffer_load_dwordx4 v[80:83], v8, s[16:19], s69 offen offset:0 sc1
    buffer_load_dwordx4 v[84:87], v8, s[16:19], s69 offen offset:256 sc1
    buffer_load_dwordx4 v[88:91], v8, s[16:19], s69 offen offset:2048 sc1
    buffer_load_dwordx4 v[92:95], v8, s[16:19], s69 offen offset:2304 sc1
    s_add_u32 s69, s68, 0xfffff000
    buffer_load_dwordx4 v[96:99], v8, s[16:19], s69 offen offset:0 sc1
    buffer_load_dwordx4 v[100:103], v8, s[16:19], s69 offen offset:256 sc1
    buffer_load_dwordx4 v[104:107], v8, s[16:19], s69 offen offset:2048 sc1
    buffer_load_dwordx4 v[108:111], v8, s[16:19], s69 offen offset:2304 sc1
    s_add_u32 s69, s68, 0x0
    buffer_load_dwordx4 v[48:51], v8, s[16:19], s69 offen offset:0 sc1
    buffer_load_dwordx4 v[52:55], v8, s[16:19], s69 offen offset:256 sc1
    s_branch LadaLN_cond__grouped_kv_mqa__dense_activation_relu__prompt_kernel_fbk100
LadaLN_cond__grouped_kv_mqa__dense_activation_relu__prompt_kernel_ffb101:
    s_mov_b32 s67, 400000
LadaLN_cond__grouped_kv_mqa__dense_activation_relu__prompt_kernel_poll174:
    s_add_u32 s69, s68, 0xffffd000
    buffer_load_dwordx4 v[80:83], v8, s[16:19], s69 offen offset:0 sc1
    buffer_load_dwordx4 v[84:87], v8, s[16:19], s69 offen offset:256 sc1
    s_waitcnt vmcnt(0)
    v_max_u32 v200, v80, v84
    v_cmp_eq_u32 vcc, -1, v200
    s_nop 1
    s_cbranch_vccz LadaLN_cond__grouped_kv_mqa__dense_activation_relu__prompt_kernel_pok175
    s_sleep 1
    s_sub_u32 s67, s67, 1
    s_cbranch_scc0 LadaLN_cond__grouped_kv_mqa__dense_activation_relu__prompt_kernel_poll174
    s_branch LadaLN_cond__grouped_kv_mqa__dense_activation_relu__prompt_kernel_exit
LadaLN_cond__grouped_kv_mqa__dense_activation_relu__prompt_kernel_pok175:
    s_add_u32 s69, s68, 0xffffd000
    buffer_load_dwordx4 v[88:91], v8, s[16:19], s69 offen offset:2048 sc1
    buffer_load_dwordx4 v[92:95], v8, s[16:19], s69 offen offset:2304 sc1
    s_add_u32 s69, s68, 0xffffe000
    buffer_load_dwordx4 v[96:99], v8, s[16:19], s69 offen offset:0 sc1
    buffer_load_dwordx4 v[100:103], v8, s[16:19], s69 offen offset:256 sc1
    buffer_load_dwordx4 v[104:107], v8, s[16:19], s69 offen offset:2048 sc1
    buffer_load_dwordx4 v[108:111], v8, s[16:19], s69 offen offset:2304 sc1
    s_add_u32 s69, s68, 0xfffff000
    buffer_load_dwordx4 v[48:51], v8, s[16:19], s69 offen offset:0 sc1
    buffer_load_dwordx4 v[52:55], v8, s[16:19], s69 offen offset:256 sc1
    buffer_load_dwordx4 v[56:59], v8, s[16:19], s69 offen offset:2048 sc1
    buffer_load_dwordx4 v[60:63], v8, s[16:19], s69 offen offset:2304 sc1
    s_branch LadaLN_cond__grouped_kv_mqa__dense_activation_relu__prompt_kernel_fbk102
LadaLN_cond__grouped_kv_mqa__dense_activation_relu__prompt_kernel_ffb103:
    s_mov_b32 s67, 400000
LadaLN_cond__grouped_kv_mqa__dense_activation_relu__prompt_kernel_poll176:
    s_add_u32 s69, s68, 0xffffd000
    buffer_load_dwordx4 v[88:91], v8, s[16:19], s69 offen offset:2048 sc1
    buffer_load_dwordx4 v[92:95], v8, s[16:19], s69 offen offset:2304 sc1
    s_waitcnt vmcnt(0)
    v_max_u32 v200, v88, v92
    v_cmp_eq_u32 vcc, -1, v200
    s_nop 1
    s_cbranch_vccz LadaLN_cond__grouped_kv_mqa__dense_activation_relu__prompt_kernel_pok177
    s_sleep 1
    s_sub_u32 s67, s67, 1
    s_cbranch_scc0 LadaLN_cond__grouped_kv_mqa__dense_activation_relu__prompt_kernel_poll176
    s_branch LadaLN_cond__grouped_kv_mqa__dense_activation_relu__prompt_kernel_exit
LadaLN_cond__grouped_kv_mqa__dense_activation_relu__prompt_kernel_pok177:
    s_add_u32 s69, s68, 0xffffe000
    buffer_load_dwordx4 v[96:99], v8, s[16:19], s69 offen offset:0 sc1
    buffer_load_dwordx4 v[100:103], v8, s[16:19], s69 offen offset:256 sc1
    buffer_load_dwordx4 v[104:107], v8, s[16:19], s69 offen offset:2048 sc1
    buffer_load_dwordx4 v[108:111], v8, s[16:19], s69 offen offset:2304 sc1
    s_add_u32 s69, s68, 0xfffff000
    buffer_load_dwordx4 v[48:51], v8, s[16:19], s69 offen offset:0 sc1
    buffer_load_dwordx4 v[52:55], v8, s[16:19], s69 offen offset:256 sc1
    buffer_load_dwordx4 v[56:59], v8, s[16:19], s69 offen offset:2048 sc1
    buffer_load_dwordx4 v[60:63], v8, s[16:19], s69 offen offset:2304 sc1
    s_add_u32 s69, s68, 0x0
    buffer_load_dwordx4 v[64:67], v8, s[16:19], s69 offen offset:0 sc1
    buffer_load_dwordx4 v[68:71], v8, s[16:19], s69 offen offset:256 sc1
    s_branch LadaLN_cond__grouped_kv_mqa__dense_activation_relu__prompt_kernel_fbk104
LadaLN_cond__grouped_kv_mqa__dense_activation_relu__prompt_kernel_codeend:
    s_endpgm
.section .rodata,"a"
.p2align 6
.amdhsa_kernel adaLN_cond__grouped_kv_mqa__dense_activation_relu__prompt_kernel
  .amdhsa_next_free_vgpr 256
  .amdhsa_next_free_sgpr 98
  .amdhsa_accum_offset 256
  .amdhsa_group_segment_fixed_size 0
  .amdhsa_kernarg_size 104
  .amdhsa_user_sgpr_count 2
  .amdhsa_user_sgpr_kernarg_segment_ptr 1
  .amdhsa_system_sgpr_workgroup_id_x 1
.end_amdhsa_kernel
```
